```python
import torch

def _softmax(x, axis=-1):
    return torch.softmax(x, dim=axis)

def _gelu(x):
    return torch.nn.functional.gelu(x, approximate='tanh')

def _silu(x):
    return torch.nn.functional.silu(x)

def _sigmoid(x):
    return torch.sigmoid(x)

def _layernorm(x, axis=-1, eps=1e-05):
    m = x.mean(dim=axis, keepdim=True)
    v = x.var(dim=axis, keepdim=True, unbiased=False)
    return (x - m) / torch.sqrt(v + eps)

def _scatter_add(tgt, idx, src, axis=0):
    return tgt.clone().index_add_(axis, idx, src)

def _segment_sum(src, seg, n):
    out = torch.zeros((n,) + src.shape[1:], dtype=src.dtype)
    return out.index_add_(0, seg, src)

def _pad(x, pw):
    flat = tuple((v for pair in reversed(pw) for v in pair))
    return torch.nn.functional.pad(x, flat)
kernel_name = 'adaLN_cond__sliding_block_cached__dense_activation_relu__prompt'

def setup_inputs():

    _w = lambda a: (lambda t: t.to(torch.bfloat16) if t.is_floating_point() else t)(torch.as_tensor(a))

    def _A_setup():
        B, Sq, D = (1, 2048, 1024)
        Hq, Hkv, Sk, Dh = (32, 4, 2048, 128)
        assert Hq % Hkv == 0, (Hq, Hkv)
        return {'x': _w((lambda *s: torch.randn(*s, dtype=torch.bfloat16) * 0.05)(B, Sq, D)), 'k_cache': _w((lambda *s: torch.randn(*s, dtype=torch.bfloat16) * 3.2)(B, Hkv, Sk, Dh)), 'v_cache': _w((lambda *s: torch.randn(*s, dtype=torch.bfloat16) * 0.4)(B, Hkv, Sk, Dh)), 'wq': _w((lambda *s: torch.randn(*s, dtype=torch.bfloat16) * 3.2)(D, Hq * Dh) * D ** (-0.5)), 'wo': _w((lambda *s: torch.randn(*s, dtype=torch.bfloat16) * 0.4)(Hq * Dh, D) * (Hq * Dh) ** (-0.5))}
    _A_in = _A_setup()

    def _B_setup():
        B, S, D, Dff = (1, 2048, 1024, 3584)
        return {'x': _w((lambda *s: torch.randn(*s, dtype=torch.bfloat16) * 0.05)(B, S, D)), 'w1': _w((lambda *s: torch.randn(*s, dtype=torch.bfloat16) * 0.05)(D, Dff)), 'w2': _w((lambda *s: torch.randn(*s, dtype=torch.bfloat16) * 0.05)(Dff, D))}
    _B_in = _B_setup()
    return {'A_x': _A_in['x'], 'A_k_cache': _A_in['k_cache'], 'A_v_cache': _A_in['v_cache'], 'A_wq': _A_in['wq'], 'A_wo': _A_in['wo'], 'B_x': _B_in['x'], 'B_w1': _B_in['w1'], 'B_w2': _B_in['w2'], 'c': _w((lambda *s: torch.randn(*s, dtype=torch.bfloat16) * 0.1)(1, 1024) * 8.0), 'w_mod': _w((lambda *s: torch.randn(*s, dtype=torch.bfloat16) * 0.1)(1024, 6 * 1024) * 1024 ** (-0.5) * 8.0)}

def reference(A_x, A_k_cache, A_v_cache, A_wq, A_wo, B_x, B_w1, B_w2, c, w_mod):

    def _A_ref(x, k_cache, v_cache, wq, wo):
        B, Sq, D = x.shape
        Hq, Dh = (32, 128)
        Hkv, Sk = (k_cache.shape[1], k_cache.shape[2])
        W = min(4096, max(256, Sk // 4))
        rep = Hq // Hkv
        q = (lambda x, *d: x.permute(*d))((x @ wq).reshape(B, Sq, Hq, Dh), 0, 2, 1, 3)
        k = (lambda x, n, axis: torch.repeat_interleave(x, n, dim=axis))(k_cache[:, :, Sk - W:, :], rep, axis=1)
        v = (lambda x, n, axis: torch.repeat_interleave(x, n, dim=axis))(v_cache[:, :, Sk - W:, :], rep, axis=1)
        scores = torch.einsum('bhqd,bhkd->bhqk', q, k) * Dh ** (-0.5)
        p = _softmax(scores, axis=-1)
        o = torch.einsum('bhqk,bhkd->bhqd', p, v)
        return (lambda x, *d: x.permute(*d))(o, 0, 2, 1, 3).reshape(B, Sq, Hq * Dh) @ wo

    def _B_ref(x, w1, w2):
        h = torch.einsum('bsd,df->bsf', x, w1)
        zero = torch.zeros_like(h)
        h = torch.maximum(h, zero)
        return torch.einsum('bsf,fd->bsd', h, w2)
    x = A_x
    mod = (_silu(c) @ w_mod).reshape(c.shape[0], 6, 1, -1)
    sa, ca, ga, sb, cb, gb = (mod[:, 0].clone(), mod[:, 1].clone(), mod[:, 2].clone(), mod[:, 3].clone(), mod[:, 4].clone(), mod[:, 5].clone())
    h = _layernorm(x, axis=-1) * (1 + ca) + sa
    x = x + ga * _A_ref(h, A_k_cache, A_v_cache, A_wq, A_wo)
    h = _layernorm(x, axis=-1) * (1 + cb) + sb
    x = x + gb * _B_ref(h, B_w1, B_w2)
    return x
```

```asm
; @launch kernel=k0_kernel grid=(256,1,1) block=(512,1,1) lds=2048
; @launch kernel=ln1_kernel grid=(256,1,1) block=(512,1,1) lds=9216
; @launch kernel=attn_kernel grid=(256,1,1) block=(256,1,1) lds=163840
; @launch kernel=oproj_kernel grid=(256,1,1) block=(256,1,1) lds=98304
; @launch kernel=ln2_kernel grid=(256,1,1) block=(512,1,1) lds=17408
; @launch kernel=ffn1_kernel grid=(224,1,1) block=(256,1,1) lds=98304
; @launch kernel=ffn2_kernel grid=(256,1,1) block=(256,1,1) lds=114688
.amdgcn_target "amdgcn-amd-amdhsa--gfx950"
.text
.globl k0_kernel
.p2align 8
.type k0_kernel,@function
k0_kernel:
    s_cmp_ge_u32 s2, 128
    s_cbranch_scc1 L_k0_kernel_pf
    s_load_dwordx4 s[4:7], s[0:1], 64
    s_load_dwordx2 s[8:9], s[0:1], 96
    v_lshrrev_b32 v1, 3, v0
    v_and_b32 v2, 7, v0
    s_and_b32 s20, s2, 3
    s_lshr_b32 s21, s2, 2
    v_lshlrev_b32 v3, 2, v1
    s_lshl_b32 s22, s20, 8
    v_add_u32 v3, s22, v3
    s_mov_b32 s24, 12288
    v_mul_lo_u32 v4, v3, s24
    v_lshlrev_b32 v2, 4, v2
    s_lshl_b32 s25, s21, 7
    v_add3_u32 v4, v4, v2, s25
    v_lshlrev_b32 v3, 1, v3
    s_waitcnt lgkmcnt(0)
    s_mov_b32 s12, s4
    s_mov_b32 s13, s5
    s_mov_b32 s14, 2048
    s_mov_b32 s15, 0x20000
    s_mov_b32 s16, s6
    s_mov_b32 s17, s7
    s_mov_b32 s18, 12582912
    s_mov_b32 s19, 0x20000
    s_add_u32 s36, s8, 65536
    s_addc_u32 s37, s9, 0
    s_mov_b32 s38, 32768
    s_mov_b32 s39, 0x20000
    buffer_load_dwordx2 v[8:9], v3, s[12:15], 0 offen
    s_mov_b32 s26, 0
    buffer_load_dwordx4 v[64:67], v4, s[16:19], s26 offen
    s_add_u32 s26, s26, 12288
    buffer_load_dwordx4 v[68:71], v4, s[16:19], s26 offen
    s_add_u32 s26, s26, 12288
    buffer_load_dwordx4 v[72:75], v4, s[16:19], s26 offen
    s_add_u32 s26, s26, 12288
    buffer_load_dwordx4 v[76:79], v4, s[16:19], s26 offen
    s_mov_b32 s27, 0xffff0000
    s_mov_b32 s33, 0xbfb8aa3b
    s_waitcnt vmcnt(4)
    v_lshlrev_b32 v16, 16, v8
    v_and_b32 v17, s27, v8
    v_lshlrev_b32 v18, 16, v9
    v_and_b32 v19, s27, v9
    v_mul_f32 v20, s33, v16
    v_mul_f32 v21, s33, v17
    v_mul_f32 v22, s33, v18
    v_mul_f32 v23, s33, v19
    v_exp_f32 v20, v20
    v_exp_f32 v21, v21
    v_exp_f32 v22, v22
    v_exp_f32 v23, v23
    v_add_f32 v20, 1.0, v20
    v_add_f32 v21, 1.0, v21
    v_add_f32 v22, 1.0, v22
    v_add_f32 v23, 1.0, v23
    v_rcp_f32 v20, v20
    v_rcp_f32 v21, v21
    v_rcp_f32 v22, v22
    v_rcp_f32 v23, v23
    v_mul_f32 v16, v16, v20
    v_mul_f32 v17, v17, v21
    v_mul_f32 v18, v18, v22
    v_mul_f32 v19, v19, v23
    v_cvt_pk_bf16_f32 v8, v16, v17
    v_cvt_pk_bf16_f32 v9, v18, v19
    v_lshlrev_b32 v16, 16, v8
    v_and_b32 v17, s27, v8
    v_lshlrev_b32 v18, 16, v9
    v_and_b32 v19, s27, v9
    v_mov_b32 v32, 0
    v_mov_b32 v33, 0
    v_mov_b32 v34, 0
    v_mov_b32 v35, 0
    v_mov_b32 v36, 0
    v_mov_b32 v37, 0
    v_mov_b32 v38, 0
    v_mov_b32 v39, 0
    s_waitcnt vmcnt(3)
    v_lshlrev_b32 v40, 16, v64
    v_and_b32 v41, s27, v64
    v_fmac_f32 v32, v16, v40
    v_fmac_f32 v33, v16, v41
    v_lshlrev_b32 v40, 16, v65
    v_and_b32 v41, s27, v65
    v_fmac_f32 v34, v16, v40
    v_fmac_f32 v35, v16, v41
    v_lshlrev_b32 v40, 16, v66
    v_and_b32 v41, s27, v66
    v_fmac_f32 v36, v16, v40
    v_fmac_f32 v37, v16, v41
    v_lshlrev_b32 v40, 16, v67
    v_and_b32 v41, s27, v67
    v_fmac_f32 v38, v16, v40
    v_fmac_f32 v39, v16, v41
    s_waitcnt vmcnt(2)
    v_lshlrev_b32 v40, 16, v68
    v_and_b32 v41, s27, v68
    v_fmac_f32 v32, v17, v40
    v_fmac_f32 v33, v17, v41
    v_lshlrev_b32 v40, 16, v69
    v_and_b32 v41, s27, v69
    v_fmac_f32 v34, v17, v40
    v_fmac_f32 v35, v17, v41
    v_lshlrev_b32 v40, 16, v70
    v_and_b32 v41, s27, v70
    v_fmac_f32 v36, v17, v40
    v_fmac_f32 v37, v17, v41
    v_lshlrev_b32 v40, 16, v71
    v_and_b32 v41, s27, v71
    v_fmac_f32 v38, v17, v40
    v_fmac_f32 v39, v17, v41
    s_waitcnt vmcnt(1)
    v_lshlrev_b32 v40, 16, v72
    v_and_b32 v41, s27, v72
    v_fmac_f32 v32, v18, v40
    v_fmac_f32 v33, v18, v41
    v_lshlrev_b32 v40, 16, v73
    v_and_b32 v41, s27, v73
    v_fmac_f32 v34, v18, v40
    v_fmac_f32 v35, v18, v41
    v_lshlrev_b32 v40, 16, v74
    v_and_b32 v41, s27, v74
    v_fmac_f32 v36, v18, v40
    v_fmac_f32 v37, v18, v41
    v_lshlrev_b32 v40, 16, v75
    v_and_b32 v41, s27, v75
    v_fmac_f32 v38, v18, v40
    v_fmac_f32 v39, v18, v41
    s_waitcnt vmcnt(0)
    v_lshlrev_b32 v40, 16, v76
    v_and_b32 v41, s27, v76
    v_fmac_f32 v32, v19, v40
    v_fmac_f32 v33, v19, v41
    v_lshlrev_b32 v40, 16, v77
    v_and_b32 v41, s27, v77
    v_fmac_f32 v34, v19, v40
    v_fmac_f32 v35, v19, v41
    v_lshlrev_b32 v40, 16, v78
    v_and_b32 v41, s27, v78
    v_fmac_f32 v36, v19, v40
    v_fmac_f32 v37, v19, v41
    v_lshlrev_b32 v40, 16, v79
    v_and_b32 v41, s27, v79
    v_fmac_f32 v38, v19, v40
    v_fmac_f32 v39, v19, v41
    s_nop 1
    v_add_f32_dpp v32, v32, v32 row_ror:8 row_mask:0xf bank_mask:0xf
    v_add_f32_dpp v33, v33, v33 row_ror:8 row_mask:0xf bank_mask:0xf
    v_add_f32_dpp v34, v34, v34 row_ror:8 row_mask:0xf bank_mask:0xf
    v_add_f32_dpp v35, v35, v35 row_ror:8 row_mask:0xf bank_mask:0xf
    v_add_f32_dpp v36, v36, v36 row_ror:8 row_mask:0xf bank_mask:0xf
    v_add_f32_dpp v37, v37, v37 row_ror:8 row_mask:0xf bank_mask:0xf
    v_add_f32_dpp v38, v38, v38 row_ror:8 row_mask:0xf bank_mask:0xf
    v_add_f32_dpp v39, v39, v39 row_ror:8 row_mask:0xf bank_mask:0xf
    v_mov_b32 v40, v32
    v_mov_b32 v41, v33
    v_mov_b32 v42, v34
    v_mov_b32 v43, v35
    v_mov_b32 v44, v36
    v_mov_b32 v45, v37
    v_mov_b32 v46, v38
    v_mov_b32 v47, v39
    s_nop 1
    v_permlane16_swap_b32 v32, v40
    v_permlane16_swap_b32 v33, v41
    v_permlane16_swap_b32 v34, v42
    v_permlane16_swap_b32 v35, v43
    v_permlane16_swap_b32 v36, v44
    v_permlane16_swap_b32 v37, v45
    v_permlane16_swap_b32 v38, v46
    v_permlane16_swap_b32 v39, v47
    s_nop 1
    v_add_f32 v32, v32, v40
    v_add_f32 v33, v33, v41
    v_add_f32 v34, v34, v42
    v_add_f32 v35, v35, v43
    v_add_f32 v36, v36, v44
    v_add_f32 v37, v37, v45
    v_add_f32 v38, v38, v46
    v_add_f32 v39, v39, v47
    v_mov_b32 v40, v32
    v_mov_b32 v41, v33
    v_mov_b32 v42, v34
    v_mov_b32 v43, v35
    v_mov_b32 v44, v36
    v_mov_b32 v45, v37
    v_mov_b32 v46, v38
    v_mov_b32 v47, v39
    s_nop 1
    v_permlane32_swap_b32 v32, v40
    v_permlane32_swap_b32 v33, v41
    v_permlane32_swap_b32 v34, v42
    v_permlane32_swap_b32 v35, v43
    v_permlane32_swap_b32 v36, v44
    v_permlane32_swap_b32 v37, v45
    v_permlane32_swap_b32 v38, v46
    v_permlane32_swap_b32 v39, v47
    s_nop 1
    v_add_f32 v32, v32, v40
    v_add_f32 v33, v33, v41
    v_add_f32 v34, v34, v42
    v_add_f32 v35, v35, v43
    v_add_f32 v36, v36, v44
    v_add_f32 v37, v37, v45
    v_add_f32 v38, v38, v46
    v_add_f32 v39, v39, v47
    v_and_b32 v5, 63, v0
    v_lshrrev_b32 v6, 6, v0
    v_lshlrev_b32 v7, 8, v6
    v_lshl_add_u32 v7, v5, 5, v7
    v_cmp_gt_u32 vcc, 8, v5
    s_and_saveexec_b64 s[30:31], vcc
    ds_write_b128 v7, v[32:35]
    ds_write_b128 v7, v[36:39] offset:16
    s_mov_b64 exec, s[30:31]
    s_waitcnt lgkmcnt(0)
    s_barrier
    v_cmp_gt_u32 vcc, 64, v0
    s_and_saveexec_b64 s[30:31], vcc
    s_cbranch_execz L_k0_kernel_end
    v_lshlrev_b32 v7, 2, v0
    ds_read_b32 v16, v7 offset:0
    ds_read_b32 v17, v7 offset:256
    ds_read_b32 v18, v7 offset:512
    ds_read_b32 v19, v7 offset:768
    ds_read_b32 v20, v7 offset:1024
    ds_read_b32 v21, v7 offset:1280
    ds_read_b32 v22, v7 offset:1536
    ds_read_b32 v23, v7 offset:1792
    s_lshl_b32 s25, s21, 8
    s_lshl_b32 s26, s20, 13
    s_add_u32 s25, s25, s26
    v_add_u32 v6, s25, v7
    s_waitcnt lgkmcnt(0)
    v_add_f32 v16, v16, v17
    v_add_f32 v18, v18, v19
    v_add_f32 v20, v20, v21
    v_add_f32 v22, v22, v23
    v_add_f32 v16, v16, v18
    v_add_f32 v20, v20, v22
    v_add_f32 v16, v16, v20
    buffer_store_dword v16, v6, s[36:39], 0 offen
L_k0_kernel_end:
    s_mov_b64 exec, s[30:31]
L_k0_kernel_done:
    s_endpgm
L_k0_kernel_pf:
    s_cmp_ge_u32 s2, 256
    s_cbranch_scc1 L_k0_kernel_done
    s_load_dwordx4 s[4:7], s[0:1], 0
    s_load_dwordx2 s[8:9], s[0:1], 16
    s_getpc_b64 s[28:29]
L_k0_kernel_pc:
    s_add_u32 s28, s28, L_code_begin-L_k0_kernel_pc
    s_addc_u32 s29, s29, 0
    v_lshrrev_b32 v2, 6, v0
    v_and_b32 v1, 63, v0
    v_readfirstlane_b32 s20, v2
    s_and_b32 s21, s2, 7
    s_sub_u32 s22, s2, 128
    s_lshr_b32 s22, s22, 3
    s_lshl_b32 s22, s22, 3
    s_add_u32 s22, s22, s20
    v_lshrrev_b32 v3, 4, v1
    v_and_b32 v4, 15, v1
    v_lshlrev_b32 v4, 7, v4
    v_lshlrev_b32 v5, 7, v1
    s_waitcnt lgkmcnt(0)
    s_mov_b32 s12, s4
    s_mov_b32 s13, s5
    s_mov_b32 s14, 4194304
    s_mov_b32 s15, 0x20000
    s_cmp_ge_u32 s22, 64
    s_cbranch_scc1 L_k0_kernel_pf_kv
    s_lshr_b32 s23, s22, 1
    s_lshl_b32 s23, s23, 3
    s_add_u32 s23, s23, s21
    s_lshl_b32 s23, s23, 3
    s_and_b32 s24, s22, 1
    s_lshl_b32 s24, s24, 2
    s_add_u32 s23, s23, s24
    s_lshl_b32 s23, s23, 11
    v_lshl_add_u32 v6, v3, 11, v4
    buffer_load_dword v8, v6, s[12:15], s23 offen
    s_endpgm
L_k0_kernel_pf_kv:
    s_cmp_ge_u32 s22, 96
    s_cbranch_scc1 L_k0_kernel_pf_code
    s_sub_u32 s23, s22, 64
    s_cmp_ge_u32 s23, 16
    s_cselect_b32 s12, s8, s6
    s_cselect_b32 s13, s9, s7
    s_mov_b32 s14, 2097152
    s_and_b32 s23, s23, 15
    s_lshl_b32 s23, s23, 13
    s_and_b32 s24, s21, 3
    s_lshl_b32 s24, s24, 19
    s_add_u32 s23, s23, s24
    s_add_u32 s23, s23, 393216
    buffer_load_dword v8, v5, s[12:15], s23 offen
    s_endpgm
L_k0_kernel_pf_code:
    s_cmp_ge_u32 s22, 112
    s_cbranch_scc1 L_k0_kernel_done
    s_sub_u32 s23, s22, 96
    s_lshl_b32 s23, s23, 13
    v_add_u32 v6, s23, v5
    v_min_u32 v6, L_code_end-L_code_begin, v6
    global_load_dword v8, v6, s[28:29]
    s_endpgm
L_code_begin:
    s_endpgm
.globl ln1_kernel
.p2align 8
.type ln1_kernel,@function
ln1_kernel:
    s_cmp_ge_u32 s2, 256
    s_cbranch_scc1 L_ln1_kernel_done
    s_load_dwordx2 s[4:5], s[0:1], 0
    s_load_dwordx2 s[8:9], s[0:1], 96
    v_and_b32 v1, 7, v0
    v_lshrrev_b32 v2, 3, v0
    v_and_b32 v3, 7, v2
    v_lshrrev_b32 v4, 6, v0
    v_lshl_add_u32 v5, v4, 4, v3
    s_lshr_b32 s10, s2, 2
    s_and_b32 s11, s2, 3
    s_lshl_b32 s10, s10, 16
    s_lshl_b32 s11, s11, 7
    s_add_u32 s10, s10, s11
    v_lshlrev_b32 v6, 9, v5
    v_lshl_add_u32 v6, v1, 4, v6
    v_add_u32 v6, s10, v6
    v_lshlrev_b32 v9, 5, v5
    s_lshl_b32 s12, s2, 14
    v_lshlrev_b32 v7, 11, v1
    v_lshl_add_u32 v7, v5, 4, v7
    v_add_u32 v7, s12, v7
    s_waitcnt lgkmcnt(0)
    s_mov_b32 s12, s4
    s_mov_b32 s13, s5
    s_mov_b32 s14, 4194304
    s_mov_b32 s15, 0x20000
    buffer_load_dwordx4 v[12:15], v7, s[12:15], 0 offen
    buffer_load_dwordx4 v[16:19], v7, s[12:15], 0 offen offset:128
    s_load_dwordx2 s[34:35], s[0:1], 24
    v_and_b32 v44, 63, v0
    v_lshrrev_b32 v45, 4, v44
    v_and_b32 v44, 15, v44
    v_lshlrev_b32 v44, 7, v44
    v_lshl_add_u32 v44, v45, 13, v44
    v_readfirstlane_b32 s36, v4
    s_lshr_b32 s37, s2, 3
    s_lshl_b32 s37, s37, 3
    s_add_u32 s37, s37, s36
    s_lshl_b32 s37, s37, 15
    s_and_b32 s38, s2, 3
    s_lshl_b32 s38, s38, 11
    s_add_u32 s37, s37, s38
    s_waitcnt lgkmcnt(0)
    s_mov_b32 s40, s34
    s_mov_b32 s41, s35
    s_mov_b32 s42, 8388608
    s_mov_b32 s43, 0x20000
    s_add_u32 s16, s8, 65536
    s_addc_u32 s17, s9, 0
    s_mov_b32 s18, 32768
    s_mov_b32 s19, 0x20000
    s_add_u32 s20, s8, 1048576
    s_addc_u32 s21, s9, 0
    s_mov_b32 s22, 4194304
    s_mov_b32 s23, 0x20000
    v_and_b32 v116, 31, v0
    v_lshlrev_b32 v116, 4, v116
    v_lshl_add_u32 v116, v4, 9, v116
    v_bfe_u32 v117, v0, 5, 1
    v_mul_u32_u24 v117, 4096, v117
    v_add_u32 v116, v116, v117
    s_mov_b32 s60, 0
    s_mov_b32 s61, 8192
    s_mov_b32 s62, 16384
    s_mov_b32 s63, 24576
    buffer_load_dwordx4 v[100:103], v116, s[16:19], s60 offen
    buffer_load_dwordx4 v[104:107], v116, s[16:19], s61 offen
    buffer_load_dwordx4 v[108:111], v116, s[16:19], s62 offen
    buffer_load_dwordx4 v[112:115], v116, s[16:19], s63 offen
    buffer_load_dword v46, v44, s[40:43], s37 offen
    s_mov_b32 s27, 0xffff0000
    s_waitcnt vmcnt(5)
    v_lshlrev_b32 v20, 16, v12
    v_and_b32 v21, s27, v12
    v_lshlrev_b32 v22, 16, v13
    v_and_b32 v23, s27, v13
    v_lshlrev_b32 v24, 16, v14
    v_and_b32 v25, s27, v14
    v_lshlrev_b32 v26, 16, v15
    v_and_b32 v27, s27, v15
    v_lshlrev_b32 v28, 16, v16
    v_and_b32 v29, s27, v16
    v_lshlrev_b32 v30, 16, v17
    v_and_b32 v31, s27, v17
    v_lshlrev_b32 v32, 16, v18
    v_and_b32 v33, s27, v18
    v_lshlrev_b32 v34, 16, v19
    v_and_b32 v35, s27, v19
    v_add_f32 v36, v20, v21
    v_add_f32 v37, v22, v23
    v_add_f32 v36, v36, v24
    v_add_f32 v36, v36, v25
    v_add_f32 v37, v37, v26
    v_add_f32 v37, v37, v27
    v_add_f32 v36, v36, v28
    v_add_f32 v36, v36, v29
    v_add_f32 v37, v37, v30
    v_add_f32 v37, v37, v31
    v_add_f32 v36, v36, v32
    v_add_f32 v36, v36, v33
    v_add_f32 v37, v37, v34
    v_add_f32 v37, v37, v35
    v_add_f32 v36, v36, v37
    s_nop 1
    v_add_f32_dpp v36, v36, v36 row_ror:8 row_mask:0xf bank_mask:0xf
    v_mov_b32 v38, v36
    s_nop 1
    v_permlane16_swap_b32 v36, v38
    s_nop 1
    v_add_f32 v36, v36, v38
    v_mov_b32 v38, v36
    s_nop 1
    v_permlane32_swap_b32 v36, v38
    s_nop 1
    v_add_f32 v36, v36, v38
    v_mul_f32 v36, 0x3c000000, v36
    v_sub_f32 v84, v20, v36
    v_sub_f32 v85, v21, v36
    v_sub_f32 v86, v22, v36
    v_sub_f32 v87, v23, v36
    v_sub_f32 v88, v24, v36
    v_sub_f32 v89, v25, v36
    v_sub_f32 v90, v26, v36
    v_sub_f32 v91, v27, v36
    v_sub_f32 v92, v28, v36
    v_sub_f32 v93, v29, v36
    v_sub_f32 v94, v30, v36
    v_sub_f32 v95, v31, v36
    v_sub_f32 v96, v32, v36
    v_sub_f32 v97, v33, v36
    v_sub_f32 v98, v34, v36
    v_sub_f32 v99, v35, v36
    v_mul_f32 v37, v84, v84
    v_mul_f32 v39, v85, v85
    v_fmac_f32 v37, v86, v86
    v_fmac_f32 v39, v87, v87
    v_fmac_f32 v37, v88, v88
    v_fmac_f32 v39, v89, v89
    v_fmac_f32 v37, v90, v90
    v_fmac_f32 v39, v91, v91
    v_fmac_f32 v37, v92, v92
    v_fmac_f32 v39, v93, v93
    v_fmac_f32 v37, v94, v94
    v_fmac_f32 v39, v95, v95
    v_fmac_f32 v37, v96, v96
    v_fmac_f32 v39, v97, v97
    v_fmac_f32 v37, v98, v98
    v_fmac_f32 v39, v99, v99
    v_add_f32 v37, v37, v39
    s_nop 1
    v_add_f32_dpp v37, v37, v37 row_ror:8 row_mask:0xf bank_mask:0xf
    v_mov_b32 v38, v37
    s_nop 1
    v_permlane16_swap_b32 v37, v38
    s_nop 1
    v_add_f32 v37, v37, v38
    v_mov_b32 v38, v37
    s_nop 1
    v_permlane32_swap_b32 v37, v38
    s_nop 1
    v_add_f32 v37, v37, v38
    s_waitcnt vmcnt(1)
    v_add_f32 v100, v100, v104
    v_add_f32 v108, v108, v112
    v_add_f32 v101, v101, v105
    v_add_f32 v109, v109, v113
    v_add_f32 v102, v102, v106
    v_add_f32 v110, v110, v114
    v_add_f32 v103, v103, v107
    v_add_f32 v111, v111, v115
    v_add_f32 v100, v100, v108
    v_add_f32 v101, v101, v109
    v_add_f32 v102, v102, v110
    v_add_f32 v103, v103, v111
    v_and_b32 v104, 63, v0
    v_lshlrev_b32 v104, 4, v104
    v_lshl_add_u32 v104, v4, 10, v104
    ds_write_b128 v104, v[100:103] offset:1024
    v_lshlrev_b32 v40, 6, v1
    v_lshl_add_u32 v41, v4, 3, v40
    v_and_b32 v42, 63, v0
    v_cmp_gt_u32 vcc, 8, v42
    s_and_saveexec_b64 s[30:31], vcc
    ds_write_b64 v41, v[36:37]
    s_mov_b64 exec, s[30:31]
    s_waitcnt lgkmcnt(0)
    s_barrier
    ds_read_b128 v[84:87], v40
    ds_read_b128 v[88:91], v40 offset:16
    ds_read_b128 v[92:95], v40 offset:32
    ds_read_b128 v[96:99], v40 offset:48
    v_lshlrev_b32 v104, 5, v3
    v_lshl_add_u32 v104, v4, 10, v104
    ds_read_b128 v[68:71], v104 offset:1024
    ds_read_b128 v[72:75], v104 offset:1040
    ds_read_b128 v[76:79], v104 offset:1280
    ds_read_b128 v[80:83], v104 offset:1296
    v_lshlrev_b32 v105, 5, v3
    v_lshl_add_u32 v105, v4, 10, v105
    ds_read_b128 v[52:55], v105 offset:1536
    ds_read_b128 v[56:59], v105 offset:1552
    ds_read_b128 v[60:63], v105 offset:1792
    ds_read_b128 v[64:67], v105 offset:1808
    s_waitcnt lgkmcnt(8)
    v_add_f32 v36, v84, v86
    v_add_f32 v36, v36, v88
    v_add_f32 v36, v36, v90
    v_add_f32 v36, v36, v92
    v_add_f32 v36, v36, v94
    v_add_f32 v36, v36, v96
    v_add_f32 v36, v36, v98
    v_mul_f32 v36, 0x3e000000, v36
    v_add_f32 v37, v85, v87
    v_add_f32 v37, v37, v89
    v_add_f32 v37, v37, v91
    v_add_f32 v37, v37, v93
    v_add_f32 v37, v37, v95
    v_add_f32 v37, v37, v97
    v_add_f32 v37, v37, v99
    v_sub_f32 v84, v84, v36
    v_sub_f32 v86, v86, v36
    v_sub_f32 v88, v88, v36
    v_sub_f32 v90, v90, v36
    v_sub_f32 v92, v92, v36
    v_sub_f32 v94, v94, v36
    v_sub_f32 v96, v96, v36
    v_sub_f32 v98, v98, v36
    v_mul_f32 v38, v84, v84
    v_fmac_f32 v38, v86, v86
    v_fmac_f32 v38, v88, v88
    v_fmac_f32 v38, v90, v90
    v_fmac_f32 v38, v92, v92
    v_fmac_f32 v38, v94, v94
    v_fmac_f32 v38, v96, v96
    v_fmac_f32 v38, v98, v98
    v_mov_b32 v39, 0x43000000
    v_fmac_f32 v37, v39, v38
    v_mov_b32 v39, 0x3727c5ac
    v_fmac_f32 v39, 0x3a800000, v37
    v_rsq_f32 v39, v39
    s_waitcnt lgkmcnt(0)
    v_sub_f32 v20, v20, v36
    v_sub_f32 v21, v21, v36
    v_sub_f32 v22, v22, v36
    v_sub_f32 v23, v23, v36
    v_sub_f32 v24, v24, v36
    v_sub_f32 v25, v25, v36
    v_sub_f32 v26, v26, v36
    v_sub_f32 v27, v27, v36
    v_sub_f32 v28, v28, v36
    v_sub_f32 v29, v29, v36
    v_sub_f32 v30, v30, v36
    v_sub_f32 v31, v31, v36
    v_sub_f32 v32, v32, v36
    v_sub_f32 v33, v33, v36
    v_sub_f32 v34, v34, v36
    v_sub_f32 v35, v35, v36
    v_add_f32 v52, 1.0, v52
    v_add_f32 v53, 1.0, v53
    v_add_f32 v54, 1.0, v54
    v_add_f32 v55, 1.0, v55
    v_add_f32 v56, 1.0, v56
    v_add_f32 v57, 1.0, v57
    v_add_f32 v58, 1.0, v58
    v_add_f32 v59, 1.0, v59
    v_add_f32 v60, 1.0, v60
    v_add_f32 v61, 1.0, v61
    v_add_f32 v62, 1.0, v62
    v_add_f32 v63, 1.0, v63
    v_add_f32 v64, 1.0, v64
    v_add_f32 v65, 1.0, v65
    v_add_f32 v66, 1.0, v66
    v_add_f32 v67, 1.0, v67
    v_mul_f32 v20, v20, v39
    v_mul_f32 v21, v21, v39
    v_mul_f32 v22, v22, v39
    v_mul_f32 v23, v23, v39
    v_mul_f32 v24, v24, v39
    v_mul_f32 v25, v25, v39
    v_mul_f32 v26, v26, v39
    v_mul_f32 v27, v27, v39
    v_mul_f32 v28, v28, v39
    v_mul_f32 v29, v29, v39
    v_mul_f32 v30, v30, v39
    v_mul_f32 v31, v31, v39
    v_mul_f32 v32, v32, v39
    v_mul_f32 v33, v33, v39
    v_mul_f32 v34, v34, v39
    v_mul_f32 v35, v35, v39
    v_fmac_f32 v68, v20, v52
    v_fmac_f32 v69, v21, v53
    v_fmac_f32 v70, v22, v54
    v_fmac_f32 v71, v23, v55
    v_fmac_f32 v72, v24, v56
    v_fmac_f32 v73, v25, v57
    v_fmac_f32 v74, v26, v58
    v_fmac_f32 v75, v27, v59
    v_fmac_f32 v76, v28, v60
    v_fmac_f32 v77, v29, v61
    v_fmac_f32 v78, v30, v62
    v_fmac_f32 v79, v31, v63
    v_fmac_f32 v80, v32, v64
    v_fmac_f32 v81, v33, v65
    v_fmac_f32 v82, v34, v66
    v_fmac_f32 v83, v35, v67
    s_mov_b32 s28, 1040356334
    v_mul_f32 v68, s28, v68
    v_mul_f32 v69, s28, v69
    v_mul_f32 v70, s28, v70
    v_mul_f32 v71, s28, v71
    v_mul_f32 v72, s28, v72
    v_mul_f32 v73, s28, v73
    v_mul_f32 v74, s28, v74
    v_mul_f32 v75, s28, v75
    v_mul_f32 v76, s28, v76
    v_mul_f32 v77, s28, v77
    v_mul_f32 v78, s28, v78
    v_mul_f32 v79, s28, v79
    v_mul_f32 v80, s28, v80
    v_mul_f32 v81, s28, v81
    v_mul_f32 v82, s28, v82
    v_mul_f32 v83, s28, v83
    v_cvt_pk_bf16_f32 v12, v68, v69
    v_cvt_pk_bf16_f32 v13, v70, v71
    v_cvt_pk_bf16_f32 v14, v72, v73
    v_cvt_pk_bf16_f32 v15, v74, v75
    v_cvt_pk_bf16_f32 v16, v76, v77
    v_cvt_pk_bf16_f32 v17, v78, v79
    v_cvt_pk_bf16_f32 v18, v80, v81
    v_cvt_pk_bf16_f32 v19, v82, v83
    v_add_u32 v7, 4096, v6
    buffer_store_dwordx4 v[12:15], v6, s[20:23], 0 offen sc1
    buffer_store_dwordx4 v[16:19], v7, s[20:23], 0 offen sc1
L_ln1_kernel_done:
    s_endpgm
.globl attn_kernel
.p2align 8
.type attn_kernel,@function
attn_kernel:
    s_cmp_ge_u32 s2, 256
    s_cbranch_scc1 L_attn_kernel_done
    s_load_dwordx4 s[4:7], s[0:1], 8
    s_load_dwordx2 s[8:9], s[0:1], 24
    s_load_dwordx2 s[10:11], s[0:1], 96
    s_load_dwordx2 s[60:61], s[0:1], 32
    s_load_dwordx4 s[64:67], s[0:1], 48
    s_load_dwordx2 s[82:83], s[0:1], 72
    s_load_dwordx2 s[100:101], s[0:1], 64
    v_lshrrev_b32 v2, 6, v0
    v_and_b32 v1, 63, v0
    v_readfirstlane_b32 s20, v2
    v_lshlrev_b32 v2, 4, v1
    s_and_b32 s21, s2, 7
    s_lshr_b32 s22, s2, 3
    s_and_b32 s23, s21, 3
    s_lshl_b32 s24, s23, 3
    s_and_b32 s25, s22, 7
    s_add_u32 s24, s24, s25
    s_lshr_b32 s25, s21, 2
    s_lshl_b32 s25, s25, 2
    s_lshr_b32 s26, s22, 3
    s_add_u32 s25, s25, s26
    s_lshl_b32 s25, s25, 3
    s_lshl_b32 s26, s20, 1
    s_add_u32 s25, s25, s26
    v_add_u32 v3, 0x10000, v2
    v_lshrrev_b32 v32, 4, v1
    v_and_b32 v33, 15, v1
    v_lshlrev_b32 v34, 2, v32
    v_xor_b32 v34, v33, v34
    v_lshlrev_b32 v34, 4, v34
    v_lshl_add_u32 v4, v32, 13, v34
    v_add_u32 v5, 31744, v4
    v_add_u32 v6, 63488, v4
    v_add_u32 v7, 95232, v4
    v_lshl_add_u32 v16, v32, 8, v34
    v_add_u32 v35, 0, v32
    v_xor_b32 v35, v33, v35
    v_lshlrev_b32 v35, 4, v35
    v_lshl_add_u32 v12, v32, 8, v35
    v_add_u32 v35, 4, v32
    v_xor_b32 v35, v33, v35
    v_lshlrev_b32 v35, 4, v35
    v_lshl_add_u32 v13, v32, 8, v35
    v_add_u32 v35, 8, v32
    v_xor_b32 v35, v33, v35
    v_lshlrev_b32 v35, 4, v35
    v_lshl_add_u32 v14, v32, 8, v35
    v_add_u32 v35, 12, v32
    v_xor_b32 v35, v33, v35
    v_lshlrev_b32 v35, 4, v35
    v_lshl_add_u32 v15, v32, 8, v35
    v_lshrrev_b32 v35, 5, v1
    v_bfe_u32 v32, v1, 2, 2
    v_lshl_add_u32 v32, v35, 3, v32
    v_bfe_u32 v33, v1, 4, 1
    v_and_b32 v35, 1, v1
    v_bfe_u32 v34, v1, 1, 1
    v_lshl_or_b32 v34, v35, 1, v34
    v_lshrrev_b32 v35, 1, v34
    v_lshl_add_u32 v35, v33, 1, v35
    v_bfe_u32 v36, v1, 2, 2
    v_lshlrev_b32 v37, 2, v36
    v_and_b32 v34, 1, v34
    v_lshlrev_b32 v34, 3, v34
    v_lshl_add_u32 v38, v32, 8, v34
    v_lshrrev_b32 v39, 5, v1
    v_lshl_add_u32 v39, v39, 2, v36
    v_lshl_add_u32 v39, v39, 8, v34
    v_or_b32 v42, 0, v35
    v_xor_b32 v42, v42, v37
    v_lshl_add_u32 v8, v42, 4, v38
    v_lshl_add_u32 v28, v42, 4, v39
    v_add_u32 v28, 114688, v28
    v_or_b32 v42, 4, v35
    v_xor_b32 v42, v42, v37
    v_lshl_add_u32 v9, v42, 4, v38
    v_lshl_add_u32 v29, v42, 4, v39
    v_add_u32 v29, 114688, v29
    v_or_b32 v42, 8, v35
    v_xor_b32 v42, v42, v37
    v_lshl_add_u32 v10, v42, 4, v38
    v_lshl_add_u32 v30, v42, 4, v39
    v_add_u32 v30, 114688, v30
    v_or_b32 v42, 12, v35
    v_xor_b32 v42, v42, v37
    v_lshl_add_u32 v11, v42, 4, v38
    v_lshl_add_u32 v31, v42, 4, v39
    v_add_u32 v31, 114688, v31
    v_and_b32 v32, 31, v1
    v_lshrrev_b32 v33, 5, v1
    v_and_b32 v34, 15, v1
    v_or_b32 v35, 0, v33
    v_xor_b32 v35, v35, v34
    v_lshlrev_b32 v35, 4, v35
    v_lshl_add_u32 v20, v32, 8, v35
    v_add_u32 v20, 65536, v20
    v_or_b32 v35, 2, v33
    v_xor_b32 v35, v35, v34
    v_lshlrev_b32 v35, 4, v35
    v_lshl_add_u32 v21, v32, 8, v35
    v_add_u32 v21, 65536, v21
    v_or_b32 v35, 4, v33
    v_xor_b32 v35, v35, v34
    v_lshlrev_b32 v35, 4, v35
    v_lshl_add_u32 v22, v32, 8, v35
    v_add_u32 v22, 65536, v22
    v_or_b32 v35, 6, v33
    v_xor_b32 v35, v35, v34
    v_lshlrev_b32 v35, 4, v35
    v_lshl_add_u32 v23, v32, 8, v35
    v_add_u32 v23, 65536, v23
    v_or_b32 v35, 8, v33
    v_xor_b32 v35, v35, v34
    v_lshlrev_b32 v35, 4, v35
    v_lshl_add_u32 v24, v32, 8, v35
    v_add_u32 v24, 65536, v24
    v_or_b32 v35, 10, v33
    v_xor_b32 v35, v35, v34
    v_lshlrev_b32 v35, 4, v35
    v_lshl_add_u32 v25, v32, 8, v35
    v_add_u32 v25, 65536, v25
    v_or_b32 v35, 12, v33
    v_xor_b32 v35, v35, v34
    v_lshlrev_b32 v35, 4, v35
    v_lshl_add_u32 v26, v32, 8, v35
    v_add_u32 v26, 65536, v26
    v_or_b32 v35, 14, v33
    v_xor_b32 v35, v35, v34
    v_lshlrev_b32 v35, 4, v35
    v_lshl_add_u32 v27, v32, 8, v35
    v_add_u32 v27, 65536, v27
    v_lshrrev_b32 v32, 4, v1
    v_and_b32 v33, 15, v1
    v_lshlrev_b32 v34, 1, v32
    v_xor_b32 v34, v33, v34
    v_xor_b32 v36, 8, v34
    v_lshlrev_b32 v34, 4, v34
    v_lshlrev_b32 v36, 4, v36
    v_mul_u32_u24 v35, 8192, v32
    v_add_u32 v4, v35, v34
    v_add_u32 v5, 31744, v4
    v_add_u32 v6, v35, v36
    v_add_u32 v7, 95232, v6
    v_add_u32 v6, 63488, v6
    v_lshrrev_b32 v32, 4, v1
    v_bfe_u32 v33, v1, 2, 2
    v_lshl_add_u32 v34, v32, 3, v33
    v_and_b32 v35, 1, v32
    v_lshl_or_b32 v35, v35, 2, v33
    v_bfe_u32 v36, v1, 1, 1
    v_lshlrev_b32 v36, 4, v36
    v_and_b32 v37, 1, v1
    v_lshl_or_b32 v36, v37, 3, v36
    v_lshl_add_u32 v36, v34, 8, v36
    v_xor_b32 v37, 0, v35
    v_lshl_add_u32 v44, v37, 5, v36
    v_xor_b32 v37, 1, v35
    v_lshl_add_u32 v45, v37, 5, v36
    v_xor_b32 v37, 2, v35
    v_lshl_add_u32 v46, v37, 5, v36
    v_xor_b32 v37, 3, v35
    v_lshl_add_u32 v47, v37, 5, v36
    v_xor_b32 v37, 4, v35
    v_lshl_add_u32 v48, v37, 5, v36
    v_xor_b32 v37, 5, v35
    v_lshl_add_u32 v49, v37, 5, v36
    v_xor_b32 v37, 6, v35
    v_lshl_add_u32 v50, v37, 5, v36
    v_xor_b32 v37, 7, v35
    v_lshl_add_u32 v51, v37, 5, v36
    v_lshrrev_b32 v52, 4, v1
    v_lshlrev_b32 v52, 9, v52
    v_and_b32 v53, 15, v1
    v_lshl_add_u32 v52, v53, 4, v52
    v_add_u32 v53, 0x10000, v52
    s_waitcnt lgkmcnt(0)
    s_mov_b32 s12, s8
    s_mov_b32 s13, s9
    s_mov_b32 s14, 8388608
    s_mov_b32 s15, 0x20000
    s_lshl_b32 s26, s25, 16
    s_add_u32 s26, s26, 1048576
    s_add_u32 s16, s10, s26
    s_addc_u32 s17, s11, 0
    s_mov_b32 s18, 131072
    s_mov_b32 s19, 0x20000
    s_mov_b32 s32, s4
    s_mov_b32 s33, s5
    s_mov_b32 s34, 2097152
    s_mov_b32 s35, 0x20000
    s_mov_b32 s36, s6
    s_mov_b32 s37, s7
    s_mov_b32 s38, 2097152
    s_mov_b32 s39, 0x20000
    s_add_u32 s40, s10, 16777216
    s_addc_u32 s41, s11, 0
    s_mov_b32 s42, 16777216
    s_mov_b32 s43, 0x20000
    s_mul_i32 s28, s20, 131072
    s_lshl_b32 s26, s24, 8
    s_add_u32 s28, s28, s26
    s_mov_b32 s29, 0
    s_lshl_b32 s30, s20, 12
    s_lshl_b32 s44, s23, 19
    s_add_u32 s44, s44, 393216
    s_add_u32 s44, s44, s30
    s_lshl_b32 s26, s2, 2
    s_add_u32 s26, s26, s20
    s_mul_i32 s26, s26, 8192
    v_lshlrev_b32 v17, 7, v1
    v_add_u32 v17, s26, v17
    s_mul_i32 s26, s26, 3
    s_lshr_b32 s26, s26, 1
    s_add_u32 s26, s26, 4096
    v_lshlrev_b32 v19, 7, v1
    v_add_u32 v19, s26, v19
    s_mov_b32 s62, 7340032
    s_mov_b32 s79, 0x20000
    s_and_b32 s80, s2, 1
    s_mov_b32 s81, 8388608
    s_and_b32 s6, s2, 3
    s_lshr_b32 s7, s2, 2
    s_lshl_b32 s8, s6, 8
    s_lshl_b32 s9, s20, 6
    s_add_u32 s8, s8, s9
    v_lshrrev_b32 v56, 3, v1
    v_lshl_add_u32 v56, v56, 3, s8
    v_lshlrev_b32 v57, 1, v56
    s_mov_b32 s9, 12288
    v_mul_lo_u32 v56, v56, s9
    v_and_b32 v58, 7, v1
    v_lshlrev_b32 v58, 4, v58
    s_lshl_b32 s9, s7, 7
    s_add_u32 s9, s9, 4096
    v_add3_u32 v56, v56, v58, s9
    s_mov_b32 s84, s82
    s_mov_b32 s85, s83
    s_mov_b32 s86, 12582912
    s_mov_b32 s87, 0x20000
    s_lshl_b32 s8, s20, 13
    s_add_u32 s8, s8, 8192
    s_mov_b32 s4, s100
    s_mov_b32 s5, s101
    s_mov_b32 s6, 2048
    s_mov_b32 s7, 0x20000
    buffer_load_dwordx4 v[60:63], v57, s[4:7], 0 offen
    s_and_b32 s6, s2, 3
    s_lshr_b32 s7, s2, 2
    s_add_u32 m0, s30, 0
    s_nop 0
    buffer_load_dwordx4 v4, s[12:15], s28 offen offset:0 lds
    buffer_load_dwordx4 a[0:3], v52, s[16:19], s29 offen offset:0
    buffer_load_dwordx4 a[4:7], v52, s[16:19], s29 offen offset:256
    buffer_load_dwordx4 v5, s[12:15], s28 offen offset:1024 lds
    buffer_load_dwordx4 a[8:11], v53, s[16:19], s29 offen offset:0
    buffer_load_dwordx4 a[12:15], v53, s[16:19], s29 offen offset:256
    buffer_load_dwordx4 v6, s[12:15], s28 offen offset:2048 lds
    buffer_load_dwordx4 a[16:19], v52, s[16:19], s29 offen offset:2048
    buffer_load_dwordx4 a[20:23], v52, s[16:19], s29 offen offset:2304
    buffer_load_dwordx4 v7, s[12:15], s28 offen offset:3072 lds
    buffer_load_dwordx4 a[24:27], v53, s[16:19], s29 offen offset:2048
    buffer_load_dwordx4 a[28:31], v53, s[16:19], s29 offen offset:2304
    s_add_u32 s28, s28, 524288
    s_add_u32 m0, s30, 16384
    s_nop 0
    buffer_load_dwordx4 v4, s[12:15], s28 offen offset:0 lds
    s_mov_b32 s29, 4096
    buffer_load_dwordx4 a[32:35], v52, s[16:19], s29 offen offset:0
    buffer_load_dwordx4 a[36:39], v52, s[16:19], s29 offen offset:256
    buffer_load_dwordx4 v5, s[12:15], s28 offen offset:1024 lds
    buffer_load_dwordx4 a[40:43], v53, s[16:19], s29 offen offset:0
    buffer_load_dwordx4 a[44:47], v53, s[16:19], s29 offen offset:256
    buffer_load_dwordx4 v6, s[12:15], s28 offen offset:2048 lds
    buffer_load_dwordx4 a[48:51], v52, s[16:19], s29 offen offset:2048
    buffer_load_dwordx4 a[52:55], v52, s[16:19], s29 offen offset:2304
    buffer_load_dwordx4 v7, s[12:15], s28 offen offset:3072 lds
    buffer_load_dwordx4 a[56:59], v53, s[16:19], s29 offen offset:2048
    buffer_load_dwordx4 a[60:63], v53, s[16:19], s29 offen offset:2304
    v_mov_b32 v64, 0
    v_mov_b32 v65, 0
    v_mov_b32 v66, 0
    v_mov_b32 v67, 0
    v_mov_b32 v68, 0
    v_mov_b32 v69, 0
    v_mov_b32 v70, 0
    v_mov_b32 v71, 0
    v_mov_b32 v72, 0
    v_mov_b32 v73, 0
    v_mov_b32 v74, 0
    v_mov_b32 v75, 0
    v_mov_b32 v76, 0
    v_mov_b32 v77, 0
    v_mov_b32 v78, 0
    v_mov_b32 v79, 0
    v_mov_b32 v80, 0
    v_mov_b32 v81, 0
    v_mov_b32 v82, 0
    v_mov_b32 v83, 0
    v_mov_b32 v84, 0
    v_mov_b32 v85, 0
    v_mov_b32 v86, 0
    v_mov_b32 v87, 0
    v_mov_b32 v88, 0
    v_mov_b32 v89, 0
    v_mov_b32 v90, 0
    v_mov_b32 v91, 0
    v_mov_b32 v92, 0
    v_mov_b32 v93, 0
    v_mov_b32 v94, 0
    v_mov_b32 v95, 0
    v_mov_b32 v96, 0
    v_mov_b32 v97, 0
    v_mov_b32 v98, 0
    v_mov_b32 v99, 0
    v_mov_b32 v100, 0
    v_mov_b32 v101, 0
    v_mov_b32 v102, 0
    v_mov_b32 v103, 0
    v_mov_b32 v104, 0
    v_mov_b32 v105, 0
    v_mov_b32 v106, 0
    v_mov_b32 v107, 0
    v_mov_b32 v108, 0
    v_mov_b32 v109, 0
    v_mov_b32 v110, 0
    v_mov_b32 v111, 0
    v_mov_b32 v112, 0
    v_mov_b32 v113, 0
    v_mov_b32 v114, 0
    v_mov_b32 v115, 0
    v_mov_b32 v116, 0
    v_mov_b32 v117, 0
    v_mov_b32 v118, 0
    v_mov_b32 v119, 0
    v_mov_b32 v120, 0
    v_mov_b32 v121, 0
    v_mov_b32 v122, 0
    v_mov_b32 v123, 0
    v_mov_b32 v124, 0
    v_mov_b32 v125, 0
    v_mov_b32 v126, 0
    v_mov_b32 v127, 0
    v_mov_b32 v128, 0
    v_mov_b32 v129, 0
    v_mov_b32 v130, 0
    v_mov_b32 v131, 0
    v_mov_b32 v132, 0
    v_mov_b32 v133, 0
    v_mov_b32 v134, 0
    v_mov_b32 v135, 0
    v_mov_b32 v136, 0
    v_mov_b32 v137, 0
    v_mov_b32 v138, 0
    v_mov_b32 v139, 0
    v_mov_b32 v140, 0
    v_mov_b32 v141, 0
    v_mov_b32 v142, 0
    v_mov_b32 v143, 0
    v_mov_b32 v144, 0
    v_mov_b32 v145, 0
    v_mov_b32 v146, 0
    v_mov_b32 v147, 0
    v_mov_b32 v148, 0
    v_mov_b32 v149, 0
    v_mov_b32 v150, 0
    v_mov_b32 v151, 0
    v_mov_b32 v152, 0
    v_mov_b32 v153, 0
    v_mov_b32 v154, 0
    v_mov_b32 v155, 0
    v_mov_b32 v156, 0
    v_mov_b32 v157, 0
    v_mov_b32 v158, 0
    v_mov_b32 v159, 0
    v_mov_b32 v160, 0
    v_mov_b32 v161, 0
    v_mov_b32 v162, 0
    v_mov_b32 v163, 0
    v_mov_b32 v164, 0
    v_mov_b32 v165, 0
    v_mov_b32 v166, 0
    v_mov_b32 v167, 0
    v_mov_b32 v168, 0
    v_mov_b32 v169, 0
    v_mov_b32 v170, 0
    v_mov_b32 v171, 0
    v_mov_b32 v172, 0
    v_mov_b32 v173, 0
    v_mov_b32 v174, 0
    v_mov_b32 v175, 0
    v_mov_b32 v176, 0
    v_mov_b32 v177, 0
    v_mov_b32 v178, 0
    v_mov_b32 v179, 0
    v_mov_b32 v180, 0
    v_mov_b32 v181, 0
    v_mov_b32 v182, 0
    v_mov_b32 v183, 0
    v_mov_b32 v184, 0
    v_mov_b32 v185, 0
    v_mov_b32 v186, 0
    v_mov_b32 v187, 0
    v_mov_b32 v188, 0
    v_mov_b32 v189, 0
    v_mov_b32 v190, 0
    v_mov_b32 v191, 0
    s_mov_b32 s46, 0
    s_add_u32 s45, s44, 16384
    s_waitcnt vmcnt(12)
    s_barrier
    ds_read_b64_tr_b16 a[128:129], v44 offset:0
    ds_read_b64_tr_b16 a[130:131], v44 offset:1024
    ds_read_b64_tr_b16 a[132:133], v45 offset:0
    ds_read_b64_tr_b16 a[134:135], v45 offset:1024
    ds_read_b64_tr_b16 a[136:137], v46 offset:0
    ds_read_b64_tr_b16 a[138:139], v46 offset:1024
    ds_read_b64_tr_b16 a[140:141], v47 offset:0
    ds_read_b64_tr_b16 a[142:143], v47 offset:1024
    s_waitcnt lgkmcnt(6)
    v_mfma_f32_16x16x32_bf16 v[64:67], a[128:131], a[0:3], v[64:67]
    ds_read_b64_tr_b16 a[144:145], v48 offset:0
    v_mfma_f32_16x16x32_bf16 v[68:71], a[128:131], a[4:7], v[68:71]
    ds_read_b64_tr_b16 a[146:147], v48 offset:1024
    s_add_u32 s28, s28, 524288
    s_add_u32 m0, s30, 32768
    v_mfma_f32_16x16x32_bf16 v[72:75], a[128:131], a[8:11], v[72:75]
    buffer_load_dwordx4 v4, s[12:15], s28 offen offset:0 lds
    v_mfma_f32_16x16x32_bf16 v[76:79], a[128:131], a[12:15], v[76:79]
    s_waitcnt lgkmcnt(6)
    v_mfma_f32_16x16x32_bf16 v[80:83], a[132:135], a[0:3], v[80:83]
    ds_read_b64_tr_b16 a[148:149], v49 offset:0
    v_mfma_f32_16x16x32_bf16 v[84:87], a[132:135], a[4:7], v[84:87]
    ds_read_b64_tr_b16 a[150:151], v49 offset:1024
    s_mov_b32 s29, 8192
    v_mfma_f32_16x16x32_bf16 v[88:91], a[132:135], a[8:11], v[88:91]
    buffer_load_dwordx4 a[64:67], v52, s[16:19], s29 offen offset:0
    v_mfma_f32_16x16x32_bf16 v[92:95], a[132:135], a[12:15], v[92:95]
    s_waitcnt lgkmcnt(6)
    v_mfma_f32_16x16x32_bf16 v[96:99], a[136:139], a[0:3], v[96:99]
    ds_read_b64_tr_b16 a[152:153], v50 offset:0
    v_mfma_f32_16x16x32_bf16 v[100:103], a[136:139], a[4:7], v[100:103]
    ds_read_b64_tr_b16 a[154:155], v50 offset:1024
    v_mfma_f32_16x16x32_bf16 v[104:107], a[136:139], a[8:11], v[104:107]
    buffer_load_dwordx4 a[68:71], v52, s[16:19], s29 offen offset:256
    v_mfma_f32_16x16x32_bf16 v[108:111], a[136:139], a[12:15], v[108:111]
    s_waitcnt lgkmcnt(6)
    v_mfma_f32_16x16x32_bf16 v[112:115], a[140:143], a[0:3], v[112:115]
    ds_read_b64_tr_b16 a[156:157], v51 offset:0
    v_mfma_f32_16x16x32_bf16 v[116:119], a[140:143], a[4:7], v[116:119]
    ds_read_b64_tr_b16 a[158:159], v51 offset:1024
    v_mfma_f32_16x16x32_bf16 v[120:123], a[140:143], a[8:11], v[120:123]
    buffer_load_dwordx4 v5, s[12:15], s28 offen offset:1024 lds
    v_mfma_f32_16x16x32_bf16 v[124:127], a[140:143], a[12:15], v[124:127]
    s_waitcnt lgkmcnt(6)
    v_mfma_f32_16x16x32_bf16 v[128:131], a[144:147], a[0:3], v[128:131]
    ds_read_b64_tr_b16 a[128:129], v44 offset:8192
    v_mfma_f32_16x16x32_bf16 v[132:135], a[144:147], a[4:7], v[132:135]
    ds_read_b64_tr_b16 a[130:131], v44 offset:9216
    v_mfma_f32_16x16x32_bf16 v[136:139], a[144:147], a[8:11], v[136:139]
    buffer_load_dwordx4 a[72:75], v53, s[16:19], s29 offen offset:0
    v_mfma_f32_16x16x32_bf16 v[140:143], a[144:147], a[12:15], v[140:143]
    s_waitcnt lgkmcnt(6)
    v_mfma_f32_16x16x32_bf16 v[144:147], a[148:151], a[0:3], v[144:147]
    ds_read_b64_tr_b16 a[132:133], v45 offset:8192
    v_mfma_f32_16x16x32_bf16 v[148:151], a[148:151], a[4:7], v[148:151]
    ds_read_b64_tr_b16 a[134:135], v45 offset:9216
    v_mfma_f32_16x16x32_bf16 v[152:155], a[148:151], a[8:11], v[152:155]
    buffer_load_dwordx4 a[76:79], v53, s[16:19], s29 offen offset:256
    v_mfma_f32_16x16x32_bf16 v[156:159], a[148:151], a[12:15], v[156:159]
    s_waitcnt lgkmcnt(6)
    v_mfma_f32_16x16x32_bf16 v[160:163], a[152:155], a[0:3], v[160:163]
    ds_read_b64_tr_b16 a[136:137], v46 offset:8192
    v_mfma_f32_16x16x32_bf16 v[164:167], a[152:155], a[4:7], v[164:167]
    ds_read_b64_tr_b16 a[138:139], v46 offset:9216
    v_mfma_f32_16x16x32_bf16 v[168:171], a[152:155], a[8:11], v[168:171]
    buffer_load_dwordx4 v6, s[12:15], s28 offen offset:2048 lds
    v_mfma_f32_16x16x32_bf16 v[172:175], a[152:155], a[12:15], v[172:175]
    s_waitcnt lgkmcnt(6)
    v_mfma_f32_16x16x32_bf16 v[176:179], a[156:159], a[0:3], v[176:179]
    ds_read_b64_tr_b16 a[140:141], v47 offset:8192
    v_mfma_f32_16x16x32_bf16 v[180:183], a[156:159], a[4:7], v[180:183]
    ds_read_b64_tr_b16 a[142:143], v47 offset:9216
    v_mfma_f32_16x16x32_bf16 v[184:187], a[156:159], a[8:11], v[184:187]
    buffer_load_dwordx4 a[80:83], v52, s[16:19], s29 offen offset:2048
    v_mfma_f32_16x16x32_bf16 v[188:191], a[156:159], a[12:15], v[188:191]
    s_waitcnt lgkmcnt(6)
    v_mfma_f32_16x16x32_bf16 v[64:67], a[128:131], a[16:19], v[64:67]
    ds_read_b64_tr_b16 a[144:145], v48 offset:8192
    v_mfma_f32_16x16x32_bf16 v[68:71], a[128:131], a[20:23], v[68:71]
    ds_read_b64_tr_b16 a[146:147], v48 offset:9216
    v_mfma_f32_16x16x32_bf16 v[72:75], a[128:131], a[24:27], v[72:75]
    buffer_load_dwordx4 a[84:87], v52, s[16:19], s29 offen offset:2304
    v_mfma_f32_16x16x32_bf16 v[76:79], a[128:131], a[28:31], v[76:79]
    s_waitcnt lgkmcnt(6)
    v_mfma_f32_16x16x32_bf16 v[80:83], a[132:135], a[16:19], v[80:83]
    ds_read_b64_tr_b16 a[148:149], v49 offset:8192
    v_mfma_f32_16x16x32_bf16 v[84:87], a[132:135], a[20:23], v[84:87]
    ds_read_b64_tr_b16 a[150:151], v49 offset:9216
    v_mfma_f32_16x16x32_bf16 v[88:91], a[132:135], a[24:27], v[88:91]
    buffer_load_dwordx4 v7, s[12:15], s28 offen offset:3072 lds
    v_mfma_f32_16x16x32_bf16 v[92:95], a[132:135], a[28:31], v[92:95]
    s_waitcnt lgkmcnt(6)
    v_mfma_f32_16x16x32_bf16 v[96:99], a[136:139], a[16:19], v[96:99]
    ds_read_b64_tr_b16 a[152:153], v50 offset:8192
    v_mfma_f32_16x16x32_bf16 v[100:103], a[136:139], a[20:23], v[100:103]
    ds_read_b64_tr_b16 a[154:155], v50 offset:9216
    v_mfma_f32_16x16x32_bf16 v[104:107], a[136:139], a[24:27], v[104:107]
    buffer_load_dwordx4 a[88:91], v53, s[16:19], s29 offen offset:2048
    v_mfma_f32_16x16x32_bf16 v[108:111], a[136:139], a[28:31], v[108:111]
    s_waitcnt lgkmcnt(6)
    v_mfma_f32_16x16x32_bf16 v[112:115], a[140:143], a[16:19], v[112:115]
    ds_read_b64_tr_b16 a[156:157], v51 offset:8192
    v_mfma_f32_16x16x32_bf16 v[116:119], a[140:143], a[20:23], v[116:119]
    ds_read_b64_tr_b16 a[158:159], v51 offset:9216
    v_mfma_f32_16x16x32_bf16 v[120:123], a[140:143], a[24:27], v[120:123]
    buffer_load_dwordx4 a[92:95], v53, s[16:19], s29 offen offset:2304
    v_mfma_f32_16x16x32_bf16 v[124:127], a[140:143], a[28:31], v[124:127]
    s_waitcnt vmcnt(12) lgkmcnt(0)
    s_barrier
    v_mfma_f32_16x16x32_bf16 v[128:131], a[144:147], a[16:19], v[128:131]
    ds_read_b64_tr_b16 a[128:129], v44 offset:16384
    v_mfma_f32_16x16x32_bf16 v[132:135], a[144:147], a[20:23], v[132:135]
    ds_read_b64_tr_b16 a[130:131], v44 offset:17408
    s_add_u32 s28, s28, 524288
    s_add_u32 m0, s30, 49152
    v_mfma_f32_16x16x32_bf16 v[136:139], a[144:147], a[24:27], v[136:139]
    buffer_load_dwordx4 v4, s[12:15], s28 offen offset:0 lds
    v_mfma_f32_16x16x32_bf16 v[140:143], a[144:147], a[28:31], v[140:143]
    s_waitcnt lgkmcnt(6)
    v_mfma_f32_16x16x32_bf16 v[144:147], a[148:151], a[16:19], v[144:147]
    ds_read_b64_tr_b16 a[132:133], v45 offset:16384
    v_mfma_f32_16x16x32_bf16 v[148:151], a[148:151], a[20:23], v[148:151]
    ds_read_b64_tr_b16 a[134:135], v45 offset:17408
    s_mov_b32 s29, 12288
    v_mfma_f32_16x16x32_bf16 v[152:155], a[148:151], a[24:27], v[152:155]
    buffer_load_dwordx4 a[96:99], v52, s[16:19], s29 offen offset:0
    v_mfma_f32_16x16x32_bf16 v[156:159], a[148:151], a[28:31], v[156:159]
    s_waitcnt lgkmcnt(6)
    v_mfma_f32_16x16x32_bf16 v[160:163], a[152:155], a[16:19], v[160:163]
    ds_read_b64_tr_b16 a[136:137], v46 offset:16384
    v_mfma_f32_16x16x32_bf16 v[164:167], a[152:155], a[20:23], v[164:167]
    ds_read_b64_tr_b16 a[138:139], v46 offset:17408
    v_mfma_f32_16x16x32_bf16 v[168:171], a[152:155], a[24:27], v[168:171]
    buffer_load_dwordx4 a[100:103], v52, s[16:19], s29 offen offset:256
    v_mfma_f32_16x16x32_bf16 v[172:175], a[152:155], a[28:31], v[172:175]
    s_waitcnt lgkmcnt(6)
    v_mfma_f32_16x16x32_bf16 v[176:179], a[156:159], a[16:19], v[176:179]
    ds_read_b64_tr_b16 a[140:141], v47 offset:16384
    v_mfma_f32_16x16x32_bf16 v[180:183], a[156:159], a[20:23], v[180:183]
    ds_read_b64_tr_b16 a[142:143], v47 offset:17408
    v_mfma_f32_16x16x32_bf16 v[184:187], a[156:159], a[24:27], v[184:187]
    buffer_load_dwordx4 v5, s[12:15], s28 offen offset:1024 lds
    v_mfma_f32_16x16x32_bf16 v[188:191], a[156:159], a[28:31], v[188:191]
    s_waitcnt lgkmcnt(6)
    v_mfma_f32_16x16x32_bf16 v[64:67], a[128:131], a[32:35], v[64:67]
    ds_read_b64_tr_b16 a[144:145], v48 offset:16384
    v_mfma_f32_16x16x32_bf16 v[68:71], a[128:131], a[36:39], v[68:71]
    ds_read_b64_tr_b16 a[146:147], v48 offset:17408
    v_mfma_f32_16x16x32_bf16 v[72:75], a[128:131], a[40:43], v[72:75]
    buffer_load_dwordx4 a[104:107], v53, s[16:19], s29 offen offset:0
    v_mfma_f32_16x16x32_bf16 v[76:79], a[128:131], a[44:47], v[76:79]
    s_waitcnt lgkmcnt(6)
    v_mfma_f32_16x16x32_bf16 v[80:83], a[132:135], a[32:35], v[80:83]
    ds_read_b64_tr_b16 a[148:149], v49 offset:16384
    v_mfma_f32_16x16x32_bf16 v[84:87], a[132:135], a[36:39], v[84:87]
    ds_read_b64_tr_b16 a[150:151], v49 offset:17408
    v_mfma_f32_16x16x32_bf16 v[88:91], a[132:135], a[40:43], v[88:91]
    buffer_load_dwordx4 a[108:111], v53, s[16:19], s29 offen offset:256
    v_mfma_f32_16x16x32_bf16 v[92:95], a[132:135], a[44:47], v[92:95]
    s_waitcnt lgkmcnt(6)
    v_mfma_f32_16x16x32_bf16 v[96:99], a[136:139], a[32:35], v[96:99]
    ds_read_b64_tr_b16 a[152:153], v50 offset:16384
    v_mfma_f32_16x16x32_bf16 v[100:103], a[136:139], a[36:39], v[100:103]
    ds_read_b64_tr_b16 a[154:155], v50 offset:17408
    v_mfma_f32_16x16x32_bf16 v[104:107], a[136:139], a[40:43], v[104:107]
    buffer_load_dwordx4 v6, s[12:15], s28 offen offset:2048 lds
    v_mfma_f32_16x16x32_bf16 v[108:111], a[136:139], a[44:47], v[108:111]
    s_waitcnt lgkmcnt(6)
    v_mfma_f32_16x16x32_bf16 v[112:115], a[140:143], a[32:35], v[112:115]
    ds_read_b64_tr_b16 a[156:157], v51 offset:16384
    v_mfma_f32_16x16x32_bf16 v[116:119], a[140:143], a[36:39], v[116:119]
    ds_read_b64_tr_b16 a[158:159], v51 offset:17408
    v_mfma_f32_16x16x32_bf16 v[120:123], a[140:143], a[40:43], v[120:123]
    buffer_load_dwordx4 a[112:115], v52, s[16:19], s29 offen offset:2048
    v_mfma_f32_16x16x32_bf16 v[124:127], a[140:143], a[44:47], v[124:127]
    s_waitcnt lgkmcnt(6)
    v_mfma_f32_16x16x32_bf16 v[128:131], a[144:147], a[32:35], v[128:131]
    ds_read_b64_tr_b16 a[128:129], v44 offset:24576
    v_mfma_f32_16x16x32_bf16 v[132:135], a[144:147], a[36:39], v[132:135]
    ds_read_b64_tr_b16 a[130:131], v44 offset:25600
    v_mfma_f32_16x16x32_bf16 v[136:139], a[144:147], a[40:43], v[136:139]
    buffer_load_dwordx4 a[116:119], v52, s[16:19], s29 offen offset:2304
    v_mfma_f32_16x16x32_bf16 v[140:143], a[144:147], a[44:47], v[140:143]
    s_waitcnt lgkmcnt(6)
    v_mfma_f32_16x16x32_bf16 v[144:147], a[148:151], a[32:35], v[144:147]
    ds_read_b64_tr_b16 a[132:133], v45 offset:24576
    v_mfma_f32_16x16x32_bf16 v[148:151], a[148:151], a[36:39], v[148:151]
    ds_read_b64_tr_b16 a[134:135], v45 offset:25600
    v_mfma_f32_16x16x32_bf16 v[152:155], a[148:151], a[40:43], v[152:155]
    buffer_load_dwordx4 v7, s[12:15], s28 offen offset:3072 lds
    v_mfma_f32_16x16x32_bf16 v[156:159], a[148:151], a[44:47], v[156:159]
    s_waitcnt lgkmcnt(6)
    v_mfma_f32_16x16x32_bf16 v[160:163], a[152:155], a[32:35], v[160:163]
    ds_read_b64_tr_b16 a[136:137], v46 offset:24576
    v_mfma_f32_16x16x32_bf16 v[164:167], a[152:155], a[36:39], v[164:167]
    ds_read_b64_tr_b16 a[138:139], v46 offset:25600
    v_mfma_f32_16x16x32_bf16 v[168:171], a[152:155], a[40:43], v[168:171]
    buffer_load_dwordx4 a[120:123], v53, s[16:19], s29 offen offset:2048
    v_mfma_f32_16x16x32_bf16 v[172:175], a[152:155], a[44:47], v[172:175]
    s_waitcnt lgkmcnt(6)
    v_mfma_f32_16x16x32_bf16 v[176:179], a[156:159], a[32:35], v[176:179]
    ds_read_b64_tr_b16 a[140:141], v47 offset:24576
    v_mfma_f32_16x16x32_bf16 v[180:183], a[156:159], a[36:39], v[180:183]
    ds_read_b64_tr_b16 a[142:143], v47 offset:25600
    v_mfma_f32_16x16x32_bf16 v[184:187], a[156:159], a[40:43], v[184:187]
    buffer_load_dwordx4 a[124:127], v53, s[16:19], s29 offen offset:2304
    v_mfma_f32_16x16x32_bf16 v[188:191], a[156:159], a[44:47], v[188:191]
    s_waitcnt lgkmcnt(6)
    v_mfma_f32_16x16x32_bf16 v[64:67], a[128:131], a[48:51], v[64:67]
    ds_read_b64_tr_b16 a[144:145], v48 offset:24576
    v_mfma_f32_16x16x32_bf16 v[68:71], a[128:131], a[52:55], v[68:71]
    ds_read_b64_tr_b16 a[146:147], v48 offset:25600
    s_add_u32 s28, s28, 524288
    s_add_u32 m0, s30, 0
    v_mfma_f32_16x16x32_bf16 v[72:75], a[128:131], a[56:59], v[72:75]
    buffer_load_dwordx4 v4, s[12:15], s28 offen offset:0 lds
    v_mfma_f32_16x16x32_bf16 v[76:79], a[128:131], a[60:63], v[76:79]
    s_waitcnt lgkmcnt(6)
    v_mfma_f32_16x16x32_bf16 v[80:83], a[132:135], a[48:51], v[80:83]
    ds_read_b64_tr_b16 a[148:149], v49 offset:24576
    v_mfma_f32_16x16x32_bf16 v[84:87], a[132:135], a[52:55], v[84:87]
    ds_read_b64_tr_b16 a[150:151], v49 offset:25600
    s_mov_b32 s29, 16384
    v_mfma_f32_16x16x32_bf16 v[88:91], a[132:135], a[56:59], v[88:91]
    buffer_load_dwordx4 a[0:3], v52, s[16:19], s29 offen offset:0
    v_mfma_f32_16x16x32_bf16 v[92:95], a[132:135], a[60:63], v[92:95]
    s_waitcnt lgkmcnt(6)
    v_mfma_f32_16x16x32_bf16 v[96:99], a[136:139], a[48:51], v[96:99]
    ds_read_b64_tr_b16 a[152:153], v50 offset:24576
    v_mfma_f32_16x16x32_bf16 v[100:103], a[136:139], a[52:55], v[100:103]
    ds_read_b64_tr_b16 a[154:155], v50 offset:25600
    v_mfma_f32_16x16x32_bf16 v[104:107], a[136:139], a[56:59], v[104:107]
    buffer_load_dwordx4 a[4:7], v52, s[16:19], s29 offen offset:256
    v_mfma_f32_16x16x32_bf16 v[108:111], a[136:139], a[60:63], v[108:111]
    s_waitcnt lgkmcnt(6)
    v_mfma_f32_16x16x32_bf16 v[112:115], a[140:143], a[48:51], v[112:115]
    ds_read_b64_tr_b16 a[156:157], v51 offset:24576
    v_mfma_f32_16x16x32_bf16 v[116:119], a[140:143], a[52:55], v[116:119]
    ds_read_b64_tr_b16 a[158:159], v51 offset:25600
    v_mfma_f32_16x16x32_bf16 v[120:123], a[140:143], a[56:59], v[120:123]
    buffer_load_dwordx4 v5, s[12:15], s28 offen offset:1024 lds
    v_mfma_f32_16x16x32_bf16 v[124:127], a[140:143], a[60:63], v[124:127]
    s_waitcnt vmcnt(16) lgkmcnt(0)
    s_barrier
    v_mfma_f32_16x16x32_bf16 v[128:131], a[144:147], a[48:51], v[128:131]
    ds_read_b64_tr_b16 a[128:129], v44 offset:32768
    v_mfma_f32_16x16x32_bf16 v[132:135], a[144:147], a[52:55], v[132:135]
    ds_read_b64_tr_b16 a[130:131], v44 offset:33792
    v_mfma_f32_16x16x32_bf16 v[136:139], a[144:147], a[56:59], v[136:139]
    buffer_load_dwordx4 a[8:11], v53, s[16:19], s29 offen offset:0
    v_mfma_f32_16x16x32_bf16 v[140:143], a[144:147], a[60:63], v[140:143]
    s_waitcnt lgkmcnt(6)
    v_mfma_f32_16x16x32_bf16 v[144:147], a[148:151], a[48:51], v[144:147]
    ds_read_b64_tr_b16 a[132:133], v45 offset:32768
    v_mfma_f32_16x16x32_bf16 v[148:151], a[148:151], a[52:55], v[148:151]
    ds_read_b64_tr_b16 a[134:135], v45 offset:33792
    v_mfma_f32_16x16x32_bf16 v[152:155], a[148:151], a[56:59], v[152:155]
    buffer_load_dwordx4 a[12:15], v53, s[16:19], s29 offen offset:256
    v_mfma_f32_16x16x32_bf16 v[156:159], a[148:151], a[60:63], v[156:159]
    s_waitcnt lgkmcnt(6)
    v_mfma_f32_16x16x32_bf16 v[160:163], a[152:155], a[48:51], v[160:163]
    ds_read_b64_tr_b16 a[136:137], v46 offset:32768
    v_mfma_f32_16x16x32_bf16 v[164:167], a[152:155], a[52:55], v[164:167]
    ds_read_b64_tr_b16 a[138:139], v46 offset:33792
    v_mfma_f32_16x16x32_bf16 v[168:171], a[152:155], a[56:59], v[168:171]
    buffer_load_dwordx4 v6, s[12:15], s28 offen offset:2048 lds
    v_mfma_f32_16x16x32_bf16 v[172:175], a[152:155], a[60:63], v[172:175]
    s_waitcnt lgkmcnt(6)
    v_mfma_f32_16x16x32_bf16 v[176:179], a[156:159], a[48:51], v[176:179]
    ds_read_b64_tr_b16 a[140:141], v47 offset:32768
    v_mfma_f32_16x16x32_bf16 v[180:183], a[156:159], a[52:55], v[180:183]
    ds_read_b64_tr_b16 a[142:143], v47 offset:33792
    v_mfma_f32_16x16x32_bf16 v[184:187], a[156:159], a[56:59], v[184:187]
    buffer_load_dwordx4 a[16:19], v52, s[16:19], s29 offen offset:2048
    v_mfma_f32_16x16x32_bf16 v[188:191], a[156:159], a[60:63], v[188:191]
    s_waitcnt lgkmcnt(6)
    v_mfma_f32_16x16x32_bf16 v[64:67], a[128:131], a[64:67], v[64:67]
    ds_read_b64_tr_b16 a[144:145], v48 offset:32768
    v_mfma_f32_16x16x32_bf16 v[68:71], a[128:131], a[68:71], v[68:71]
    ds_read_b64_tr_b16 a[146:147], v48 offset:33792
    v_mfma_f32_16x16x32_bf16 v[72:75], a[128:131], a[72:75], v[72:75]
    buffer_load_dwordx4 a[20:23], v52, s[16:19], s29 offen offset:2304
    v_mfma_f32_16x16x32_bf16 v[76:79], a[128:131], a[76:79], v[76:79]
    s_waitcnt lgkmcnt(6)
    v_mfma_f32_16x16x32_bf16 v[80:83], a[132:135], a[64:67], v[80:83]
    ds_read_b64_tr_b16 a[148:149], v49 offset:32768
    v_mfma_f32_16x16x32_bf16 v[84:87], a[132:135], a[68:71], v[84:87]
    ds_read_b64_tr_b16 a[150:151], v49 offset:33792
    v_mfma_f32_16x16x32_bf16 v[88:91], a[132:135], a[72:75], v[88:91]
    buffer_load_dwordx4 v7, s[12:15], s28 offen offset:3072 lds
    v_mfma_f32_16x16x32_bf16 v[92:95], a[132:135], a[76:79], v[92:95]
    s_waitcnt lgkmcnt(6)
    v_mfma_f32_16x16x32_bf16 v[96:99], a[136:139], a[64:67], v[96:99]
    ds_read_b64_tr_b16 a[152:153], v50 offset:32768
    v_mfma_f32_16x16x32_bf16 v[100:103], a[136:139], a[68:71], v[100:103]
    ds_read_b64_tr_b16 a[154:155], v50 offset:33792
    v_mfma_f32_16x16x32_bf16 v[104:107], a[136:139], a[72:75], v[104:107]
    buffer_load_dwordx4 a[24:27], v53, s[16:19], s29 offen offset:2048
    v_mfma_f32_16x16x32_bf16 v[108:111], a[136:139], a[76:79], v[108:111]
    s_waitcnt lgkmcnt(6)
    v_mfma_f32_16x16x32_bf16 v[112:115], a[140:143], a[64:67], v[112:115]
    ds_read_b64_tr_b16 a[156:157], v51 offset:32768
    v_mfma_f32_16x16x32_bf16 v[116:119], a[140:143], a[68:71], v[116:119]
    ds_read_b64_tr_b16 a[158:159], v51 offset:33792
    v_mfma_f32_16x16x32_bf16 v[120:123], a[140:143], a[72:75], v[120:123]
    buffer_load_dwordx4 a[28:31], v53, s[16:19], s29 offen offset:2304
    v_mfma_f32_16x16x32_bf16 v[124:127], a[140:143], a[76:79], v[124:127]
    s_waitcnt lgkmcnt(6)
    v_mfma_f32_16x16x32_bf16 v[128:131], a[144:147], a[64:67], v[128:131]
    ds_read_b64_tr_b16 a[128:129], v44 offset:40960
    v_mfma_f32_16x16x32_bf16 v[132:135], a[144:147], a[68:71], v[132:135]
    ds_read_b64_tr_b16 a[130:131], v44 offset:41984
    s_add_u32 s28, s28, 524288
    s_add_u32 m0, s30, 16384
    v_mfma_f32_16x16x32_bf16 v[136:139], a[144:147], a[72:75], v[136:139]
    buffer_load_dwordx4 v4, s[12:15], s28 offen offset:0 lds
    v_mfma_f32_16x16x32_bf16 v[140:143], a[144:147], a[76:79], v[140:143]
    s_waitcnt lgkmcnt(6)
    v_mfma_f32_16x16x32_bf16 v[144:147], a[148:151], a[64:67], v[144:147]
    ds_read_b64_tr_b16 a[132:133], v45 offset:40960
    v_mfma_f32_16x16x32_bf16 v[148:151], a[148:151], a[68:71], v[148:151]
    ds_read_b64_tr_b16 a[134:135], v45 offset:41984
    s_mov_b32 s29, 20480
    v_mfma_f32_16x16x32_bf16 v[152:155], a[148:151], a[72:75], v[152:155]
    buffer_load_dwordx4 a[32:35], v52, s[16:19], s29 offen offset:0
    v_mfma_f32_16x16x32_bf16 v[156:159], a[148:151], a[76:79], v[156:159]
    s_waitcnt lgkmcnt(6)
    v_mfma_f32_16x16x32_bf16 v[160:163], a[152:155], a[64:67], v[160:163]
    ds_read_b64_tr_b16 a[136:137], v46 offset:40960
    v_mfma_f32_16x16x32_bf16 v[164:167], a[152:155], a[68:71], v[164:167]
    ds_read_b64_tr_b16 a[138:139], v46 offset:41984
    v_mfma_f32_16x16x32_bf16 v[168:171], a[152:155], a[72:75], v[168:171]
    buffer_load_dwordx4 a[36:39], v52, s[16:19], s29 offen offset:256
    v_mfma_f32_16x16x32_bf16 v[172:175], a[152:155], a[76:79], v[172:175]
    s_waitcnt lgkmcnt(6)
    v_mfma_f32_16x16x32_bf16 v[176:179], a[156:159], a[64:67], v[176:179]
    ds_read_b64_tr_b16 a[140:141], v47 offset:40960
    v_mfma_f32_16x16x32_bf16 v[180:183], a[156:159], a[68:71], v[180:183]
    ds_read_b64_tr_b16 a[142:143], v47 offset:41984
    v_mfma_f32_16x16x32_bf16 v[184:187], a[156:159], a[72:75], v[184:187]
    buffer_load_dwordx4 v5, s[12:15], s28 offen offset:1024 lds
    v_mfma_f32_16x16x32_bf16 v[188:191], a[156:159], a[76:79], v[188:191]
    s_waitcnt lgkmcnt(6)
    v_mfma_f32_16x16x32_bf16 v[64:67], a[128:131], a[80:83], v[64:67]
    ds_read_b64_tr_b16 a[144:145], v48 offset:40960
    v_mfma_f32_16x16x32_bf16 v[68:71], a[128:131], a[84:87], v[68:71]
    ds_read_b64_tr_b16 a[146:147], v48 offset:41984
    v_mfma_f32_16x16x32_bf16 v[72:75], a[128:131], a[88:91], v[72:75]
    buffer_load_dwordx4 a[40:43], v53, s[16:19], s29 offen offset:0
    v_mfma_f32_16x16x32_bf16 v[76:79], a[128:131], a[92:95], v[76:79]
    s_waitcnt lgkmcnt(6)
    v_mfma_f32_16x16x32_bf16 v[80:83], a[132:135], a[80:83], v[80:83]
    ds_read_b64_tr_b16 a[148:149], v49 offset:40960
    v_mfma_f32_16x16x32_bf16 v[84:87], a[132:135], a[84:87], v[84:87]
    ds_read_b64_tr_b16 a[150:151], v49 offset:41984
    v_mfma_f32_16x16x32_bf16 v[88:91], a[132:135], a[88:91], v[88:91]
    buffer_load_dwordx4 a[44:47], v53, s[16:19], s29 offen offset:256
    v_mfma_f32_16x16x32_bf16 v[92:95], a[132:135], a[92:95], v[92:95]
    s_waitcnt lgkmcnt(6)
    v_mfma_f32_16x16x32_bf16 v[96:99], a[136:139], a[80:83], v[96:99]
    ds_read_b64_tr_b16 a[152:153], v50 offset:40960
    v_mfma_f32_16x16x32_bf16 v[100:103], a[136:139], a[84:87], v[100:103]
    ds_read_b64_tr_b16 a[154:155], v50 offset:41984
    v_mfma_f32_16x16x32_bf16 v[104:107], a[136:139], a[88:91], v[104:107]
    buffer_load_dwordx4 v6, s[12:15], s28 offen offset:2048 lds
    v_mfma_f32_16x16x32_bf16 v[108:111], a[136:139], a[92:95], v[108:111]
    s_waitcnt lgkmcnt(6)
    v_mfma_f32_16x16x32_bf16 v[112:115], a[140:143], a[80:83], v[112:115]
    ds_read_b64_tr_b16 a[156:157], v51 offset:40960
    v_mfma_f32_16x16x32_bf16 v[116:119], a[140:143], a[84:87], v[116:119]
    ds_read_b64_tr_b16 a[158:159], v51 offset:41984
    v_mfma_f32_16x16x32_bf16 v[120:123], a[140:143], a[88:91], v[120:123]
    buffer_load_dwordx4 a[48:51], v52, s[16:19], s29 offen offset:2048
    v_mfma_f32_16x16x32_bf16 v[124:127], a[140:143], a[92:95], v[124:127]
    s_waitcnt vmcnt(20) lgkmcnt(0)
    s_barrier
    v_mfma_f32_16x16x32_bf16 v[128:131], a[144:147], a[80:83], v[128:131]
    ds_read_b64_tr_b16 a[128:129], v44 offset:49152
    v_mfma_f32_16x16x32_bf16 v[132:135], a[144:147], a[84:87], v[132:135]
    ds_read_b64_tr_b16 a[130:131], v44 offset:50176
    v_mfma_f32_16x16x32_bf16 v[136:139], a[144:147], a[88:91], v[136:139]
    buffer_load_dwordx4 a[52:55], v52, s[16:19], s29 offen offset:2304
    v_mfma_f32_16x16x32_bf16 v[140:143], a[144:147], a[92:95], v[140:143]
    s_waitcnt lgkmcnt(6)
    v_mfma_f32_16x16x32_bf16 v[144:147], a[148:151], a[80:83], v[144:147]
    ds_read_b64_tr_b16 a[132:133], v45 offset:49152
    v_mfma_f32_16x16x32_bf16 v[148:151], a[148:151], a[84:87], v[148:151]
    ds_read_b64_tr_b16 a[134:135], v45 offset:50176
    v_mfma_f32_16x16x32_bf16 v[152:155], a[148:151], a[88:91], v[152:155]
    buffer_load_dwordx4 v7, s[12:15], s28 offen offset:3072 lds
    v_mfma_f32_16x16x32_bf16 v[156:159], a[148:151], a[92:95], v[156:159]
    s_waitcnt lgkmcnt(6)
    v_mfma_f32_16x16x32_bf16 v[160:163], a[152:155], a[80:83], v[160:163]
    ds_read_b64_tr_b16 a[136:137], v46 offset:49152
    v_mfma_f32_16x16x32_bf16 v[164:167], a[152:155], a[84:87], v[164:167]
    ds_read_b64_tr_b16 a[138:139], v46 offset:50176
    v_mfma_f32_16x16x32_bf16 v[168:171], a[152:155], a[88:91], v[168:171]
    buffer_load_dwordx4 a[56:59], v53, s[16:19], s29 offen offset:2048
    v_mfma_f32_16x16x32_bf16 v[172:175], a[152:155], a[92:95], v[172:175]
    s_waitcnt lgkmcnt(6)
    v_mfma_f32_16x16x32_bf16 v[176:179], a[156:159], a[80:83], v[176:179]
    ds_read_b64_tr_b16 a[140:141], v47 offset:49152
    v_mfma_f32_16x16x32_bf16 v[180:183], a[156:159], a[84:87], v[180:183]
    ds_read_b64_tr_b16 a[142:143], v47 offset:50176
    v_mfma_f32_16x16x32_bf16 v[184:187], a[156:159], a[88:91], v[184:187]
    buffer_load_dwordx4 a[60:63], v53, s[16:19], s29 offen offset:2304
    v_mfma_f32_16x16x32_bf16 v[188:191], a[156:159], a[92:95], v[188:191]
    s_waitcnt lgkmcnt(6)
    v_mfma_f32_16x16x32_bf16 v[64:67], a[128:131], a[96:99], v[64:67]
    ds_read_b64_tr_b16 a[144:145], v48 offset:49152
    v_mfma_f32_16x16x32_bf16 v[68:71], a[128:131], a[100:103], v[68:71]
    ds_read_b64_tr_b16 a[146:147], v48 offset:50176
    s_add_u32 s28, s28, 524288
    s_add_u32 m0, s30, 32768
    v_mfma_f32_16x16x32_bf16 v[72:75], a[128:131], a[104:107], v[72:75]
    buffer_load_dwordx4 v4, s[12:15], s28 offen offset:0 lds
    v_mfma_f32_16x16x32_bf16 v[76:79], a[128:131], a[108:111], v[76:79]
    s_waitcnt lgkmcnt(6)
    v_mfma_f32_16x16x32_bf16 v[80:83], a[132:135], a[96:99], v[80:83]
    ds_read_b64_tr_b16 a[148:149], v49 offset:49152
    v_mfma_f32_16x16x32_bf16 v[84:87], a[132:135], a[100:103], v[84:87]
    ds_read_b64_tr_b16 a[150:151], v49 offset:50176
    s_mov_b32 s29, 24576
    v_mfma_f32_16x16x32_bf16 v[88:91], a[132:135], a[104:107], v[88:91]
    buffer_load_dwordx4 a[64:67], v52, s[16:19], s29 offen offset:0
    v_mfma_f32_16x16x32_bf16 v[92:95], a[132:135], a[108:111], v[92:95]
    s_waitcnt lgkmcnt(6)
    v_mfma_f32_16x16x32_bf16 v[96:99], a[136:139], a[96:99], v[96:99]
    ds_read_b64_tr_b16 a[152:153], v50 offset:49152
    v_mfma_f32_16x16x32_bf16 v[100:103], a[136:139], a[100:103], v[100:103]
    ds_read_b64_tr_b16 a[154:155], v50 offset:50176
    v_mfma_f32_16x16x32_bf16 v[104:107], a[136:139], a[104:107], v[104:107]
    buffer_load_dwordx4 a[68:71], v52, s[16:19], s29 offen offset:256
    v_mfma_f32_16x16x32_bf16 v[108:111], a[136:139], a[108:111], v[108:111]
    s_waitcnt lgkmcnt(6)
    v_mfma_f32_16x16x32_bf16 v[112:115], a[140:143], a[96:99], v[112:115]
    ds_read_b64_tr_b16 a[156:157], v51 offset:49152
    v_mfma_f32_16x16x32_bf16 v[116:119], a[140:143], a[100:103], v[116:119]
    ds_read_b64_tr_b16 a[158:159], v51 offset:50176
    v_mfma_f32_16x16x32_bf16 v[120:123], a[140:143], a[104:107], v[120:123]
    buffer_load_dwordx4 v5, s[12:15], s28 offen offset:1024 lds
    v_mfma_f32_16x16x32_bf16 v[124:127], a[140:143], a[108:111], v[124:127]
    s_waitcnt lgkmcnt(6)
    v_mfma_f32_16x16x32_bf16 v[128:131], a[144:147], a[96:99], v[128:131]
    ds_read_b64_tr_b16 a[128:129], v44 offset:57344
    v_mfma_f32_16x16x32_bf16 v[132:135], a[144:147], a[100:103], v[132:135]
    ds_read_b64_tr_b16 a[130:131], v44 offset:58368
    v_mfma_f32_16x16x32_bf16 v[136:139], a[144:147], a[104:107], v[136:139]
    buffer_load_dwordx4 a[72:75], v53, s[16:19], s29 offen offset:0
    v_mfma_f32_16x16x32_bf16 v[140:143], a[144:147], a[108:111], v[140:143]
    s_waitcnt lgkmcnt(6)
    v_mfma_f32_16x16x32_bf16 v[144:147], a[148:151], a[96:99], v[144:147]
    ds_read_b64_tr_b16 a[132:133], v45 offset:57344
    v_mfma_f32_16x16x32_bf16 v[148:151], a[148:151], a[100:103], v[148:151]
    ds_read_b64_tr_b16 a[134:135], v45 offset:58368
    v_mfma_f32_16x16x32_bf16 v[152:155], a[148:151], a[104:107], v[152:155]
    buffer_load_dwordx4 a[76:79], v53, s[16:19], s29 offen offset:256
    v_mfma_f32_16x16x32_bf16 v[156:159], a[148:151], a[108:111], v[156:159]
    s_waitcnt lgkmcnt(6)
    v_mfma_f32_16x16x32_bf16 v[160:163], a[152:155], a[96:99], v[160:163]
    ds_read_b64_tr_b16 a[136:137], v46 offset:57344
    v_mfma_f32_16x16x32_bf16 v[164:167], a[152:155], a[100:103], v[164:167]
    ds_read_b64_tr_b16 a[138:139], v46 offset:58368
    v_mfma_f32_16x16x32_bf16 v[168:171], a[152:155], a[104:107], v[168:171]
    buffer_load_dwordx4 v6, s[12:15], s28 offen offset:2048 lds
    v_mfma_f32_16x16x32_bf16 v[172:175], a[152:155], a[108:111], v[172:175]
    s_waitcnt lgkmcnt(6)
    v_mfma_f32_16x16x32_bf16 v[176:179], a[156:159], a[96:99], v[176:179]
    ds_read_b64_tr_b16 a[140:141], v47 offset:57344
    v_mfma_f32_16x16x32_bf16 v[180:183], a[156:159], a[100:103], v[180:183]
    ds_read_b64_tr_b16 a[142:143], v47 offset:58368
    v_mfma_f32_16x16x32_bf16 v[184:187], a[156:159], a[104:107], v[184:187]
    buffer_load_dwordx4 a[80:83], v52, s[16:19], s29 offen offset:2048
    v_mfma_f32_16x16x32_bf16 v[188:191], a[156:159], a[108:111], v[188:191]
    s_waitcnt lgkmcnt(6)
    v_mfma_f32_16x16x32_bf16 v[64:67], a[128:131], a[112:115], v[64:67]
    ds_read_b64_tr_b16 a[144:145], v48 offset:57344
    v_mfma_f32_16x16x32_bf16 v[68:71], a[128:131], a[116:119], v[68:71]
    ds_read_b64_tr_b16 a[146:147], v48 offset:58368
    v_mfma_f32_16x16x32_bf16 v[72:75], a[128:131], a[120:123], v[72:75]
    buffer_load_dwordx4 a[84:87], v52, s[16:19], s29 offen offset:2304
    v_mfma_f32_16x16x32_bf16 v[76:79], a[128:131], a[124:127], v[76:79]
    s_waitcnt lgkmcnt(6)
    v_mfma_f32_16x16x32_bf16 v[80:83], a[132:135], a[112:115], v[80:83]
    ds_read_b64_tr_b16 a[148:149], v49 offset:57344
    v_mfma_f32_16x16x32_bf16 v[84:87], a[132:135], a[116:119], v[84:87]
    ds_read_b64_tr_b16 a[150:151], v49 offset:58368
    v_mfma_f32_16x16x32_bf16 v[88:91], a[132:135], a[120:123], v[88:91]
    buffer_load_dwordx4 v7, s[12:15], s28 offen offset:3072 lds
    v_mfma_f32_16x16x32_bf16 v[92:95], a[132:135], a[124:127], v[92:95]
    s_waitcnt lgkmcnt(6)
    v_mfma_f32_16x16x32_bf16 v[96:99], a[136:139], a[112:115], v[96:99]
    ds_read_b64_tr_b16 a[152:153], v50 offset:57344
    v_mfma_f32_16x16x32_bf16 v[100:103], a[136:139], a[116:119], v[100:103]
    ds_read_b64_tr_b16 a[154:155], v50 offset:58368
    v_mfma_f32_16x16x32_bf16 v[104:107], a[136:139], a[120:123], v[104:107]
    buffer_load_dwordx4 a[88:91], v53, s[16:19], s29 offen offset:2048
    v_mfma_f32_16x16x32_bf16 v[108:111], a[136:139], a[124:127], v[108:111]
    s_waitcnt lgkmcnt(6)
    v_mfma_f32_16x16x32_bf16 v[112:115], a[140:143], a[112:115], v[112:115]
    ds_read_b64_tr_b16 a[156:157], v51 offset:57344
    v_mfma_f32_16x16x32_bf16 v[116:119], a[140:143], a[116:119], v[116:119]
    ds_read_b64_tr_b16 a[158:159], v51 offset:58368
    v_mfma_f32_16x16x32_bf16 v[120:123], a[140:143], a[120:123], v[120:123]
    buffer_load_dwordx4 a[92:95], v53, s[16:19], s29 offen offset:2304
    v_mfma_f32_16x16x32_bf16 v[124:127], a[140:143], a[124:127], v[124:127]
    s_waitcnt vmcnt(24) lgkmcnt(0)
    s_barrier
    v_mfma_f32_16x16x32_bf16 v[128:131], a[144:147], a[112:115], v[128:131]
    ds_read_b64_tr_b16 a[128:129], v44 offset:0
    v_mfma_f32_16x16x32_bf16 v[132:135], a[144:147], a[116:119], v[132:135]
    ds_read_b64_tr_b16 a[130:131], v44 offset:1024
    s_add_u32 s28, s28, 524288
    s_add_u32 m0, s30, 49152
    v_mfma_f32_16x16x32_bf16 v[136:139], a[144:147], a[120:123], v[136:139]
    buffer_load_dwordx4 v4, s[12:15], s28 offen offset:0 lds
    v_mfma_f32_16x16x32_bf16 v[140:143], a[144:147], a[124:127], v[140:143]
    s_waitcnt lgkmcnt(6)
    v_mfma_f32_16x16x32_bf16 v[144:147], a[148:151], a[112:115], v[144:147]
    ds_read_b64_tr_b16 a[132:133], v45 offset:0
    v_mfma_f32_16x16x32_bf16 v[148:151], a[148:151], a[116:119], v[148:151]
    ds_read_b64_tr_b16 a[134:135], v45 offset:1024
    s_mov_b32 s29, 28672
    v_mfma_f32_16x16x32_bf16 v[152:155], a[148:151], a[120:123], v[152:155]
    buffer_load_dwordx4 a[96:99], v52, s[16:19], s29 offen offset:0
    v_mfma_f32_16x16x32_bf16 v[156:159], a[148:151], a[124:127], v[156:159]
    s_waitcnt lgkmcnt(6)
    v_mfma_f32_16x16x32_bf16 v[160:163], a[152:155], a[112:115], v[160:163]
    ds_read_b64_tr_b16 a[136:137], v46 offset:0
    v_mfma_f32_16x16x32_bf16 v[164:167], a[152:155], a[116:119], v[164:167]
    ds_read_b64_tr_b16 a[138:139], v46 offset:1024
    v_mfma_f32_16x16x32_bf16 v[168:171], a[152:155], a[120:123], v[168:171]
    buffer_load_dwordx4 a[100:103], v52, s[16:19], s29 offen offset:256
    v_mfma_f32_16x16x32_bf16 v[172:175], a[152:155], a[124:127], v[172:175]
    s_waitcnt lgkmcnt(6)
    v_mfma_f32_16x16x32_bf16 v[176:179], a[156:159], a[112:115], v[176:179]
    ds_read_b64_tr_b16 a[140:141], v47 offset:0
    v_mfma_f32_16x16x32_bf16 v[180:183], a[156:159], a[116:119], v[180:183]
    ds_read_b64_tr_b16 a[142:143], v47 offset:1024
    v_mfma_f32_16x16x32_bf16 v[184:187], a[156:159], a[120:123], v[184:187]
    buffer_load_dwordx4 v5, s[12:15], s28 offen offset:1024 lds
    v_mfma_f32_16x16x32_bf16 v[188:191], a[156:159], a[124:127], v[188:191]
    s_waitcnt lgkmcnt(6)
    v_mfma_f32_16x16x32_bf16 v[64:67], a[128:131], a[0:3], v[64:67]
    ds_read_b64_tr_b16 a[144:145], v48 offset:0
    v_mfma_f32_16x16x32_bf16 v[68:71], a[128:131], a[4:7], v[68:71]
    ds_read_b64_tr_b16 a[146:147], v48 offset:1024
    v_mfma_f32_16x16x32_bf16 v[72:75], a[128:131], a[8:11], v[72:75]
    buffer_load_dwordx4 a[104:107], v53, s[16:19], s29 offen offset:0
    v_mfma_f32_16x16x32_bf16 v[76:79], a[128:131], a[12:15], v[76:79]
    s_waitcnt lgkmcnt(6)
    v_mfma_f32_16x16x32_bf16 v[80:83], a[132:135], a[0:3], v[80:83]
    ds_read_b64_tr_b16 a[148:149], v49 offset:0
    v_mfma_f32_16x16x32_bf16 v[84:87], a[132:135], a[4:7], v[84:87]
    ds_read_b64_tr_b16 a[150:151], v49 offset:1024
    v_mfma_f32_16x16x32_bf16 v[88:91], a[132:135], a[8:11], v[88:91]
    buffer_load_dwordx4 a[108:111], v53, s[16:19], s29 offen offset:256
    v_mfma_f32_16x16x32_bf16 v[92:95], a[132:135], a[12:15], v[92:95]
    s_waitcnt lgkmcnt(6)
    v_mfma_f32_16x16x32_bf16 v[96:99], a[136:139], a[0:3], v[96:99]
    ds_read_b64_tr_b16 a[152:153], v50 offset:0
    v_mfma_f32_16x16x32_bf16 v[100:103], a[136:139], a[4:7], v[100:103]
    ds_read_b64_tr_b16 a[154:155], v50 offset:1024
    v_mfma_f32_16x16x32_bf16 v[104:107], a[136:139], a[8:11], v[104:107]
    buffer_load_dwordx4 v6, s[12:15], s28 offen offset:2048 lds
    v_mfma_f32_16x16x32_bf16 v[108:111], a[136:139], a[12:15], v[108:111]
    s_waitcnt lgkmcnt(6)
    v_mfma_f32_16x16x32_bf16 v[112:115], a[140:143], a[0:3], v[112:115]
    ds_read_b64_tr_b16 a[156:157], v51 offset:0
    v_mfma_f32_16x16x32_bf16 v[116:119], a[140:143], a[4:7], v[116:119]
    ds_read_b64_tr_b16 a[158:159], v51 offset:1024
    v_mfma_f32_16x16x32_bf16 v[120:123], a[140:143], a[8:11], v[120:123]
    buffer_load_dwordx4 a[112:115], v52, s[16:19], s29 offen offset:2048
    v_mfma_f32_16x16x32_bf16 v[124:127], a[140:143], a[12:15], v[124:127]
    s_waitcnt lgkmcnt(6)
    v_mfma_f32_16x16x32_bf16 v[128:131], a[144:147], a[0:3], v[128:131]
    ds_read_b64_tr_b16 a[128:129], v44 offset:8192
    v_mfma_f32_16x16x32_bf16 v[132:135], a[144:147], a[4:7], v[132:135]
    ds_read_b64_tr_b16 a[130:131], v44 offset:9216
    v_mfma_f32_16x16x32_bf16 v[136:139], a[144:147], a[8:11], v[136:139]
    buffer_load_dwordx4 a[116:119], v52, s[16:19], s29 offen offset:2304
    v_mfma_f32_16x16x32_bf16 v[140:143], a[144:147], a[12:15], v[140:143]
    s_waitcnt lgkmcnt(6)
    v_mfma_f32_16x16x32_bf16 v[144:147], a[148:151], a[0:3], v[144:147]
    ds_read_b64_tr_b16 a[132:133], v45 offset:8192
    v_mfma_f32_16x16x32_bf16 v[148:151], a[148:151], a[4:7], v[148:151]
    ds_read_b64_tr_b16 a[134:135], v45 offset:9216
    v_mfma_f32_16x16x32_bf16 v[152:155], a[148:151], a[8:11], v[152:155]
    buffer_load_dwordx4 v7, s[12:15], s28 offen offset:3072 lds
    v_mfma_f32_16x16x32_bf16 v[156:159], a[148:151], a[12:15], v[156:159]
    s_waitcnt lgkmcnt(6)
    v_mfma_f32_16x16x32_bf16 v[160:163], a[152:155], a[0:3], v[160:163]
    ds_read_b64_tr_b16 a[136:137], v46 offset:8192
    v_mfma_f32_16x16x32_bf16 v[164:167], a[152:155], a[4:7], v[164:167]
    ds_read_b64_tr_b16 a[138:139], v46 offset:9216
    v_mfma_f32_16x16x32_bf16 v[168:171], a[152:155], a[8:11], v[168:171]
    buffer_load_dwordx4 a[120:123], v53, s[16:19], s29 offen offset:2048
    v_mfma_f32_16x16x32_bf16 v[172:175], a[152:155], a[12:15], v[172:175]
    s_waitcnt lgkmcnt(6)
    v_mfma_f32_16x16x32_bf16 v[176:179], a[156:159], a[0:3], v[176:179]
    ds_read_b64_tr_b16 a[140:141], v47 offset:8192
    v_mfma_f32_16x16x32_bf16 v[180:183], a[156:159], a[4:7], v[180:183]
    ds_read_b64_tr_b16 a[142:143], v47 offset:9216
    v_mfma_f32_16x16x32_bf16 v[184:187], a[156:159], a[8:11], v[184:187]
    buffer_load_dwordx4 a[124:127], v53, s[16:19], s29 offen offset:2304
    v_mfma_f32_16x16x32_bf16 v[188:191], a[156:159], a[12:15], v[188:191]
    s_waitcnt lgkmcnt(6)
    v_mfma_f32_16x16x32_bf16 v[64:67], a[128:131], a[16:19], v[64:67]
    ds_read_b64_tr_b16 a[144:145], v48 offset:8192
    v_mfma_f32_16x16x32_bf16 v[68:71], a[128:131], a[20:23], v[68:71]
    ds_read_b64_tr_b16 a[146:147], v48 offset:9216
    s_add_u32 m0, s30, 65536
    v_mfma_f32_16x16x32_bf16 v[72:75], a[128:131], a[24:27], v[72:75]
    buffer_load_dwordx4 v12, s[32:35], s44 offen offset:0 lds
    v_mfma_f32_16x16x32_bf16 v[76:79], a[128:131], a[28:31], v[76:79]
    s_waitcnt lgkmcnt(6)
    v_mfma_f32_16x16x32_bf16 v[80:83], a[132:135], a[16:19], v[80:83]
    ds_read_b64_tr_b16 a[148:149], v49 offset:8192
    v_mfma_f32_16x16x32_bf16 v[84:87], a[132:135], a[20:23], v[84:87]
    ds_read_b64_tr_b16 a[150:151], v49 offset:9216
    v_mfma_f32_16x16x32_bf16 v[88:91], a[132:135], a[24:27], v[88:91]
    buffer_load_dwordx4 v13, s[32:35], s44 offen offset:1024 lds
    v_mfma_f32_16x16x32_bf16 v[92:95], a[132:135], a[28:31], v[92:95]
    s_waitcnt lgkmcnt(6)
    v_mfma_f32_16x16x32_bf16 v[96:99], a[136:139], a[16:19], v[96:99]
    ds_read_b64_tr_b16 a[152:153], v50 offset:8192
    v_mfma_f32_16x16x32_bf16 v[100:103], a[136:139], a[20:23], v[100:103]
    ds_read_b64_tr_b16 a[154:155], v50 offset:9216
    v_mfma_f32_16x16x32_bf16 v[104:107], a[136:139], a[24:27], v[104:107]
    buffer_load_dwordx4 v14, s[32:35], s44 offen offset:2048 lds
    v_mfma_f32_16x16x32_bf16 v[108:111], a[136:139], a[28:31], v[108:111]
    s_waitcnt lgkmcnt(6)
    v_mfma_f32_16x16x32_bf16 v[112:115], a[140:143], a[16:19], v[112:115]
    ds_read_b64_tr_b16 a[156:157], v51 offset:8192
    v_mfma_f32_16x16x32_bf16 v[116:119], a[140:143], a[20:23], v[116:119]
    ds_read_b64_tr_b16 a[158:159], v51 offset:9216
    v_mfma_f32_16x16x32_bf16 v[120:123], a[140:143], a[24:27], v[120:123]
    buffer_load_dwordx4 v15, s[32:35], s44 offen offset:3072 lds
    v_mfma_f32_16x16x32_bf16 v[124:127], a[140:143], a[28:31], v[124:127]
    s_waitcnt vmcnt(28) lgkmcnt(0)
    s_barrier
    v_mfma_f32_16x16x32_bf16 v[128:131], a[144:147], a[16:19], v[128:131]
    ds_read_b64_tr_b16 a[128:129], v44 offset:16384
    v_mfma_f32_16x16x32_bf16 v[132:135], a[144:147], a[20:23], v[132:135]
    ds_read_b64_tr_b16 a[130:131], v44 offset:17408
    s_add_u32 s28, s28, 524288
    s_add_u32 m0, s30, 0
    v_mfma_f32_16x16x32_bf16 v[136:139], a[144:147], a[24:27], v[136:139]
    buffer_load_dwordx4 v4, s[12:15], s28 offen offset:0 lds
    v_mfma_f32_16x16x32_bf16 v[140:143], a[144:147], a[28:31], v[140:143]
    s_waitcnt lgkmcnt(6)
    v_mfma_f32_16x16x32_bf16 v[144:147], a[148:151], a[16:19], v[144:147]
    ds_read_b64_tr_b16 a[132:133], v45 offset:16384
    v_mfma_f32_16x16x32_bf16 v[148:151], a[148:151], a[20:23], v[148:151]
    ds_read_b64_tr_b16 a[134:135], v45 offset:17408
    s_mov_b32 s29, 32768
    v_mfma_f32_16x16x32_bf16 v[152:155], a[148:151], a[24:27], v[152:155]
    buffer_load_dwordx4 a[0:3], v52, s[16:19], s29 offen offset:0
    v_mfma_f32_16x16x32_bf16 v[156:159], a[148:151], a[28:31], v[156:159]
    s_waitcnt lgkmcnt(6)
    v_mfma_f32_16x16x32_bf16 v[160:163], a[152:155], a[16:19], v[160:163]
    ds_read_b64_tr_b16 a[136:137], v46 offset:16384
    v_mfma_f32_16x16x32_bf16 v[164:167], a[152:155], a[20:23], v[164:167]
    ds_read_b64_tr_b16 a[138:139], v46 offset:17408
    v_mfma_f32_16x16x32_bf16 v[168:171], a[152:155], a[24:27], v[168:171]
    buffer_load_dwordx4 a[4:7], v52, s[16:19], s29 offen offset:256
    v_mfma_f32_16x16x32_bf16 v[172:175], a[152:155], a[28:31], v[172:175]
    s_waitcnt lgkmcnt(6)
    v_mfma_f32_16x16x32_bf16 v[176:179], a[156:159], a[16:19], v[176:179]
    ds_read_b64_tr_b16 a[140:141], v47 offset:16384
    v_mfma_f32_16x16x32_bf16 v[180:183], a[156:159], a[20:23], v[180:183]
    ds_read_b64_tr_b16 a[142:143], v47 offset:17408
    v_mfma_f32_16x16x32_bf16 v[184:187], a[156:159], a[24:27], v[184:187]
    buffer_load_dwordx4 v5, s[12:15], s28 offen offset:1024 lds
    v_mfma_f32_16x16x32_bf16 v[188:191], a[156:159], a[28:31], v[188:191]
    s_waitcnt lgkmcnt(6)
    v_mfma_f32_16x16x32_bf16 v[64:67], a[128:131], a[32:35], v[64:67]
    ds_read_b64_tr_b16 a[144:145], v48 offset:16384
    v_mfma_f32_16x16x32_bf16 v[68:71], a[128:131], a[36:39], v[68:71]
    ds_read_b64_tr_b16 a[146:147], v48 offset:17408
    v_mfma_f32_16x16x32_bf16 v[72:75], a[128:131], a[40:43], v[72:75]
    buffer_load_dwordx4 a[8:11], v53, s[16:19], s29 offen offset:0
    v_mfma_f32_16x16x32_bf16 v[76:79], a[128:131], a[44:47], v[76:79]
    s_waitcnt lgkmcnt(6)
    v_mfma_f32_16x16x32_bf16 v[80:83], a[132:135], a[32:35], v[80:83]
    ds_read_b64_tr_b16 a[148:149], v49 offset:16384
    v_mfma_f32_16x16x32_bf16 v[84:87], a[132:135], a[36:39], v[84:87]
    ds_read_b64_tr_b16 a[150:151], v49 offset:17408
    v_mfma_f32_16x16x32_bf16 v[88:91], a[132:135], a[40:43], v[88:91]
    buffer_load_dwordx4 a[12:15], v53, s[16:19], s29 offen offset:256
    v_mfma_f32_16x16x32_bf16 v[92:95], a[132:135], a[44:47], v[92:95]
    s_waitcnt lgkmcnt(6)
    v_mfma_f32_16x16x32_bf16 v[96:99], a[136:139], a[32:35], v[96:99]
    ds_read_b64_tr_b16 a[152:153], v50 offset:16384
    v_mfma_f32_16x16x32_bf16 v[100:103], a[136:139], a[36:39], v[100:103]
    ds_read_b64_tr_b16 a[154:155], v50 offset:17408
    v_mfma_f32_16x16x32_bf16 v[104:107], a[136:139], a[40:43], v[104:107]
    buffer_load_dwordx4 v6, s[12:15], s28 offen offset:2048 lds
    v_mfma_f32_16x16x32_bf16 v[108:111], a[136:139], a[44:47], v[108:111]
    s_waitcnt lgkmcnt(6)
    v_mfma_f32_16x16x32_bf16 v[112:115], a[140:143], a[32:35], v[112:115]
    ds_read_b64_tr_b16 a[156:157], v51 offset:16384
    v_mfma_f32_16x16x32_bf16 v[116:119], a[140:143], a[36:39], v[116:119]
    ds_read_b64_tr_b16 a[158:159], v51 offset:17408
    v_mfma_f32_16x16x32_bf16 v[120:123], a[140:143], a[40:43], v[120:123]
    buffer_load_dwordx4 a[16:19], v52, s[16:19], s29 offen offset:2048
    v_mfma_f32_16x16x32_bf16 v[124:127], a[140:143], a[44:47], v[124:127]
    s_waitcnt lgkmcnt(6)
    v_mfma_f32_16x16x32_bf16 v[128:131], a[144:147], a[32:35], v[128:131]
    ds_read_b64_tr_b16 a[128:129], v44 offset:24576
    v_mfma_f32_16x16x32_bf16 v[132:135], a[144:147], a[36:39], v[132:135]
    ds_read_b64_tr_b16 a[130:131], v44 offset:25600
    v_mfma_f32_16x16x32_bf16 v[136:139], a[144:147], a[40:43], v[136:139]
    buffer_load_dwordx4 a[20:23], v52, s[16:19], s29 offen offset:2304
    v_mfma_f32_16x16x32_bf16 v[140:143], a[144:147], a[44:47], v[140:143]
    s_waitcnt lgkmcnt(6)
    v_mfma_f32_16x16x32_bf16 v[144:147], a[148:151], a[32:35], v[144:147]
    ds_read_b64_tr_b16 a[132:133], v45 offset:24576
    v_mfma_f32_16x16x32_bf16 v[148:151], a[148:151], a[36:39], v[148:151]
    ds_read_b64_tr_b16 a[134:135], v45 offset:25600
    v_mfma_f32_16x16x32_bf16 v[152:155], a[148:151], a[40:43], v[152:155]
    buffer_load_dwordx4 v7, s[12:15], s28 offen offset:3072 lds
    v_mfma_f32_16x16x32_bf16 v[156:159], a[148:151], a[44:47], v[156:159]
    s_waitcnt lgkmcnt(6)
    v_mfma_f32_16x16x32_bf16 v[160:163], a[152:155], a[32:35], v[160:163]
    ds_read_b64_tr_b16 a[136:137], v46 offset:24576
    v_mfma_f32_16x16x32_bf16 v[164:167], a[152:155], a[36:39], v[164:167]
    ds_read_b64_tr_b16 a[138:139], v46 offset:25600
    v_mfma_f32_16x16x32_bf16 v[168:171], a[152:155], a[40:43], v[168:171]
    buffer_load_dwordx4 a[24:27], v53, s[16:19], s29 offen offset:2048
    v_mfma_f32_16x16x32_bf16 v[172:175], a[152:155], a[44:47], v[172:175]
    s_waitcnt lgkmcnt(6)
    v_mfma_f32_16x16x32_bf16 v[176:179], a[156:159], a[32:35], v[176:179]
    ds_read_b64_tr_b16 a[140:141], v47 offset:24576
    v_mfma_f32_16x16x32_bf16 v[180:183], a[156:159], a[36:39], v[180:183]
    ds_read_b64_tr_b16 a[142:143], v47 offset:25600
    v_mfma_f32_16x16x32_bf16 v[184:187], a[156:159], a[40:43], v[184:187]
    buffer_load_dwordx4 a[28:31], v53, s[16:19], s29 offen offset:2304
    v_mfma_f32_16x16x32_bf16 v[188:191], a[156:159], a[44:47], v[188:191]
    s_waitcnt lgkmcnt(6)
    v_mfma_f32_16x16x32_bf16 v[64:67], a[128:131], a[48:51], v[64:67]
    ds_read_b64_tr_b16 a[144:145], v48 offset:24576
    v_mfma_f32_16x16x32_bf16 v[68:71], a[128:131], a[52:55], v[68:71]
    ds_read_b64_tr_b16 a[146:147], v48 offset:25600
    v_mfma_f32_16x16x32_bf16 v[72:75], a[128:131], a[56:59], v[72:75]
    v_mfma_f32_16x16x32_bf16 v[76:79], a[128:131], a[60:63], v[76:79]
    s_waitcnt lgkmcnt(6)
    v_mfma_f32_16x16x32_bf16 v[80:83], a[132:135], a[48:51], v[80:83]
    ds_read_b64_tr_b16 a[148:149], v49 offset:24576
    v_mfma_f32_16x16x32_bf16 v[84:87], a[132:135], a[52:55], v[84:87]
    ds_read_b64_tr_b16 a[150:151], v49 offset:25600
    v_mfma_f32_16x16x32_bf16 v[88:91], a[132:135], a[56:59], v[88:91]
    v_mfma_f32_16x16x32_bf16 v[92:95], a[132:135], a[60:63], v[92:95]
    s_waitcnt lgkmcnt(6)
    v_mfma_f32_16x16x32_bf16 v[96:99], a[136:139], a[48:51], v[96:99]
    ds_read_b64_tr_b16 a[152:153], v50 offset:24576
    v_mfma_f32_16x16x32_bf16 v[100:103], a[136:139], a[52:55], v[100:103]
    ds_read_b64_tr_b16 a[154:155], v50 offset:25600
    v_mfma_f32_16x16x32_bf16 v[104:107], a[136:139], a[56:59], v[104:107]
    v_mfma_f32_16x16x32_bf16 v[108:111], a[136:139], a[60:63], v[108:111]
    s_waitcnt lgkmcnt(6)
    v_mfma_f32_16x16x32_bf16 v[112:115], a[140:143], a[48:51], v[112:115]
    ds_read_b64_tr_b16 a[156:157], v51 offset:24576
    v_mfma_f32_16x16x32_bf16 v[116:119], a[140:143], a[52:55], v[116:119]
    ds_read_b64_tr_b16 a[158:159], v51 offset:25600
    v_mfma_f32_16x16x32_bf16 v[120:123], a[140:143], a[56:59], v[120:123]
    v_mfma_f32_16x16x32_bf16 v[124:127], a[140:143], a[60:63], v[124:127]
    s_waitcnt vmcnt(28) lgkmcnt(0)
    s_barrier
    v_mfma_f32_16x16x32_bf16 v[128:131], a[144:147], a[48:51], v[128:131]
    ds_read_b64_tr_b16 a[128:129], v44 offset:32768
    v_mfma_f32_16x16x32_bf16 v[132:135], a[144:147], a[52:55], v[132:135]
    ds_read_b64_tr_b16 a[130:131], v44 offset:33792
    s_add_u32 s28, s28, 524288
    s_add_u32 m0, s30, 16384
    v_mfma_f32_16x16x32_bf16 v[136:139], a[144:147], a[56:59], v[136:139]
    buffer_load_dwordx4 v4, s[12:15], s28 offen offset:0 lds
    v_mfma_f32_16x16x32_bf16 v[140:143], a[144:147], a[60:63], v[140:143]
    s_waitcnt lgkmcnt(6)
    v_mfma_f32_16x16x32_bf16 v[144:147], a[148:151], a[48:51], v[144:147]
    ds_read_b64_tr_b16 a[132:133], v45 offset:32768
    v_mfma_f32_16x16x32_bf16 v[148:151], a[148:151], a[52:55], v[148:151]
    ds_read_b64_tr_b16 a[134:135], v45 offset:33792
    s_mov_b32 s29, 36864
    v_mfma_f32_16x16x32_bf16 v[152:155], a[148:151], a[56:59], v[152:155]
    buffer_load_dwordx4 a[32:35], v52, s[16:19], s29 offen offset:0
    v_mfma_f32_16x16x32_bf16 v[156:159], a[148:151], a[60:63], v[156:159]
    s_waitcnt lgkmcnt(6)
    v_mfma_f32_16x16x32_bf16 v[160:163], a[152:155], a[48:51], v[160:163]
    ds_read_b64_tr_b16 a[136:137], v46 offset:32768
    v_mfma_f32_16x16x32_bf16 v[164:167], a[152:155], a[52:55], v[164:167]
    ds_read_b64_tr_b16 a[138:139], v46 offset:33792
    v_mfma_f32_16x16x32_bf16 v[168:171], a[152:155], a[56:59], v[168:171]
    buffer_load_dwordx4 a[36:39], v52, s[16:19], s29 offen offset:256
    v_mfma_f32_16x16x32_bf16 v[172:175], a[152:155], a[60:63], v[172:175]
    s_waitcnt lgkmcnt(6)
    v_mfma_f32_16x16x32_bf16 v[176:179], a[156:159], a[48:51], v[176:179]
    ds_read_b64_tr_b16 a[140:141], v47 offset:32768
    v_mfma_f32_16x16x32_bf16 v[180:183], a[156:159], a[52:55], v[180:183]
    ds_read_b64_tr_b16 a[142:143], v47 offset:33792
    v_mfma_f32_16x16x32_bf16 v[184:187], a[156:159], a[56:59], v[184:187]
    buffer_load_dwordx4 v5, s[12:15], s28 offen offset:1024 lds
    v_mfma_f32_16x16x32_bf16 v[188:191], a[156:159], a[60:63], v[188:191]
    s_waitcnt lgkmcnt(6)
    v_mfma_f32_16x16x32_bf16 v[64:67], a[128:131], a[64:67], v[64:67]
    ds_read_b64_tr_b16 a[144:145], v48 offset:32768
    v_mfma_f32_16x16x32_bf16 v[68:71], a[128:131], a[68:71], v[68:71]
    ds_read_b64_tr_b16 a[146:147], v48 offset:33792
    v_mfma_f32_16x16x32_bf16 v[72:75], a[128:131], a[72:75], v[72:75]
    buffer_load_dwordx4 a[40:43], v53, s[16:19], s29 offen offset:0
    v_mfma_f32_16x16x32_bf16 v[76:79], a[128:131], a[76:79], v[76:79]
    s_waitcnt lgkmcnt(6)
    v_mfma_f32_16x16x32_bf16 v[80:83], a[132:135], a[64:67], v[80:83]
    ds_read_b64_tr_b16 a[148:149], v49 offset:32768
    v_mfma_f32_16x16x32_bf16 v[84:87], a[132:135], a[68:71], v[84:87]
    ds_read_b64_tr_b16 a[150:151], v49 offset:33792
    v_mfma_f32_16x16x32_bf16 v[88:91], a[132:135], a[72:75], v[88:91]
    buffer_load_dwordx4 a[44:47], v53, s[16:19], s29 offen offset:256
    v_mfma_f32_16x16x32_bf16 v[92:95], a[132:135], a[76:79], v[92:95]
    s_waitcnt lgkmcnt(6)
    v_mfma_f32_16x16x32_bf16 v[96:99], a[136:139], a[64:67], v[96:99]
    ds_read_b64_tr_b16 a[152:153], v50 offset:32768
    v_mfma_f32_16x16x32_bf16 v[100:103], a[136:139], a[68:71], v[100:103]
    ds_read_b64_tr_b16 a[154:155], v50 offset:33792
    v_mfma_f32_16x16x32_bf16 v[104:107], a[136:139], a[72:75], v[104:107]
    buffer_load_dwordx4 v6, s[12:15], s28 offen offset:2048 lds
    v_mfma_f32_16x16x32_bf16 v[108:111], a[136:139], a[76:79], v[108:111]
    s_waitcnt lgkmcnt(6)
    v_mfma_f32_16x16x32_bf16 v[112:115], a[140:143], a[64:67], v[112:115]
    ds_read_b64_tr_b16 a[156:157], v51 offset:32768
    v_mfma_f32_16x16x32_bf16 v[116:119], a[140:143], a[68:71], v[116:119]
    ds_read_b64_tr_b16 a[158:159], v51 offset:33792
    v_mfma_f32_16x16x32_bf16 v[120:123], a[140:143], a[72:75], v[120:123]
    buffer_load_dwordx4 a[48:51], v52, s[16:19], s29 offen offset:2048
    v_mfma_f32_16x16x32_bf16 v[124:127], a[140:143], a[76:79], v[124:127]
    s_waitcnt lgkmcnt(6)
    v_mfma_f32_16x16x32_bf16 v[128:131], a[144:147], a[64:67], v[128:131]
    ds_read_b64_tr_b16 a[128:129], v44 offset:40960
    v_mfma_f32_16x16x32_bf16 v[132:135], a[144:147], a[68:71], v[132:135]
    ds_read_b64_tr_b16 a[130:131], v44 offset:41984
    v_mfma_f32_16x16x32_bf16 v[136:139], a[144:147], a[72:75], v[136:139]
    buffer_load_dwordx4 a[52:55], v52, s[16:19], s29 offen offset:2304
    v_mfma_f32_16x16x32_bf16 v[140:143], a[144:147], a[76:79], v[140:143]
    s_waitcnt lgkmcnt(6)
    v_mfma_f32_16x16x32_bf16 v[144:147], a[148:151], a[64:67], v[144:147]
    ds_read_b64_tr_b16 a[132:133], v45 offset:40960
    v_mfma_f32_16x16x32_bf16 v[148:151], a[148:151], a[68:71], v[148:151]
    ds_read_b64_tr_b16 a[134:135], v45 offset:41984
    v_mfma_f32_16x16x32_bf16 v[152:155], a[148:151], a[72:75], v[152:155]
    buffer_load_dwordx4 v7, s[12:15], s28 offen offset:3072 lds
    v_mfma_f32_16x16x32_bf16 v[156:159], a[148:151], a[76:79], v[156:159]
    s_waitcnt lgkmcnt(6)
    v_mfma_f32_16x16x32_bf16 v[160:163], a[152:155], a[64:67], v[160:163]
    ds_read_b64_tr_b16 a[136:137], v46 offset:40960
    v_mfma_f32_16x16x32_bf16 v[164:167], a[152:155], a[68:71], v[164:167]
    ds_read_b64_tr_b16 a[138:139], v46 offset:41984
    v_mfma_f32_16x16x32_bf16 v[168:171], a[152:155], a[72:75], v[168:171]
    buffer_load_dwordx4 a[56:59], v53, s[16:19], s29 offen offset:2048
    v_mfma_f32_16x16x32_bf16 v[172:175], a[152:155], a[76:79], v[172:175]
    s_waitcnt lgkmcnt(6)
    v_mfma_f32_16x16x32_bf16 v[176:179], a[156:159], a[64:67], v[176:179]
    ds_read_b64_tr_b16 a[140:141], v47 offset:40960
    v_mfma_f32_16x16x32_bf16 v[180:183], a[156:159], a[68:71], v[180:183]
    ds_read_b64_tr_b16 a[142:143], v47 offset:41984
    v_mfma_f32_16x16x32_bf16 v[184:187], a[156:159], a[72:75], v[184:187]
    buffer_load_dwordx4 a[60:63], v53, s[16:19], s29 offen offset:2304
    v_mfma_f32_16x16x32_bf16 v[188:191], a[156:159], a[76:79], v[188:191]
    s_waitcnt lgkmcnt(6)
    v_mfma_f32_16x16x32_bf16 v[64:67], a[128:131], a[80:83], v[64:67]
    ds_read_b64_tr_b16 a[144:145], v48 offset:40960
    v_mfma_f32_16x16x32_bf16 v[68:71], a[128:131], a[84:87], v[68:71]
    ds_read_b64_tr_b16 a[146:147], v48 offset:41984
    s_add_u32 m0, s30, 81920
    v_mfma_f32_16x16x32_bf16 v[72:75], a[128:131], a[88:91], v[72:75]
    buffer_load_dwordx4 v12, s[32:35], s45 offen offset:0 lds
    v_mfma_f32_16x16x32_bf16 v[76:79], a[128:131], a[92:95], v[76:79]
    s_waitcnt lgkmcnt(6)
    v_mfma_f32_16x16x32_bf16 v[80:83], a[132:135], a[80:83], v[80:83]
    ds_read_b64_tr_b16 a[148:149], v49 offset:40960
    v_mfma_f32_16x16x32_bf16 v[84:87], a[132:135], a[84:87], v[84:87]
    ds_read_b64_tr_b16 a[150:151], v49 offset:41984
    v_mfma_f32_16x16x32_bf16 v[88:91], a[132:135], a[88:91], v[88:91]
    buffer_load_dwordx4 v13, s[32:35], s45 offen offset:1024 lds
    v_mfma_f32_16x16x32_bf16 v[92:95], a[132:135], a[92:95], v[92:95]
    s_waitcnt lgkmcnt(6)
    v_mfma_f32_16x16x32_bf16 v[96:99], a[136:139], a[80:83], v[96:99]
    ds_read_b64_tr_b16 a[152:153], v50 offset:40960
    v_mfma_f32_16x16x32_bf16 v[100:103], a[136:139], a[84:87], v[100:103]
    ds_read_b64_tr_b16 a[154:155], v50 offset:41984
    v_mfma_f32_16x16x32_bf16 v[104:107], a[136:139], a[88:91], v[104:107]
    buffer_load_dwordx4 v14, s[32:35], s45 offen offset:2048 lds
    v_mfma_f32_16x16x32_bf16 v[108:111], a[136:139], a[92:95], v[108:111]
    s_waitcnt lgkmcnt(6)
    v_mfma_f32_16x16x32_bf16 v[112:115], a[140:143], a[80:83], v[112:115]
    ds_read_b64_tr_b16 a[156:157], v51 offset:40960
    v_mfma_f32_16x16x32_bf16 v[116:119], a[140:143], a[84:87], v[116:119]
    ds_read_b64_tr_b16 a[158:159], v51 offset:41984
    v_mfma_f32_16x16x32_bf16 v[120:123], a[140:143], a[88:91], v[120:123]
    buffer_load_dwordx4 v15, s[32:35], s45 offen offset:3072 lds
    v_mfma_f32_16x16x32_bf16 v[124:127], a[140:143], a[92:95], v[124:127]
    s_waitcnt vmcnt(32) lgkmcnt(0)
    s_barrier
    v_mfma_f32_16x16x32_bf16 v[128:131], a[144:147], a[80:83], v[128:131]
    ds_read_b64_tr_b16 a[128:129], v44 offset:49152
    v_mfma_f32_16x16x32_bf16 v[132:135], a[144:147], a[84:87], v[132:135]
    ds_read_b64_tr_b16 a[130:131], v44 offset:50176
    s_add_u32 s28, s28, 524288
    s_add_u32 m0, s30, 32768
    v_mfma_f32_16x16x32_bf16 v[136:139], a[144:147], a[88:91], v[136:139]
    buffer_load_dwordx4 v4, s[12:15], s28 offen offset:0 lds
    v_mfma_f32_16x16x32_bf16 v[140:143], a[144:147], a[92:95], v[140:143]
    s_waitcnt lgkmcnt(6)
    v_mfma_f32_16x16x32_bf16 v[144:147], a[148:151], a[80:83], v[144:147]
    ds_read_b64_tr_b16 a[132:133], v45 offset:49152
    v_mfma_f32_16x16x32_bf16 v[148:151], a[148:151], a[84:87], v[148:151]
    ds_read_b64_tr_b16 a[134:135], v45 offset:50176
    s_mov_b32 s29, 40960
    v_mfma_f32_16x16x32_bf16 v[152:155], a[148:151], a[88:91], v[152:155]
    buffer_load_dwordx4 a[64:67], v52, s[16:19], s29 offen offset:0
    v_mfma_f32_16x16x32_bf16 v[156:159], a[148:151], a[92:95], v[156:159]
    s_waitcnt lgkmcnt(6)
    v_mfma_f32_16x16x32_bf16 v[160:163], a[152:155], a[80:83], v[160:163]
    ds_read_b64_tr_b16 a[136:137], v46 offset:49152
    v_mfma_f32_16x16x32_bf16 v[164:167], a[152:155], a[84:87], v[164:167]
    ds_read_b64_tr_b16 a[138:139], v46 offset:50176
    v_mfma_f32_16x16x32_bf16 v[168:171], a[152:155], a[88:91], v[168:171]
    buffer_load_dwordx4 a[68:71], v52, s[16:19], s29 offen offset:256
    v_mfma_f32_16x16x32_bf16 v[172:175], a[152:155], a[92:95], v[172:175]
    s_waitcnt lgkmcnt(6)
    v_mfma_f32_16x16x32_bf16 v[176:179], a[156:159], a[80:83], v[176:179]
    ds_read_b64_tr_b16 a[140:141], v47 offset:49152
    v_mfma_f32_16x16x32_bf16 v[180:183], a[156:159], a[84:87], v[180:183]
    ds_read_b64_tr_b16 a[142:143], v47 offset:50176
    v_mfma_f32_16x16x32_bf16 v[184:187], a[156:159], a[88:91], v[184:187]
    buffer_load_dwordx4 v5, s[12:15], s28 offen offset:1024 lds
    v_mfma_f32_16x16x32_bf16 v[188:191], a[156:159], a[92:95], v[188:191]
    s_waitcnt lgkmcnt(6)
    v_mfma_f32_16x16x32_bf16 v[64:67], a[128:131], a[96:99], v[64:67]
    ds_read_b64_tr_b16 a[144:145], v48 offset:49152
    v_mfma_f32_16x16x32_bf16 v[68:71], a[128:131], a[100:103], v[68:71]
    ds_read_b64_tr_b16 a[146:147], v48 offset:50176
    v_mfma_f32_16x16x32_bf16 v[72:75], a[128:131], a[104:107], v[72:75]
    buffer_load_dwordx4 a[72:75], v53, s[16:19], s29 offen offset:0
    v_mfma_f32_16x16x32_bf16 v[76:79], a[128:131], a[108:111], v[76:79]
    s_waitcnt lgkmcnt(6)
    v_mfma_f32_16x16x32_bf16 v[80:83], a[132:135], a[96:99], v[80:83]
    ds_read_b64_tr_b16 a[148:149], v49 offset:49152
    v_mfma_f32_16x16x32_bf16 v[84:87], a[132:135], a[100:103], v[84:87]
    ds_read_b64_tr_b16 a[150:151], v49 offset:50176
    v_mfma_f32_16x16x32_bf16 v[88:91], a[132:135], a[104:107], v[88:91]
    buffer_load_dwordx4 a[76:79], v53, s[16:19], s29 offen offset:256
    v_mfma_f32_16x16x32_bf16 v[92:95], a[132:135], a[108:111], v[92:95]
    s_waitcnt lgkmcnt(6)
    v_mfma_f32_16x16x32_bf16 v[96:99], a[136:139], a[96:99], v[96:99]
    ds_read_b64_tr_b16 a[152:153], v50 offset:49152
    v_mfma_f32_16x16x32_bf16 v[100:103], a[136:139], a[100:103], v[100:103]
    ds_read_b64_tr_b16 a[154:155], v50 offset:50176
    v_mfma_f32_16x16x32_bf16 v[104:107], a[136:139], a[104:107], v[104:107]
    buffer_load_dwordx4 v6, s[12:15], s28 offen offset:2048 lds
    v_mfma_f32_16x16x32_bf16 v[108:111], a[136:139], a[108:111], v[108:111]
    s_waitcnt lgkmcnt(6)
    v_mfma_f32_16x16x32_bf16 v[112:115], a[140:143], a[96:99], v[112:115]
    ds_read_b64_tr_b16 a[156:157], v51 offset:49152
    v_mfma_f32_16x16x32_bf16 v[116:119], a[140:143], a[100:103], v[116:119]
    ds_read_b64_tr_b16 a[158:159], v51 offset:50176
    v_mfma_f32_16x16x32_bf16 v[120:123], a[140:143], a[104:107], v[120:123]
    buffer_load_dwordx4 a[80:83], v52, s[16:19], s29 offen offset:2048
    v_mfma_f32_16x16x32_bf16 v[124:127], a[140:143], a[108:111], v[124:127]
    s_waitcnt lgkmcnt(6)
    v_mfma_f32_16x16x32_bf16 v[128:131], a[144:147], a[96:99], v[128:131]
    ds_read_b64_tr_b16 a[128:129], v44 offset:57344
    v_mfma_f32_16x16x32_bf16 v[132:135], a[144:147], a[100:103], v[132:135]
    ds_read_b64_tr_b16 a[130:131], v44 offset:58368
    v_mfma_f32_16x16x32_bf16 v[136:139], a[144:147], a[104:107], v[136:139]
    buffer_load_dwordx4 a[84:87], v52, s[16:19], s29 offen offset:2304
    v_mfma_f32_16x16x32_bf16 v[140:143], a[144:147], a[108:111], v[140:143]
    s_waitcnt lgkmcnt(6)
    v_mfma_f32_16x16x32_bf16 v[144:147], a[148:151], a[96:99], v[144:147]
    ds_read_b64_tr_b16 a[132:133], v45 offset:57344
    v_mfma_f32_16x16x32_bf16 v[148:151], a[148:151], a[100:103], v[148:151]
    ds_read_b64_tr_b16 a[134:135], v45 offset:58368
    v_mfma_f32_16x16x32_bf16 v[152:155], a[148:151], a[104:107], v[152:155]
    buffer_load_dwordx4 v7, s[12:15], s28 offen offset:3072 lds
    v_mfma_f32_16x16x32_bf16 v[156:159], a[148:151], a[108:111], v[156:159]
    s_waitcnt lgkmcnt(6)
    v_mfma_f32_16x16x32_bf16 v[160:163], a[152:155], a[96:99], v[160:163]
    ds_read_b64_tr_b16 a[136:137], v46 offset:57344
    v_mfma_f32_16x16x32_bf16 v[164:167], a[152:155], a[100:103], v[164:167]
    ds_read_b64_tr_b16 a[138:139], v46 offset:58368
    v_mfma_f32_16x16x32_bf16 v[168:171], a[152:155], a[104:107], v[168:171]
    buffer_load_dwordx4 a[88:91], v53, s[16:19], s29 offen offset:2048
    v_mfma_f32_16x16x32_bf16 v[172:175], a[152:155], a[108:111], v[172:175]
    s_waitcnt lgkmcnt(6)
    v_mfma_f32_16x16x32_bf16 v[176:179], a[156:159], a[96:99], v[176:179]
    ds_read_b64_tr_b16 a[140:141], v47 offset:57344
    v_mfma_f32_16x16x32_bf16 v[180:183], a[156:159], a[100:103], v[180:183]
    ds_read_b64_tr_b16 a[142:143], v47 offset:58368
    v_mfma_f32_16x16x32_bf16 v[184:187], a[156:159], a[104:107], v[184:187]
    buffer_load_dwordx4 a[92:95], v53, s[16:19], s29 offen offset:2304
    v_mfma_f32_16x16x32_bf16 v[188:191], a[156:159], a[108:111], v[188:191]
    s_waitcnt lgkmcnt(6)
    v_mfma_f32_16x16x32_bf16 v[64:67], a[128:131], a[112:115], v[64:67]
    ds_read_b64_tr_b16 a[144:145], v48 offset:57344
    v_mfma_f32_16x16x32_bf16 v[68:71], a[128:131], a[116:119], v[68:71]
    ds_read_b64_tr_b16 a[146:147], v48 offset:58368
    v_mfma_f32_16x16x32_bf16 v[72:75], a[128:131], a[120:123], v[72:75]
    v_mfma_f32_16x16x32_bf16 v[76:79], a[128:131], a[124:127], v[76:79]
    s_waitcnt lgkmcnt(6)
    v_mfma_f32_16x16x32_bf16 v[80:83], a[132:135], a[112:115], v[80:83]
    ds_read_b64_tr_b16 a[148:149], v49 offset:57344
    v_mfma_f32_16x16x32_bf16 v[84:87], a[132:135], a[116:119], v[84:87]
    ds_read_b64_tr_b16 a[150:151], v49 offset:58368
    v_mfma_f32_16x16x32_bf16 v[88:91], a[132:135], a[120:123], v[88:91]
    v_mfma_f32_16x16x32_bf16 v[92:95], a[132:135], a[124:127], v[92:95]
    s_waitcnt lgkmcnt(6)
    v_mfma_f32_16x16x32_bf16 v[96:99], a[136:139], a[112:115], v[96:99]
    ds_read_b64_tr_b16 a[152:153], v50 offset:57344
    v_mfma_f32_16x16x32_bf16 v[100:103], a[136:139], a[116:119], v[100:103]
    ds_read_b64_tr_b16 a[154:155], v50 offset:58368
    v_mfma_f32_16x16x32_bf16 v[104:107], a[136:139], a[120:123], v[104:107]
    v_mfma_f32_16x16x32_bf16 v[108:111], a[136:139], a[124:127], v[108:111]
    s_waitcnt lgkmcnt(6)
    v_mfma_f32_16x16x32_bf16 v[112:115], a[140:143], a[112:115], v[112:115]
    ds_read_b64_tr_b16 a[156:157], v51 offset:57344
    v_mfma_f32_16x16x32_bf16 v[116:119], a[140:143], a[116:119], v[116:119]
    ds_read_b64_tr_b16 a[158:159], v51 offset:58368
    v_mfma_f32_16x16x32_bf16 v[120:123], a[140:143], a[120:123], v[120:123]
    v_mfma_f32_16x16x32_bf16 v[124:127], a[140:143], a[124:127], v[124:127]
    s_waitcnt vmcnt(28) lgkmcnt(0)
    s_barrier
    v_mfma_f32_16x16x32_bf16 v[128:131], a[144:147], a[112:115], v[128:131]
    ds_read_b64_tr_b16 a[128:129], v44 offset:0
    v_mfma_f32_16x16x32_bf16 v[132:135], a[144:147], a[116:119], v[132:135]
    ds_read_b64_tr_b16 a[130:131], v44 offset:1024
    s_add_u32 s28, s28, 524288
    s_add_u32 m0, s30, 49152
    v_mfma_f32_16x16x32_bf16 v[136:139], a[144:147], a[120:123], v[136:139]
    buffer_load_dwordx4 v4, s[12:15], s28 offen offset:0 lds
    v_mfma_f32_16x16x32_bf16 v[140:143], a[144:147], a[124:127], v[140:143]
    s_waitcnt lgkmcnt(6)
    v_mfma_f32_16x16x32_bf16 v[144:147], a[148:151], a[112:115], v[144:147]
    ds_read_b64_tr_b16 a[132:133], v45 offset:0
    v_mfma_f32_16x16x32_bf16 v[148:151], a[148:151], a[116:119], v[148:151]
    ds_read_b64_tr_b16 a[134:135], v45 offset:1024
    s_mov_b32 s29, 45056
    v_mfma_f32_16x16x32_bf16 v[152:155], a[148:151], a[120:123], v[152:155]
    buffer_load_dwordx4 a[96:99], v52, s[16:19], s29 offen offset:0
    v_mfma_f32_16x16x32_bf16 v[156:159], a[148:151], a[124:127], v[156:159]
    s_waitcnt lgkmcnt(6)
    v_mfma_f32_16x16x32_bf16 v[160:163], a[152:155], a[112:115], v[160:163]
    ds_read_b64_tr_b16 a[136:137], v46 offset:0
    v_mfma_f32_16x16x32_bf16 v[164:167], a[152:155], a[116:119], v[164:167]
    ds_read_b64_tr_b16 a[138:139], v46 offset:1024
    v_mfma_f32_16x16x32_bf16 v[168:171], a[152:155], a[120:123], v[168:171]
    buffer_load_dwordx4 a[100:103], v52, s[16:19], s29 offen offset:256
    v_mfma_f32_16x16x32_bf16 v[172:175], a[152:155], a[124:127], v[172:175]
    s_waitcnt lgkmcnt(6)
    v_mfma_f32_16x16x32_bf16 v[176:179], a[156:159], a[112:115], v[176:179]
    ds_read_b64_tr_b16 a[140:141], v47 offset:0
    v_mfma_f32_16x16x32_bf16 v[180:183], a[156:159], a[116:119], v[180:183]
    ds_read_b64_tr_b16 a[142:143], v47 offset:1024
    v_mfma_f32_16x16x32_bf16 v[184:187], a[156:159], a[120:123], v[184:187]
    buffer_load_dwordx4 v5, s[12:15], s28 offen offset:1024 lds
    v_mfma_f32_16x16x32_bf16 v[188:191], a[156:159], a[124:127], v[188:191]
    s_waitcnt lgkmcnt(6)
    v_mfma_f32_16x16x32_bf16 v[64:67], a[128:131], a[0:3], v[64:67]
    ds_read_b64_tr_b16 a[144:145], v48 offset:0
    v_mfma_f32_16x16x32_bf16 v[68:71], a[128:131], a[4:7], v[68:71]
    ds_read_b64_tr_b16 a[146:147], v48 offset:1024
    v_mfma_f32_16x16x32_bf16 v[72:75], a[128:131], a[8:11], v[72:75]
    buffer_load_dwordx4 a[104:107], v53, s[16:19], s29 offen offset:0
    v_mfma_f32_16x16x32_bf16 v[76:79], a[128:131], a[12:15], v[76:79]
    s_waitcnt lgkmcnt(6)
    v_mfma_f32_16x16x32_bf16 v[80:83], a[132:135], a[0:3], v[80:83]
    ds_read_b64_tr_b16 a[148:149], v49 offset:0
    v_mfma_f32_16x16x32_bf16 v[84:87], a[132:135], a[4:7], v[84:87]
    ds_read_b64_tr_b16 a[150:151], v49 offset:1024
    v_mfma_f32_16x16x32_bf16 v[88:91], a[132:135], a[8:11], v[88:91]
    buffer_load_dwordx4 a[108:111], v53, s[16:19], s29 offen offset:256
    v_mfma_f32_16x16x32_bf16 v[92:95], a[132:135], a[12:15], v[92:95]
    s_waitcnt lgkmcnt(6)
    v_mfma_f32_16x16x32_bf16 v[96:99], a[136:139], a[0:3], v[96:99]
    ds_read_b64_tr_b16 a[152:153], v50 offset:0
    v_mfma_f32_16x16x32_bf16 v[100:103], a[136:139], a[4:7], v[100:103]
    ds_read_b64_tr_b16 a[154:155], v50 offset:1024
    v_mfma_f32_16x16x32_bf16 v[104:107], a[136:139], a[8:11], v[104:107]
    buffer_load_dwordx4 v6, s[12:15], s28 offen offset:2048 lds
    v_mfma_f32_16x16x32_bf16 v[108:111], a[136:139], a[12:15], v[108:111]
    s_waitcnt lgkmcnt(6)
    v_mfma_f32_16x16x32_bf16 v[112:115], a[140:143], a[0:3], v[112:115]
    ds_read_b64_tr_b16 a[156:157], v51 offset:0
    v_mfma_f32_16x16x32_bf16 v[116:119], a[140:143], a[4:7], v[116:119]
    ds_read_b64_tr_b16 a[158:159], v51 offset:1024
    v_mfma_f32_16x16x32_bf16 v[120:123], a[140:143], a[8:11], v[120:123]
    buffer_load_dwordx4 a[112:115], v52, s[16:19], s29 offen offset:2048
    v_mfma_f32_16x16x32_bf16 v[124:127], a[140:143], a[12:15], v[124:127]
    s_waitcnt lgkmcnt(6)
    v_mfma_f32_16x16x32_bf16 v[128:131], a[144:147], a[0:3], v[128:131]
    ds_read_b64_tr_b16 a[128:129], v44 offset:8192
    v_mfma_f32_16x16x32_bf16 v[132:135], a[144:147], a[4:7], v[132:135]
    ds_read_b64_tr_b16 a[130:131], v44 offset:9216
    v_mfma_f32_16x16x32_bf16 v[136:139], a[144:147], a[8:11], v[136:139]
    buffer_load_dwordx4 a[116:119], v52, s[16:19], s29 offen offset:2304
    v_mfma_f32_16x16x32_bf16 v[140:143], a[144:147], a[12:15], v[140:143]
    s_waitcnt lgkmcnt(6)
    v_mfma_f32_16x16x32_bf16 v[144:147], a[148:151], a[0:3], v[144:147]
    ds_read_b64_tr_b16 a[132:133], v45 offset:8192
    v_mfma_f32_16x16x32_bf16 v[148:151], a[148:151], a[4:7], v[148:151]
    ds_read_b64_tr_b16 a[134:135], v45 offset:9216
    v_mfma_f32_16x16x32_bf16 v[152:155], a[148:151], a[8:11], v[152:155]
    buffer_load_dwordx4 v7, s[12:15], s28 offen offset:3072 lds
    v_mfma_f32_16x16x32_bf16 v[156:159], a[148:151], a[12:15], v[156:159]
    s_waitcnt lgkmcnt(6)
    v_mfma_f32_16x16x32_bf16 v[160:163], a[152:155], a[0:3], v[160:163]
    ds_read_b64_tr_b16 a[136:137], v46 offset:8192
    v_mfma_f32_16x16x32_bf16 v[164:167], a[152:155], a[4:7], v[164:167]
    ds_read_b64_tr_b16 a[138:139], v46 offset:9216
    v_mfma_f32_16x16x32_bf16 v[168:171], a[152:155], a[8:11], v[168:171]
    buffer_load_dwordx4 a[120:123], v53, s[16:19], s29 offen offset:2048
    v_mfma_f32_16x16x32_bf16 v[172:175], a[152:155], a[12:15], v[172:175]
    s_waitcnt lgkmcnt(6)
    v_mfma_f32_16x16x32_bf16 v[176:179], a[156:159], a[0:3], v[176:179]
    ds_read_b64_tr_b16 a[140:141], v47 offset:8192
    v_mfma_f32_16x16x32_bf16 v[180:183], a[156:159], a[4:7], v[180:183]
    ds_read_b64_tr_b16 a[142:143], v47 offset:9216
    v_mfma_f32_16x16x32_bf16 v[184:187], a[156:159], a[8:11], v[184:187]
    buffer_load_dwordx4 a[124:127], v53, s[16:19], s29 offen offset:2304
    v_mfma_f32_16x16x32_bf16 v[188:191], a[156:159], a[12:15], v[188:191]
    s_waitcnt lgkmcnt(6)
    v_mfma_f32_16x16x32_bf16 v[64:67], a[128:131], a[16:19], v[64:67]
    ds_read_b64_tr_b16 a[144:145], v48 offset:8192
    v_mfma_f32_16x16x32_bf16 v[68:71], a[128:131], a[20:23], v[68:71]
    ds_read_b64_tr_b16 a[146:147], v48 offset:9216
    s_add_u32 m0, s30, 114688
    v_mfma_f32_16x16x32_bf16 v[72:75], a[128:131], a[24:27], v[72:75]
    buffer_load_dwordx4 v16, s[36:39], s44 offen offset:0 lds
    v_mfma_f32_16x16x32_bf16 v[76:79], a[128:131], a[28:31], v[76:79]
    s_waitcnt lgkmcnt(6)
    v_mfma_f32_16x16x32_bf16 v[80:83], a[132:135], a[16:19], v[80:83]
    ds_read_b64_tr_b16 a[148:149], v49 offset:8192
    v_mfma_f32_16x16x32_bf16 v[84:87], a[132:135], a[20:23], v[84:87]
    ds_read_b64_tr_b16 a[150:151], v49 offset:9216
    v_mfma_f32_16x16x32_bf16 v[88:91], a[132:135], a[24:27], v[88:91]
    buffer_load_dwordx4 v16, s[36:39], s44 offen offset:1024 lds
    v_mfma_f32_16x16x32_bf16 v[92:95], a[132:135], a[28:31], v[92:95]
    s_waitcnt lgkmcnt(6)
    v_mfma_f32_16x16x32_bf16 v[96:99], a[136:139], a[16:19], v[96:99]
    ds_read_b64_tr_b16 a[152:153], v50 offset:8192
    v_mfma_f32_16x16x32_bf16 v[100:103], a[136:139], a[20:23], v[100:103]
    ds_read_b64_tr_b16 a[154:155], v50 offset:9216
    v_mfma_f32_16x16x32_bf16 v[104:107], a[136:139], a[24:27], v[104:107]
    buffer_load_dwordx4 v16, s[36:39], s44 offen offset:2048 lds
    v_mfma_f32_16x16x32_bf16 v[108:111], a[136:139], a[28:31], v[108:111]
    s_waitcnt lgkmcnt(6)
    v_mfma_f32_16x16x32_bf16 v[112:115], a[140:143], a[16:19], v[112:115]
    ds_read_b64_tr_b16 a[156:157], v51 offset:8192
    v_mfma_f32_16x16x32_bf16 v[116:119], a[140:143], a[20:23], v[116:119]
    ds_read_b64_tr_b16 a[158:159], v51 offset:9216
    v_mfma_f32_16x16x32_bf16 v[120:123], a[140:143], a[24:27], v[120:123]
    buffer_load_dwordx4 v16, s[36:39], s44 offen offset:3072 lds
    v_mfma_f32_16x16x32_bf16 v[124:127], a[140:143], a[28:31], v[124:127]
    s_waitcnt vmcnt(32) lgkmcnt(0)
    s_barrier
    v_mfma_f32_16x16x32_bf16 v[128:131], a[144:147], a[16:19], v[128:131]
    ds_read_b64_tr_b16 a[128:129], v44 offset:16384
    v_mfma_f32_16x16x32_bf16 v[132:135], a[144:147], a[20:23], v[132:135]
    ds_read_b64_tr_b16 a[130:131], v44 offset:17408
    s_add_u32 s28, s28, 524288
    s_add_u32 m0, s30, 0
    v_mfma_f32_16x16x32_bf16 v[136:139], a[144:147], a[24:27], v[136:139]
    buffer_load_dwordx4 v4, s[12:15], s28 offen offset:0 lds
    v_mfma_f32_16x16x32_bf16 v[140:143], a[144:147], a[28:31], v[140:143]
    s_waitcnt lgkmcnt(6)
    v_mfma_f32_16x16x32_bf16 v[144:147], a[148:151], a[16:19], v[144:147]
    ds_read_b64_tr_b16 a[132:133], v45 offset:16384
    v_mfma_f32_16x16x32_bf16 v[148:151], a[148:151], a[20:23], v[148:151]
    ds_read_b64_tr_b16 a[134:135], v45 offset:17408
    s_mov_b32 s29, 49152
    v_mfma_f32_16x16x32_bf16 v[152:155], a[148:151], a[24:27], v[152:155]
    buffer_load_dwordx4 a[0:3], v52, s[16:19], s29 offen offset:0
    v_mfma_f32_16x16x32_bf16 v[156:159], a[148:151], a[28:31], v[156:159]
    s_waitcnt lgkmcnt(6)
    v_mfma_f32_16x16x32_bf16 v[160:163], a[152:155], a[16:19], v[160:163]
    ds_read_b64_tr_b16 a[136:137], v46 offset:16384
    v_mfma_f32_16x16x32_bf16 v[164:167], a[152:155], a[20:23], v[164:167]
    ds_read_b64_tr_b16 a[138:139], v46 offset:17408
    v_mfma_f32_16x16x32_bf16 v[168:171], a[152:155], a[24:27], v[168:171]
    buffer_load_dwordx4 a[4:7], v52, s[16:19], s29 offen offset:256
    v_mfma_f32_16x16x32_bf16 v[172:175], a[152:155], a[28:31], v[172:175]
    s_waitcnt lgkmcnt(6)
    v_mfma_f32_16x16x32_bf16 v[176:179], a[156:159], a[16:19], v[176:179]
    ds_read_b64_tr_b16 a[140:141], v47 offset:16384
    v_mfma_f32_16x16x32_bf16 v[180:183], a[156:159], a[20:23], v[180:183]
    ds_read_b64_tr_b16 a[142:143], v47 offset:17408
    v_mfma_f32_16x16x32_bf16 v[184:187], a[156:159], a[24:27], v[184:187]
    buffer_load_dwordx4 v5, s[12:15], s28 offen offset:1024 lds
    v_mfma_f32_16x16x32_bf16 v[188:191], a[156:159], a[28:31], v[188:191]
    s_waitcnt lgkmcnt(6)
    v_mfma_f32_16x16x32_bf16 v[64:67], a[128:131], a[32:35], v[64:67]
    ds_read_b64_tr_b16 a[144:145], v48 offset:16384
    v_mfma_f32_16x16x32_bf16 v[68:71], a[128:131], a[36:39], v[68:71]
    ds_read_b64_tr_b16 a[146:147], v48 offset:17408
    v_mfma_f32_16x16x32_bf16 v[72:75], a[128:131], a[40:43], v[72:75]
    buffer_load_dwordx4 a[8:11], v53, s[16:19], s29 offen offset:0
    v_mfma_f32_16x16x32_bf16 v[76:79], a[128:131], a[44:47], v[76:79]
    s_waitcnt lgkmcnt(6)
    v_mfma_f32_16x16x32_bf16 v[80:83], a[132:135], a[32:35], v[80:83]
    ds_read_b64_tr_b16 a[148:149], v49 offset:16384
    v_mfma_f32_16x16x32_bf16 v[84:87], a[132:135], a[36:39], v[84:87]
    ds_read_b64_tr_b16 a[150:151], v49 offset:17408
    v_mfma_f32_16x16x32_bf16 v[88:91], a[132:135], a[40:43], v[88:91]
    buffer_load_dwordx4 a[12:15], v53, s[16:19], s29 offen offset:256
    v_mfma_f32_16x16x32_bf16 v[92:95], a[132:135], a[44:47], v[92:95]
    s_waitcnt lgkmcnt(6)
    v_mfma_f32_16x16x32_bf16 v[96:99], a[136:139], a[32:35], v[96:99]
    ds_read_b64_tr_b16 a[152:153], v50 offset:16384
    v_mfma_f32_16x16x32_bf16 v[100:103], a[136:139], a[36:39], v[100:103]
    ds_read_b64_tr_b16 a[154:155], v50 offset:17408
    v_mfma_f32_16x16x32_bf16 v[104:107], a[136:139], a[40:43], v[104:107]
    buffer_load_dwordx4 v6, s[12:15], s28 offen offset:2048 lds
    v_mfma_f32_16x16x32_bf16 v[108:111], a[136:139], a[44:47], v[108:111]
    s_waitcnt lgkmcnt(6)
    v_mfma_f32_16x16x32_bf16 v[112:115], a[140:143], a[32:35], v[112:115]
    ds_read_b64_tr_b16 a[156:157], v51 offset:16384
    v_mfma_f32_16x16x32_bf16 v[116:119], a[140:143], a[36:39], v[116:119]
    ds_read_b64_tr_b16 a[158:159], v51 offset:17408
    v_mfma_f32_16x16x32_bf16 v[120:123], a[140:143], a[40:43], v[120:123]
    buffer_load_dwordx4 a[16:19], v52, s[16:19], s29 offen offset:2048
    v_mfma_f32_16x16x32_bf16 v[124:127], a[140:143], a[44:47], v[124:127]
    s_waitcnt lgkmcnt(6)
    v_mfma_f32_16x16x32_bf16 v[128:131], a[144:147], a[32:35], v[128:131]
    ds_read_b64_tr_b16 a[128:129], v44 offset:24576
    v_mfma_f32_16x16x32_bf16 v[132:135], a[144:147], a[36:39], v[132:135]
    ds_read_b64_tr_b16 a[130:131], v44 offset:25600
    v_mfma_f32_16x16x32_bf16 v[136:139], a[144:147], a[40:43], v[136:139]
    buffer_load_dwordx4 a[20:23], v52, s[16:19], s29 offen offset:2304
    v_mfma_f32_16x16x32_bf16 v[140:143], a[144:147], a[44:47], v[140:143]
    s_waitcnt lgkmcnt(6)
    v_mfma_f32_16x16x32_bf16 v[144:147], a[148:151], a[32:35], v[144:147]
    ds_read_b64_tr_b16 a[132:133], v45 offset:24576
    v_mfma_f32_16x16x32_bf16 v[148:151], a[148:151], a[36:39], v[148:151]
    ds_read_b64_tr_b16 a[134:135], v45 offset:25600
    v_mfma_f32_16x16x32_bf16 v[152:155], a[148:151], a[40:43], v[152:155]
    buffer_load_dwordx4 v7, s[12:15], s28 offen offset:3072 lds
    v_mfma_f32_16x16x32_bf16 v[156:159], a[148:151], a[44:47], v[156:159]
    s_waitcnt lgkmcnt(6)
    v_mfma_f32_16x16x32_bf16 v[160:163], a[152:155], a[32:35], v[160:163]
    ds_read_b64_tr_b16 a[136:137], v46 offset:24576
    v_mfma_f32_16x16x32_bf16 v[164:167], a[152:155], a[36:39], v[164:167]
    ds_read_b64_tr_b16 a[138:139], v46 offset:25600
    v_mfma_f32_16x16x32_bf16 v[168:171], a[152:155], a[40:43], v[168:171]
    buffer_load_dwordx4 a[24:27], v53, s[16:19], s29 offen offset:2048
    v_mfma_f32_16x16x32_bf16 v[172:175], a[152:155], a[44:47], v[172:175]
    s_waitcnt lgkmcnt(6)
    v_mfma_f32_16x16x32_bf16 v[176:179], a[156:159], a[32:35], v[176:179]
    ds_read_b64_tr_b16 a[140:141], v47 offset:24576
    v_mfma_f32_16x16x32_bf16 v[180:183], a[156:159], a[36:39], v[180:183]
    ds_read_b64_tr_b16 a[142:143], v47 offset:25600
    v_mfma_f32_16x16x32_bf16 v[184:187], a[156:159], a[40:43], v[184:187]
    buffer_load_dwordx4 a[28:31], v53, s[16:19], s29 offen offset:2304
    v_mfma_f32_16x16x32_bf16 v[188:191], a[156:159], a[44:47], v[188:191]
    s_waitcnt lgkmcnt(6)
    v_mfma_f32_16x16x32_bf16 v[64:67], a[128:131], a[48:51], v[64:67]
    ds_read_b64_tr_b16 a[144:145], v48 offset:24576
    v_mfma_f32_16x16x32_bf16 v[68:71], a[128:131], a[52:55], v[68:71]
    ds_read_b64_tr_b16 a[146:147], v48 offset:25600
    v_mfma_f32_16x16x32_bf16 v[72:75], a[128:131], a[56:59], v[72:75]
    v_mfma_f32_16x16x32_bf16 v[76:79], a[128:131], a[60:63], v[76:79]
    s_waitcnt lgkmcnt(6)
    v_mfma_f32_16x16x32_bf16 v[80:83], a[132:135], a[48:51], v[80:83]
    ds_read_b64_tr_b16 a[148:149], v49 offset:24576
    v_mfma_f32_16x16x32_bf16 v[84:87], a[132:135], a[52:55], v[84:87]
    ds_read_b64_tr_b16 a[150:151], v49 offset:25600
    v_mfma_f32_16x16x32_bf16 v[88:91], a[132:135], a[56:59], v[88:91]
    v_mfma_f32_16x16x32_bf16 v[92:95], a[132:135], a[60:63], v[92:95]
    s_waitcnt lgkmcnt(6)
    v_mfma_f32_16x16x32_bf16 v[96:99], a[136:139], a[48:51], v[96:99]
    ds_read_b64_tr_b16 a[152:153], v50 offset:24576
    v_mfma_f32_16x16x32_bf16 v[100:103], a[136:139], a[52:55], v[100:103]
    ds_read_b64_tr_b16 a[154:155], v50 offset:25600
    v_mfma_f32_16x16x32_bf16 v[104:107], a[136:139], a[56:59], v[104:107]
    v_mfma_f32_16x16x32_bf16 v[108:111], a[136:139], a[60:63], v[108:111]
    s_waitcnt lgkmcnt(6)
    v_mfma_f32_16x16x32_bf16 v[112:115], a[140:143], a[48:51], v[112:115]
    ds_read_b64_tr_b16 a[156:157], v51 offset:24576
    v_mfma_f32_16x16x32_bf16 v[116:119], a[140:143], a[52:55], v[116:119]
    ds_read_b64_tr_b16 a[158:159], v51 offset:25600
    v_mfma_f32_16x16x32_bf16 v[120:123], a[140:143], a[56:59], v[120:123]
    v_mfma_f32_16x16x32_bf16 v[124:127], a[140:143], a[60:63], v[124:127]
    s_waitcnt vmcnt(28) lgkmcnt(0)
    s_barrier
    v_mfma_f32_16x16x32_bf16 v[128:131], a[144:147], a[48:51], v[128:131]
    ds_read_b64_tr_b16 a[128:129], v44 offset:32768
    v_mfma_f32_16x16x32_bf16 v[132:135], a[144:147], a[52:55], v[132:135]
    ds_read_b64_tr_b16 a[130:131], v44 offset:33792
    s_add_u32 s28, s28, 524288
    s_add_u32 m0, s30, 16384
    v_mfma_f32_16x16x32_bf16 v[136:139], a[144:147], a[56:59], v[136:139]
    buffer_load_dwordx4 v4, s[12:15], s28 offen offset:0 lds
    v_mfma_f32_16x16x32_bf16 v[140:143], a[144:147], a[60:63], v[140:143]
    s_waitcnt lgkmcnt(6)
    v_mfma_f32_16x16x32_bf16 v[144:147], a[148:151], a[48:51], v[144:147]
    ds_read_b64_tr_b16 a[132:133], v45 offset:32768
    v_mfma_f32_16x16x32_bf16 v[148:151], a[148:151], a[52:55], v[148:151]
    ds_read_b64_tr_b16 a[134:135], v45 offset:33792
    s_mov_b32 s29, 53248
    v_mfma_f32_16x16x32_bf16 v[152:155], a[148:151], a[56:59], v[152:155]
    buffer_load_dwordx4 a[32:35], v52, s[16:19], s29 offen offset:0
    v_mfma_f32_16x16x32_bf16 v[156:159], a[148:151], a[60:63], v[156:159]
    s_waitcnt lgkmcnt(6)
    v_mfma_f32_16x16x32_bf16 v[160:163], a[152:155], a[48:51], v[160:163]
    ds_read_b64_tr_b16 a[136:137], v46 offset:32768
    v_mfma_f32_16x16x32_bf16 v[164:167], a[152:155], a[52:55], v[164:167]
    ds_read_b64_tr_b16 a[138:139], v46 offset:33792
    v_mfma_f32_16x16x32_bf16 v[168:171], a[152:155], a[56:59], v[168:171]
    buffer_load_dwordx4 a[36:39], v52, s[16:19], s29 offen offset:256
    v_mfma_f32_16x16x32_bf16 v[172:175], a[152:155], a[60:63], v[172:175]
    s_waitcnt lgkmcnt(6)
    v_mfma_f32_16x16x32_bf16 v[176:179], a[156:159], a[48:51], v[176:179]
    ds_read_b64_tr_b16 a[140:141], v47 offset:32768
    v_mfma_f32_16x16x32_bf16 v[180:183], a[156:159], a[52:55], v[180:183]
    ds_read_b64_tr_b16 a[142:143], v47 offset:33792
    v_mfma_f32_16x16x32_bf16 v[184:187], a[156:159], a[56:59], v[184:187]
    buffer_load_dwordx4 v5, s[12:15], s28 offen offset:1024 lds
    v_mfma_f32_16x16x32_bf16 v[188:191], a[156:159], a[60:63], v[188:191]
    s_waitcnt lgkmcnt(6)
    v_mfma_f32_16x16x32_bf16 v[64:67], a[128:131], a[64:67], v[64:67]
    ds_read_b64_tr_b16 a[144:145], v48 offset:32768
    v_mfma_f32_16x16x32_bf16 v[68:71], a[128:131], a[68:71], v[68:71]
    ds_read_b64_tr_b16 a[146:147], v48 offset:33792
    v_mfma_f32_16x16x32_bf16 v[72:75], a[128:131], a[72:75], v[72:75]
    buffer_load_dwordx4 a[40:43], v53, s[16:19], s29 offen offset:0
    v_mfma_f32_16x16x32_bf16 v[76:79], a[128:131], a[76:79], v[76:79]
    s_waitcnt lgkmcnt(6)
    v_mfma_f32_16x16x32_bf16 v[80:83], a[132:135], a[64:67], v[80:83]
    ds_read_b64_tr_b16 a[148:149], v49 offset:32768
    v_mfma_f32_16x16x32_bf16 v[84:87], a[132:135], a[68:71], v[84:87]
    ds_read_b64_tr_b16 a[150:151], v49 offset:33792
    v_mfma_f32_16x16x32_bf16 v[88:91], a[132:135], a[72:75], v[88:91]
    buffer_load_dwordx4 a[44:47], v53, s[16:19], s29 offen offset:256
    v_mfma_f32_16x16x32_bf16 v[92:95], a[132:135], a[76:79], v[92:95]
    s_waitcnt lgkmcnt(6)
    v_mfma_f32_16x16x32_bf16 v[96:99], a[136:139], a[64:67], v[96:99]
    ds_read_b64_tr_b16 a[152:153], v50 offset:32768
    v_mfma_f32_16x16x32_bf16 v[100:103], a[136:139], a[68:71], v[100:103]
    ds_read_b64_tr_b16 a[154:155], v50 offset:33792
    v_mfma_f32_16x16x32_bf16 v[104:107], a[136:139], a[72:75], v[104:107]
    buffer_load_dwordx4 v6, s[12:15], s28 offen offset:2048 lds
    v_mfma_f32_16x16x32_bf16 v[108:111], a[136:139], a[76:79], v[108:111]
    s_waitcnt lgkmcnt(6)
    v_mfma_f32_16x16x32_bf16 v[112:115], a[140:143], a[64:67], v[112:115]
    ds_read_b64_tr_b16 a[156:157], v51 offset:32768
    v_mfma_f32_16x16x32_bf16 v[116:119], a[140:143], a[68:71], v[116:119]
    ds_read_b64_tr_b16 a[158:159], v51 offset:33792
    v_mfma_f32_16x16x32_bf16 v[120:123], a[140:143], a[72:75], v[120:123]
    buffer_load_dwordx4 a[48:51], v52, s[16:19], s29 offen offset:2048
    v_mfma_f32_16x16x32_bf16 v[124:127], a[140:143], a[76:79], v[124:127]
    s_waitcnt lgkmcnt(6)
    v_mfma_f32_16x16x32_bf16 v[128:131], a[144:147], a[64:67], v[128:131]
    ds_read_b64_tr_b16 a[128:129], v44 offset:40960
    v_mfma_f32_16x16x32_bf16 v[132:135], a[144:147], a[68:71], v[132:135]
    ds_read_b64_tr_b16 a[130:131], v44 offset:41984
    v_mfma_f32_16x16x32_bf16 v[136:139], a[144:147], a[72:75], v[136:139]
    buffer_load_dwordx4 a[52:55], v52, s[16:19], s29 offen offset:2304
    v_mfma_f32_16x16x32_bf16 v[140:143], a[144:147], a[76:79], v[140:143]
    s_waitcnt lgkmcnt(6)
    v_mfma_f32_16x16x32_bf16 v[144:147], a[148:151], a[64:67], v[144:147]
    ds_read_b64_tr_b16 a[132:133], v45 offset:40960
    v_mfma_f32_16x16x32_bf16 v[148:151], a[148:151], a[68:71], v[148:151]
    ds_read_b64_tr_b16 a[134:135], v45 offset:41984
    v_mfma_f32_16x16x32_bf16 v[152:155], a[148:151], a[72:75], v[152:155]
    buffer_load_dwordx4 v7, s[12:15], s28 offen offset:3072 lds
    v_mfma_f32_16x16x32_bf16 v[156:159], a[148:151], a[76:79], v[156:159]
    s_waitcnt lgkmcnt(6)
    v_mfma_f32_16x16x32_bf16 v[160:163], a[152:155], a[64:67], v[160:163]
    ds_read_b64_tr_b16 a[136:137], v46 offset:40960
    v_mfma_f32_16x16x32_bf16 v[164:167], a[152:155], a[68:71], v[164:167]
    ds_read_b64_tr_b16 a[138:139], v46 offset:41984
    v_mfma_f32_16x16x32_bf16 v[168:171], a[152:155], a[72:75], v[168:171]
    buffer_load_dwordx4 a[56:59], v53, s[16:19], s29 offen offset:2048
    v_mfma_f32_16x16x32_bf16 v[172:175], a[152:155], a[76:79], v[172:175]
    s_waitcnt lgkmcnt(6)
    v_mfma_f32_16x16x32_bf16 v[176:179], a[156:159], a[64:67], v[176:179]
    ds_read_b64_tr_b16 a[140:141], v47 offset:40960
    v_mfma_f32_16x16x32_bf16 v[180:183], a[156:159], a[68:71], v[180:183]
    ds_read_b64_tr_b16 a[142:143], v47 offset:41984
    v_mfma_f32_16x16x32_bf16 v[184:187], a[156:159], a[72:75], v[184:187]
    buffer_load_dwordx4 a[60:63], v53, s[16:19], s29 offen offset:2304
    v_mfma_f32_16x16x32_bf16 v[188:191], a[156:159], a[76:79], v[188:191]
    s_waitcnt lgkmcnt(6)
    v_mfma_f32_16x16x32_bf16 v[64:67], a[128:131], a[80:83], v[64:67]
    ds_read_b64_tr_b16 a[144:145], v48 offset:40960
    v_mfma_f32_16x16x32_bf16 v[68:71], a[128:131], a[84:87], v[68:71]
    ds_read_b64_tr_b16 a[146:147], v48 offset:41984
    v_mfma_f32_16x16x32_bf16 v[72:75], a[128:131], a[88:91], v[72:75]
    v_mfma_f32_16x16x32_bf16 v[76:79], a[128:131], a[92:95], v[76:79]
    s_waitcnt lgkmcnt(6)
    v_mfma_f32_16x16x32_bf16 v[80:83], a[132:135], a[80:83], v[80:83]
    ds_read_b64_tr_b16 a[148:149], v49 offset:40960
    v_mfma_f32_16x16x32_bf16 v[84:87], a[132:135], a[84:87], v[84:87]
    ds_read_b64_tr_b16 a[150:151], v49 offset:41984
    v_mfma_f32_16x16x32_bf16 v[88:91], a[132:135], a[88:91], v[88:91]
    v_mfma_f32_16x16x32_bf16 v[92:95], a[132:135], a[92:95], v[92:95]
    s_waitcnt lgkmcnt(6)
    v_mfma_f32_16x16x32_bf16 v[96:99], a[136:139], a[80:83], v[96:99]
    ds_read_b64_tr_b16 a[152:153], v50 offset:40960
    v_mfma_f32_16x16x32_bf16 v[100:103], a[136:139], a[84:87], v[100:103]
    ds_read_b64_tr_b16 a[154:155], v50 offset:41984
    v_mfma_f32_16x16x32_bf16 v[104:107], a[136:139], a[88:91], v[104:107]
    v_mfma_f32_16x16x32_bf16 v[108:111], a[136:139], a[92:95], v[108:111]
    s_waitcnt lgkmcnt(6)
    v_mfma_f32_16x16x32_bf16 v[112:115], a[140:143], a[80:83], v[112:115]
    ds_read_b64_tr_b16 a[156:157], v51 offset:40960
    v_mfma_f32_16x16x32_bf16 v[116:119], a[140:143], a[84:87], v[116:119]
    ds_read_b64_tr_b16 a[158:159], v51 offset:41984
    v_mfma_f32_16x16x32_bf16 v[120:123], a[140:143], a[88:91], v[120:123]
    v_mfma_f32_16x16x32_bf16 v[124:127], a[140:143], a[92:95], v[124:127]
    s_waitcnt vmcnt(28) lgkmcnt(0)
    s_barrier
    v_mfma_f32_16x16x32_bf16 v[128:131], a[144:147], a[80:83], v[128:131]
    ds_read_b64_tr_b16 a[128:129], v44 offset:49152
    v_mfma_f32_16x16x32_bf16 v[132:135], a[144:147], a[84:87], v[132:135]
    ds_read_b64_tr_b16 a[130:131], v44 offset:50176
    s_add_u32 s28, s28, 524288
    s_add_u32 m0, s30, 32768
    v_mfma_f32_16x16x32_bf16 v[136:139], a[144:147], a[88:91], v[136:139]
    buffer_load_dwordx4 v4, s[12:15], s28 offen offset:0 lds
    v_mfma_f32_16x16x32_bf16 v[140:143], a[144:147], a[92:95], v[140:143]
    s_waitcnt lgkmcnt(6)
    v_mfma_f32_16x16x32_bf16 v[144:147], a[148:151], a[80:83], v[144:147]
    ds_read_b64_tr_b16 a[132:133], v45 offset:49152
    v_mfma_f32_16x16x32_bf16 v[148:151], a[148:151], a[84:87], v[148:151]
    ds_read_b64_tr_b16 a[134:135], v45 offset:50176
    s_mov_b32 s29, 57344
    v_mfma_f32_16x16x32_bf16 v[152:155], a[148:151], a[88:91], v[152:155]
    buffer_load_dwordx4 a[64:67], v52, s[16:19], s29 offen offset:0
    v_mfma_f32_16x16x32_bf16 v[156:159], a[148:151], a[92:95], v[156:159]
    s_waitcnt lgkmcnt(6)
    v_mfma_f32_16x16x32_bf16 v[160:163], a[152:155], a[80:83], v[160:163]
    ds_read_b64_tr_b16 a[136:137], v46 offset:49152
    v_mfma_f32_16x16x32_bf16 v[164:167], a[152:155], a[84:87], v[164:167]
    ds_read_b64_tr_b16 a[138:139], v46 offset:50176
    v_mfma_f32_16x16x32_bf16 v[168:171], a[152:155], a[88:91], v[168:171]
    buffer_load_dwordx4 a[68:71], v52, s[16:19], s29 offen offset:256
    v_mfma_f32_16x16x32_bf16 v[172:175], a[152:155], a[92:95], v[172:175]
    s_waitcnt lgkmcnt(6)
    v_mfma_f32_16x16x32_bf16 v[176:179], a[156:159], a[80:83], v[176:179]
    ds_read_b64_tr_b16 a[140:141], v47 offset:49152
    v_mfma_f32_16x16x32_bf16 v[180:183], a[156:159], a[84:87], v[180:183]
    ds_read_b64_tr_b16 a[142:143], v47 offset:50176
    v_mfma_f32_16x16x32_bf16 v[184:187], a[156:159], a[88:91], v[184:187]
    buffer_load_dwordx4 v5, s[12:15], s28 offen offset:1024 lds
    v_mfma_f32_16x16x32_bf16 v[188:191], a[156:159], a[92:95], v[188:191]
    s_waitcnt lgkmcnt(6)
    v_mfma_f32_16x16x32_bf16 v[64:67], a[128:131], a[96:99], v[64:67]
    ds_read_b64_tr_b16 a[144:145], v48 offset:49152
    v_mfma_f32_16x16x32_bf16 v[68:71], a[128:131], a[100:103], v[68:71]
    ds_read_b64_tr_b16 a[146:147], v48 offset:50176
    v_mfma_f32_16x16x32_bf16 v[72:75], a[128:131], a[104:107], v[72:75]
    buffer_load_dwordx4 a[72:75], v53, s[16:19], s29 offen offset:0
    v_mfma_f32_16x16x32_bf16 v[76:79], a[128:131], a[108:111], v[76:79]
    s_waitcnt lgkmcnt(6)
    v_mfma_f32_16x16x32_bf16 v[80:83], a[132:135], a[96:99], v[80:83]
    ds_read_b64_tr_b16 a[148:149], v49 offset:49152
    v_mfma_f32_16x16x32_bf16 v[84:87], a[132:135], a[100:103], v[84:87]
    ds_read_b64_tr_b16 a[150:151], v49 offset:50176
    v_mfma_f32_16x16x32_bf16 v[88:91], a[132:135], a[104:107], v[88:91]
    buffer_load_dwordx4 a[76:79], v53, s[16:19], s29 offen offset:256
    v_mfma_f32_16x16x32_bf16 v[92:95], a[132:135], a[108:111], v[92:95]
    s_waitcnt lgkmcnt(6)
    v_mfma_f32_16x16x32_bf16 v[96:99], a[136:139], a[96:99], v[96:99]
    ds_read_b64_tr_b16 a[152:153], v50 offset:49152
    v_mfma_f32_16x16x32_bf16 v[100:103], a[136:139], a[100:103], v[100:103]
    ds_read_b64_tr_b16 a[154:155], v50 offset:50176
    v_mfma_f32_16x16x32_bf16 v[104:107], a[136:139], a[104:107], v[104:107]
    buffer_load_dwordx4 v6, s[12:15], s28 offen offset:2048 lds
    v_mfma_f32_16x16x32_bf16 v[108:111], a[136:139], a[108:111], v[108:111]
    s_waitcnt lgkmcnt(6)
    v_mfma_f32_16x16x32_bf16 v[112:115], a[140:143], a[96:99], v[112:115]
    ds_read_b64_tr_b16 a[156:157], v51 offset:49152
    v_mfma_f32_16x16x32_bf16 v[116:119], a[140:143], a[100:103], v[116:119]
    ds_read_b64_tr_b16 a[158:159], v51 offset:50176
    v_mfma_f32_16x16x32_bf16 v[120:123], a[140:143], a[104:107], v[120:123]
    buffer_load_dwordx4 a[80:83], v52, s[16:19], s29 offen offset:2048
    v_mfma_f32_16x16x32_bf16 v[124:127], a[140:143], a[108:111], v[124:127]
    s_waitcnt lgkmcnt(6)
    v_mfma_f32_16x16x32_bf16 v[128:131], a[144:147], a[96:99], v[128:131]
    ds_read_b64_tr_b16 a[128:129], v44 offset:57344
    v_mfma_f32_16x16x32_bf16 v[132:135], a[144:147], a[100:103], v[132:135]
    ds_read_b64_tr_b16 a[130:131], v44 offset:58368
    v_mfma_f32_16x16x32_bf16 v[136:139], a[144:147], a[104:107], v[136:139]
    buffer_load_dwordx4 a[84:87], v52, s[16:19], s29 offen offset:2304
    v_mfma_f32_16x16x32_bf16 v[140:143], a[144:147], a[108:111], v[140:143]
    s_waitcnt lgkmcnt(6)
    v_mfma_f32_16x16x32_bf16 v[144:147], a[148:151], a[96:99], v[144:147]
    ds_read_b64_tr_b16 a[132:133], v45 offset:57344
    v_mfma_f32_16x16x32_bf16 v[148:151], a[148:151], a[100:103], v[148:151]
    ds_read_b64_tr_b16 a[134:135], v45 offset:58368
    v_mfma_f32_16x16x32_bf16 v[152:155], a[148:151], a[104:107], v[152:155]
    buffer_load_dwordx4 v7, s[12:15], s28 offen offset:3072 lds
    v_mfma_f32_16x16x32_bf16 v[156:159], a[148:151], a[108:111], v[156:159]
    s_waitcnt lgkmcnt(6)
    v_mfma_f32_16x16x32_bf16 v[160:163], a[152:155], a[96:99], v[160:163]
    ds_read_b64_tr_b16 a[136:137], v46 offset:57344
    v_mfma_f32_16x16x32_bf16 v[164:167], a[152:155], a[100:103], v[164:167]
    ds_read_b64_tr_b16 a[138:139], v46 offset:58368
    v_mfma_f32_16x16x32_bf16 v[168:171], a[152:155], a[104:107], v[168:171]
    buffer_load_dwordx4 a[88:91], v53, s[16:19], s29 offen offset:2048
    v_mfma_f32_16x16x32_bf16 v[172:175], a[152:155], a[108:111], v[172:175]
    s_waitcnt lgkmcnt(6)
    v_mfma_f32_16x16x32_bf16 v[176:179], a[156:159], a[96:99], v[176:179]
    ds_read_b64_tr_b16 a[140:141], v47 offset:57344
    v_mfma_f32_16x16x32_bf16 v[180:183], a[156:159], a[100:103], v[180:183]
    ds_read_b64_tr_b16 a[142:143], v47 offset:58368
    v_mfma_f32_16x16x32_bf16 v[184:187], a[156:159], a[104:107], v[184:187]
    buffer_load_dwordx4 a[92:95], v53, s[16:19], s29 offen offset:2304
    v_mfma_f32_16x16x32_bf16 v[188:191], a[156:159], a[108:111], v[188:191]
    s_waitcnt lgkmcnt(6)
    v_mfma_f32_16x16x32_bf16 v[64:67], a[128:131], a[112:115], v[64:67]
    ds_read_b64_tr_b16 a[144:145], v48 offset:57344
    v_mfma_f32_16x16x32_bf16 v[68:71], a[128:131], a[116:119], v[68:71]
    ds_read_b64_tr_b16 a[146:147], v48 offset:58368
    v_mfma_f32_16x16x32_bf16 v[72:75], a[128:131], a[120:123], v[72:75]
    v_mfma_f32_16x16x32_bf16 v[76:79], a[128:131], a[124:127], v[76:79]
    s_waitcnt lgkmcnt(6)
    v_mfma_f32_16x16x32_bf16 v[80:83], a[132:135], a[112:115], v[80:83]
    ds_read_b64_tr_b16 a[148:149], v49 offset:57344
    v_mfma_f32_16x16x32_bf16 v[84:87], a[132:135], a[116:119], v[84:87]
    ds_read_b64_tr_b16 a[150:151], v49 offset:58368
    v_mfma_f32_16x16x32_bf16 v[88:91], a[132:135], a[120:123], v[88:91]
    v_mfma_f32_16x16x32_bf16 v[92:95], a[132:135], a[124:127], v[92:95]
    s_waitcnt lgkmcnt(6)
    v_mfma_f32_16x16x32_bf16 v[96:99], a[136:139], a[112:115], v[96:99]
    ds_read_b64_tr_b16 a[152:153], v50 offset:57344
    v_mfma_f32_16x16x32_bf16 v[100:103], a[136:139], a[116:119], v[100:103]
    ds_read_b64_tr_b16 a[154:155], v50 offset:58368
    v_mfma_f32_16x16x32_bf16 v[104:107], a[136:139], a[120:123], v[104:107]
    v_mfma_f32_16x16x32_bf16 v[108:111], a[136:139], a[124:127], v[108:111]
    s_waitcnt lgkmcnt(6)
    v_mfma_f32_16x16x32_bf16 v[112:115], a[140:143], a[112:115], v[112:115]
    ds_read_b64_tr_b16 a[156:157], v51 offset:57344
    v_mfma_f32_16x16x32_bf16 v[116:119], a[140:143], a[116:119], v[116:119]
    ds_read_b64_tr_b16 a[158:159], v51 offset:58368
    v_mfma_f32_16x16x32_bf16 v[120:123], a[140:143], a[120:123], v[120:123]
    v_mfma_f32_16x16x32_bf16 v[124:127], a[140:143], a[124:127], v[124:127]
    s_waitcnt vmcnt(24) lgkmcnt(0)
    s_barrier
    v_mfma_f32_16x16x32_bf16 v[128:131], a[144:147], a[112:115], v[128:131]
    ds_read_b64_tr_b16 a[128:129], v44 offset:0
    v_mfma_f32_16x16x32_bf16 v[132:135], a[144:147], a[116:119], v[132:135]
    ds_read_b64_tr_b16 a[130:131], v44 offset:1024
    s_add_u32 s28, s28, 524288
    s_add_u32 m0, s30, 49152
    v_mfma_f32_16x16x32_bf16 v[136:139], a[144:147], a[120:123], v[136:139]
    buffer_load_dwordx4 v4, s[12:15], s28 offen offset:0 lds
    v_mfma_f32_16x16x32_bf16 v[140:143], a[144:147], a[124:127], v[140:143]
    s_waitcnt lgkmcnt(6)
    v_mfma_f32_16x16x32_bf16 v[144:147], a[148:151], a[112:115], v[144:147]
    ds_read_b64_tr_b16 a[132:133], v45 offset:0
    v_mfma_f32_16x16x32_bf16 v[148:151], a[148:151], a[116:119], v[148:151]
    ds_read_b64_tr_b16 a[134:135], v45 offset:1024
    s_mov_b32 s29, 61440
    v_mfma_f32_16x16x32_bf16 v[152:155], a[148:151], a[120:123], v[152:155]
    buffer_load_dwordx4 a[96:99], v52, s[16:19], s29 offen offset:0
    v_mfma_f32_16x16x32_bf16 v[156:159], a[148:151], a[124:127], v[156:159]
    s_waitcnt lgkmcnt(6)
    v_mfma_f32_16x16x32_bf16 v[160:163], a[152:155], a[112:115], v[160:163]
    ds_read_b64_tr_b16 a[136:137], v46 offset:0
    v_mfma_f32_16x16x32_bf16 v[164:167], a[152:155], a[116:119], v[164:167]
    ds_read_b64_tr_b16 a[138:139], v46 offset:1024
    v_mfma_f32_16x16x32_bf16 v[168:171], a[152:155], a[120:123], v[168:171]
    buffer_load_dwordx4 a[100:103], v52, s[16:19], s29 offen offset:256
    v_mfma_f32_16x16x32_bf16 v[172:175], a[152:155], a[124:127], v[172:175]
    s_waitcnt lgkmcnt(6)
    v_mfma_f32_16x16x32_bf16 v[176:179], a[156:159], a[112:115], v[176:179]
    ds_read_b64_tr_b16 a[140:141], v47 offset:0
    v_mfma_f32_16x16x32_bf16 v[180:183], a[156:159], a[116:119], v[180:183]
    ds_read_b64_tr_b16 a[142:143], v47 offset:1024
    v_mfma_f32_16x16x32_bf16 v[184:187], a[156:159], a[120:123], v[184:187]
    buffer_load_dwordx4 v5, s[12:15], s28 offen offset:1024 lds
    v_mfma_f32_16x16x32_bf16 v[188:191], a[156:159], a[124:127], v[188:191]
    s_waitcnt lgkmcnt(6)
    v_mfma_f32_16x16x32_bf16 v[64:67], a[128:131], a[0:3], v[64:67]
    ds_read_b64_tr_b16 a[144:145], v48 offset:0
    v_mfma_f32_16x16x32_bf16 v[68:71], a[128:131], a[4:7], v[68:71]
    ds_read_b64_tr_b16 a[146:147], v48 offset:1024
    v_mfma_f32_16x16x32_bf16 v[72:75], a[128:131], a[8:11], v[72:75]
    buffer_load_dwordx4 a[104:107], v53, s[16:19], s29 offen offset:0
    v_mfma_f32_16x16x32_bf16 v[76:79], a[128:131], a[12:15], v[76:79]
    s_waitcnt lgkmcnt(6)
    v_mfma_f32_16x16x32_bf16 v[80:83], a[132:135], a[0:3], v[80:83]
    ds_read_b64_tr_b16 a[148:149], v49 offset:0
    v_mfma_f32_16x16x32_bf16 v[84:87], a[132:135], a[4:7], v[84:87]
    ds_read_b64_tr_b16 a[150:151], v49 offset:1024
    v_mfma_f32_16x16x32_bf16 v[88:91], a[132:135], a[8:11], v[88:91]
    buffer_load_dwordx4 a[108:111], v53, s[16:19], s29 offen offset:256
    v_mfma_f32_16x16x32_bf16 v[92:95], a[132:135], a[12:15], v[92:95]
    s_waitcnt lgkmcnt(6)
    v_mfma_f32_16x16x32_bf16 v[96:99], a[136:139], a[0:3], v[96:99]
    ds_read_b64_tr_b16 a[152:153], v50 offset:0
    v_mfma_f32_16x16x32_bf16 v[100:103], a[136:139], a[4:7], v[100:103]
    ds_read_b64_tr_b16 a[154:155], v50 offset:1024
    v_mfma_f32_16x16x32_bf16 v[104:107], a[136:139], a[8:11], v[104:107]
    buffer_load_dwordx4 v6, s[12:15], s28 offen offset:2048 lds
    v_mfma_f32_16x16x32_bf16 v[108:111], a[136:139], a[12:15], v[108:111]
    s_waitcnt lgkmcnt(6)
    v_mfma_f32_16x16x32_bf16 v[112:115], a[140:143], a[0:3], v[112:115]
    ds_read_b64_tr_b16 a[156:157], v51 offset:0
    v_mfma_f32_16x16x32_bf16 v[116:119], a[140:143], a[4:7], v[116:119]
    ds_read_b64_tr_b16 a[158:159], v51 offset:1024
    v_mfma_f32_16x16x32_bf16 v[120:123], a[140:143], a[8:11], v[120:123]
    buffer_load_dwordx4 a[112:115], v52, s[16:19], s29 offen offset:2048
    v_mfma_f32_16x16x32_bf16 v[124:127], a[140:143], a[12:15], v[124:127]
    s_waitcnt lgkmcnt(6)
    v_mfma_f32_16x16x32_bf16 v[128:131], a[144:147], a[0:3], v[128:131]
    ds_read_b64_tr_b16 a[128:129], v44 offset:8192
    v_mfma_f32_16x16x32_bf16 v[132:135], a[144:147], a[4:7], v[132:135]
    ds_read_b64_tr_b16 a[130:131], v44 offset:9216
    v_mfma_f32_16x16x32_bf16 v[136:139], a[144:147], a[8:11], v[136:139]
    buffer_load_dwordx4 a[116:119], v52, s[16:19], s29 offen offset:2304
    v_mfma_f32_16x16x32_bf16 v[140:143], a[144:147], a[12:15], v[140:143]
    s_waitcnt lgkmcnt(6)
    v_mfma_f32_16x16x32_bf16 v[144:147], a[148:151], a[0:3], v[144:147]
    ds_read_b64_tr_b16 a[132:133], v45 offset:8192
    v_mfma_f32_16x16x32_bf16 v[148:151], a[148:151], a[4:7], v[148:151]
    ds_read_b64_tr_b16 a[134:135], v45 offset:9216
    v_mfma_f32_16x16x32_bf16 v[152:155], a[148:151], a[8:11], v[152:155]
    buffer_load_dwordx4 v7, s[12:15], s28 offen offset:3072 lds
    v_mfma_f32_16x16x32_bf16 v[156:159], a[148:151], a[12:15], v[156:159]
    s_waitcnt lgkmcnt(6)
    v_mfma_f32_16x16x32_bf16 v[160:163], a[152:155], a[0:3], v[160:163]
    ds_read_b64_tr_b16 a[136:137], v46 offset:8192
    v_mfma_f32_16x16x32_bf16 v[164:167], a[152:155], a[4:7], v[164:167]
    ds_read_b64_tr_b16 a[138:139], v46 offset:9216
    v_mfma_f32_16x16x32_bf16 v[168:171], a[152:155], a[8:11], v[168:171]
    buffer_load_dwordx4 a[120:123], v53, s[16:19], s29 offen offset:2048
    v_mfma_f32_16x16x32_bf16 v[172:175], a[152:155], a[12:15], v[172:175]
    s_waitcnt lgkmcnt(6)
    v_mfma_f32_16x16x32_bf16 v[176:179], a[156:159], a[0:3], v[176:179]
    ds_read_b64_tr_b16 a[140:141], v47 offset:8192
    v_mfma_f32_16x16x32_bf16 v[180:183], a[156:159], a[4:7], v[180:183]
    ds_read_b64_tr_b16 a[142:143], v47 offset:9216
    v_mfma_f32_16x16x32_bf16 v[184:187], a[156:159], a[8:11], v[184:187]
    buffer_load_dwordx4 a[124:127], v53, s[16:19], s29 offen offset:2304
    v_mfma_f32_16x16x32_bf16 v[188:191], a[156:159], a[12:15], v[188:191]
    s_waitcnt lgkmcnt(6)
    v_mfma_f32_16x16x32_bf16 v[64:67], a[128:131], a[16:19], v[64:67]
    ds_read_b64_tr_b16 a[144:145], v48 offset:8192
    v_mfma_f32_16x16x32_bf16 v[68:71], a[128:131], a[20:23], v[68:71]
    ds_read_b64_tr_b16 a[146:147], v48 offset:9216
    v_mfma_f32_16x16x32_bf16 v[72:75], a[128:131], a[24:27], v[72:75]
    v_mfma_f32_16x16x32_bf16 v[76:79], a[128:131], a[28:31], v[76:79]
    s_waitcnt lgkmcnt(6)
    v_mfma_f32_16x16x32_bf16 v[80:83], a[132:135], a[16:19], v[80:83]
    ds_read_b64_tr_b16 a[148:149], v49 offset:8192
    v_mfma_f32_16x16x32_bf16 v[84:87], a[132:135], a[20:23], v[84:87]
    ds_read_b64_tr_b16 a[150:151], v49 offset:9216
    v_mfma_f32_16x16x32_bf16 v[88:91], a[132:135], a[24:27], v[88:91]
    v_mfma_f32_16x16x32_bf16 v[92:95], a[132:135], a[28:31], v[92:95]
    s_waitcnt lgkmcnt(6)
    v_mfma_f32_16x16x32_bf16 v[96:99], a[136:139], a[16:19], v[96:99]
    ds_read_b64_tr_b16 a[152:153], v50 offset:8192
    v_mfma_f32_16x16x32_bf16 v[100:103], a[136:139], a[20:23], v[100:103]
    ds_read_b64_tr_b16 a[154:155], v50 offset:9216
    v_mfma_f32_16x16x32_bf16 v[104:107], a[136:139], a[24:27], v[104:107]
    v_mfma_f32_16x16x32_bf16 v[108:111], a[136:139], a[28:31], v[108:111]
    s_waitcnt lgkmcnt(6)
    v_mfma_f32_16x16x32_bf16 v[112:115], a[140:143], a[16:19], v[112:115]
    ds_read_b64_tr_b16 a[156:157], v51 offset:8192
    v_mfma_f32_16x16x32_bf16 v[116:119], a[140:143], a[20:23], v[116:119]
    ds_read_b64_tr_b16 a[158:159], v51 offset:9216
    v_mfma_f32_16x16x32_bf16 v[120:123], a[140:143], a[24:27], v[120:123]
    v_mfma_f32_16x16x32_bf16 v[124:127], a[140:143], a[28:31], v[124:127]
    s_waitcnt vmcnt(24) lgkmcnt(0)
    s_barrier
    v_mfma_f32_16x16x32_bf16 v[128:131], a[144:147], a[16:19], v[128:131]
    ds_read_b64_tr_b16 a[128:129], v44 offset:16384
    v_mfma_f32_16x16x32_bf16 v[132:135], a[144:147], a[20:23], v[132:135]
    ds_read_b64_tr_b16 a[130:131], v44 offset:17408
    v_mfma_f32_16x16x32_bf16 v[136:139], a[144:147], a[24:27], v[136:139]
    v_mfma_f32_16x16x32_bf16 v[140:143], a[144:147], a[28:31], v[140:143]
    s_waitcnt lgkmcnt(6)
    v_mfma_f32_16x16x32_bf16 v[144:147], a[148:151], a[16:19], v[144:147]
    ds_read_b64_tr_b16 a[132:133], v45 offset:16384
    v_mfma_f32_16x16x32_bf16 v[148:151], a[148:151], a[20:23], v[148:151]
    ds_read_b64_tr_b16 a[134:135], v45 offset:17408
    v_mfma_f32_16x16x32_bf16 v[152:155], a[148:151], a[24:27], v[152:155]
    v_mfma_f32_16x16x32_bf16 v[156:159], a[148:151], a[28:31], v[156:159]
    s_waitcnt lgkmcnt(6)
    v_mfma_f32_16x16x32_bf16 v[160:163], a[152:155], a[16:19], v[160:163]
    ds_read_b64_tr_b16 a[136:137], v46 offset:16384
    v_mfma_f32_16x16x32_bf16 v[164:167], a[152:155], a[20:23], v[164:167]
    ds_read_b64_tr_b16 a[138:139], v46 offset:17408
    v_mfma_f32_16x16x32_bf16 v[168:171], a[152:155], a[24:27], v[168:171]
    v_mfma_f32_16x16x32_bf16 v[172:175], a[152:155], a[28:31], v[172:175]
    s_waitcnt lgkmcnt(6)
    v_mfma_f32_16x16x32_bf16 v[176:179], a[156:159], a[16:19], v[176:179]
    ds_read_b64_tr_b16 a[140:141], v47 offset:16384
    v_mfma_f32_16x16x32_bf16 v[180:183], a[156:159], a[20:23], v[180:183]
    ds_read_b64_tr_b16 a[142:143], v47 offset:17408
    v_mfma_f32_16x16x32_bf16 v[184:187], a[156:159], a[24:27], v[184:187]
    v_mfma_f32_16x16x32_bf16 v[188:191], a[156:159], a[28:31], v[188:191]
    s_waitcnt lgkmcnt(6)
    v_mfma_f32_16x16x32_bf16 v[64:67], a[128:131], a[32:35], v[64:67]
    ds_read_b64_tr_b16 a[144:145], v48 offset:16384
    v_mfma_f32_16x16x32_bf16 v[68:71], a[128:131], a[36:39], v[68:71]
    ds_read_b64_tr_b16 a[146:147], v48 offset:17408
    v_mfma_f32_16x16x32_bf16 v[72:75], a[128:131], a[40:43], v[72:75]
    v_mfma_f32_16x16x32_bf16 v[76:79], a[128:131], a[44:47], v[76:79]
    s_waitcnt lgkmcnt(6)
    v_mfma_f32_16x16x32_bf16 v[80:83], a[132:135], a[32:35], v[80:83]
    ds_read_b64_tr_b16 a[148:149], v49 offset:16384
    v_mfma_f32_16x16x32_bf16 v[84:87], a[132:135], a[36:39], v[84:87]
    ds_read_b64_tr_b16 a[150:151], v49 offset:17408
    v_mfma_f32_16x16x32_bf16 v[88:91], a[132:135], a[40:43], v[88:91]
    v_mfma_f32_16x16x32_bf16 v[92:95], a[132:135], a[44:47], v[92:95]
    s_waitcnt lgkmcnt(6)
    v_mfma_f32_16x16x32_bf16 v[96:99], a[136:139], a[32:35], v[96:99]
    ds_read_b64_tr_b16 a[152:153], v50 offset:16384
    v_mfma_f32_16x16x32_bf16 v[100:103], a[136:139], a[36:39], v[100:103]
    ds_read_b64_tr_b16 a[154:155], v50 offset:17408
    v_mfma_f32_16x16x32_bf16 v[104:107], a[136:139], a[40:43], v[104:107]
    v_mfma_f32_16x16x32_bf16 v[108:111], a[136:139], a[44:47], v[108:111]
    s_waitcnt lgkmcnt(6)
    v_mfma_f32_16x16x32_bf16 v[112:115], a[140:143], a[32:35], v[112:115]
    ds_read_b64_tr_b16 a[156:157], v51 offset:16384
    v_mfma_f32_16x16x32_bf16 v[116:119], a[140:143], a[36:39], v[116:119]
    ds_read_b64_tr_b16 a[158:159], v51 offset:17408
    v_mfma_f32_16x16x32_bf16 v[120:123], a[140:143], a[40:43], v[120:123]
    v_mfma_f32_16x16x32_bf16 v[124:127], a[140:143], a[44:47], v[124:127]
    s_waitcnt lgkmcnt(6)
    v_mfma_f32_16x16x32_bf16 v[128:131], a[144:147], a[32:35], v[128:131]
    ds_read_b64_tr_b16 a[128:129], v44 offset:24576
    v_mfma_f32_16x16x32_bf16 v[132:135], a[144:147], a[36:39], v[132:135]
    ds_read_b64_tr_b16 a[130:131], v44 offset:25600
    v_mfma_f32_16x16x32_bf16 v[136:139], a[144:147], a[40:43], v[136:139]
    v_mfma_f32_16x16x32_bf16 v[140:143], a[144:147], a[44:47], v[140:143]
    s_waitcnt lgkmcnt(6)
    v_mfma_f32_16x16x32_bf16 v[144:147], a[148:151], a[32:35], v[144:147]
    ds_read_b64_tr_b16 a[132:133], v45 offset:24576
    v_mfma_f32_16x16x32_bf16 v[148:151], a[148:151], a[36:39], v[148:151]
    ds_read_b64_tr_b16 a[134:135], v45 offset:25600
    v_mfma_f32_16x16x32_bf16 v[152:155], a[148:151], a[40:43], v[152:155]
    v_mfma_f32_16x16x32_bf16 v[156:159], a[148:151], a[44:47], v[156:159]
    s_waitcnt lgkmcnt(6)
    v_mfma_f32_16x16x32_bf16 v[160:163], a[152:155], a[32:35], v[160:163]
    ds_read_b64_tr_b16 a[136:137], v46 offset:24576
    v_mfma_f32_16x16x32_bf16 v[164:167], a[152:155], a[36:39], v[164:167]
    ds_read_b64_tr_b16 a[138:139], v46 offset:25600
    v_mfma_f32_16x16x32_bf16 v[168:171], a[152:155], a[40:43], v[168:171]
    v_mfma_f32_16x16x32_bf16 v[172:175], a[152:155], a[44:47], v[172:175]
    s_waitcnt lgkmcnt(6)
    v_mfma_f32_16x16x32_bf16 v[176:179], a[156:159], a[32:35], v[176:179]
    ds_read_b64_tr_b16 a[140:141], v47 offset:24576
    v_mfma_f32_16x16x32_bf16 v[180:183], a[156:159], a[36:39], v[180:183]
    ds_read_b64_tr_b16 a[142:143], v47 offset:25600
    v_mfma_f32_16x16x32_bf16 v[184:187], a[156:159], a[40:43], v[184:187]
    v_mfma_f32_16x16x32_bf16 v[188:191], a[156:159], a[44:47], v[188:191]
    s_waitcnt lgkmcnt(6)
    v_mfma_f32_16x16x32_bf16 v[64:67], a[128:131], a[48:51], v[64:67]
    ds_read_b64_tr_b16 a[144:145], v48 offset:24576
    v_mfma_f32_16x16x32_bf16 v[68:71], a[128:131], a[52:55], v[68:71]
    ds_read_b64_tr_b16 a[146:147], v48 offset:25600
    v_mfma_f32_16x16x32_bf16 v[72:75], a[128:131], a[56:59], v[72:75]
    v_mfma_f32_16x16x32_bf16 v[76:79], a[128:131], a[60:63], v[76:79]
    s_waitcnt lgkmcnt(6)
    v_mfma_f32_16x16x32_bf16 v[80:83], a[132:135], a[48:51], v[80:83]
    ds_read_b64_tr_b16 a[148:149], v49 offset:24576
    v_mfma_f32_16x16x32_bf16 v[84:87], a[132:135], a[52:55], v[84:87]
    ds_read_b64_tr_b16 a[150:151], v49 offset:25600
    v_mfma_f32_16x16x32_bf16 v[88:91], a[132:135], a[56:59], v[88:91]
    v_mfma_f32_16x16x32_bf16 v[92:95], a[132:135], a[60:63], v[92:95]
    s_waitcnt lgkmcnt(6)
    v_mfma_f32_16x16x32_bf16 v[96:99], a[136:139], a[48:51], v[96:99]
    ds_read_b64_tr_b16 a[152:153], v50 offset:24576
    v_mfma_f32_16x16x32_bf16 v[100:103], a[136:139], a[52:55], v[100:103]
    ds_read_b64_tr_b16 a[154:155], v50 offset:25600
    v_mfma_f32_16x16x32_bf16 v[104:107], a[136:139], a[56:59], v[104:107]
    v_mfma_f32_16x16x32_bf16 v[108:111], a[136:139], a[60:63], v[108:111]
    s_waitcnt lgkmcnt(6)
    v_mfma_f32_16x16x32_bf16 v[112:115], a[140:143], a[48:51], v[112:115]
    ds_read_b64_tr_b16 a[156:157], v51 offset:24576
    v_mfma_f32_16x16x32_bf16 v[116:119], a[140:143], a[52:55], v[116:119]
    ds_read_b64_tr_b16 a[158:159], v51 offset:25600
    v_mfma_f32_16x16x32_bf16 v[120:123], a[140:143], a[56:59], v[120:123]
    v_mfma_f32_16x16x32_bf16 v[124:127], a[140:143], a[60:63], v[124:127]
    s_waitcnt vmcnt(12) lgkmcnt(0)
    s_barrier
    v_mfma_f32_16x16x32_bf16 v[128:131], a[144:147], a[48:51], v[128:131]
    ds_read_b64_tr_b16 a[128:129], v44 offset:32768
    v_mfma_f32_16x16x32_bf16 v[132:135], a[144:147], a[52:55], v[132:135]
    ds_read_b64_tr_b16 a[130:131], v44 offset:33792
    v_mfma_f32_16x16x32_bf16 v[136:139], a[144:147], a[56:59], v[136:139]
    v_mfma_f32_16x16x32_bf16 v[140:143], a[144:147], a[60:63], v[140:143]
    s_waitcnt lgkmcnt(6)
    v_mfma_f32_16x16x32_bf16 v[144:147], a[148:151], a[48:51], v[144:147]
    ds_read_b64_tr_b16 a[132:133], v45 offset:32768
    v_mfma_f32_16x16x32_bf16 v[148:151], a[148:151], a[52:55], v[148:151]
    ds_read_b64_tr_b16 a[134:135], v45 offset:33792
    v_mfma_f32_16x16x32_bf16 v[152:155], a[148:151], a[56:59], v[152:155]
    v_mfma_f32_16x16x32_bf16 v[156:159], a[148:151], a[60:63], v[156:159]
    s_waitcnt lgkmcnt(6)
    v_mfma_f32_16x16x32_bf16 v[160:163], a[152:155], a[48:51], v[160:163]
    ds_read_b64_tr_b16 a[136:137], v44 offset:40960
    v_mfma_f32_16x16x32_bf16 v[164:167], a[152:155], a[52:55], v[164:167]
    ds_read_b64_tr_b16 a[138:139], v44 offset:41984
    v_mfma_f32_16x16x32_bf16 v[168:171], a[152:155], a[56:59], v[168:171]
    v_mfma_f32_16x16x32_bf16 v[172:175], a[152:155], a[60:63], v[172:175]
    s_waitcnt lgkmcnt(6)
    v_mfma_f32_16x16x32_bf16 v[176:179], a[156:159], a[48:51], v[176:179]
    ds_read_b64_tr_b16 a[140:141], v45 offset:40960
    v_mfma_f32_16x16x32_bf16 v[180:183], a[156:159], a[52:55], v[180:183]
    ds_read_b64_tr_b16 a[142:143], v45 offset:41984
    v_mfma_f32_16x16x32_bf16 v[184:187], a[156:159], a[56:59], v[184:187]
    v_mfma_f32_16x16x32_bf16 v[188:191], a[156:159], a[60:63], v[188:191]
    s_waitcnt vmcnt(0) lgkmcnt(0)
    s_barrier
    v_mfma_f32_16x16x32_bf16 v[64:67], a[128:131], a[64:67], v[64:67]
    ds_read_b64_tr_b16 a[144:145], v44 offset:49152
    v_mfma_f32_16x16x32_bf16 v[68:71], a[128:131], a[68:71], v[68:71]
    ds_read_b64_tr_b16 a[146:147], v44 offset:50176
    v_mfma_f32_16x16x32_bf16 v[72:75], a[128:131], a[72:75], v[72:75]
    v_mfma_f32_16x16x32_bf16 v[76:79], a[128:131], a[76:79], v[76:79]
    v_accvgpr_write_b32 a0, 0
    v_accvgpr_write_b32 a1, 0
    s_waitcnt lgkmcnt(6)
    v_mfma_f32_16x16x32_bf16 v[80:83], a[132:135], a[64:67], v[80:83]
    ds_read_b64_tr_b16 a[148:149], v45 offset:49152
    v_mfma_f32_16x16x32_bf16 v[84:87], a[132:135], a[68:71], v[84:87]
    ds_read_b64_tr_b16 a[150:151], v45 offset:50176
    v_mfma_f32_16x16x32_bf16 v[88:91], a[132:135], a[72:75], v[88:91]
    v_mfma_f32_16x16x32_bf16 v[92:95], a[132:135], a[76:79], v[92:95]
    v_accvgpr_write_b32 a2, 0
    v_accvgpr_write_b32 a3, 0
    s_waitcnt lgkmcnt(6)
    v_mfma_f32_16x16x32_bf16 v[64:67], a[136:139], a[80:83], v[64:67]
    ds_read_b64_tr_b16 a[152:153], v44 offset:57344
    v_mfma_f32_16x16x32_bf16 v[68:71], a[136:139], a[84:87], v[68:71]
    ds_read_b64_tr_b16 a[154:155], v44 offset:58368
    v_mfma_f32_16x16x32_bf16 v[72:75], a[136:139], a[88:91], v[72:75]
    v_mfma_f32_16x16x32_bf16 v[76:79], a[136:139], a[92:95], v[76:79]
    v_accvgpr_write_b32 a4, 0
    v_accvgpr_write_b32 a5, 0
    s_waitcnt lgkmcnt(6)
    v_mfma_f32_16x16x32_bf16 v[80:83], a[140:143], a[80:83], v[80:83]
    ds_read_b64_tr_b16 a[156:157], v45 offset:57344
    v_mfma_f32_16x16x32_bf16 v[84:87], a[140:143], a[84:87], v[84:87]
    ds_read_b64_tr_b16 a[158:159], v45 offset:58368
    v_mfma_f32_16x16x32_bf16 v[88:91], a[140:143], a[88:91], v[88:91]
    v_mfma_f32_16x16x32_bf16 v[92:95], a[140:143], a[92:95], v[92:95]
    v_accvgpr_write_b32 a6, 0
    v_accvgpr_write_b32 a7, 0
    s_waitcnt lgkmcnt(6)
    v_mfma_f32_16x16x32_bf16 v[64:67], a[144:147], a[96:99], v[64:67]
    ds_read_b64_tr_b16 a[128:129], v46 offset:32768
    v_mfma_f32_16x16x32_bf16 v[68:71], a[144:147], a[100:103], v[68:71]
    ds_read_b64_tr_b16 a[130:131], v46 offset:33792
    v_mfma_f32_16x16x32_bf16 v[72:75], a[144:147], a[104:107], v[72:75]
    v_mfma_f32_16x16x32_bf16 v[76:79], a[144:147], a[108:111], v[76:79]
    v_accvgpr_write_b32 a8, 0
    v_accvgpr_write_b32 a9, 0
    s_waitcnt lgkmcnt(6)
    v_mfma_f32_16x16x32_bf16 v[80:83], a[148:151], a[96:99], v[80:83]
    ds_read_b64_tr_b16 a[132:133], v47 offset:32768
    v_mfma_f32_16x16x32_bf16 v[84:87], a[148:151], a[100:103], v[84:87]
    ds_read_b64_tr_b16 a[134:135], v47 offset:33792
    v_mfma_f32_16x16x32_bf16 v[88:91], a[148:151], a[104:107], v[88:91]
    v_mfma_f32_16x16x32_bf16 v[92:95], a[148:151], a[108:111], v[92:95]
    v_accvgpr_write_b32 a10, 0
    v_accvgpr_write_b32 a11, 0
    s_waitcnt lgkmcnt(6)
    v_mfma_f32_16x16x32_bf16 v[64:67], a[152:155], a[112:115], v[64:67]
    ds_read_b64_tr_b16 a[136:137], v46 offset:40960
    v_mfma_f32_16x16x32_bf16 v[68:71], a[152:155], a[116:119], v[68:71]
    ds_read_b64_tr_b16 a[138:139], v46 offset:41984
    v_mfma_f32_16x16x32_bf16 v[72:75], a[152:155], a[120:123], v[72:75]
    v_mfma_f32_16x16x32_bf16 v[76:79], a[152:155], a[124:127], v[76:79]
    v_accvgpr_write_b32 a12, 0
    v_accvgpr_write_b32 a13, 0
    s_waitcnt lgkmcnt(6)
    v_mfma_f32_16x16x32_bf16 v[80:83], a[156:159], a[112:115], v[80:83]
    ds_read_b64_tr_b16 a[140:141], v47 offset:40960
    v_mfma_f32_16x16x32_bf16 v[84:87], a[156:159], a[116:119], v[84:87]
    ds_read_b64_tr_b16 a[142:143], v47 offset:41984
    v_mfma_f32_16x16x32_bf16 v[88:91], a[156:159], a[120:123], v[88:91]
    v_mfma_f32_16x16x32_bf16 v[92:95], a[156:159], a[124:127], v[92:95]
    v_accvgpr_write_b32 a14, 0
    v_accvgpr_write_b32 a15, 0
    s_waitcnt lgkmcnt(6)
    v_mfma_f32_16x16x32_bf16 v[96:99], a[128:131], a[64:67], v[96:99]
    ds_read_b64_tr_b16 a[144:145], v46 offset:49152
    v_mfma_f32_16x16x32_bf16 v[100:103], a[128:131], a[68:71], v[100:103]
    ds_read_b64_tr_b16 a[146:147], v46 offset:50176
    v_mfma_f32_16x16x32_bf16 v[104:107], a[128:131], a[72:75], v[104:107]
    v_mfma_f32_16x16x32_bf16 v[108:111], a[128:131], a[76:79], v[108:111]
    v_accvgpr_write_b32 a16, 0
    v_accvgpr_write_b32 a17, 0
    s_waitcnt lgkmcnt(6)
    v_mfma_f32_16x16x32_bf16 v[112:115], a[132:135], a[64:67], v[112:115]
    ds_read_b64_tr_b16 a[148:149], v47 offset:49152
    v_mfma_f32_16x16x32_bf16 v[116:119], a[132:135], a[68:71], v[116:119]
    ds_read_b64_tr_b16 a[150:151], v47 offset:50176
    v_mfma_f32_16x16x32_bf16 v[120:123], a[132:135], a[72:75], v[120:123]
    v_mfma_f32_16x16x32_bf16 v[124:127], a[132:135], a[76:79], v[124:127]
    v_accvgpr_write_b32 a18, 0
    v_accvgpr_write_b32 a19, 0
    s_waitcnt lgkmcnt(6)
    v_mfma_f32_16x16x32_bf16 v[96:99], a[136:139], a[80:83], v[96:99]
    ds_read_b64_tr_b16 a[152:153], v46 offset:57344
    v_mfma_f32_16x16x32_bf16 v[100:103], a[136:139], a[84:87], v[100:103]
    ds_read_b64_tr_b16 a[154:155], v46 offset:58368
    v_mfma_f32_16x16x32_bf16 v[104:107], a[136:139], a[88:91], v[104:107]
    v_mfma_f32_16x16x32_bf16 v[108:111], a[136:139], a[92:95], v[108:111]
    v_accvgpr_write_b32 a20, 0
    v_accvgpr_write_b32 a21, 0
    s_waitcnt lgkmcnt(6)
    v_mfma_f32_16x16x32_bf16 v[112:115], a[140:143], a[80:83], v[112:115]
    ds_read_b64_tr_b16 a[156:157], v47 offset:57344
    v_cvt_pk_bf16_f32 v192, v64, v65
    v_cvt_pk_bf16_f32 v193, v66, v67
    v_cvt_pk_bf16_f32 v194, v68, v69
    v_cvt_pk_bf16_f32 v195, v70, v71
    v_mfma_f32_16x16x32_bf16 v[116:119], a[140:143], a[84:87], v[116:119]
    ds_read_b64_tr_b16 a[158:159], v47 offset:58368
    v_mfma_f32_16x16x32_bf16 v[120:123], a[140:143], a[88:91], v[120:123]
    v_mfma_f32_16x16x32_bf16 v[124:127], a[140:143], a[92:95], v[124:127]
    s_nop 1
    v_permlane16_swap_b32 v192, v194
    v_permlane16_swap_b32 v193, v195
    v_cvt_pk_bf16_f32 v196, v80, v81
    v_accvgpr_write_b32 a22, 0
    v_accvgpr_write_b32 a23, 0
    s_waitcnt lgkmcnt(6)
    v_mfma_f32_16x16x32_bf16 v[96:99], a[144:147], a[96:99], v[96:99]
    ds_read_b64_tr_b16 a[128:129], v48 offset:32768
    v_cvt_pk_bf16_f32 v197, v82, v83
    v_cvt_pk_bf16_f32 v198, v84, v85
    v_cvt_pk_bf16_f32 v199, v86, v87
    s_nop 1
    v_mfma_f32_16x16x32_bf16 v[100:103], a[144:147], a[100:103], v[100:103]
    ds_read_b64_tr_b16 a[130:131], v48 offset:33792
    v_mfma_f32_16x16x32_bf16 v[104:107], a[144:147], a[104:107], v[104:107]
    v_mfma_f32_16x16x32_bf16 v[108:111], a[144:147], a[108:111], v[108:111]
    v_permlane16_swap_b32 v196, v198
    v_permlane16_swap_b32 v197, v199
    v_cvt_pk_bf16_f32 v224, v72, v73
    v_cvt_pk_bf16_f32 v225, v74, v75
    v_accvgpr_write_b32 a24, 0
    v_accvgpr_write_b32 a25, 0
    s_waitcnt lgkmcnt(6)
    v_mfma_f32_16x16x32_bf16 v[112:115], a[148:151], a[96:99], v[112:115]
    ds_read_b64_tr_b16 a[132:133], v49 offset:32768
    v_cvt_pk_bf16_f32 v226, v76, v77
    v_cvt_pk_bf16_f32 v227, v78, v79
    s_nop 1
    v_permlane16_swap_b32 v224, v226
    v_mfma_f32_16x16x32_bf16 v[116:119], a[148:151], a[100:103], v[116:119]
    ds_read_b64_tr_b16 a[134:135], v49 offset:33792
    v_mfma_f32_16x16x32_bf16 v[120:123], a[148:151], a[104:107], v[120:123]
    v_mfma_f32_16x16x32_bf16 v[124:127], a[148:151], a[108:111], v[124:127]
    v_permlane16_swap_b32 v225, v227
    v_cvt_pk_bf16_f32 v228, v88, v89
    v_cvt_pk_bf16_f32 v229, v90, v91
    v_cvt_pk_bf16_f32 v230, v92, v93
    v_accvgpr_write_b32 a26, 0
    v_accvgpr_write_b32 a27, 0
    s_waitcnt lgkmcnt(6)
    v_mfma_f32_16x16x32_bf16 v[96:99], a[152:155], a[112:115], v[96:99]
    ds_read_b64_tr_b16 a[136:137], v48 offset:40960
    v_cvt_pk_bf16_f32 v231, v94, v95
    s_nop 1
    v_permlane16_swap_b32 v228, v230
    v_permlane16_swap_b32 v229, v231
    v_mfma_f32_16x16x32_bf16 v[100:103], a[152:155], a[116:119], v[100:103]
    ds_read_b64_tr_b16 a[138:139], v48 offset:41984
    v_mfma_f32_16x16x32_bf16 v[104:107], a[152:155], a[120:123], v[104:107]
    v_mfma_f32_16x16x32_bf16 v[108:111], a[152:155], a[124:127], v[108:111]
    v_accvgpr_write_b32 a28, 0
    v_accvgpr_write_b32 a29, 0
    s_waitcnt lgkmcnt(6)
    v_mfma_f32_16x16x32_bf16 v[112:115], a[156:159], a[112:115], v[112:115]
    ds_read_b64_tr_b16 a[140:141], v49 offset:40960
    v_mfma_f32_16x16x32_bf16 v[116:119], a[156:159], a[116:119], v[116:119]
    ds_read_b64_tr_b16 a[142:143], v49 offset:41984
    v_mfma_f32_16x16x32_bf16 v[120:123], a[156:159], a[120:123], v[120:123]
    v_mfma_f32_16x16x32_bf16 v[124:127], a[156:159], a[124:127], v[124:127]
    v_accvgpr_write_b32 a30, 0
    v_accvgpr_write_b32 a31, 0
    s_waitcnt lgkmcnt(6)
    v_mfma_f32_16x16x32_bf16 v[128:131], a[128:131], a[64:67], v[128:131]
    ds_read_b64_tr_b16 a[144:145], v48 offset:49152
    v_mfma_f32_16x16x32_bf16 v[132:135], a[128:131], a[68:71], v[132:135]
    ds_read_b64_tr_b16 a[146:147], v48 offset:50176
    v_mfma_f32_16x16x32_bf16 v[136:139], a[128:131], a[72:75], v[136:139]
    v_mfma_f32_16x16x32_bf16 v[140:143], a[128:131], a[76:79], v[140:143]
    v_accvgpr_write_b32 a32, 0
    v_accvgpr_write_b32 a33, 0
    s_waitcnt lgkmcnt(6)
    v_mfma_f32_16x16x32_bf16 v[144:147], a[132:135], a[64:67], v[144:147]
    ds_read_b64_tr_b16 a[148:149], v49 offset:49152
    v_mfma_f32_16x16x32_bf16 v[148:151], a[132:135], a[68:71], v[148:151]
    ds_read_b64_tr_b16 a[150:151], v49 offset:50176
    v_mfma_f32_16x16x32_bf16 v[152:155], a[132:135], a[72:75], v[152:155]
    v_mfma_f32_16x16x32_bf16 v[156:159], a[132:135], a[76:79], v[156:159]
    v_accvgpr_write_b32 a34, 0
    v_accvgpr_write_b32 a35, 0
    s_waitcnt lgkmcnt(6)
    v_mfma_f32_16x16x32_bf16 v[128:131], a[136:139], a[80:83], v[128:131]
    ds_read_b64_tr_b16 a[152:153], v48 offset:57344
    v_mfma_f32_16x16x32_bf16 v[132:135], a[136:139], a[84:87], v[132:135]
    ds_read_b64_tr_b16 a[154:155], v48 offset:58368
    v_mfma_f32_16x16x32_bf16 v[136:139], a[136:139], a[88:91], v[136:139]
    v_mfma_f32_16x16x32_bf16 v[140:143], a[136:139], a[92:95], v[140:143]
    v_accvgpr_write_b32 a36, 0
    v_accvgpr_write_b32 a37, 0
    s_waitcnt lgkmcnt(6)
    v_mfma_f32_16x16x32_bf16 v[144:147], a[140:143], a[80:83], v[144:147]
    ds_read_b64_tr_b16 a[156:157], v49 offset:57344
    v_cvt_pk_bf16_f32 v200, v96, v97
    v_cvt_pk_bf16_f32 v201, v98, v99
    v_cvt_pk_bf16_f32 v202, v100, v101
    v_cvt_pk_bf16_f32 v203, v102, v103
    v_mfma_f32_16x16x32_bf16 v[148:151], a[140:143], a[84:87], v[148:151]
    ds_read_b64_tr_b16 a[158:159], v49 offset:58368
    v_mfma_f32_16x16x32_bf16 v[152:155], a[140:143], a[88:91], v[152:155]
    v_mfma_f32_16x16x32_bf16 v[156:159], a[140:143], a[92:95], v[156:159]
    s_nop 1
    v_permlane16_swap_b32 v200, v202
    v_permlane16_swap_b32 v201, v203
    v_cvt_pk_bf16_f32 v204, v112, v113
    v_accvgpr_write_b32 a38, 0
    v_accvgpr_write_b32 a39, 0
    s_waitcnt lgkmcnt(6)
    v_mfma_f32_16x16x32_bf16 v[128:131], a[144:147], a[96:99], v[128:131]
    ds_read_b64_tr_b16 a[128:129], v50 offset:32768
    v_cvt_pk_bf16_f32 v205, v114, v115
    v_cvt_pk_bf16_f32 v206, v116, v117
    v_cvt_pk_bf16_f32 v207, v118, v119
    s_nop 1
    v_mfma_f32_16x16x32_bf16 v[132:135], a[144:147], a[100:103], v[132:135]
    ds_read_b64_tr_b16 a[130:131], v50 offset:33792
    v_mfma_f32_16x16x32_bf16 v[136:139], a[144:147], a[104:107], v[136:139]
    v_mfma_f32_16x16x32_bf16 v[140:143], a[144:147], a[108:111], v[140:143]
    v_permlane16_swap_b32 v204, v206
    v_permlane16_swap_b32 v205, v207
    v_cvt_pk_bf16_f32 v232, v104, v105
    v_cvt_pk_bf16_f32 v233, v106, v107
    v_accvgpr_write_b32 a40, 0
    v_accvgpr_write_b32 a41, 0
    s_waitcnt lgkmcnt(6)
    v_mfma_f32_16x16x32_bf16 v[144:147], a[148:151], a[96:99], v[144:147]
    ds_read_b64_tr_b16 a[132:133], v51 offset:32768
    v_cvt_pk_bf16_f32 v234, v108, v109
    v_cvt_pk_bf16_f32 v235, v110, v111
    s_nop 1
    v_permlane16_swap_b32 v232, v234
    v_mfma_f32_16x16x32_bf16 v[148:151], a[148:151], a[100:103], v[148:151]
    ds_read_b64_tr_b16 a[134:135], v51 offset:33792
    v_mfma_f32_16x16x32_bf16 v[152:155], a[148:151], a[104:107], v[152:155]
    v_mfma_f32_16x16x32_bf16 v[156:159], a[148:151], a[108:111], v[156:159]
    v_permlane16_swap_b32 v233, v235
    v_cvt_pk_bf16_f32 v236, v120, v121
    v_cvt_pk_bf16_f32 v237, v122, v123
    v_cvt_pk_bf16_f32 v238, v124, v125
    v_accvgpr_write_b32 a42, 0
    v_accvgpr_write_b32 a43, 0
    s_waitcnt lgkmcnt(6)
    v_mfma_f32_16x16x32_bf16 v[128:131], a[152:155], a[112:115], v[128:131]
    ds_read_b64_tr_b16 a[136:137], v50 offset:40960
    v_cvt_pk_bf16_f32 v239, v126, v127
    s_nop 1
    v_permlane16_swap_b32 v236, v238
    v_permlane16_swap_b32 v237, v239
    v_mfma_f32_16x16x32_bf16 v[132:135], a[152:155], a[116:119], v[132:135]
    ds_read_b64_tr_b16 a[138:139], v50 offset:41984
    v_mfma_f32_16x16x32_bf16 v[136:139], a[152:155], a[120:123], v[136:139]
    v_mfma_f32_16x16x32_bf16 v[140:143], a[152:155], a[124:127], v[140:143]
    v_accvgpr_write_b32 a44, 0
    v_accvgpr_write_b32 a45, 0
    s_waitcnt lgkmcnt(6)
    v_mfma_f32_16x16x32_bf16 v[144:147], a[156:159], a[112:115], v[144:147]
    ds_read_b64_tr_b16 a[140:141], v51 offset:40960
    v_mfma_f32_16x16x32_bf16 v[148:151], a[156:159], a[116:119], v[148:151]
    ds_read_b64_tr_b16 a[142:143], v51 offset:41984
    v_mfma_f32_16x16x32_bf16 v[152:155], a[156:159], a[120:123], v[152:155]
    v_mfma_f32_16x16x32_bf16 v[156:159], a[156:159], a[124:127], v[156:159]
    v_accvgpr_write_b32 a46, 0
    v_accvgpr_write_b32 a47, 0
    s_waitcnt lgkmcnt(6)
    v_mfma_f32_16x16x32_bf16 v[160:163], a[128:131], a[64:67], v[160:163]
    ds_read_b64_tr_b16 a[144:145], v50 offset:49152
    v_mfma_f32_16x16x32_bf16 v[164:167], a[128:131], a[68:71], v[164:167]
    ds_read_b64_tr_b16 a[146:147], v50 offset:50176
    v_mfma_f32_16x16x32_bf16 v[168:171], a[128:131], a[72:75], v[168:171]
    v_mfma_f32_16x16x32_bf16 v[172:175], a[128:131], a[76:79], v[172:175]
    v_accvgpr_write_b32 a48, 0
    v_accvgpr_write_b32 a49, 0
    s_waitcnt lgkmcnt(6)
    v_mfma_f32_16x16x32_bf16 v[176:179], a[132:135], a[64:67], v[176:179]
    ds_read_b64_tr_b16 a[148:149], v51 offset:49152
    v_mfma_f32_16x16x32_bf16 v[180:183], a[132:135], a[68:71], v[180:183]
    ds_read_b64_tr_b16 a[150:151], v51 offset:50176
    v_mfma_f32_16x16x32_bf16 v[184:187], a[132:135], a[72:75], v[184:187]
    v_mfma_f32_16x16x32_bf16 v[188:191], a[132:135], a[76:79], v[188:191]
    v_accvgpr_write_b32 a50, 0
    v_accvgpr_write_b32 a51, 0
    s_waitcnt lgkmcnt(6)
    v_mfma_f32_16x16x32_bf16 v[160:163], a[136:139], a[80:83], v[160:163]
    ds_read_b64_tr_b16 a[152:153], v50 offset:57344
    v_mfma_f32_16x16x32_bf16 v[164:167], a[136:139], a[84:87], v[164:167]
    ds_read_b64_tr_b16 a[154:155], v50 offset:58368
    v_mfma_f32_16x16x32_bf16 v[168:171], a[136:139], a[88:91], v[168:171]
    v_mfma_f32_16x16x32_bf16 v[172:175], a[136:139], a[92:95], v[172:175]
    v_accvgpr_write_b32 a52, 0
    v_accvgpr_write_b32 a53, 0
    s_waitcnt lgkmcnt(6)
    v_mfma_f32_16x16x32_bf16 v[176:179], a[140:143], a[80:83], v[176:179]
    ds_read_b64_tr_b16 a[156:157], v51 offset:57344
    v_cvt_pk_bf16_f32 v208, v128, v129
    v_cvt_pk_bf16_f32 v209, v130, v131
    v_cvt_pk_bf16_f32 v210, v132, v133
    v_cvt_pk_bf16_f32 v211, v134, v135
    v_mfma_f32_16x16x32_bf16 v[180:183], a[140:143], a[84:87], v[180:183]
    ds_read_b64_tr_b16 a[158:159], v51 offset:58368
    v_mfma_f32_16x16x32_bf16 v[184:187], a[140:143], a[88:91], v[184:187]
    v_mfma_f32_16x16x32_bf16 v[188:191], a[140:143], a[92:95], v[188:191]
    s_nop 1
    v_permlane16_swap_b32 v208, v210
    v_permlane16_swap_b32 v209, v211
    v_cvt_pk_bf16_f32 v212, v144, v145
    v_accvgpr_write_b32 a54, 0
    v_accvgpr_write_b32 a55, 0
    s_waitcnt lgkmcnt(6)
    v_mfma_f32_16x16x32_bf16 v[160:163], a[144:147], a[96:99], v[160:163]
    v_cvt_pk_bf16_f32 v213, v146, v147
    v_cvt_pk_bf16_f32 v214, v148, v149
    v_cvt_pk_bf16_f32 v215, v150, v151
    s_nop 1
    v_mfma_f32_16x16x32_bf16 v[164:167], a[144:147], a[100:103], v[164:167]
    v_mfma_f32_16x16x32_bf16 v[168:171], a[144:147], a[104:107], v[168:171]
    v_mfma_f32_16x16x32_bf16 v[172:175], a[144:147], a[108:111], v[172:175]
    v_permlane16_swap_b32 v212, v214
    v_permlane16_swap_b32 v213, v215
    v_cvt_pk_bf16_f32 v240, v136, v137
    v_cvt_pk_bf16_f32 v241, v138, v139
    v_accvgpr_write_b32 a56, 0
    v_accvgpr_write_b32 a57, 0
    s_waitcnt lgkmcnt(4)
    v_mfma_f32_16x16x32_bf16 v[176:179], a[148:151], a[96:99], v[176:179]
    v_cvt_pk_bf16_f32 v242, v140, v141
    v_cvt_pk_bf16_f32 v243, v142, v143
    s_nop 1
    v_permlane16_swap_b32 v240, v242
    v_mfma_f32_16x16x32_bf16 v[180:183], a[148:151], a[100:103], v[180:183]
    v_mfma_f32_16x16x32_bf16 v[184:187], a[148:151], a[104:107], v[184:187]
    v_mfma_f32_16x16x32_bf16 v[188:191], a[148:151], a[108:111], v[188:191]
    v_permlane16_swap_b32 v241, v243
    v_cvt_pk_bf16_f32 v244, v152, v153
    v_cvt_pk_bf16_f32 v245, v154, v155
    v_cvt_pk_bf16_f32 v246, v156, v157
    v_accvgpr_write_b32 a58, 0
    v_accvgpr_write_b32 a59, 0
    s_waitcnt lgkmcnt(2)
    v_mfma_f32_16x16x32_bf16 v[160:163], a[152:155], a[112:115], v[160:163]
    v_cvt_pk_bf16_f32 v247, v158, v159
    s_nop 1
    v_permlane16_swap_b32 v244, v246
    v_permlane16_swap_b32 v245, v247
    v_mfma_f32_16x16x32_bf16 v[164:167], a[152:155], a[116:119], v[164:167]
    v_mfma_f32_16x16x32_bf16 v[168:171], a[152:155], a[120:123], v[168:171]
    v_mfma_f32_16x16x32_bf16 v[172:175], a[152:155], a[124:127], v[172:175]
    v_accvgpr_write_b32 a60, 0
    v_accvgpr_write_b32 a61, 0
    s_waitcnt lgkmcnt(0)
    v_mfma_f32_16x16x32_bf16 v[176:179], a[156:159], a[112:115], v[176:179]
    v_mfma_f32_16x16x32_bf16 v[180:183], a[156:159], a[116:119], v[180:183]
    v_mfma_f32_16x16x32_bf16 v[184:187], a[156:159], a[120:123], v[184:187]
    v_mfma_f32_16x16x32_bf16 v[188:191], a[156:159], a[124:127], v[188:191]
    v_accvgpr_write_b32 a62, 0
    v_accvgpr_write_b32 a63, 0
    s_nop 15
    v_cvt_pk_bf16_f32 v216, v160, v161
    v_cvt_pk_bf16_f32 v217, v162, v163
    v_cvt_pk_bf16_f32 v218, v164, v165
    v_cvt_pk_bf16_f32 v219, v166, v167
    s_nop 1
    v_permlane16_swap_b32 v216, v218
    v_permlane16_swap_b32 v217, v219
    v_cvt_pk_bf16_f32 v220, v176, v177
    v_cvt_pk_bf16_f32 v221, v178, v179
    v_cvt_pk_bf16_f32 v222, v180, v181
    v_cvt_pk_bf16_f32 v223, v182, v183
    s_nop 1
    v_permlane16_swap_b32 v220, v222
    v_permlane16_swap_b32 v221, v223
    v_cvt_pk_bf16_f32 v248, v168, v169
    v_cvt_pk_bf16_f32 v249, v170, v171
    v_cvt_pk_bf16_f32 v250, v172, v173
    v_cvt_pk_bf16_f32 v251, v174, v175
    s_nop 1
    v_permlane16_swap_b32 v248, v250
    v_permlane16_swap_b32 v249, v251
    v_cvt_pk_bf16_f32 v252, v184, v185
    v_cvt_pk_bf16_f32 v253, v186, v187
    v_cvt_pk_bf16_f32 v254, v188, v189
    v_cvt_pk_bf16_f32 v255, v190, v191
    s_nop 1
    v_permlane16_swap_b32 v252, v254
    v_permlane16_swap_b32 v253, v255
    s_waitcnt vmcnt(0)
    s_barrier
    s_add_u32 m0, s8, 7168
    s_mov_b32 s63, 86016
    buffer_load_dwordx4 v56, s[84:87], s63 offen lds
L_attn_kernel_att:
    v_mov_b32 v40, 0
    v_mov_b32 v41, 0
    ds_read_b128 a[128:131], v20 offset:0
    ds_read_b128 a[132:135], v21 offset:0
    ds_read_b128 a[136:139], v22 offset:0
    ds_read_b128 a[140:143], v23 offset:0
    s_waitcnt lgkmcnt(3)
    v_mfma_f32_32x32x16_bf16 v[64:79], a[128:131], v[192:195], 0
    ds_read_b128 a[144:147], v24 offset:0
    v_accvgpr_write_b32 a64, 0
    v_accvgpr_write_b32 a65, 0
    v_accvgpr_write_b32 a66, 0
    v_accvgpr_write_b32 a67, 0
    v_mfma_f32_32x32x16_bf16 v[80:95], a[128:131], v[224:227], 0
    v_accvgpr_write_b32 a68, 0
    v_accvgpr_write_b32 a69, 0
    v_accvgpr_write_b32 a70, 0
    v_accvgpr_write_b32 a71, 0
    s_waitcnt lgkmcnt(3)
    v_mfma_f32_32x32x16_bf16 v[64:79], a[132:135], v[196:199], v[64:79]
    ds_read_b128 a[148:151], v25 offset:0
    v_accvgpr_write_b32 a72, 0
    v_accvgpr_write_b32 a73, 0
    v_accvgpr_write_b32 a74, 0
    v_accvgpr_write_b32 a75, 0
    v_mfma_f32_32x32x16_bf16 v[80:95], a[132:135], v[228:231], v[80:95]
    v_accvgpr_write_b32 a76, 0
    v_accvgpr_write_b32 a77, 0
    v_accvgpr_write_b32 a78, 0
    v_accvgpr_write_b32 a79, 0
    s_waitcnt lgkmcnt(3)
    v_mfma_f32_32x32x16_bf16 v[64:79], a[136:139], v[200:203], v[64:79]
    ds_read_b128 a[152:155], v26 offset:0
    v_accvgpr_write_b32 a80, 0
    v_accvgpr_write_b32 a81, 0
    v_accvgpr_write_b32 a82, 0
    v_accvgpr_write_b32 a83, 0
    v_mfma_f32_32x32x16_bf16 v[80:95], a[136:139], v[232:235], v[80:95]
    v_accvgpr_write_b32 a84, 0
    v_accvgpr_write_b32 a85, 0
    v_accvgpr_write_b32 a86, 0
    v_accvgpr_write_b32 a87, 0
    s_waitcnt lgkmcnt(3)
    v_mfma_f32_32x32x16_bf16 v[64:79], a[140:143], v[204:207], v[64:79]
    ds_read_b128 a[156:159], v27 offset:0
    v_accvgpr_write_b32 a88, 0
    v_accvgpr_write_b32 a89, 0
    v_accvgpr_write_b32 a90, 0
    v_accvgpr_write_b32 a91, 0
    v_mfma_f32_32x32x16_bf16 v[80:95], a[140:143], v[236:239], v[80:95]
    v_accvgpr_write_b32 a92, 0
    v_accvgpr_write_b32 a93, 0
    v_accvgpr_write_b32 a94, 0
    v_accvgpr_write_b32 a95, 0
    s_waitcnt lgkmcnt(3)
    v_mfma_f32_32x32x16_bf16 v[64:79], a[144:147], v[208:211], v[64:79]
    ds_read_b128 a[128:131], v20 offset:8192
    v_accvgpr_write_b32 a96, 0
    v_accvgpr_write_b32 a97, 0
    v_accvgpr_write_b32 a98, 0
    v_accvgpr_write_b32 a99, 0
    v_mfma_f32_32x32x16_bf16 v[80:95], a[144:147], v[240:243], v[80:95]
    v_accvgpr_write_b32 a100, 0
    v_accvgpr_write_b32 a101, 0
    v_accvgpr_write_b32 a102, 0
    v_accvgpr_write_b32 a103, 0
    s_waitcnt lgkmcnt(3)
    v_mfma_f32_32x32x16_bf16 v[64:79], a[148:151], v[212:215], v[64:79]
    ds_read_b128 a[132:135], v21 offset:8192
    v_accvgpr_write_b32 a104, 0
    v_accvgpr_write_b32 a105, 0
    v_accvgpr_write_b32 a106, 0
    v_accvgpr_write_b32 a107, 0
    v_mfma_f32_32x32x16_bf16 v[80:95], a[148:151], v[244:247], v[80:95]
    v_accvgpr_write_b32 a108, 0
    v_accvgpr_write_b32 a109, 0
    v_accvgpr_write_b32 a110, 0
    v_accvgpr_write_b32 a111, 0
    s_waitcnt lgkmcnt(3)
    v_mfma_f32_32x32x16_bf16 v[64:79], a[152:155], v[216:219], v[64:79]
    ds_read_b128 a[136:139], v22 offset:8192
    v_accvgpr_write_b32 a112, 0
    v_accvgpr_write_b32 a113, 0
    v_accvgpr_write_b32 a114, 0
    v_accvgpr_write_b32 a115, 0
    v_mfma_f32_32x32x16_bf16 v[80:95], a[152:155], v[248:251], v[80:95]
    v_accvgpr_write_b32 a116, 0
    v_accvgpr_write_b32 a117, 0
    v_accvgpr_write_b32 a118, 0
    v_accvgpr_write_b32 a119, 0
    s_waitcnt lgkmcnt(3)
    v_mfma_f32_32x32x16_bf16 v[64:79], a[156:159], v[220:223], v[64:79]
    ds_read_b128 a[140:143], v23 offset:8192
    v_accvgpr_write_b32 a120, 0
    v_accvgpr_write_b32 a121, 0
    v_accvgpr_write_b32 a122, 0
    v_accvgpr_write_b32 a123, 0
    v_mfma_f32_32x32x16_bf16 v[80:95], a[156:159], v[252:255], v[80:95]
    v_accvgpr_write_b32 a124, 0
    v_accvgpr_write_b32 a125, 0
    v_accvgpr_write_b32 a126, 0
    v_accvgpr_write_b32 a127, 0
    s_nop 7
    s_nop 7
    s_cmp_eq_u32 s46, 1
    s_cbranch_scc1 L_attn_kernel_havem
    v_max3_f32 v42, v64, v65, v66
    v_max3_f32 v42, v42, v67, v68
    v_max3_f32 v42, v42, v69, v70
    v_max3_f32 v42, v42, v71, v72
    v_max3_f32 v42, v42, v73, v74
    v_max3_f32 v42, v42, v75, v76
    v_max3_f32 v42, v42, v77, v78
    v_max_f32 v42, v42, v79
    v_max3_f32 v43, v80, v81, v82
    v_max3_f32 v43, v43, v83, v84
    v_max3_f32 v43, v43, v85, v86
    v_max3_f32 v43, v43, v87, v88
    v_max3_f32 v43, v43, v89, v90
    v_max3_f32 v43, v43, v91, v92
    v_max3_f32 v43, v43, v93, v94
    v_max_f32 v43, v43, v95
    v_mov_b32 v44, v42
    v_mov_b32 v45, v43
    s_nop 1
    v_permlane32_swap_b32 v42, v44
    v_permlane32_swap_b32 v43, v45
    s_nop 1
    v_max_f32 v42, v42, v44
    v_max_f32 v43, v43, v45
    v_sub_f32 v42, 0xc1f00000, v42
    v_sub_f32 v43, 0xc1f00000, v43
L_attn_kernel_havem:
    v_mov_b32 v160, v42
    v_mov_b32 v161, v42
    v_mov_b32 v162, v42
    v_mov_b32 v163, v42
    v_mov_b32 v164, v42
    v_mov_b32 v165, v42
    v_mov_b32 v166, v42
    v_mov_b32 v167, v42
    v_mov_b32 v168, v42
    v_mov_b32 v169, v42
    v_mov_b32 v170, v42
    v_mov_b32 v171, v42
    v_mov_b32 v172, v42
    v_mov_b32 v173, v42
    v_mov_b32 v174, v42
    v_mov_b32 v175, v42
    v_add_f32 v64, v64, v42
    v_add_f32 v65, v65, v42
    v_add_f32 v66, v66, v42
    v_add_f32 v67, v67, v42
    v_add_f32 v68, v68, v42
    v_add_f32 v69, v69, v42
    v_add_f32 v70, v70, v42
    v_add_f32 v71, v71, v42
    v_add_f32 v72, v72, v42
    v_add_f32 v73, v73, v42
    v_add_f32 v74, v74, v42
    v_add_f32 v75, v75, v42
    v_add_f32 v76, v76, v42
    v_add_f32 v77, v77, v42
    v_add_f32 v78, v78, v42
    v_add_f32 v79, v79, v42
    v_mov_b32 v176, v43
    v_mov_b32 v177, v43
    v_mov_b32 v178, v43
    v_mov_b32 v179, v43
    v_mov_b32 v180, v43
    v_mov_b32 v181, v43
    v_mov_b32 v182, v43
    v_mov_b32 v183, v43
    v_mov_b32 v184, v43
    v_mov_b32 v185, v43
    v_mov_b32 v186, v43
    v_mov_b32 v187, v43
    v_mov_b32 v188, v43
    v_mov_b32 v189, v43
    v_mov_b32 v190, v43
    v_mov_b32 v191, v43
    v_add_f32 v80, v80, v43
    v_add_f32 v81, v81, v43
    v_add_f32 v82, v82, v43
    v_add_f32 v83, v83, v43
    v_add_f32 v84, v84, v43
    v_add_f32 v85, v85, v43
    v_add_f32 v86, v86, v43
    v_add_f32 v87, v87, v43
    v_add_f32 v88, v88, v43
    v_add_f32 v89, v89, v43
    v_add_f32 v90, v90, v43
    v_add_f32 v91, v91, v43
    v_add_f32 v92, v92, v43
    v_add_f32 v93, v93, v43
    v_add_f32 v94, v94, v43
    v_add_f32 v95, v95, v43
    s_waitcnt lgkmcnt(3)
    v_mfma_f32_32x32x16_bf16 v[96:111], a[128:131], v[192:195], v[160:175]
    ds_read_b128 a[144:147], v24 offset:8192
    v_exp_f32 v64, v64
    v_exp_f32 v65, v65
    v_exp_f32 v66, v66
    v_exp_f32 v67, v67
    v_add_f32 v40, v40, v64
    v_mfma_f32_32x32x16_bf16 v[112:127], a[128:131], v[224:227], v[176:191]
    v_cvt_pk_bf16_f32 v128, v64, v65
    v_add_f32 v40, v40, v65
    v_exp_f32 v68, v68
    v_exp_f32 v69, v69
    v_add_f32 v40, v40, v66
    s_waitcnt lgkmcnt(3)
    v_mfma_f32_32x32x16_bf16 v[96:111], a[132:135], v[196:199], v[96:111]
    ds_read_b128 a[148:151], v25 offset:8192
    v_cvt_pk_bf16_f32 v129, v66, v67
    v_add_f32 v40, v40, v67
    v_exp_f32 v70, v70
    v_exp_f32 v71, v71
    v_add_f32 v40, v40, v68
    v_mfma_f32_32x32x16_bf16 v[112:127], a[132:135], v[228:231], v[112:127]
    v_cvt_pk_bf16_f32 v130, v68, v69
    v_add_f32 v40, v40, v69
    v_exp_f32 v72, v72
    v_exp_f32 v73, v73
    v_add_f32 v40, v40, v70
    s_waitcnt lgkmcnt(3)
    v_mfma_f32_32x32x16_bf16 v[96:111], a[136:139], v[200:203], v[96:111]
    ds_read_b128 a[152:155], v26 offset:8192
    v_cvt_pk_bf16_f32 v131, v70, v71
    v_add_f32 v40, v40, v71
    v_exp_f32 v74, v74
    v_exp_f32 v75, v75
    v_add_f32 v40, v40, v72
    v_mfma_f32_32x32x16_bf16 v[112:127], a[136:139], v[232:235], v[112:127]
    v_cvt_pk_bf16_f32 v132, v72, v73
    v_add_f32 v40, v40, v73
    v_exp_f32 v76, v76
    v_exp_f32 v77, v77
    v_add_f32 v40, v40, v74
    s_waitcnt lgkmcnt(3)
    v_mfma_f32_32x32x16_bf16 v[96:111], a[140:143], v[204:207], v[96:111]
    ds_read_b128 a[156:159], v27 offset:8192
    v_cvt_pk_bf16_f32 v133, v74, v75
    v_add_f32 v40, v40, v75
    v_exp_f32 v78, v78
    v_exp_f32 v79, v79
    v_add_f32 v40, v40, v76
    v_mfma_f32_32x32x16_bf16 v[112:127], a[140:143], v[236:239], v[112:127]
    v_cvt_pk_bf16_f32 v134, v76, v77
    v_add_f32 v40, v40, v77
    v_exp_f32 v80, v80
    v_exp_f32 v81, v81
    v_add_f32 v40, v40, v78
    s_waitcnt lgkmcnt(3)
    v_mfma_f32_32x32x16_bf16 v[96:111], a[144:147], v[208:211], v[96:111]
    v_add_u32 v20, 16384, v20
    v_add_u32 v21, 16384, v21
    v_add_u32 v22, 16384, v22
    v_add_u32 v23, 16384, v23
    v_add_u32 v24, 16384, v24
    v_add_u32 v25, 16384, v25
    v_add_u32 v26, 16384, v26
    v_add_u32 v27, 16384, v27
    ds_read_b128 a[128:131], v20 offset:0
    v_cvt_pk_bf16_f32 v135, v78, v79
    v_add_f32 v40, v40, v79
    v_exp_f32 v82, v82
    v_exp_f32 v83, v83
    v_add_f32 v41, v41, v80
    v_mfma_f32_32x32x16_bf16 v[112:127], a[144:147], v[240:243], v[112:127]
    v_cvt_pk_bf16_f32 v136, v80, v81
    v_add_f32 v41, v41, v81
    v_exp_f32 v84, v84
    v_exp_f32 v85, v85
    v_add_f32 v41, v41, v82
    s_waitcnt lgkmcnt(3)
    v_mfma_f32_32x32x16_bf16 v[96:111], a[148:151], v[212:215], v[96:111]
    ds_read_b128 a[132:135], v21 offset:0
    v_cvt_pk_bf16_f32 v137, v82, v83
    v_add_f32 v41, v41, v83
    v_exp_f32 v86, v86
    v_exp_f32 v87, v87
    v_add_f32 v41, v41, v84
    v_mfma_f32_32x32x16_bf16 v[112:127], a[148:151], v[244:247], v[112:127]
    v_cvt_pk_bf16_f32 v138, v84, v85
    v_add_f32 v41, v41, v85
    v_exp_f32 v88, v88
    v_exp_f32 v89, v89
    v_add_f32 v41, v41, v86
    s_waitcnt lgkmcnt(3)
    v_mfma_f32_32x32x16_bf16 v[96:111], a[152:155], v[216:219], v[96:111]
    ds_read_b128 a[136:139], v22 offset:0
    v_cvt_pk_bf16_f32 v139, v86, v87
    v_add_f32 v41, v41, v87
    v_exp_f32 v90, v90
    v_exp_f32 v91, v91
    v_add_f32 v41, v41, v88
    v_mfma_f32_32x32x16_bf16 v[112:127], a[152:155], v[248:251], v[112:127]
    v_cvt_pk_bf16_f32 v140, v88, v89
    v_add_f32 v41, v41, v89
    v_exp_f32 v92, v92
    v_exp_f32 v93, v93
    v_add_f32 v41, v41, v90
    s_waitcnt lgkmcnt(3)
    v_mfma_f32_32x32x16_bf16 v[96:111], a[156:159], v[220:223], v[96:111]
    ds_read_b128 a[140:143], v23 offset:0
    v_cvt_pk_bf16_f32 v141, v90, v91
    v_add_f32 v41, v41, v91
    v_exp_f32 v94, v94
    v_exp_f32 v95, v95
    v_add_f32 v41, v41, v92
    v_mfma_f32_32x32x16_bf16 v[112:127], a[156:159], v[252:255], v[112:127]
    v_cvt_pk_bf16_f32 v142, v92, v93
    v_add_f32 v41, v41, v93
    s_nop 0
    v_add_f32 v41, v41, v94
    v_cvt_pk_bf16_f32 v143, v94, v95
    v_add_f32 v41, v41, v95
    s_mov_b32 s47, 16384
    s_mov_b32 s48, 1
    s_add_u32 s49, s44, 16384
L_attn_kernel_aloop:
    s_add_u32 s50, s47, 16384
    s_cmp_eq_u32 s50, 49152
    s_cselect_b32 s50, 0, s50
    s_add_u32 s51, s50, 16384
    s_cmp_eq_u32 s51, 49152
    s_cselect_b32 s51, 0, s51
    s_sub_u32 s52, s50, s47
    s_sub_u32 s53, s47, s51
    s_add_u32 s45, s49, 16384
    s_add_u32 s54, s50, 65536
    s_add_u32 s55, s47, 114688
    s_waitcnt lgkmcnt(3)
    v_mfma_f32_32x32x16_bf16 v[64:79], a[128:131], v[192:195], v[160:175]
    s_add_u32 m0, s30, s54
    s_nop 0
    buffer_load_dwordx4 v12, s[32:35], s45 offen offset:0 lds
    ds_read_b128 a[144:147], v24 offset:0
    v_exp_f32 v96, v96
    v_exp_f32 v97, v97
    v_mfma_f32_32x32x16_bf16 v[80:95], a[128:131], v[224:227], v[176:191]
    v_exp_f32 v98, v98
    v_exp_f32 v99, v99
    v_add_f32 v40, v40, v96
    s_waitcnt lgkmcnt(3)
    v_mfma_f32_32x32x16_bf16 v[64:79], a[132:135], v[196:199], v[64:79]
    buffer_load_dwordx4 v13, s[32:35], s45 offen offset:1024 lds
    ds_read_b128 a[148:151], v25 offset:0
    v_cvt_pk_bf16_f32 v144, v96, v97
    v_add_f32 v40, v40, v97
    v_mfma_f32_32x32x16_bf16 v[80:95], a[132:135], v[228:231], v[80:95]
    v_exp_f32 v100, v100
    v_exp_f32 v101, v101
    v_add_f32 v40, v40, v98
    s_waitcnt lgkmcnt(3)
    v_mfma_f32_32x32x16_bf16 v[64:79], a[136:139], v[200:203], v[64:79]
    buffer_load_dwordx4 v14, s[32:35], s45 offen offset:2048 lds
    ds_read_b128 a[152:155], v26 offset:0
    v_cvt_pk_bf16_f32 v145, v98, v99
    v_add_f32 v40, v40, v99
    v_mfma_f32_32x32x16_bf16 v[80:95], a[136:139], v[232:235], v[80:95]
    v_exp_f32 v102, v102
    v_exp_f32 v103, v103
    v_add_f32 v40, v40, v100
    s_waitcnt lgkmcnt(3)
    v_mfma_f32_32x32x16_bf16 v[64:79], a[140:143], v[204:207], v[64:79]
    buffer_load_dwordx4 v15, s[32:35], s45 offen offset:3072 lds
    ds_read_b128 a[156:159], v27 offset:0
    v_cvt_pk_bf16_f32 v146, v100, v101
    v_add_f32 v40, v40, v101
    v_mfma_f32_32x32x16_bf16 v[80:95], a[140:143], v[236:239], v[80:95]
    v_exp_f32 v104, v104
    v_exp_f32 v105, v105
    v_add_f32 v40, v40, v102
    s_waitcnt lgkmcnt(3)
    v_mfma_f32_32x32x16_bf16 v[64:79], a[144:147], v[208:211], v[64:79]
    s_add_u32 m0, s30, s55
    s_nop 0
    buffer_load_dwordx4 v16, s[36:39], s49 offen offset:0 lds
    ds_read_b64_tr_b16 a[128:129], v28 offset:0
    ds_read_b64_tr_b16 a[130:131], v28 offset:2048
    v_cvt_pk_bf16_f32 v147, v102, v103
    v_add_f32 v40, v40, v103
    v_mfma_f32_32x32x16_bf16 v[80:95], a[144:147], v[240:243], v[80:95]
    v_exp_f32 v106, v106
    v_exp_f32 v107, v107
    v_add_f32 v40, v40, v104
    s_waitcnt lgkmcnt(4)
    v_mfma_f32_32x32x16_bf16 v[64:79], a[148:151], v[212:215], v[64:79]
    buffer_load_dwordx4 v16, s[36:39], s49 offen offset:1024 lds
    ds_read_b64_tr_b16 a[132:133], v29 offset:0
    ds_read_b64_tr_b16 a[134:135], v29 offset:2048
    v_cvt_pk_bf16_f32 v148, v104, v105
    v_add_f32 v40, v40, v105
    v_mfma_f32_32x32x16_bf16 v[80:95], a[148:151], v[244:247], v[80:95]
    v_exp_f32 v108, v108
    v_exp_f32 v109, v109
    v_add_f32 v40, v40, v106
    s_waitcnt lgkmcnt(5)
    v_mfma_f32_32x32x16_bf16 v[64:79], a[152:155], v[216:219], v[64:79]
    buffer_load_dwordx4 v16, s[36:39], s49 offen offset:2048 lds
    ds_read_b64_tr_b16 a[136:137], v30 offset:0
    ds_read_b64_tr_b16 a[138:139], v30 offset:2048
    v_cvt_pk_bf16_f32 v149, v106, v107
    v_add_f32 v40, v40, v107
    v_mfma_f32_32x32x16_bf16 v[80:95], a[152:155], v[248:251], v[80:95]
    v_exp_f32 v110, v110
    v_exp_f32 v111, v111
    v_add_f32 v40, v40, v108
    s_waitcnt lgkmcnt(6)
    v_mfma_f32_32x32x16_bf16 v[64:79], a[156:159], v[220:223], v[64:79]
    buffer_load_dwordx4 v16, s[36:39], s49 offen offset:3072 lds
    ds_read_b64_tr_b16 a[140:141], v31 offset:0
    ds_read_b64_tr_b16 a[142:143], v31 offset:2048
    v_cvt_pk_bf16_f32 v150, v108, v109
    v_add_f32 v40, v40, v109
    v_mfma_f32_32x32x16_bf16 v[80:95], a[156:159], v[252:255], v[80:95]
    v_exp_f32 v112, v112
    v_exp_f32 v113, v113
    v_add_f32 v40, v40, v110
    s_waitcnt lgkmcnt(6)
    v_mfma_f32_32x32x16_bf16 a[0:15], a[128:131], v[128:131], a[0:15]
    ds_read_b64_tr_b16 a[144:145], v28 offset:4096
    ds_read_b64_tr_b16 a[146:147], v28 offset:6144
    v_cvt_pk_bf16_f32 v151, v110, v111
    v_add_f32 v40, v40, v111
    v_exp_f32 v114, v114
    v_mfma_f32_32x32x16_bf16 a[16:31], a[128:131], v[136:139], a[16:31]
    v_exp_f32 v115, v115
    v_add_f32 v41, v41, v112
    s_waitcnt lgkmcnt(6)
    v_mfma_f32_32x32x16_bf16 a[32:47], a[132:135], v[128:131], a[32:47]
    s_sub_u32 s63, s48, 1
    s_lshl_b32 s9, s63, 10
    s_add_u32 m0, s8, s9
    s_mul_i32 s63, s63, 12288
    buffer_load_dwordx4 v56, s[84:87], s63 offen lds
    s_sub_u32 s63, s48, s80
    s_cmp_eq_u32 s63, 1
    s_cselect_b32 s76, s60, s64
    s_cselect_b32 s77, s61, s65
    s_cselect_b32 s78, s81, 0
    s_cmp_eq_u32 s63, 3
    s_cselect_b32 s78, s62, s78
    s_cmp_eq_u32 s63, 5
    s_cselect_b32 s76, s66, s76
    s_cselect_b32 s77, s67, s77
    s_cselect_b32 s78, s62, s78
    buffer_load_dword v18, v17, s[76:79], 0 offen
    ds_read_b64_tr_b16 a[148:149], v29 offset:4096
    ds_read_b64_tr_b16 a[150:151], v29 offset:6144
    v_cvt_pk_bf16_f32 v152, v112, v113
    v_add_f32 v41, v41, v113
    v_exp_f32 v116, v116
    v_mfma_f32_32x32x16_bf16 a[48:63], a[132:135], v[136:139], a[48:63]
    v_exp_f32 v117, v117
    v_add_f32 v41, v41, v114
    s_waitcnt lgkmcnt(6)
    v_mfma_f32_32x32x16_bf16 a[64:79], a[136:139], v[128:131], a[64:79]
    ds_read_b64_tr_b16 a[152:153], v30 offset:4096
    ds_read_b64_tr_b16 a[154:155], v30 offset:6144
    v_cvt_pk_bf16_f32 v153, v114, v115
    v_add_f32 v41, v41, v115
    v_exp_f32 v118, v118
    v_mfma_f32_32x32x16_bf16 a[80:95], a[136:139], v[136:139], a[80:95]
    v_exp_f32 v119, v119
    v_add_f32 v41, v41, v116
    s_waitcnt lgkmcnt(6)
    v_mfma_f32_32x32x16_bf16 a[96:111], a[140:143], v[128:131], a[96:111]
    ds_read_b64_tr_b16 a[156:157], v31 offset:4096
    ds_read_b64_tr_b16 a[158:159], v31 offset:6144
    v_cvt_pk_bf16_f32 v154, v116, v117
    v_add_f32 v41, v41, v117
    v_exp_f32 v120, v120
    v_mfma_f32_32x32x16_bf16 a[112:127], a[140:143], v[136:139], a[112:127]
    v_exp_f32 v121, v121
    v_add_f32 v41, v41, v118
    s_waitcnt lgkmcnt(6)
    v_mfma_f32_32x32x16_bf16 a[0:15], a[144:147], v[132:135], a[0:15]
    ds_read_b128 a[128:131], v20 offset:8192
    v_cvt_pk_bf16_f32 v155, v118, v119
    v_add_f32 v41, v41, v119
    v_exp_f32 v122, v122
    v_mfma_f32_32x32x16_bf16 a[16:31], a[144:147], v[140:143], a[16:31]
    v_exp_f32 v123, v123
    v_add_f32 v41, v41, v120
    s_waitcnt lgkmcnt(5)
    v_mfma_f32_32x32x16_bf16 a[32:47], a[148:151], v[132:135], a[32:47]
    ds_read_b128 a[132:135], v21 offset:8192
    v_cvt_pk_bf16_f32 v156, v120, v121
    v_add_f32 v41, v41, v121
    v_exp_f32 v124, v124
    v_mfma_f32_32x32x16_bf16 a[48:63], a[148:151], v[140:143], a[48:63]
    v_exp_f32 v125, v125
    v_add_f32 v41, v41, v122
    s_waitcnt lgkmcnt(4)
    v_mfma_f32_32x32x16_bf16 a[64:79], a[152:155], v[132:135], a[64:79]
    ds_read_b128 a[136:139], v22 offset:8192
    v_cvt_pk_bf16_f32 v157, v122, v123
    v_add_f32 v41, v41, v123
    v_exp_f32 v126, v126
    v_mfma_f32_32x32x16_bf16 a[80:95], a[152:155], v[140:143], a[80:95]
    v_exp_f32 v127, v127
    v_add_f32 v41, v41, v124
    s_waitcnt lgkmcnt(3)
    v_mfma_f32_32x32x16_bf16 a[96:111], a[156:159], v[132:135], a[96:111]
    ds_read_b128 a[140:143], v23 offset:8192
    v_cvt_pk_bf16_f32 v158, v124, v125
    v_add_f32 v41, v41, v125
    s_nop 0
    v_mfma_f32_32x32x16_bf16 a[112:127], a[156:159], v[140:143], a[112:127]
    v_add_f32 v41, v41, v126
    v_cvt_pk_bf16_f32 v159, v126, v127
    v_add_f32 v41, v41, v127
    s_waitcnt lgkmcnt(3)
    v_mfma_f32_32x32x16_bf16 v[96:111], a[128:131], v[192:195], v[160:175]
    ds_read_b128 a[144:147], v24 offset:8192
    v_exp_f32 v64, v64
    v_exp_f32 v65, v65
    v_mfma_f32_32x32x16_bf16 v[112:127], a[128:131], v[224:227], v[176:191]
    v_exp_f32 v66, v66
    v_exp_f32 v67, v67
    v_add_f32 v40, v40, v64
    s_waitcnt lgkmcnt(3)
    v_mfma_f32_32x32x16_bf16 v[96:111], a[132:135], v[196:199], v[96:111]
    ds_read_b128 a[148:151], v25 offset:8192
    v_cvt_pk_bf16_f32 v128, v64, v65
    v_add_f32 v40, v40, v65
    v_mfma_f32_32x32x16_bf16 v[112:127], a[132:135], v[228:231], v[112:127]
    v_exp_f32 v68, v68
    v_exp_f32 v69, v69
    v_add_f32 v40, v40, v66
    s_waitcnt lgkmcnt(3)
    v_mfma_f32_32x32x16_bf16 v[96:111], a[136:139], v[200:203], v[96:111]
    ds_read_b128 a[152:155], v26 offset:8192
    v_cvt_pk_bf16_f32 v129, v66, v67
    v_add_f32 v40, v40, v67
    v_mfma_f32_32x32x16_bf16 v[112:127], a[136:139], v[232:235], v[112:127]
    v_exp_f32 v70, v70
    v_exp_f32 v71, v71
    v_add_f32 v40, v40, v68
    s_waitcnt lgkmcnt(3)
    v_mfma_f32_32x32x16_bf16 v[96:111], a[140:143], v[204:207], v[96:111]
    ds_read_b128 a[156:159], v27 offset:8192
    v_cvt_pk_bf16_f32 v130, v68, v69
    v_add_f32 v40, v40, v69
    v_mfma_f32_32x32x16_bf16 v[112:127], a[140:143], v[236:239], v[112:127]
    v_exp_f32 v72, v72
    v_exp_f32 v73, v73
    v_add_f32 v40, v40, v70
    s_waitcnt lgkmcnt(3)
    v_mfma_f32_32x32x16_bf16 v[96:111], a[144:147], v[208:211], v[96:111]
    v_add_u32 v20, s52, v20
    v_add_u32 v21, s52, v21
    v_add_u32 v22, s52, v22
    v_add_u32 v23, s52, v23
    v_add_u32 v24, s52, v24
    v_add_u32 v25, s52, v25
    v_add_u32 v26, s52, v26
    v_add_u32 v27, s52, v27
    ds_read_b64_tr_b16 a[128:129], v28 offset:8192
    ds_read_b64_tr_b16 a[130:131], v28 offset:10240
    v_cvt_pk_bf16_f32 v131, v70, v71
    v_add_f32 v40, v40, v71
    v_mfma_f32_32x32x16_bf16 v[112:127], a[144:147], v[240:243], v[112:127]
    v_exp_f32 v74, v74
    v_exp_f32 v75, v75
    v_add_f32 v40, v40, v72
    s_waitcnt lgkmcnt(4)
    v_mfma_f32_32x32x16_bf16 v[96:111], a[148:151], v[212:215], v[96:111]
    ds_read_b64_tr_b16 a[132:133], v29 offset:8192
    ds_read_b64_tr_b16 a[134:135], v29 offset:10240
    v_cvt_pk_bf16_f32 v132, v72, v73
    v_add_f32 v40, v40, v73
    v_mfma_f32_32x32x16_bf16 v[112:127], a[148:151], v[244:247], v[112:127]
    v_exp_f32 v76, v76
    v_exp_f32 v77, v77
    v_add_f32 v40, v40, v74
    s_waitcnt lgkmcnt(5)
    v_mfma_f32_32x32x16_bf16 v[96:111], a[152:155], v[216:219], v[96:111]
    ds_read_b64_tr_b16 a[136:137], v30 offset:8192
    ds_read_b64_tr_b16 a[138:139], v30 offset:10240
    v_cvt_pk_bf16_f32 v133, v74, v75
    v_add_f32 v40, v40, v75
    v_mfma_f32_32x32x16_bf16 v[112:127], a[152:155], v[248:251], v[112:127]
    v_exp_f32 v78, v78
    v_exp_f32 v79, v79
    v_add_f32 v40, v40, v76
    s_waitcnt lgkmcnt(6)
    v_mfma_f32_32x32x16_bf16 v[96:111], a[156:159], v[220:223], v[96:111]
    ds_read_b64_tr_b16 a[140:141], v31 offset:8192
    ds_read_b64_tr_b16 a[142:143], v31 offset:10240
    v_cvt_pk_bf16_f32 v134, v76, v77
    v_add_f32 v40, v40, v77
    v_mfma_f32_32x32x16_bf16 v[112:127], a[156:159], v[252:255], v[112:127]
    v_exp_f32 v80, v80
    v_exp_f32 v81, v81
    v_add_f32 v40, v40, v78
    s_waitcnt lgkmcnt(6)
    v_mfma_f32_32x32x16_bf16 a[0:15], a[128:131], v[144:147], a[0:15]
    ds_read_b64_tr_b16 a[144:145], v28 offset:12288
    ds_read_b64_tr_b16 a[146:147], v28 offset:14336
    v_cvt_pk_bf16_f32 v135, v78, v79
    v_add_f32 v40, v40, v79
    v_exp_f32 v82, v82
    v_mfma_f32_32x32x16_bf16 a[16:31], a[128:131], v[152:155], a[16:31]
    v_exp_f32 v83, v83
    v_add_f32 v41, v41, v80
    s_waitcnt lgkmcnt(6)
    v_mfma_f32_32x32x16_bf16 a[32:47], a[132:135], v[144:147], a[32:47]
    ds_read_b64_tr_b16 a[148:149], v29 offset:12288
    ds_read_b64_tr_b16 a[150:151], v29 offset:14336
    v_cvt_pk_bf16_f32 v136, v80, v81
    v_add_f32 v41, v41, v81
    v_exp_f32 v84, v84
    v_mfma_f32_32x32x16_bf16 a[48:63], a[132:135], v[152:155], a[48:63]
    v_exp_f32 v85, v85
    v_add_f32 v41, v41, v82
    s_waitcnt lgkmcnt(6)
    v_mfma_f32_32x32x16_bf16 a[64:79], a[136:139], v[144:147], a[64:79]
    ds_read_b64_tr_b16 a[152:153], v30 offset:12288
    ds_read_b64_tr_b16 a[154:155], v30 offset:14336
    v_cvt_pk_bf16_f32 v137, v82, v83
    v_add_f32 v41, v41, v83
    v_exp_f32 v86, v86
    v_mfma_f32_32x32x16_bf16 a[80:95], a[136:139], v[152:155], a[80:95]
    v_exp_f32 v87, v87
    v_add_f32 v41, v41, v84
    s_waitcnt lgkmcnt(6)
    v_mfma_f32_32x32x16_bf16 a[96:111], a[140:143], v[144:147], a[96:111]
    ds_read_b64_tr_b16 a[156:157], v31 offset:12288
    ds_read_b64_tr_b16 a[158:159], v31 offset:14336
    v_cvt_pk_bf16_f32 v138, v84, v85
    v_add_f32 v41, v41, v85
    v_exp_f32 v88, v88
    v_mfma_f32_32x32x16_bf16 a[112:127], a[140:143], v[152:155], a[112:127]
    v_exp_f32 v89, v89
    v_add_f32 v41, v41, v86
    s_waitcnt lgkmcnt(6)
    v_mfma_f32_32x32x16_bf16 a[0:15], a[144:147], v[148:151], a[0:15]
    s_waitcnt vmcnt(2)
    s_barrier
    v_add_u32 v28, s53, v28
    v_add_u32 v29, s53, v29
    v_add_u32 v30, s53, v30
    v_add_u32 v31, s53, v31
    ds_read_b128 a[128:131], v20 offset:0
    v_cvt_pk_bf16_f32 v139, v86, v87
    v_add_f32 v41, v41, v87
    v_exp_f32 v90, v90
    v_mfma_f32_32x32x16_bf16 a[16:31], a[144:147], v[156:159], a[16:31]
    v_exp_f32 v91, v91
    v_add_f32 v41, v41, v88
    s_waitcnt lgkmcnt(5)
    v_mfma_f32_32x32x16_bf16 a[32:47], a[148:151], v[148:151], a[32:47]
    ds_read_b128 a[132:135], v21 offset:0
    v_cvt_pk_bf16_f32 v140, v88, v89
    v_add_f32 v41, v41, v89
    v_exp_f32 v92, v92
    v_mfma_f32_32x32x16_bf16 a[48:63], a[148:151], v[156:159], a[48:63]
    v_exp_f32 v93, v93
    v_add_f32 v41, v41, v90
    s_waitcnt lgkmcnt(4)
    v_mfma_f32_32x32x16_bf16 a[64:79], a[152:155], v[148:151], a[64:79]
    ds_read_b128 a[136:139], v22 offset:0
    v_cvt_pk_bf16_f32 v141, v90, v91
    v_add_f32 v41, v41, v91
    v_exp_f32 v94, v94
    v_mfma_f32_32x32x16_bf16 a[80:95], a[152:155], v[156:159], a[80:95]
    v_exp_f32 v95, v95
    v_add_f32 v41, v41, v92
    s_waitcnt lgkmcnt(3)
    v_mfma_f32_32x32x16_bf16 a[96:111], a[156:159], v[148:151], a[96:111]
    ds_read_b128 a[140:143], v23 offset:0
    v_cvt_pk_bf16_f32 v142, v92, v93
    v_add_f32 v41, v41, v93
    s_nop 0
    v_mfma_f32_32x32x16_bf16 a[112:127], a[156:159], v[156:159], a[112:127]
    v_add_f32 v41, v41, v94
    v_cvt_pk_bf16_f32 v143, v94, v95
    v_add_f32 v41, v41, v95
    s_mov_b32 s47, s50
    s_add_u32 s49, s49, 16384
    s_add_u32 s48, s48, 1
    s_cmp_lt_u32 s48, 8
    s_cbranch_scc1 L_attn_kernel_aloop
    s_waitcnt lgkmcnt(0)
    ds_read_b64_tr_b16 a[128:129], v28 offset:0
    ds_read_b64_tr_b16 a[130:131], v28 offset:2048
    ds_read_b64_tr_b16 a[132:133], v29 offset:0
    ds_read_b64_tr_b16 a[134:135], v29 offset:2048
    ds_read_b64_tr_b16 a[136:137], v30 offset:0
    ds_read_b64_tr_b16 a[138:139], v30 offset:2048
    ds_read_b64_tr_b16 a[140:141], v31 offset:0
    ds_read_b64_tr_b16 a[142:143], v31 offset:2048
    s_waitcnt lgkmcnt(6)
    v_mfma_f32_32x32x16_bf16 a[0:15], a[128:131], v[128:131], a[0:15]
    ds_read_b64_tr_b16 a[144:145], v28 offset:4096
    ds_read_b64_tr_b16 a[146:147], v28 offset:6144
    v_exp_f32 v96, v96
    v_exp_f32 v97, v97
    v_exp_f32 v98, v98
    v_exp_f32 v99, v99
    v_add_f32 v40, v40, v96
    v_mfma_f32_32x32x16_bf16 a[16:31], a[128:131], v[136:139], a[16:31]
    v_cvt_pk_bf16_f32 v144, v96, v97
    v_add_f32 v40, v40, v97
    v_exp_f32 v100, v100
    v_exp_f32 v101, v101
    v_add_f32 v40, v40, v98
    s_waitcnt lgkmcnt(6)
    v_mfma_f32_32x32x16_bf16 a[32:47], a[132:135], v[128:131], a[32:47]
    ds_read_b64_tr_b16 a[148:149], v29 offset:4096
    ds_read_b64_tr_b16 a[150:151], v29 offset:6144
    v_cvt_pk_bf16_f32 v145, v98, v99
    v_add_f32 v40, v40, v99
    v_exp_f32 v102, v102
    v_exp_f32 v103, v103
    v_add_f32 v40, v40, v100
    v_mfma_f32_32x32x16_bf16 a[48:63], a[132:135], v[136:139], a[48:63]
    v_cvt_pk_bf16_f32 v146, v100, v101
    v_add_f32 v40, v40, v101
    v_exp_f32 v104, v104
    v_exp_f32 v105, v105
    v_add_f32 v40, v40, v102
    s_waitcnt lgkmcnt(6)
    v_mfma_f32_32x32x16_bf16 a[64:79], a[136:139], v[128:131], a[64:79]
    ds_read_b64_tr_b16 a[152:153], v30 offset:4096
    ds_read_b64_tr_b16 a[154:155], v30 offset:6144
    v_cvt_pk_bf16_f32 v147, v102, v103
    v_add_f32 v40, v40, v103
    v_exp_f32 v106, v106
    v_exp_f32 v107, v107
    v_add_f32 v40, v40, v104
    v_mfma_f32_32x32x16_bf16 a[80:95], a[136:139], v[136:139], a[80:95]
    v_cvt_pk_bf16_f32 v148, v104, v105
    v_add_f32 v40, v40, v105
    v_exp_f32 v108, v108
    v_exp_f32 v109, v109
    v_add_f32 v40, v40, v106
    s_waitcnt lgkmcnt(6)
    v_mfma_f32_32x32x16_bf16 a[96:111], a[140:143], v[128:131], a[96:111]
    ds_read_b64_tr_b16 a[156:157], v31 offset:4096
    ds_read_b64_tr_b16 a[158:159], v31 offset:6144
    v_cvt_pk_bf16_f32 v149, v106, v107
    v_add_f32 v40, v40, v107
    v_exp_f32 v110, v110
    v_exp_f32 v111, v111
    v_add_f32 v40, v40, v108
    v_mfma_f32_32x32x16_bf16 a[112:127], a[140:143], v[136:139], a[112:127]
    v_cvt_pk_bf16_f32 v150, v108, v109
    v_add_f32 v40, v40, v109
    v_exp_f32 v112, v112
    v_exp_f32 v113, v113
    v_add_f32 v40, v40, v110
    s_waitcnt lgkmcnt(6)
    v_mfma_f32_32x32x16_bf16 a[0:15], a[144:147], v[132:135], a[0:15]
    ds_read_b64_tr_b16 a[128:129], v28 offset:8192
    ds_read_b64_tr_b16 a[130:131], v28 offset:10240
    v_cvt_pk_bf16_f32 v151, v110, v111
    v_add_f32 v40, v40, v111
    v_exp_f32 v114, v114
    v_exp_f32 v115, v115
    v_add_f32 v41, v41, v112
    v_mfma_f32_32x32x16_bf16 a[16:31], a[144:147], v[140:143], a[16:31]
    v_cvt_pk_bf16_f32 v152, v112, v113
    v_add_f32 v41, v41, v113
    v_exp_f32 v116, v116
    v_exp_f32 v117, v117
    v_add_f32 v41, v41, v114
    s_waitcnt lgkmcnt(6)
    v_mfma_f32_32x32x16_bf16 a[32:47], a[148:151], v[132:135], a[32:47]
    ds_read_b64_tr_b16 a[132:133], v29 offset:8192
    ds_read_b64_tr_b16 a[134:135], v29 offset:10240
    v_cvt_pk_bf16_f32 v153, v114, v115
    v_add_f32 v41, v41, v115
    v_exp_f32 v118, v118
    v_exp_f32 v119, v119
    v_add_f32 v41, v41, v116
    v_mfma_f32_32x32x16_bf16 a[48:63], a[148:151], v[140:143], a[48:63]
    v_cvt_pk_bf16_f32 v154, v116, v117
    v_add_f32 v41, v41, v117
    v_exp_f32 v120, v120
    v_exp_f32 v121, v121
    v_add_f32 v41, v41, v118
    s_waitcnt lgkmcnt(6)
    v_mfma_f32_32x32x16_bf16 a[64:79], a[152:155], v[132:135], a[64:79]
    ds_read_b64_tr_b16 a[136:137], v30 offset:8192
    ds_read_b64_tr_b16 a[138:139], v30 offset:10240
    v_cvt_pk_bf16_f32 v155, v118, v119
    v_add_f32 v41, v41, v119
    v_exp_f32 v122, v122
    v_exp_f32 v123, v123
    v_add_f32 v41, v41, v120
    v_mfma_f32_32x32x16_bf16 a[80:95], a[152:155], v[140:143], a[80:95]
    v_cvt_pk_bf16_f32 v156, v120, v121
    v_add_f32 v41, v41, v121
    v_exp_f32 v124, v124
    v_exp_f32 v125, v125
    v_add_f32 v41, v41, v122
    s_waitcnt lgkmcnt(6)
    v_mfma_f32_32x32x16_bf16 a[96:111], a[156:159], v[132:135], a[96:111]
    ds_read_b64_tr_b16 a[140:141], v31 offset:8192
    ds_read_b64_tr_b16 a[142:143], v31 offset:10240
    v_cvt_pk_bf16_f32 v157, v122, v123
    v_add_f32 v41, v41, v123
    v_exp_f32 v126, v126
    v_exp_f32 v127, v127
    v_add_f32 v41, v41, v124
    v_mfma_f32_32x32x16_bf16 a[112:127], a[156:159], v[140:143], a[112:127]
    v_cvt_pk_bf16_f32 v158, v124, v125
    v_add_f32 v41, v41, v125
    s_nop 0
    v_add_f32 v41, v41, v126
    v_cvt_pk_bf16_f32 v159, v126, v127
    v_add_f32 v41, v41, v127
    s_nop 1
    s_waitcnt lgkmcnt(6)
    v_mfma_f32_32x32x16_bf16 a[0:15], a[128:131], v[144:147], a[0:15]
    ds_read_b64_tr_b16 a[144:145], v28 offset:12288
    ds_read_b64_tr_b16 a[146:147], v28 offset:14336
    v_mfma_f32_32x32x16_bf16 a[16:31], a[128:131], v[152:155], a[16:31]
    s_waitcnt lgkmcnt(6)
    v_mfma_f32_32x32x16_bf16 a[32:47], a[132:135], v[144:147], a[32:47]
    ds_read_b64_tr_b16 a[148:149], v29 offset:12288
    ds_read_b64_tr_b16 a[150:151], v29 offset:14336
    v_mfma_f32_32x32x16_bf16 a[48:63], a[132:135], v[152:155], a[48:63]
    s_waitcnt lgkmcnt(6)
    v_mfma_f32_32x32x16_bf16 a[64:79], a[136:139], v[144:147], a[64:79]
    ds_read_b64_tr_b16 a[152:153], v30 offset:12288
    ds_read_b64_tr_b16 a[154:155], v30 offset:14336
    v_mfma_f32_32x32x16_bf16 a[80:95], a[136:139], v[152:155], a[80:95]
    s_waitcnt lgkmcnt(6)
    v_mfma_f32_32x32x16_bf16 a[96:111], a[140:143], v[144:147], a[96:111]
    ds_read_b64_tr_b16 a[156:157], v31 offset:12288
    ds_read_b64_tr_b16 a[158:159], v31 offset:14336
    v_mfma_f32_32x32x16_bf16 a[112:127], a[140:143], v[152:155], a[112:127]
    s_waitcnt lgkmcnt(6)
    v_mfma_f32_32x32x16_bf16 a[0:15], a[144:147], v[148:151], a[0:15]
    v_mfma_f32_32x32x16_bf16 a[16:31], a[144:147], v[156:159], a[16:31]
    s_waitcnt lgkmcnt(4)
    v_mfma_f32_32x32x16_bf16 a[32:47], a[148:151], v[148:151], a[32:47]
    v_mfma_f32_32x32x16_bf16 a[48:63], a[148:151], v[156:159], a[48:63]
    s_waitcnt lgkmcnt(2)
    v_mfma_f32_32x32x16_bf16 a[64:79], a[152:155], v[148:151], a[64:79]
    v_mfma_f32_32x32x16_bf16 a[80:95], a[152:155], v[156:159], a[80:95]
    s_waitcnt lgkmcnt(0)
    v_mfma_f32_32x32x16_bf16 a[96:111], a[156:159], v[148:151], a[96:111]
    v_mfma_f32_32x32x16_bf16 a[112:127], a[156:159], v[156:159], a[112:127]
    v_mov_b32 v44, v40
    v_mov_b32 v45, v41
    s_nop 1
    v_permlane32_swap_b32 v40, v44
    v_permlane32_swap_b32 v41, v45
    s_nop 1
    v_add_f32 v40, v40, v44
    v_add_f32 v41, v41, v45
    v_mov_b32 v46, 0x6c800000
    v_cmp_nle_f32 vcc, v40, v46
    v_cmp_nle_f32 s[56:57], v41, v46
    s_or_b64 vcc, vcc, s[56:57]
    s_cmp_lg_u64 vcc, 0
    s_cselect_b32 s58, 1, 0
    v_mov_b32 v46, s58
    v_mov_b32 v47, s30
    v_lshrrev_b32 v47, 10, v47
    ds_write_b32 v47, v46
    s_branch L_attn_kernel_fin
L_attn_kernel_fallback:
    s_barrier
    v_mov_b32 v42, 0xff800000
    v_mov_b32 v43, 0xff800000
    s_mov_b32 s48, 0
    s_mov_b32 s49, s44
L_attn_kernel_fbsub:
    v_subrev_u32 v20, s47, v20
    v_subrev_u32 v21, s47, v21
    v_subrev_u32 v22, s47, v22
    v_subrev_u32 v23, s47, v23
    v_subrev_u32 v24, s47, v24
    v_subrev_u32 v25, s47, v25
    v_subrev_u32 v26, s47, v26
    v_subrev_u32 v27, s47, v27
L_attn_kernel_fbloop:
    s_add_u32 m0, s30, 65536
    s_nop 0
    buffer_load_dwordx4 v12, s[32:35], s49 offen offset:0 lds
    buffer_load_dwordx4 v13, s[32:35], s49 offen offset:1024 lds
    buffer_load_dwordx4 v14, s[32:35], s49 offen offset:2048 lds
    buffer_load_dwordx4 v15, s[32:35], s49 offen offset:3072 lds
    s_waitcnt vmcnt(0)
    s_barrier
    ds_read_b128 a[128:131], v20 offset:0
    ds_read_b128 a[132:135], v21 offset:0
    ds_read_b128 a[136:139], v22 offset:0
    ds_read_b128 a[140:143], v23 offset:0
    ds_read_b128 a[144:147], v24 offset:0
    ds_read_b128 a[148:151], v25 offset:0
    ds_read_b128 a[152:155], v26 offset:0
    ds_read_b128 a[156:159], v27 offset:0
    s_waitcnt lgkmcnt(0)
    v_mfma_f32_32x32x16_bf16 v[64:79], a[128:131], v[192:195], 0
    v_mfma_f32_32x32x16_bf16 v[80:95], a[128:131], v[224:227], 0
    v_mfma_f32_32x32x16_bf16 v[64:79], a[132:135], v[196:199], v[64:79]
    v_mfma_f32_32x32x16_bf16 v[80:95], a[132:135], v[228:231], v[80:95]
    v_mfma_f32_32x32x16_bf16 v[64:79], a[136:139], v[200:203], v[64:79]
    v_mfma_f32_32x32x16_bf16 v[80:95], a[136:139], v[232:235], v[80:95]
    v_mfma_f32_32x32x16_bf16 v[64:79], a[140:143], v[204:207], v[64:79]
    v_mfma_f32_32x32x16_bf16 v[80:95], a[140:143], v[236:239], v[80:95]
    v_mfma_f32_32x32x16_bf16 v[64:79], a[144:147], v[208:211], v[64:79]
    v_mfma_f32_32x32x16_bf16 v[80:95], a[144:147], v[240:243], v[80:95]
    v_mfma_f32_32x32x16_bf16 v[64:79], a[148:151], v[212:215], v[64:79]
    v_mfma_f32_32x32x16_bf16 v[80:95], a[148:151], v[244:247], v[80:95]
    v_mfma_f32_32x32x16_bf16 v[64:79], a[152:155], v[216:219], v[64:79]
    v_mfma_f32_32x32x16_bf16 v[80:95], a[152:155], v[248:251], v[80:95]
    v_mfma_f32_32x32x16_bf16 v[64:79], a[156:159], v[220:223], v[64:79]
    v_mfma_f32_32x32x16_bf16 v[80:95], a[156:159], v[252:255], v[80:95]
    s_nop 7
    s_nop 7
    v_max3_f32 v42, v42, v64, v65
    v_max3_f32 v42, v42, v66, v67
    v_max3_f32 v42, v42, v68, v69
    v_max3_f32 v42, v42, v70, v71
    v_max3_f32 v42, v42, v72, v73
    v_max3_f32 v42, v42, v74, v75
    v_max3_f32 v42, v42, v76, v77
    v_max3_f32 v42, v42, v78, v79
    v_max3_f32 v43, v43, v80, v81
    v_max3_f32 v43, v43, v82, v83
    v_max3_f32 v43, v43, v84, v85
    v_max3_f32 v43, v43, v86, v87
    v_max3_f32 v43, v43, v88, v89
    v_max3_f32 v43, v43, v90, v91
    v_max3_f32 v43, v43, v92, v93
    v_max3_f32 v43, v43, v94, v95
    ds_read_b128 a[128:131], v20 offset:8192
    ds_read_b128 a[132:135], v21 offset:8192
    ds_read_b128 a[136:139], v22 offset:8192
    ds_read_b128 a[140:143], v23 offset:8192
    ds_read_b128 a[144:147], v24 offset:8192
    ds_read_b128 a[148:151], v25 offset:8192
    ds_read_b128 a[152:155], v26 offset:8192
    ds_read_b128 a[156:159], v27 offset:8192
    s_waitcnt lgkmcnt(0)
    v_mfma_f32_32x32x16_bf16 v[64:79], a[128:131], v[192:195], 0
    v_mfma_f32_32x32x16_bf16 v[80:95], a[128:131], v[224:227], 0
    v_mfma_f32_32x32x16_bf16 v[64:79], a[132:135], v[196:199], v[64:79]
    v_mfma_f32_32x32x16_bf16 v[80:95], a[132:135], v[228:231], v[80:95]
    v_mfma_f32_32x32x16_bf16 v[64:79], a[136:139], v[200:203], v[64:79]
    v_mfma_f32_32x32x16_bf16 v[80:95], a[136:139], v[232:235], v[80:95]
    v_mfma_f32_32x32x16_bf16 v[64:79], a[140:143], v[204:207], v[64:79]
    v_mfma_f32_32x32x16_bf16 v[80:95], a[140:143], v[236:239], v[80:95]
    v_mfma_f32_32x32x16_bf16 v[64:79], a[144:147], v[208:211], v[64:79]
    v_mfma_f32_32x32x16_bf16 v[80:95], a[144:147], v[240:243], v[80:95]
    v_mfma_f32_32x32x16_bf16 v[64:79], a[148:151], v[212:215], v[64:79]
    v_mfma_f32_32x32x16_bf16 v[80:95], a[148:151], v[244:247], v[80:95]
    v_mfma_f32_32x32x16_bf16 v[64:79], a[152:155], v[216:219], v[64:79]
    v_mfma_f32_32x32x16_bf16 v[80:95], a[152:155], v[248:251], v[80:95]
    v_mfma_f32_32x32x16_bf16 v[64:79], a[156:159], v[220:223], v[64:79]
    v_mfma_f32_32x32x16_bf16 v[80:95], a[156:159], v[252:255], v[80:95]
    s_nop 7
    s_nop 7
    v_max3_f32 v42, v42, v64, v65
    v_max3_f32 v42, v42, v66, v67
    v_max3_f32 v42, v42, v68, v69
    v_max3_f32 v42, v42, v70, v71
    v_max3_f32 v42, v42, v72, v73
    v_max3_f32 v42, v42, v74, v75
    v_max3_f32 v42, v42, v76, v77
    v_max3_f32 v42, v42, v78, v79
    v_max3_f32 v43, v43, v80, v81
    v_max3_f32 v43, v43, v82, v83
    v_max3_f32 v43, v43, v84, v85
    v_max3_f32 v43, v43, v86, v87
    v_max3_f32 v43, v43, v88, v89
    v_max3_f32 v43, v43, v90, v91
    v_max3_f32 v43, v43, v92, v93
    v_max3_f32 v43, v43, v94, v95
    s_barrier
    s_add_u32 s49, s49, 16384
    s_add_u32 s48, s48, 1
    s_cmp_lt_u32 s48, 8
    s_cbranch_scc1 L_attn_kernel_fbloop
    v_mov_b32 v44, v42
    v_mov_b32 v45, v43
    s_nop 1
    v_permlane32_swap_b32 v42, v44
    v_permlane32_swap_b32 v43, v45
    s_nop 1
    v_max_f32 v42, v42, v44
    v_max_f32 v43, v43, v45
    v_sub_f32 v42, 0, v42
    v_sub_f32 v43, 0, v43
    s_mov_b32 s46, 1
    v_subrev_u32 v28, 16384, v28
    v_subrev_u32 v29, 16384, v29
    v_subrev_u32 v30, 16384, v30
    v_subrev_u32 v31, 16384, v31
    s_add_u32 s45, s44, 16384
    s_add_u32 m0, s30, 65536
    s_nop 0
    buffer_load_dwordx4 v12, s[32:35], s44 offen offset:0 lds
    buffer_load_dwordx4 v13, s[32:35], s44 offen offset:1024 lds
    buffer_load_dwordx4 v14, s[32:35], s44 offen offset:2048 lds
    buffer_load_dwordx4 v15, s[32:35], s44 offen offset:3072 lds
    s_add_u32 m0, s30, 81920
    s_nop 0
    buffer_load_dwordx4 v12, s[32:35], s45 offen offset:0 lds
    buffer_load_dwordx4 v13, s[32:35], s45 offen offset:1024 lds
    buffer_load_dwordx4 v14, s[32:35], s45 offen offset:2048 lds
    buffer_load_dwordx4 v15, s[32:35], s45 offen offset:3072 lds
    s_add_u32 m0, s30, 114688
    s_nop 0
    buffer_load_dwordx4 v16, s[36:39], s44 offen offset:0 lds
    buffer_load_dwordx4 v16, s[36:39], s44 offen offset:1024 lds
    buffer_load_dwordx4 v16, s[36:39], s44 offen offset:2048 lds
    buffer_load_dwordx4 v16, s[36:39], s44 offen offset:3072 lds
    s_waitcnt vmcnt(0)
    s_barrier
    v_accvgpr_write_b32 a0, 0
    v_accvgpr_write_b32 a1, 0
    v_accvgpr_write_b32 a2, 0
    v_accvgpr_write_b32 a3, 0
    v_accvgpr_write_b32 a4, 0
    v_accvgpr_write_b32 a5, 0
    v_accvgpr_write_b32 a6, 0
    v_accvgpr_write_b32 a7, 0
    v_accvgpr_write_b32 a8, 0
    v_accvgpr_write_b32 a9, 0
    v_accvgpr_write_b32 a10, 0
    v_accvgpr_write_b32 a11, 0
    v_accvgpr_write_b32 a12, 0
    v_accvgpr_write_b32 a13, 0
    v_accvgpr_write_b32 a14, 0
    v_accvgpr_write_b32 a15, 0
    v_accvgpr_write_b32 a16, 0
    v_accvgpr_write_b32 a17, 0
    v_accvgpr_write_b32 a18, 0
    v_accvgpr_write_b32 a19, 0
    v_accvgpr_write_b32 a20, 0
    v_accvgpr_write_b32 a21, 0
    v_accvgpr_write_b32 a22, 0
    v_accvgpr_write_b32 a23, 0
    v_accvgpr_write_b32 a24, 0
    v_accvgpr_write_b32 a25, 0
    v_accvgpr_write_b32 a26, 0
    v_accvgpr_write_b32 a27, 0
    v_accvgpr_write_b32 a28, 0
    v_accvgpr_write_b32 a29, 0
    v_accvgpr_write_b32 a30, 0
    v_accvgpr_write_b32 a31, 0
    v_accvgpr_write_b32 a32, 0
    v_accvgpr_write_b32 a33, 0
    v_accvgpr_write_b32 a34, 0
    v_accvgpr_write_b32 a35, 0
    v_accvgpr_write_b32 a36, 0
    v_accvgpr_write_b32 a37, 0
    v_accvgpr_write_b32 a38, 0
    v_accvgpr_write_b32 a39, 0
    v_accvgpr_write_b32 a40, 0
    v_accvgpr_write_b32 a41, 0
    v_accvgpr_write_b32 a42, 0
    v_accvgpr_write_b32 a43, 0
    v_accvgpr_write_b32 a44, 0
    v_accvgpr_write_b32 a45, 0
    v_accvgpr_write_b32 a46, 0
    v_accvgpr_write_b32 a47, 0
    v_accvgpr_write_b32 a48, 0
    v_accvgpr_write_b32 a49, 0
    v_accvgpr_write_b32 a50, 0
    v_accvgpr_write_b32 a51, 0
    v_accvgpr_write_b32 a52, 0
    v_accvgpr_write_b32 a53, 0
    v_accvgpr_write_b32 a54, 0
    v_accvgpr_write_b32 a55, 0
    v_accvgpr_write_b32 a56, 0
    v_accvgpr_write_b32 a57, 0
    v_accvgpr_write_b32 a58, 0
    v_accvgpr_write_b32 a59, 0
    v_accvgpr_write_b32 a60, 0
    v_accvgpr_write_b32 a61, 0
    v_accvgpr_write_b32 a62, 0
    v_accvgpr_write_b32 a63, 0
    s_branch L_attn_kernel_att
L_attn_kernel_fin:
    v_rcp_f32 v44, v40
    v_rcp_f32 v45, v40
    v_rcp_f32 v46, v41
    v_rcp_f32 v47, v41
    s_nop 7
    s_nop 7
    s_mov_b32 s27, 0xffff0000
    s_mov_b32 s9, 0xbfb8aa3b
    v_lshlrev_b32 v125, 4, v1
    v_add_u32 v125, s8, v125
    s_waitcnt vmcnt(0)
    ds_read_b128 v[128:131], v125 offset:0
    ds_read_b128 v[132:135], v125 offset:1024
    ds_read_b128 v[136:139], v125 offset:2048
    ds_read_b128 v[140:143], v125 offset:3072
    ds_read_b128 v[144:147], v125 offset:4096
    ds_read_b128 v[148:151], v125 offset:5120
    ds_read_b128 v[152:155], v125 offset:6144
    ds_read_b128 v[156:159], v125 offset:7168
    s_mul_i32 s26, s25, 262144
    s_lshl_b32 s31, s24, 13
    s_add_u32 s26, s26, s31
    v_accvgpr_read_b32 v64, a0
    v_accvgpr_read_b32 v65, a1
    v_accvgpr_read_b32 v66, a2
    v_accvgpr_read_b32 v67, a3
    v_accvgpr_read_b32 v68, a4
    v_accvgpr_read_b32 v69, a5
    v_accvgpr_read_b32 v70, a6
    v_accvgpr_read_b32 v71, a7
    v_accvgpr_read_b32 v72, a8
    v_accvgpr_read_b32 v73, a9
    v_accvgpr_read_b32 v74, a10
    v_accvgpr_read_b32 v75, a11
    v_accvgpr_read_b32 v76, a12
    v_accvgpr_read_b32 v77, a13
    v_accvgpr_read_b32 v78, a14
    v_accvgpr_read_b32 v79, a15
    v_pk_mul_f32 v[64:65], v[64:65], v[44:45]
    v_pk_mul_f32 v[66:67], v[66:67], v[44:45]
    v_pk_mul_f32 v[68:69], v[68:69], v[44:45]
    v_pk_mul_f32 v[70:71], v[70:71], v[44:45]
    v_pk_mul_f32 v[72:73], v[72:73], v[44:45]
    v_pk_mul_f32 v[74:75], v[74:75], v[44:45]
    v_pk_mul_f32 v[76:77], v[76:77], v[44:45]
    v_pk_mul_f32 v[78:79], v[78:79], v[44:45]
    v_cvt_pk_bf16_f32 v80, v64, v65
    v_cvt_pk_bf16_f32 v81, v66, v67
    v_cvt_pk_bf16_f32 v82, v68, v69
    v_cvt_pk_bf16_f32 v83, v70, v71
    v_cvt_pk_bf16_f32 v84, v72, v73
    v_cvt_pk_bf16_f32 v85, v74, v75
    v_cvt_pk_bf16_f32 v86, v76, v77
    v_cvt_pk_bf16_f32 v87, v78, v79
    buffer_store_dwordx4 v[80:83], v2, s[40:43], s26 offen offset:0 sc1
    v_lshlrev_b32 v164, 16, v60
    v_and_b32 v165, s27, v60
    v_lshlrev_b32 v166, 16, v61
    v_and_b32 v167, s27, v61
    v_lshlrev_b32 v168, 16, v62
    v_and_b32 v169, s27, v62
    v_lshlrev_b32 v170, 16, v63
    v_and_b32 v171, s27, v63
    v_mul_f32 v172, s9, v164
    v_mul_f32 v173, s9, v165
    v_mul_f32 v174, s9, v166
    v_mul_f32 v175, s9, v167
    v_mul_f32 v176, s9, v168
    v_mul_f32 v177, s9, v169
    v_mul_f32 v178, s9, v170
    v_mul_f32 v179, s9, v171
    v_exp_f32 v172, v172
    v_exp_f32 v173, v173
    v_exp_f32 v174, v174
    buffer_store_dwordx4 v[84:87], v2, s[40:43], s26 offen offset:1024 sc1
    v_exp_f32 v175, v175
    v_exp_f32 v176, v176
    v_exp_f32 v177, v177
    v_exp_f32 v178, v178
    v_exp_f32 v179, v179
    v_add_f32 v172, 1.0, v172
    v_add_f32 v173, 1.0, v173
    v_add_f32 v174, 1.0, v174
    v_add_f32 v175, 1.0, v175
    v_add_f32 v176, 1.0, v176
    v_add_f32 v177, 1.0, v177
    v_add_f32 v178, 1.0, v178
    v_add_f32 v179, 1.0, v179
    v_rcp_f32 v172, v172
    v_rcp_f32 v173, v173
    v_rcp_f32 v174, v174
    v_rcp_f32 v175, v175
    v_rcp_f32 v176, v176
    v_rcp_f32 v177, v177
    v_accvgpr_read_b32 v64, a32
    v_accvgpr_read_b32 v65, a33
    v_accvgpr_read_b32 v66, a34
    v_accvgpr_read_b32 v67, a35
    v_accvgpr_read_b32 v68, a36
    v_accvgpr_read_b32 v69, a37
    v_accvgpr_read_b32 v70, a38
    v_accvgpr_read_b32 v71, a39
    v_accvgpr_read_b32 v72, a40
    v_accvgpr_read_b32 v73, a41
    v_accvgpr_read_b32 v74, a42
    v_accvgpr_read_b32 v75, a43
    v_accvgpr_read_b32 v76, a44
    v_accvgpr_read_b32 v77, a45
    v_accvgpr_read_b32 v78, a46
    v_accvgpr_read_b32 v79, a47
    v_pk_mul_f32 v[64:65], v[64:65], v[44:45]
    v_pk_mul_f32 v[66:67], v[66:67], v[44:45]
    v_pk_mul_f32 v[68:69], v[68:69], v[44:45]
    v_pk_mul_f32 v[70:71], v[70:71], v[44:45]
    v_pk_mul_f32 v[72:73], v[72:73], v[44:45]
    v_pk_mul_f32 v[74:75], v[74:75], v[44:45]
    v_pk_mul_f32 v[76:77], v[76:77], v[44:45]
    v_pk_mul_f32 v[78:79], v[78:79], v[44:45]
    v_cvt_pk_bf16_f32 v88, v64, v65
    v_cvt_pk_bf16_f32 v89, v66, v67
    v_cvt_pk_bf16_f32 v90, v68, v69
    v_cvt_pk_bf16_f32 v91, v70, v71
    v_cvt_pk_bf16_f32 v92, v72, v73
    v_cvt_pk_bf16_f32 v93, v74, v75
    v_cvt_pk_bf16_f32 v94, v76, v77
    v_cvt_pk_bf16_f32 v95, v78, v79
    buffer_store_dwordx4 v[88:91], v2, s[40:43], s26 offen offset:2048 sc1
    v_rcp_f32 v178, v178
    v_rcp_f32 v179, v179
    v_mul_f32 v164, v164, v172
    v_mul_f32 v165, v165, v173
    v_mul_f32 v166, v166, v174
    v_mul_f32 v167, v167, v175
    v_mul_f32 v168, v168, v176
    v_mul_f32 v169, v169, v177
    v_mul_f32 v170, v170, v178
    v_mul_f32 v171, v171, v179
    v_cvt_pk_bf16_f32 v160, v164, v165
    v_cvt_pk_bf16_f32 v161, v166, v167
    v_cvt_pk_bf16_f32 v162, v168, v169
    v_cvt_pk_bf16_f32 v163, v170, v171
    v_lshlrev_b32 v164, 16, v160
    v_and_b32 v165, s27, v160
    v_lshlrev_b32 v166, 16, v161
    v_and_b32 v167, s27, v161
    v_lshlrev_b32 v168, 16, v162
    buffer_store_dwordx4 v[92:95], v2, s[40:43], s26 offen offset:3072 sc1
    v_and_b32 v169, s27, v162
    v_lshlrev_b32 v170, 16, v163
    v_and_b32 v171, s27, v163
    v_mov_b32 v180, 0
    v_mov_b32 v181, 0
    v_mov_b32 v182, 0
    v_mov_b32 v183, 0
    v_mov_b32 v184, 0
    v_mov_b32 v185, 0
    v_mov_b32 v186, 0
    v_mov_b32 v187, 0
    s_waitcnt lgkmcnt(0)
    v_lshlrev_b32 v172, 16, v128
    v_and_b32 v173, s27, v128
    v_fmac_f32 v180, v164, v172
    v_fmac_f32 v181, v164, v173
    v_lshlrev_b32 v172, 16, v129
    v_and_b32 v173, s27, v129
    v_fmac_f32 v182, v164, v172
    v_accvgpr_read_b32 v64, a64
    v_accvgpr_read_b32 v65, a65
    v_accvgpr_read_b32 v66, a66
    v_accvgpr_read_b32 v67, a67
    v_accvgpr_read_b32 v68, a68
    v_accvgpr_read_b32 v69, a69
    v_accvgpr_read_b32 v70, a70
    v_accvgpr_read_b32 v71, a71
    v_accvgpr_read_b32 v72, a72
    v_accvgpr_read_b32 v73, a73
    v_accvgpr_read_b32 v74, a74
    v_accvgpr_read_b32 v75, a75
    v_accvgpr_read_b32 v76, a76
    v_accvgpr_read_b32 v77, a77
    v_accvgpr_read_b32 v78, a78
    v_accvgpr_read_b32 v79, a79
    v_pk_mul_f32 v[64:65], v[64:65], v[44:45]
    v_pk_mul_f32 v[66:67], v[66:67], v[44:45]
    v_pk_mul_f32 v[68:69], v[68:69], v[44:45]
    v_pk_mul_f32 v[70:71], v[70:71], v[44:45]
    v_pk_mul_f32 v[72:73], v[72:73], v[44:45]
    v_pk_mul_f32 v[74:75], v[74:75], v[44:45]
    v_pk_mul_f32 v[76:77], v[76:77], v[44:45]
    v_pk_mul_f32 v[78:79], v[78:79], v[44:45]
    v_cvt_pk_bf16_f32 v80, v64, v65
    v_cvt_pk_bf16_f32 v81, v66, v67
    v_cvt_pk_bf16_f32 v82, v68, v69
    v_cvt_pk_bf16_f32 v83, v70, v71
    v_cvt_pk_bf16_f32 v84, v72, v73
    v_cvt_pk_bf16_f32 v85, v74, v75
    v_cvt_pk_bf16_f32 v86, v76, v77
    v_cvt_pk_bf16_f32 v87, v78, v79
    s_add_u32 s26, s26, 4096
    buffer_store_dwordx4 v[80:83], v2, s[40:43], s26 offen offset:0 sc1
    v_fmac_f32 v183, v164, v173
    v_lshlrev_b32 v172, 16, v130
    v_and_b32 v173, s27, v130
    v_fmac_f32 v184, v164, v172
    v_fmac_f32 v185, v164, v173
    v_lshlrev_b32 v172, 16, v131
    v_and_b32 v173, s27, v131
    v_fmac_f32 v186, v164, v172
    v_fmac_f32 v187, v164, v173
    v_lshlrev_b32 v172, 16, v132
    v_and_b32 v173, s27, v132
    v_fmac_f32 v180, v165, v172
    v_fmac_f32 v181, v165, v173
    v_lshlrev_b32 v172, 16, v133
    v_and_b32 v173, s27, v133
    v_fmac_f32 v182, v165, v172
    v_fmac_f32 v183, v165, v173
    v_lshlrev_b32 v172, 16, v134
    v_and_b32 v173, s27, v134
    buffer_store_dwordx4 v[84:87], v2, s[40:43], s26 offen offset:1024 sc1
    v_fmac_f32 v184, v165, v172
    v_fmac_f32 v185, v165, v173
    v_lshlrev_b32 v172, 16, v135
    v_and_b32 v173, s27, v135
    v_fmac_f32 v186, v165, v172
    v_fmac_f32 v187, v165, v173
    v_lshlrev_b32 v172, 16, v136
    v_and_b32 v173, s27, v136
    v_fmac_f32 v180, v166, v172
    v_fmac_f32 v181, v166, v173
    v_lshlrev_b32 v172, 16, v137
    v_and_b32 v173, s27, v137
    v_fmac_f32 v182, v166, v172
    v_fmac_f32 v183, v166, v173
    v_lshlrev_b32 v172, 16, v138
    v_and_b32 v173, s27, v138
    v_fmac_f32 v184, v166, v172
    v_fmac_f32 v185, v166, v173
    v_lshlrev_b32 v172, 16, v139
    v_accvgpr_read_b32 v64, a96
    v_accvgpr_read_b32 v65, a97
    v_accvgpr_read_b32 v66, a98
    v_accvgpr_read_b32 v67, a99
    v_accvgpr_read_b32 v68, a100
    v_accvgpr_read_b32 v69, a101
    v_accvgpr_read_b32 v70, a102
    v_accvgpr_read_b32 v71, a103
    v_accvgpr_read_b32 v72, a104
    v_accvgpr_read_b32 v73, a105
    v_accvgpr_read_b32 v74, a106
    v_accvgpr_read_b32 v75, a107
    v_accvgpr_read_b32 v76, a108
    v_accvgpr_read_b32 v77, a109
    v_accvgpr_read_b32 v78, a110
    v_accvgpr_read_b32 v79, a111
    v_pk_mul_f32 v[64:65], v[64:65], v[44:45]
    v_pk_mul_f32 v[66:67], v[66:67], v[44:45]
    v_pk_mul_f32 v[68:69], v[68:69], v[44:45]
    v_pk_mul_f32 v[70:71], v[70:71], v[44:45]
    v_pk_mul_f32 v[72:73], v[72:73], v[44:45]
    v_pk_mul_f32 v[74:75], v[74:75], v[44:45]
    v_pk_mul_f32 v[76:77], v[76:77], v[44:45]
    v_pk_mul_f32 v[78:79], v[78:79], v[44:45]
    v_cvt_pk_bf16_f32 v88, v64, v65
    v_cvt_pk_bf16_f32 v89, v66, v67
    v_cvt_pk_bf16_f32 v90, v68, v69
    v_cvt_pk_bf16_f32 v91, v70, v71
    v_cvt_pk_bf16_f32 v92, v72, v73
    v_cvt_pk_bf16_f32 v93, v74, v75
    v_cvt_pk_bf16_f32 v94, v76, v77
    v_cvt_pk_bf16_f32 v95, v78, v79
    buffer_store_dwordx4 v[88:91], v2, s[40:43], s26 offen offset:2048 sc1
    v_and_b32 v173, s27, v139
    v_fmac_f32 v186, v166, v172
    v_fmac_f32 v187, v166, v173
    v_lshlrev_b32 v172, 16, v140
    v_and_b32 v173, s27, v140
    v_fmac_f32 v180, v167, v172
    v_fmac_f32 v181, v167, v173
    v_lshlrev_b32 v172, 16, v141
    v_and_b32 v173, s27, v141
    v_fmac_f32 v182, v167, v172
    v_fmac_f32 v183, v167, v173
    v_lshlrev_b32 v172, 16, v142
    v_and_b32 v173, s27, v142
    v_fmac_f32 v184, v167, v172
    v_fmac_f32 v185, v167, v173
    v_lshlrev_b32 v172, 16, v143
    v_and_b32 v173, s27, v143
    v_fmac_f32 v186, v167, v172
    v_fmac_f32 v187, v167, v173
    buffer_store_dwordx4 v[92:95], v2, s[40:43], s26 offen offset:3072 sc1
    v_lshlrev_b32 v172, 16, v144
    v_and_b32 v173, s27, v144
    v_fmac_f32 v180, v168, v172
    v_fmac_f32 v181, v168, v173
    v_lshlrev_b32 v172, 16, v145
    v_and_b32 v173, s27, v145
    v_fmac_f32 v182, v168, v172
    v_fmac_f32 v183, v168, v173
    v_lshlrev_b32 v172, 16, v146
    v_and_b32 v173, s27, v146
    v_fmac_f32 v184, v168, v172
    v_fmac_f32 v185, v168, v173
    v_lshlrev_b32 v172, 16, v147
    v_and_b32 v173, s27, v147
    v_fmac_f32 v186, v168, v172
    v_fmac_f32 v187, v168, v173
    v_lshlrev_b32 v172, 16, v148
    v_and_b32 v173, s27, v148
    v_fmac_f32 v180, v169, v172
    s_add_u32 s26, s26, 258048
    v_accvgpr_read_b32 v64, a16
    v_accvgpr_read_b32 v65, a17
    v_accvgpr_read_b32 v66, a18
    v_accvgpr_read_b32 v67, a19
    v_accvgpr_read_b32 v68, a20
    v_accvgpr_read_b32 v69, a21
    v_accvgpr_read_b32 v70, a22
    v_accvgpr_read_b32 v71, a23
    v_accvgpr_read_b32 v72, a24
    v_accvgpr_read_b32 v73, a25
    v_accvgpr_read_b32 v74, a26
    v_accvgpr_read_b32 v75, a27
    v_accvgpr_read_b32 v76, a28
    v_accvgpr_read_b32 v77, a29
    v_accvgpr_read_b32 v78, a30
    v_accvgpr_read_b32 v79, a31
    v_pk_mul_f32 v[64:65], v[64:65], v[46:47]
    v_pk_mul_f32 v[66:67], v[66:67], v[46:47]
    v_pk_mul_f32 v[68:69], v[68:69], v[46:47]
    v_pk_mul_f32 v[70:71], v[70:71], v[46:47]
    v_pk_mul_f32 v[72:73], v[72:73], v[46:47]
    v_pk_mul_f32 v[74:75], v[74:75], v[46:47]
    v_pk_mul_f32 v[76:77], v[76:77], v[46:47]
    v_pk_mul_f32 v[78:79], v[78:79], v[46:47]
    v_cvt_pk_bf16_f32 v80, v64, v65
    v_cvt_pk_bf16_f32 v81, v66, v67
    v_cvt_pk_bf16_f32 v82, v68, v69
    v_cvt_pk_bf16_f32 v83, v70, v71
    v_cvt_pk_bf16_f32 v84, v72, v73
    v_cvt_pk_bf16_f32 v85, v74, v75
    v_cvt_pk_bf16_f32 v86, v76, v77
    v_cvt_pk_bf16_f32 v87, v78, v79
    buffer_store_dwordx4 v[80:83], v2, s[40:43], s26 offen offset:0 sc1
    v_fmac_f32 v181, v169, v173
    v_lshlrev_b32 v172, 16, v149
    v_and_b32 v173, s27, v149
    v_fmac_f32 v182, v169, v172
    v_fmac_f32 v183, v169, v173
    v_lshlrev_b32 v172, 16, v150
    v_and_b32 v173, s27, v150
    v_fmac_f32 v184, v169, v172
    v_fmac_f32 v185, v169, v173
    v_lshlrev_b32 v172, 16, v151
    v_and_b32 v173, s27, v151
    v_fmac_f32 v186, v169, v172
    v_fmac_f32 v187, v169, v173
    v_lshlrev_b32 v172, 16, v152
    v_and_b32 v173, s27, v152
    v_fmac_f32 v180, v170, v172
    v_fmac_f32 v181, v170, v173
    v_lshlrev_b32 v172, 16, v153
    v_and_b32 v173, s27, v153
    buffer_store_dwordx4 v[84:87], v2, s[40:43], s26 offen offset:1024 sc1
    v_fmac_f32 v182, v170, v172
    v_fmac_f32 v183, v170, v173
    v_lshlrev_b32 v172, 16, v154
    v_and_b32 v173, s27, v154
    v_fmac_f32 v184, v170, v172
    v_fmac_f32 v185, v170, v173
    v_lshlrev_b32 v172, 16, v155
    v_and_b32 v173, s27, v155
    v_fmac_f32 v186, v170, v172
    v_fmac_f32 v187, v170, v173
    v_lshlrev_b32 v172, 16, v156
    v_and_b32 v173, s27, v156
    v_fmac_f32 v180, v171, v172
    v_fmac_f32 v181, v171, v173
    v_lshlrev_b32 v172, 16, v157
    v_and_b32 v173, s27, v157
    v_fmac_f32 v182, v171, v172
    v_fmac_f32 v183, v171, v173
    v_lshlrev_b32 v172, 16, v158
    v_accvgpr_read_b32 v64, a48
    v_accvgpr_read_b32 v65, a49
    v_accvgpr_read_b32 v66, a50
    v_accvgpr_read_b32 v67, a51
    v_accvgpr_read_b32 v68, a52
    v_accvgpr_read_b32 v69, a53
    v_accvgpr_read_b32 v70, a54
    v_accvgpr_read_b32 v71, a55
    v_accvgpr_read_b32 v72, a56
    v_accvgpr_read_b32 v73, a57
    v_accvgpr_read_b32 v74, a58
    v_accvgpr_read_b32 v75, a59
    v_accvgpr_read_b32 v76, a60
    v_accvgpr_read_b32 v77, a61
    v_accvgpr_read_b32 v78, a62
    v_accvgpr_read_b32 v79, a63
    v_pk_mul_f32 v[64:65], v[64:65], v[46:47]
    v_pk_mul_f32 v[66:67], v[66:67], v[46:47]
    v_pk_mul_f32 v[68:69], v[68:69], v[46:47]
    v_pk_mul_f32 v[70:71], v[70:71], v[46:47]
    v_pk_mul_f32 v[72:73], v[72:73], v[46:47]
    v_pk_mul_f32 v[74:75], v[74:75], v[46:47]
    v_pk_mul_f32 v[76:77], v[76:77], v[46:47]
    v_pk_mul_f32 v[78:79], v[78:79], v[46:47]
    v_cvt_pk_bf16_f32 v88, v64, v65
    v_cvt_pk_bf16_f32 v89, v66, v67
    v_cvt_pk_bf16_f32 v90, v68, v69
    v_cvt_pk_bf16_f32 v91, v70, v71
    v_cvt_pk_bf16_f32 v92, v72, v73
    v_cvt_pk_bf16_f32 v93, v74, v75
    v_cvt_pk_bf16_f32 v94, v76, v77
    v_cvt_pk_bf16_f32 v95, v78, v79
    buffer_store_dwordx4 v[88:91], v2, s[40:43], s26 offen offset:2048 sc1
    v_and_b32 v173, s27, v158
    v_fmac_f32 v184, v171, v172
    v_fmac_f32 v185, v171, v173
    v_lshlrev_b32 v172, 16, v159
    v_and_b32 v173, s27, v159
    v_fmac_f32 v186, v171, v172
    v_fmac_f32 v187, v171, v173
    s_nop 1
    v_add_f32_dpp v180, v180, v180 row_ror:8 row_mask:0xf bank_mask:0xf
    v_add_f32_dpp v181, v181, v181 row_ror:8 row_mask:0xf bank_mask:0xf
    v_add_f32_dpp v182, v182, v182 row_ror:8 row_mask:0xf bank_mask:0xf
    v_add_f32_dpp v183, v183, v183 row_ror:8 row_mask:0xf bank_mask:0xf
    v_add_f32_dpp v184, v184, v184 row_ror:8 row_mask:0xf bank_mask:0xf
    v_add_f32_dpp v185, v185, v185 row_ror:8 row_mask:0xf bank_mask:0xf
    v_add_f32_dpp v186, v186, v186 row_ror:8 row_mask:0xf bank_mask:0xf
    v_add_f32_dpp v187, v187, v187 row_ror:8 row_mask:0xf bank_mask:0xf
    v_mov_b32 v172, v180
    v_mov_b32 v173, v181
    v_mov_b32 v174, v182
    buffer_store_dwordx4 v[92:95], v2, s[40:43], s26 offen offset:3072 sc1
    v_mov_b32 v175, v183
    v_mov_b32 v176, v184
    v_mov_b32 v177, v185
    v_mov_b32 v178, v186
    v_mov_b32 v179, v187
    s_nop 1
    v_permlane16_swap_b32 v180, v172
    v_permlane16_swap_b32 v181, v173
    v_permlane16_swap_b32 v182, v174
    v_permlane16_swap_b32 v183, v175
    v_permlane16_swap_b32 v184, v176
    v_permlane16_swap_b32 v185, v177
    v_permlane16_swap_b32 v186, v178
    v_permlane16_swap_b32 v187, v179
    s_nop 1
    v_add_f32 v180, v180, v172
    v_add_f32 v181, v181, v173
    v_add_f32 v182, v182, v174
    v_add_f32 v183, v183, v175
    v_accvgpr_read_b32 v64, a80
    v_accvgpr_read_b32 v65, a81
    v_accvgpr_read_b32 v66, a82
    v_accvgpr_read_b32 v67, a83
    v_accvgpr_read_b32 v68, a84
    v_accvgpr_read_b32 v69, a85
    v_accvgpr_read_b32 v70, a86
    v_accvgpr_read_b32 v71, a87
    v_accvgpr_read_b32 v72, a88
    v_accvgpr_read_b32 v73, a89
    v_accvgpr_read_b32 v74, a90
    v_accvgpr_read_b32 v75, a91
    v_accvgpr_read_b32 v76, a92
    v_accvgpr_read_b32 v77, a93
    v_accvgpr_read_b32 v78, a94
    v_accvgpr_read_b32 v79, a95
    v_pk_mul_f32 v[64:65], v[64:65], v[46:47]
    v_pk_mul_f32 v[66:67], v[66:67], v[46:47]
    v_pk_mul_f32 v[68:69], v[68:69], v[46:47]
    v_pk_mul_f32 v[70:71], v[70:71], v[46:47]
    v_pk_mul_f32 v[72:73], v[72:73], v[46:47]
    v_pk_mul_f32 v[74:75], v[74:75], v[46:47]
    v_pk_mul_f32 v[76:77], v[76:77], v[46:47]
    v_pk_mul_f32 v[78:79], v[78:79], v[46:47]
    v_cvt_pk_bf16_f32 v80, v64, v65
    v_cvt_pk_bf16_f32 v81, v66, v67
    v_cvt_pk_bf16_f32 v82, v68, v69
    v_cvt_pk_bf16_f32 v83, v70, v71
    v_cvt_pk_bf16_f32 v84, v72, v73
    v_cvt_pk_bf16_f32 v85, v74, v75
    v_cvt_pk_bf16_f32 v86, v76, v77
    v_cvt_pk_bf16_f32 v87, v78, v79
    s_add_u32 s26, s26, 4096
    buffer_store_dwordx4 v[80:83], v2, s[40:43], s26 offen offset:0 sc1
    v_add_f32 v184, v184, v176
    v_add_f32 v185, v185, v177
    v_add_f32 v186, v186, v178
    v_add_f32 v187, v187, v179
    v_mov_b32 v172, v180
    v_mov_b32 v173, v181
    v_mov_b32 v174, v182
    v_mov_b32 v175, v183
    v_mov_b32 v176, v184
    v_mov_b32 v177, v185
    v_mov_b32 v178, v186
    v_mov_b32 v179, v187
    s_nop 1
    v_permlane32_swap_b32 v180, v172
    v_permlane32_swap_b32 v181, v173
    v_permlane32_swap_b32 v182, v174
    v_permlane32_swap_b32 v183, v175
    v_permlane32_swap_b32 v184, v176
    v_permlane32_swap_b32 v185, v177
    buffer_store_dwordx4 v[84:87], v2, s[40:43], s26 offen offset:1024 sc1
    v_permlane32_swap_b32 v186, v178
    v_permlane32_swap_b32 v187, v179
    s_nop 1
    v_add_f32 v180, v180, v172
    v_add_f32 v181, v181, v173
    v_add_f32 v182, v182, v174
    v_add_f32 v183, v183, v175
    v_add_f32 v184, v184, v176
    v_add_f32 v185, v185, v177
    v_add_f32 v186, v186, v178
    v_add_f32 v187, v187, v179
    v_accvgpr_read_b32 v64, a112
    v_accvgpr_read_b32 v65, a113
    v_accvgpr_read_b32 v66, a114
    v_accvgpr_read_b32 v67, a115
    v_accvgpr_read_b32 v68, a116
    v_accvgpr_read_b32 v69, a117
    v_accvgpr_read_b32 v70, a118
    v_accvgpr_read_b32 v71, a119
    v_accvgpr_read_b32 v72, a120
    v_accvgpr_read_b32 v73, a121
    v_accvgpr_read_b32 v74, a122
    v_accvgpr_read_b32 v75, a123
    v_accvgpr_read_b32 v76, a124
    v_accvgpr_read_b32 v77, a125
    v_accvgpr_read_b32 v78, a126
    v_accvgpr_read_b32 v79, a127
    v_pk_mul_f32 v[64:65], v[64:65], v[46:47]
    v_pk_mul_f32 v[66:67], v[66:67], v[46:47]
    v_pk_mul_f32 v[68:69], v[68:69], v[46:47]
    v_pk_mul_f32 v[70:71], v[70:71], v[46:47]
    v_pk_mul_f32 v[72:73], v[72:73], v[46:47]
    v_pk_mul_f32 v[74:75], v[74:75], v[46:47]
    v_pk_mul_f32 v[76:77], v[76:77], v[46:47]
    v_pk_mul_f32 v[78:79], v[78:79], v[46:47]
    v_cvt_pk_bf16_f32 v88, v64, v65
    v_cvt_pk_bf16_f32 v89, v66, v67
    v_cvt_pk_bf16_f32 v90, v68, v69
    v_cvt_pk_bf16_f32 v91, v70, v71
    v_cvt_pk_bf16_f32 v92, v72, v73
    v_cvt_pk_bf16_f32 v93, v74, v75
    v_cvt_pk_bf16_f32 v94, v76, v77
    v_cvt_pk_bf16_f32 v95, v78, v79
    buffer_store_dwordx4 v[88:91], v2, s[40:43], s26 offen offset:2048 sc1
    buffer_store_dwordx4 v[92:95], v2, s[40:43], s26 offen offset:3072 sc1
    s_lshl_b32 s9, s20, 8
    v_lshlrev_b32 v125, 5, v1
    v_add_u32 v125, s9, v125
    v_cmp_gt_u32 vcc, 8, v1
    s_and_saveexec_b64 s[56:57], vcc
    ds_write_b128 v125, v[180:183] offset:1024
    ds_write_b128 v125, v[184:187] offset:1040
    s_mov_b64 exec, s[56:57]
    s_waitcnt lgkmcnt(0)
    s_barrier
    s_cmp_lg_u32 s20, 0
    s_cbranch_scc1 L_attn_kernel_side_done
    v_lshlrev_b32 v125, 2, v1
    ds_read_b32 v172, v125 offset:1024
    ds_read_b32 v173, v125 offset:1280
    ds_read_b32 v174, v125 offset:1536
    ds_read_b32 v175, v125 offset:1792
    s_lshl_b32 s9, s6, 14
    s_lshl_b32 s31, s7, 8
    s_add_u32 s9, s9, s31
    s_add_u32 s56, s10, 131072
    s_addc_u32 s57, s11, 0
    s_mov_b32 s58, 65536
    s_mov_b32 s59, 0x20000
    s_waitcnt lgkmcnt(0)
    v_add_f32 v172, v172, v173
    v_add_f32 v174, v174, v175
    v_add_f32 v172, v172, v174
    buffer_store_dword v172, v125, s[56:59], s9 offen
L_attn_kernel_side_done:
    s_cmp_eq_u32 s46, 1
    s_cbranch_scc1 L_attn_kernel_end
    v_mov_b32 v47, 0
    ds_read_b128 v[48:51], v47
    s_waitcnt lgkmcnt(0)
    v_or_b32 v48, v48, v49
    v_or_b32 v50, v50, v51
    v_or_b32 v48, v48, v50
    s_nop 0
    v_readfirstlane_b32 s58, v48
    s_cmp_lg_u32 s58, 0
    s_cbranch_scc1 L_attn_kernel_fallback
L_attn_kernel_end:
L_attn_kernel_done:
    s_endpgm
.globl oproj_kernel
.p2align 8
.type oproj_kernel,@function
oproj_kernel:
    s_cmp_ge_u32 s2, 256
    s_cbranch_scc1 L_oproj_kernel_done
    s_load_dwordx2 s[4:5], s[0:1], 32
    s_load_dwordx2 s[6:7], s[0:1], 96
    s_load_dwordx4 s[60:63], s[0:1], 48
    s_load_dwordx2 s[8:9], s[0:1], 80
    v_lshrrev_b32 v2, 6, v0
    v_and_b32 v1, 63, v0
    v_readfirstlane_b32 s20, v2
    v_lshlrev_b32 v2, 4, v1
    s_and_b32 s21, s2, 7
    s_lshr_b32 s22, s2, 3
    s_and_b32 s23, s21, 3
    s_lshr_b32 s24, s21, 2
    s_lshl_b32 s24, s24, 2
    s_lshr_b32 s25, s22, 3
    s_add_u32 s24, s24, s25
    s_and_b32 s25, s22, 7
    s_mul_i32 s26, s23, 1024
    s_mul_i32 s27, s23, 65536
    s_lshl_b32 s36, s24, 3
    s_add_u32 s36, s36, s25
    s_lshl_b32 s24, s24, 3
    s_lshl_b32 s31, s20, 1
    s_add_u32 s24, s24, s31
    v_add_u32 v3, 262144, v2
    v_lshrrev_b32 v32, 4, v1
    v_and_b32 v33, 15, v1
    v_lshlrev_b32 v34, 1, v32
    v_xor_b32 v34, v33, v34
    v_xor_b32 v36, 8, v34
    v_lshlrev_b32 v34, 4, v34
    v_lshlrev_b32 v36, 4, v36
    v_mul_u32_u24 v35, 2048, v32
    v_add_u32 v4, v35, v34
    v_add_u32 v5, 7168, v4
    v_add_u32 v6, v35, v36
    v_add_u32 v7, 21504, v6
    v_add_u32 v6, 14336, v6
    v_lshrrev_b32 v16, 4, v1
    v_lshlrev_b32 v16, 9, v16
    v_and_b32 v17, 15, v1
    v_lshl_add_u32 v16, v17, 4, v16
    v_add_u32 v17, 262144, v16
    s_waitcnt lgkmcnt(0)
    s_mov_b32 s12, s4
    s_mov_b32 s13, s5
    s_mov_b32 s14, 8388608
    s_mov_b32 s15, 0x20000
    s_mul_i32 s31, s24, 262144
    s_add_u32 s31, s31, s27
    s_add_u32 s31, s31, 16777216
    s_add_u32 s16, s6, s31
    s_addc_u32 s17, s7, 0
    s_mov_b32 s18, 327680
    s_mov_b32 s19, 0x20000
    s_lshl_b32 s31, s20, 4
    s_add_u32 s31, s31, s26
    s_mul_i32 s28, s31, 2048
    s_lshl_b32 s31, s25, 8
    s_add_u32 s28, s28, s31
    s_mov_b32 s29, 0
    s_lshl_b32 s30, s20, 12
    s_add_u32 m0, s30, 0
    s_nop 0
    buffer_load_dwordx4 v4, s[12:15], s28 offen offset:0 lds
    buffer_load_dwordx4 a[0:3], v16, s[16:19], s29 offen offset:0
    buffer_load_dwordx4 a[4:7], v16, s[16:19], s29 offen offset:256
    buffer_load_dwordx4 v5, s[12:15], s28 offen offset:1024 lds
    buffer_load_dwordx4 a[8:11], v17, s[16:19], s29 offen offset:0
    buffer_load_dwordx4 a[12:15], v17, s[16:19], s29 offen offset:256
    buffer_load_dwordx4 v6, s[12:15], s28 offen offset:2048 lds
    buffer_load_dwordx4 a[16:19], v16, s[16:19], s29 offen offset:2048
    buffer_load_dwordx4 a[20:23], v16, s[16:19], s29 offen offset:2304
    buffer_load_dwordx4 v7, s[12:15], s28 offen offset:3072 lds
    buffer_load_dwordx4 a[24:27], v17, s[16:19], s29 offen offset:2048
    buffer_load_dwordx4 a[28:31], v17, s[16:19], s29 offen offset:2304
    v_lshrrev_b32 v32, 4, v1
    v_bfe_u32 v33, v1, 2, 2
    v_lshl_add_u32 v34, v32, 3, v33
    v_and_b32 v35, 1, v32
    v_lshl_or_b32 v35, v35, 2, v33
    v_bfe_u32 v36, v1, 1, 1
    v_lshlrev_b32 v36, 4, v36
    v_and_b32 v37, 1, v1
    v_lshl_or_b32 v36, v37, 3, v36
    v_lshl_add_u32 v36, v34, 8, v36
    v_xor_b32 v37, 0, v35
    v_lshl_add_u32 v200, v37, 5, v36
    v_add_u32 v208, 65536, v200
    v_xor_b32 v37, 1, v35
    v_lshl_add_u32 v201, v37, 5, v36
    v_add_u32 v209, 65536, v201
    v_xor_b32 v37, 2, v35
    v_lshl_add_u32 v202, v37, 5, v36
    v_add_u32 v210, 65536, v202
    v_xor_b32 v37, 3, v35
    v_lshl_add_u32 v203, v37, 5, v36
    v_add_u32 v211, 65536, v203
    v_xor_b32 v37, 4, v35
    v_lshl_add_u32 v204, v37, 5, v36
    v_add_u32 v212, 65536, v204
    v_xor_b32 v37, 5, v35
    v_lshl_add_u32 v205, v37, 5, v36
    v_add_u32 v213, 65536, v205
    v_xor_b32 v37, 6, v35
    v_lshl_add_u32 v206, v37, 5, v36
    v_add_u32 v214, 65536, v206
    v_xor_b32 v37, 7, v35
    v_lshl_add_u32 v207, v37, 5, v36
    v_add_u32 v215, 65536, v207
    s_add_u32 s28, s28, 131072
    s_add_u32 m0, s30, 16384
    s_nop 0
    buffer_load_dwordx4 v4, s[12:15], s28 offen offset:0 lds
    s_mov_b32 s29, 4096
    buffer_load_dwordx4 a[32:35], v16, s[16:19], s29 offen offset:0
    buffer_load_dwordx4 a[36:39], v16, s[16:19], s29 offen offset:256
    buffer_load_dwordx4 v5, s[12:15], s28 offen offset:1024 lds
    buffer_load_dwordx4 a[40:43], v17, s[16:19], s29 offen offset:0
    buffer_load_dwordx4 a[44:47], v17, s[16:19], s29 offen offset:256
    buffer_load_dwordx4 v6, s[12:15], s28 offen offset:2048 lds
    buffer_load_dwordx4 a[48:51], v16, s[16:19], s29 offen offset:2048
    buffer_load_dwordx4 a[52:55], v16, s[16:19], s29 offen offset:2304
    buffer_load_dwordx4 v7, s[12:15], s28 offen offset:3072 lds
    buffer_load_dwordx4 a[56:59], v17, s[16:19], s29 offen offset:2048
    buffer_load_dwordx4 a[60:63], v17, s[16:19], s29 offen offset:2304
    v_mov_b32 v64, 0
    v_mov_b32 v65, 0
    v_mov_b32 v66, 0
    v_mov_b32 v67, 0
    v_mov_b32 v68, 0
    v_mov_b32 v69, 0
    v_mov_b32 v70, 0
    v_mov_b32 v71, 0
    v_mov_b32 v72, 0
    v_mov_b32 v73, 0
    v_mov_b32 v74, 0
    v_mov_b32 v75, 0
    v_mov_b32 v76, 0
    v_mov_b32 v77, 0
    v_mov_b32 v78, 0
    v_mov_b32 v79, 0
    v_mov_b32 v80, 0
    v_mov_b32 v81, 0
    v_mov_b32 v82, 0
    v_mov_b32 v83, 0
    v_mov_b32 v84, 0
    v_mov_b32 v85, 0
    v_mov_b32 v86, 0
    v_mov_b32 v87, 0
    v_mov_b32 v88, 0
    v_mov_b32 v89, 0
    v_mov_b32 v90, 0
    v_mov_b32 v91, 0
    v_mov_b32 v92, 0
    v_mov_b32 v93, 0
    v_mov_b32 v94, 0
    v_mov_b32 v95, 0
    v_mov_b32 v96, 0
    v_mov_b32 v97, 0
    v_mov_b32 v98, 0
    v_mov_b32 v99, 0
    v_mov_b32 v100, 0
    v_mov_b32 v101, 0
    v_mov_b32 v102, 0
    v_mov_b32 v103, 0
    v_mov_b32 v104, 0
    v_mov_b32 v105, 0
    v_mov_b32 v106, 0
    v_mov_b32 v107, 0
    v_mov_b32 v108, 0
    v_mov_b32 v109, 0
    v_mov_b32 v110, 0
    v_mov_b32 v111, 0
    v_mov_b32 v112, 0
    v_mov_b32 v113, 0
    v_mov_b32 v114, 0
    v_mov_b32 v115, 0
    v_mov_b32 v116, 0
    v_mov_b32 v117, 0
    v_mov_b32 v118, 0
    v_mov_b32 v119, 0
    v_mov_b32 v120, 0
    v_mov_b32 v121, 0
    v_mov_b32 v122, 0
    v_mov_b32 v123, 0
    v_mov_b32 v124, 0
    v_mov_b32 v125, 0
    v_mov_b32 v126, 0
    v_mov_b32 v127, 0
    v_mov_b32 v128, 0
    v_mov_b32 v129, 0
    v_mov_b32 v130, 0
    v_mov_b32 v131, 0
    v_mov_b32 v132, 0
    v_mov_b32 v133, 0
    v_mov_b32 v134, 0
    v_mov_b32 v135, 0
    v_mov_b32 v136, 0
    v_mov_b32 v137, 0
    v_mov_b32 v138, 0
    v_mov_b32 v139, 0
    v_mov_b32 v140, 0
    v_mov_b32 v141, 0
    v_mov_b32 v142, 0
    v_mov_b32 v143, 0
    v_mov_b32 v144, 0
    v_mov_b32 v145, 0
    v_mov_b32 v146, 0
    v_mov_b32 v147, 0
    v_mov_b32 v148, 0
    v_mov_b32 v149, 0
    v_mov_b32 v150, 0
    v_mov_b32 v151, 0
    v_mov_b32 v152, 0
    v_mov_b32 v153, 0
    v_mov_b32 v154, 0
    v_mov_b32 v155, 0
    v_mov_b32 v156, 0
    v_mov_b32 v157, 0
    v_mov_b32 v158, 0
    v_mov_b32 v159, 0
    v_mov_b32 v160, 0
    v_mov_b32 v161, 0
    v_mov_b32 v162, 0
    v_mov_b32 v163, 0
    v_mov_b32 v164, 0
    v_mov_b32 v165, 0
    v_mov_b32 v166, 0
    v_mov_b32 v167, 0
    v_mov_b32 v168, 0
    v_mov_b32 v169, 0
    v_mov_b32 v170, 0
    v_mov_b32 v171, 0
    v_mov_b32 v172, 0
    v_mov_b32 v173, 0
    v_mov_b32 v174, 0
    v_mov_b32 v175, 0
    v_mov_b32 v176, 0
    v_mov_b32 v177, 0
    v_mov_b32 v178, 0
    v_mov_b32 v179, 0
    v_mov_b32 v180, 0
    v_mov_b32 v181, 0
    v_mov_b32 v182, 0
    v_mov_b32 v183, 0
    v_mov_b32 v184, 0
    v_mov_b32 v185, 0
    v_mov_b32 v186, 0
    v_mov_b32 v187, 0
    v_mov_b32 v188, 0
    v_mov_b32 v189, 0
    v_mov_b32 v190, 0
    v_mov_b32 v191, 0
    s_mul_i32 s31, s23, 4194304
    s_add_u32 s31, s31, 83886080
    s_add_u32 s40, s6, s31
    s_addc_u32 s41, s7, 0
    s_mov_b32 s42, 4194304
    s_mov_b32 s43, 0x20000
    s_lshl_b32 s26, s24, 16
    s_lshl_b32 s27, s25, 13
    s_add_u32 s26, s26, s27
    s_add_u32 s27, s26, 65536
    s_add_u32 s34, s26, 4096
    s_add_u32 s35, s27, 4096
    s_waitcnt vmcnt(12)
    s_barrier
    ds_read_b64_tr_b16 a[192:193], v200 offset:0
    ds_read_b64_tr_b16 a[194:195], v200 offset:1024
    ds_read_b64_tr_b16 a[196:197], v201 offset:0
    ds_read_b64_tr_b16 a[198:199], v201 offset:1024
    ds_read_b64_tr_b16 a[200:201], v202 offset:0
    ds_read_b64_tr_b16 a[202:203], v202 offset:1024
    ds_read_b64_tr_b16 a[204:205], v203 offset:0
    ds_read_b64_tr_b16 a[206:207], v203 offset:1024
    s_waitcnt lgkmcnt(6)
    v_mfma_f32_16x16x32_bf16 v[64:67], a[192:195], a[0:3], v[64:67]
    ds_read_b64_tr_b16 a[208:209], v204 offset:0
    v_mfma_f32_16x16x32_bf16 v[68:71], a[192:195], a[4:7], v[68:71]
    ds_read_b64_tr_b16 a[210:211], v204 offset:1024
    s_add_u32 s28, s28, 131072
    s_add_u32 m0, s30, 32768
    v_mfma_f32_16x16x32_bf16 v[72:75], a[192:195], a[8:11], v[72:75]
    buffer_load_dwordx4 v4, s[12:15], s28 offen offset:0 lds
    v_mfma_f32_16x16x32_bf16 v[76:79], a[192:195], a[12:15], v[76:79]
    s_waitcnt lgkmcnt(6)
    v_mfma_f32_16x16x32_bf16 v[80:83], a[196:199], a[0:3], v[80:83]
    ds_read_b64_tr_b16 a[212:213], v205 offset:0
    v_mfma_f32_16x16x32_bf16 v[84:87], a[196:199], a[4:7], v[84:87]
    ds_read_b64_tr_b16 a[214:215], v205 offset:1024
    s_mov_b32 s29, 8192
    v_mfma_f32_16x16x32_bf16 v[88:91], a[196:199], a[8:11], v[88:91]
    buffer_load_dwordx4 a[64:67], v16, s[16:19], s29 offen offset:0
    v_mfma_f32_16x16x32_bf16 v[92:95], a[196:199], a[12:15], v[92:95]
    s_waitcnt lgkmcnt(6)
    v_mfma_f32_16x16x32_bf16 v[96:99], a[200:203], a[0:3], v[96:99]
    ds_read_b64_tr_b16 a[216:217], v206 offset:0
    v_mfma_f32_16x16x32_bf16 v[100:103], a[200:203], a[4:7], v[100:103]
    ds_read_b64_tr_b16 a[218:219], v206 offset:1024
    v_mfma_f32_16x16x32_bf16 v[104:107], a[200:203], a[8:11], v[104:107]
    buffer_load_dwordx4 a[68:71], v16, s[16:19], s29 offen offset:256
    v_mfma_f32_16x16x32_bf16 v[108:111], a[200:203], a[12:15], v[108:111]
    s_waitcnt lgkmcnt(6)
    v_mfma_f32_16x16x32_bf16 v[112:115], a[204:207], a[0:3], v[112:115]
    ds_read_b64_tr_b16 a[220:221], v207 offset:0
    v_mfma_f32_16x16x32_bf16 v[116:119], a[204:207], a[4:7], v[116:119]
    ds_read_b64_tr_b16 a[222:223], v207 offset:1024
    v_mfma_f32_16x16x32_bf16 v[120:123], a[204:207], a[8:11], v[120:123]
    buffer_load_dwordx4 v5, s[12:15], s28 offen offset:1024 lds
    v_mfma_f32_16x16x32_bf16 v[124:127], a[204:207], a[12:15], v[124:127]
    s_waitcnt lgkmcnt(6)
    v_mfma_f32_16x16x32_bf16 v[128:131], a[208:211], a[0:3], v[128:131]
    ds_read_b64_tr_b16 a[192:193], v200 offset:8192
    v_mfma_f32_16x16x32_bf16 v[132:135], a[208:211], a[4:7], v[132:135]
    ds_read_b64_tr_b16 a[194:195], v200 offset:9216
    v_mfma_f32_16x16x32_bf16 v[136:139], a[208:211], a[8:11], v[136:139]
    buffer_load_dwordx4 a[72:75], v17, s[16:19], s29 offen offset:0
    v_mfma_f32_16x16x32_bf16 v[140:143], a[208:211], a[12:15], v[140:143]
    s_waitcnt lgkmcnt(6)
    v_mfma_f32_16x16x32_bf16 v[144:147], a[212:215], a[0:3], v[144:147]
    ds_read_b64_tr_b16 a[196:197], v201 offset:8192
    v_mfma_f32_16x16x32_bf16 v[148:151], a[212:215], a[4:7], v[148:151]
    ds_read_b64_tr_b16 a[198:199], v201 offset:9216
    v_mfma_f32_16x16x32_bf16 v[152:155], a[212:215], a[8:11], v[152:155]
    buffer_load_dwordx4 a[76:79], v17, s[16:19], s29 offen offset:256
    v_mfma_f32_16x16x32_bf16 v[156:159], a[212:215], a[12:15], v[156:159]
    s_waitcnt lgkmcnt(6)
    v_mfma_f32_16x16x32_bf16 v[160:163], a[216:219], a[0:3], v[160:163]
    ds_read_b64_tr_b16 a[200:201], v202 offset:8192
    v_mfma_f32_16x16x32_bf16 v[164:167], a[216:219], a[4:7], v[164:167]
    ds_read_b64_tr_b16 a[202:203], v202 offset:9216
    v_mfma_f32_16x16x32_bf16 v[168:171], a[216:219], a[8:11], v[168:171]
    buffer_load_dwordx4 v6, s[12:15], s28 offen offset:2048 lds
    v_mfma_f32_16x16x32_bf16 v[172:175], a[216:219], a[12:15], v[172:175]
    s_waitcnt lgkmcnt(6)
    v_mfma_f32_16x16x32_bf16 v[176:179], a[220:223], a[0:3], v[176:179]
    ds_read_b64_tr_b16 a[204:205], v203 offset:8192
    v_mfma_f32_16x16x32_bf16 v[180:183], a[220:223], a[4:7], v[180:183]
    ds_read_b64_tr_b16 a[206:207], v203 offset:9216
    v_mfma_f32_16x16x32_bf16 v[184:187], a[220:223], a[8:11], v[184:187]
    buffer_load_dwordx4 a[80:83], v16, s[16:19], s29 offen offset:2048
    v_mfma_f32_16x16x32_bf16 v[188:191], a[220:223], a[12:15], v[188:191]
    s_waitcnt lgkmcnt(6)
    v_mfma_f32_16x16x32_bf16 v[64:67], a[192:195], a[16:19], v[64:67]
    ds_read_b64_tr_b16 a[208:209], v204 offset:8192
    v_mfma_f32_16x16x32_bf16 v[68:71], a[192:195], a[20:23], v[68:71]
    ds_read_b64_tr_b16 a[210:211], v204 offset:9216
    v_mfma_f32_16x16x32_bf16 v[72:75], a[192:195], a[24:27], v[72:75]
    buffer_load_dwordx4 a[84:87], v16, s[16:19], s29 offen offset:2304
    v_mfma_f32_16x16x32_bf16 v[76:79], a[192:195], a[28:31], v[76:79]
    s_waitcnt lgkmcnt(6)
    v_mfma_f32_16x16x32_bf16 v[80:83], a[196:199], a[16:19], v[80:83]
    ds_read_b64_tr_b16 a[212:213], v205 offset:8192
    v_mfma_f32_16x16x32_bf16 v[84:87], a[196:199], a[20:23], v[84:87]
    ds_read_b64_tr_b16 a[214:215], v205 offset:9216
    v_mfma_f32_16x16x32_bf16 v[88:91], a[196:199], a[24:27], v[88:91]
    buffer_load_dwordx4 v7, s[12:15], s28 offen offset:3072 lds
    v_mfma_f32_16x16x32_bf16 v[92:95], a[196:199], a[28:31], v[92:95]
    s_waitcnt lgkmcnt(6)
    v_mfma_f32_16x16x32_bf16 v[96:99], a[200:203], a[16:19], v[96:99]
    ds_read_b64_tr_b16 a[216:217], v206 offset:8192
    v_mfma_f32_16x16x32_bf16 v[100:103], a[200:203], a[20:23], v[100:103]
    ds_read_b64_tr_b16 a[218:219], v206 offset:9216
    v_mfma_f32_16x16x32_bf16 v[104:107], a[200:203], a[24:27], v[104:107]
    buffer_load_dwordx4 a[88:91], v17, s[16:19], s29 offen offset:2048
    v_mfma_f32_16x16x32_bf16 v[108:111], a[200:203], a[28:31], v[108:111]
    s_waitcnt lgkmcnt(6)
    v_mfma_f32_16x16x32_bf16 v[112:115], a[204:207], a[16:19], v[112:115]
    ds_read_b64_tr_b16 a[220:221], v207 offset:8192
    v_mfma_f32_16x16x32_bf16 v[116:119], a[204:207], a[20:23], v[116:119]
    ds_read_b64_tr_b16 a[222:223], v207 offset:9216
    v_mfma_f32_16x16x32_bf16 v[120:123], a[204:207], a[24:27], v[120:123]
    buffer_load_dwordx4 a[92:95], v17, s[16:19], s29 offen offset:2304
    v_mfma_f32_16x16x32_bf16 v[124:127], a[204:207], a[28:31], v[124:127]
    s_waitcnt vmcnt(12) lgkmcnt(0)
    s_barrier
    v_mfma_f32_16x16x32_bf16 v[128:131], a[208:211], a[16:19], v[128:131]
    ds_read_b64_tr_b16 a[192:193], v200 offset:16384
    v_mfma_f32_16x16x32_bf16 v[132:135], a[208:211], a[20:23], v[132:135]
    ds_read_b64_tr_b16 a[194:195], v200 offset:17408
    s_add_u32 s28, s28, 131072
    s_add_u32 m0, s30, 49152
    v_mfma_f32_16x16x32_bf16 v[136:139], a[208:211], a[24:27], v[136:139]
    buffer_load_dwordx4 v4, s[12:15], s28 offen offset:0 lds
    v_mfma_f32_16x16x32_bf16 v[140:143], a[208:211], a[28:31], v[140:143]
    s_waitcnt lgkmcnt(6)
    v_mfma_f32_16x16x32_bf16 v[144:147], a[212:215], a[16:19], v[144:147]
    ds_read_b64_tr_b16 a[196:197], v201 offset:16384
    v_mfma_f32_16x16x32_bf16 v[148:151], a[212:215], a[20:23], v[148:151]
    ds_read_b64_tr_b16 a[198:199], v201 offset:17408
    s_mov_b32 s29, 12288
    v_mfma_f32_16x16x32_bf16 v[152:155], a[212:215], a[24:27], v[152:155]
    buffer_load_dwordx4 a[96:99], v16, s[16:19], s29 offen offset:0
    v_mfma_f32_16x16x32_bf16 v[156:159], a[212:215], a[28:31], v[156:159]
    s_waitcnt lgkmcnt(6)
    v_mfma_f32_16x16x32_bf16 v[160:163], a[216:219], a[16:19], v[160:163]
    ds_read_b64_tr_b16 a[200:201], v202 offset:16384
    v_mfma_f32_16x16x32_bf16 v[164:167], a[216:219], a[20:23], v[164:167]
    ds_read_b64_tr_b16 a[202:203], v202 offset:17408
    v_mfma_f32_16x16x32_bf16 v[168:171], a[216:219], a[24:27], v[168:171]
    buffer_load_dwordx4 a[100:103], v16, s[16:19], s29 offen offset:256
    v_mfma_f32_16x16x32_bf16 v[172:175], a[216:219], a[28:31], v[172:175]
    s_waitcnt lgkmcnt(6)
    v_mfma_f32_16x16x32_bf16 v[176:179], a[220:223], a[16:19], v[176:179]
    ds_read_b64_tr_b16 a[204:205], v203 offset:16384
    v_mfma_f32_16x16x32_bf16 v[180:183], a[220:223], a[20:23], v[180:183]
    ds_read_b64_tr_b16 a[206:207], v203 offset:17408
    v_mfma_f32_16x16x32_bf16 v[184:187], a[220:223], a[24:27], v[184:187]
    buffer_load_dwordx4 v5, s[12:15], s28 offen offset:1024 lds
    v_mfma_f32_16x16x32_bf16 v[188:191], a[220:223], a[28:31], v[188:191]
    s_waitcnt lgkmcnt(6)
    v_mfma_f32_16x16x32_bf16 v[64:67], a[192:195], a[32:35], v[64:67]
    ds_read_b64_tr_b16 a[208:209], v204 offset:16384
    v_mfma_f32_16x16x32_bf16 v[68:71], a[192:195], a[36:39], v[68:71]
    ds_read_b64_tr_b16 a[210:211], v204 offset:17408
    v_mfma_f32_16x16x32_bf16 v[72:75], a[192:195], a[40:43], v[72:75]
    buffer_load_dwordx4 a[104:107], v17, s[16:19], s29 offen offset:0
    v_mfma_f32_16x16x32_bf16 v[76:79], a[192:195], a[44:47], v[76:79]
    s_waitcnt lgkmcnt(6)
    v_mfma_f32_16x16x32_bf16 v[80:83], a[196:199], a[32:35], v[80:83]
    ds_read_b64_tr_b16 a[212:213], v205 offset:16384
    v_mfma_f32_16x16x32_bf16 v[84:87], a[196:199], a[36:39], v[84:87]
    ds_read_b64_tr_b16 a[214:215], v205 offset:17408
    v_mfma_f32_16x16x32_bf16 v[88:91], a[196:199], a[40:43], v[88:91]
    buffer_load_dwordx4 a[108:111], v17, s[16:19], s29 offen offset:256
    v_mfma_f32_16x16x32_bf16 v[92:95], a[196:199], a[44:47], v[92:95]
    s_waitcnt lgkmcnt(6)
    v_mfma_f32_16x16x32_bf16 v[96:99], a[200:203], a[32:35], v[96:99]
    ds_read_b64_tr_b16 a[216:217], v206 offset:16384
    v_mfma_f32_16x16x32_bf16 v[100:103], a[200:203], a[36:39], v[100:103]
    ds_read_b64_tr_b16 a[218:219], v206 offset:17408
    v_mfma_f32_16x16x32_bf16 v[104:107], a[200:203], a[40:43], v[104:107]
    buffer_load_dwordx4 v6, s[12:15], s28 offen offset:2048 lds
    v_mfma_f32_16x16x32_bf16 v[108:111], a[200:203], a[44:47], v[108:111]
    s_waitcnt lgkmcnt(6)
    v_mfma_f32_16x16x32_bf16 v[112:115], a[204:207], a[32:35], v[112:115]
    ds_read_b64_tr_b16 a[220:221], v207 offset:16384
    v_mfma_f32_16x16x32_bf16 v[116:119], a[204:207], a[36:39], v[116:119]
    ds_read_b64_tr_b16 a[222:223], v207 offset:17408
    v_mfma_f32_16x16x32_bf16 v[120:123], a[204:207], a[40:43], v[120:123]
    buffer_load_dwordx4 a[112:115], v16, s[16:19], s29 offen offset:2048
    v_mfma_f32_16x16x32_bf16 v[124:127], a[204:207], a[44:47], v[124:127]
    s_waitcnt lgkmcnt(6)
    v_mfma_f32_16x16x32_bf16 v[128:131], a[208:211], a[32:35], v[128:131]
    ds_read_b64_tr_b16 a[192:193], v200 offset:24576
    v_mfma_f32_16x16x32_bf16 v[132:135], a[208:211], a[36:39], v[132:135]
    ds_read_b64_tr_b16 a[194:195], v200 offset:25600
    v_mfma_f32_16x16x32_bf16 v[136:139], a[208:211], a[40:43], v[136:139]
    buffer_load_dwordx4 a[116:119], v16, s[16:19], s29 offen offset:2304
    v_mfma_f32_16x16x32_bf16 v[140:143], a[208:211], a[44:47], v[140:143]
    s_waitcnt lgkmcnt(6)
    v_mfma_f32_16x16x32_bf16 v[144:147], a[212:215], a[32:35], v[144:147]
    ds_read_b64_tr_b16 a[196:197], v201 offset:24576
    v_mfma_f32_16x16x32_bf16 v[148:151], a[212:215], a[36:39], v[148:151]
    ds_read_b64_tr_b16 a[198:199], v201 offset:25600
    v_mfma_f32_16x16x32_bf16 v[152:155], a[212:215], a[40:43], v[152:155]
    buffer_load_dwordx4 v7, s[12:15], s28 offen offset:3072 lds
    v_mfma_f32_16x16x32_bf16 v[156:159], a[212:215], a[44:47], v[156:159]
    s_waitcnt lgkmcnt(6)
    v_mfma_f32_16x16x32_bf16 v[160:163], a[216:219], a[32:35], v[160:163]
    ds_read_b64_tr_b16 a[200:201], v202 offset:24576
    v_mfma_f32_16x16x32_bf16 v[164:167], a[216:219], a[36:39], v[164:167]
    ds_read_b64_tr_b16 a[202:203], v202 offset:25600
    v_mfma_f32_16x16x32_bf16 v[168:171], a[216:219], a[40:43], v[168:171]
    buffer_load_dwordx4 a[120:123], v17, s[16:19], s29 offen offset:2048
    v_mfma_f32_16x16x32_bf16 v[172:175], a[216:219], a[44:47], v[172:175]
    s_waitcnt lgkmcnt(6)
    v_mfma_f32_16x16x32_bf16 v[176:179], a[220:223], a[32:35], v[176:179]
    ds_read_b64_tr_b16 a[204:205], v203 offset:24576
    v_mfma_f32_16x16x32_bf16 v[180:183], a[220:223], a[36:39], v[180:183]
    ds_read_b64_tr_b16 a[206:207], v203 offset:25600
    v_mfma_f32_16x16x32_bf16 v[184:187], a[220:223], a[40:43], v[184:187]
    buffer_load_dwordx4 a[124:127], v17, s[16:19], s29 offen offset:2304
    v_mfma_f32_16x16x32_bf16 v[188:191], a[220:223], a[44:47], v[188:191]
    s_waitcnt lgkmcnt(6)
    v_mfma_f32_16x16x32_bf16 v[64:67], a[192:195], a[48:51], v[64:67]
    ds_read_b64_tr_b16 a[208:209], v204 offset:24576
    v_mfma_f32_16x16x32_bf16 v[68:71], a[192:195], a[52:55], v[68:71]
    ds_read_b64_tr_b16 a[210:211], v204 offset:25600
    s_add_u32 s28, s28, 131072
    s_add_u32 m0, s30, 65536
    v_mfma_f32_16x16x32_bf16 v[72:75], a[192:195], a[56:59], v[72:75]
    buffer_load_dwordx4 v4, s[12:15], s28 offen offset:0 lds
    v_mfma_f32_16x16x32_bf16 v[76:79], a[192:195], a[60:63], v[76:79]
    s_waitcnt lgkmcnt(6)
    v_mfma_f32_16x16x32_bf16 v[80:83], a[196:199], a[48:51], v[80:83]
    ds_read_b64_tr_b16 a[212:213], v205 offset:24576
    v_mfma_f32_16x16x32_bf16 v[84:87], a[196:199], a[52:55], v[84:87]
    ds_read_b64_tr_b16 a[214:215], v205 offset:25600
    s_mov_b32 s29, 16384
    v_mfma_f32_16x16x32_bf16 v[88:91], a[196:199], a[56:59], v[88:91]
    buffer_load_dwordx4 a[128:131], v16, s[16:19], s29 offen offset:0
    v_mfma_f32_16x16x32_bf16 v[92:95], a[196:199], a[60:63], v[92:95]
    s_waitcnt lgkmcnt(6)
    v_mfma_f32_16x16x32_bf16 v[96:99], a[200:203], a[48:51], v[96:99]
    ds_read_b64_tr_b16 a[216:217], v206 offset:24576
    v_mfma_f32_16x16x32_bf16 v[100:103], a[200:203], a[52:55], v[100:103]
    ds_read_b64_tr_b16 a[218:219], v206 offset:25600
    v_mfma_f32_16x16x32_bf16 v[104:107], a[200:203], a[56:59], v[104:107]
    buffer_load_dwordx4 a[132:135], v16, s[16:19], s29 offen offset:256
    v_mfma_f32_16x16x32_bf16 v[108:111], a[200:203], a[60:63], v[108:111]
    s_waitcnt lgkmcnt(6)
    v_mfma_f32_16x16x32_bf16 v[112:115], a[204:207], a[48:51], v[112:115]
    ds_read_b64_tr_b16 a[220:221], v207 offset:24576
    v_mfma_f32_16x16x32_bf16 v[116:119], a[204:207], a[52:55], v[116:119]
    ds_read_b64_tr_b16 a[222:223], v207 offset:25600
    v_mfma_f32_16x16x32_bf16 v[120:123], a[204:207], a[56:59], v[120:123]
    buffer_load_dwordx4 v5, s[12:15], s28 offen offset:1024 lds
    v_mfma_f32_16x16x32_bf16 v[124:127], a[204:207], a[60:63], v[124:127]
    s_waitcnt vmcnt(16) lgkmcnt(0)
    s_barrier
    v_mfma_f32_16x16x32_bf16 v[128:131], a[208:211], a[48:51], v[128:131]
    ds_read_b64_tr_b16 a[192:193], v200 offset:32768
    v_mfma_f32_16x16x32_bf16 v[132:135], a[208:211], a[52:55], v[132:135]
    ds_read_b64_tr_b16 a[194:195], v200 offset:33792
    v_mfma_f32_16x16x32_bf16 v[136:139], a[208:211], a[56:59], v[136:139]
    buffer_load_dwordx4 a[136:139], v17, s[16:19], s29 offen offset:0
    v_mfma_f32_16x16x32_bf16 v[140:143], a[208:211], a[60:63], v[140:143]
    s_waitcnt lgkmcnt(6)
    v_mfma_f32_16x16x32_bf16 v[144:147], a[212:215], a[48:51], v[144:147]
    ds_read_b64_tr_b16 a[196:197], v201 offset:32768
    v_mfma_f32_16x16x32_bf16 v[148:151], a[212:215], a[52:55], v[148:151]
    ds_read_b64_tr_b16 a[198:199], v201 offset:33792
    v_mfma_f32_16x16x32_bf16 v[152:155], a[212:215], a[56:59], v[152:155]
    buffer_load_dwordx4 a[140:143], v17, s[16:19], s29 offen offset:256
    v_mfma_f32_16x16x32_bf16 v[156:159], a[212:215], a[60:63], v[156:159]
    s_waitcnt lgkmcnt(6)
    v_mfma_f32_16x16x32_bf16 v[160:163], a[216:219], a[48:51], v[160:163]
    ds_read_b64_tr_b16 a[200:201], v202 offset:32768
    v_mfma_f32_16x16x32_bf16 v[164:167], a[216:219], a[52:55], v[164:167]
    ds_read_b64_tr_b16 a[202:203], v202 offset:33792
    v_mfma_f32_16x16x32_bf16 v[168:171], a[216:219], a[56:59], v[168:171]
    buffer_load_dwordx4 v6, s[12:15], s28 offen offset:2048 lds
    v_mfma_f32_16x16x32_bf16 v[172:175], a[216:219], a[60:63], v[172:175]
    s_waitcnt lgkmcnt(6)
    v_mfma_f32_16x16x32_bf16 v[176:179], a[220:223], a[48:51], v[176:179]
    ds_read_b64_tr_b16 a[204:205], v203 offset:32768
    v_mfma_f32_16x16x32_bf16 v[180:183], a[220:223], a[52:55], v[180:183]
    ds_read_b64_tr_b16 a[206:207], v203 offset:33792
    v_mfma_f32_16x16x32_bf16 v[184:187], a[220:223], a[56:59], v[184:187]
    buffer_load_dwordx4 a[144:147], v16, s[16:19], s29 offen offset:2048
    v_mfma_f32_16x16x32_bf16 v[188:191], a[220:223], a[60:63], v[188:191]
    s_waitcnt lgkmcnt(6)
    v_mfma_f32_16x16x32_bf16 v[64:67], a[192:195], a[64:67], v[64:67]
    ds_read_b64_tr_b16 a[208:209], v204 offset:32768
    v_mfma_f32_16x16x32_bf16 v[68:71], a[192:195], a[68:71], v[68:71]
    ds_read_b64_tr_b16 a[210:211], v204 offset:33792
    v_mfma_f32_16x16x32_bf16 v[72:75], a[192:195], a[72:75], v[72:75]
    buffer_load_dwordx4 a[148:151], v16, s[16:19], s29 offen offset:2304
    v_mfma_f32_16x16x32_bf16 v[76:79], a[192:195], a[76:79], v[76:79]
    s_waitcnt lgkmcnt(6)
    v_mfma_f32_16x16x32_bf16 v[80:83], a[196:199], a[64:67], v[80:83]
    ds_read_b64_tr_b16 a[212:213], v205 offset:32768
    v_mfma_f32_16x16x32_bf16 v[84:87], a[196:199], a[68:71], v[84:87]
    ds_read_b64_tr_b16 a[214:215], v205 offset:33792
    v_mfma_f32_16x16x32_bf16 v[88:91], a[196:199], a[72:75], v[88:91]
    buffer_load_dwordx4 v7, s[12:15], s28 offen offset:3072 lds
    v_mfma_f32_16x16x32_bf16 v[92:95], a[196:199], a[76:79], v[92:95]
    s_waitcnt lgkmcnt(6)
    v_mfma_f32_16x16x32_bf16 v[96:99], a[200:203], a[64:67], v[96:99]
    ds_read_b64_tr_b16 a[216:217], v206 offset:32768
    v_mfma_f32_16x16x32_bf16 v[100:103], a[200:203], a[68:71], v[100:103]
    ds_read_b64_tr_b16 a[218:219], v206 offset:33792
    v_mfma_f32_16x16x32_bf16 v[104:107], a[200:203], a[72:75], v[104:107]
    buffer_load_dwordx4 a[152:155], v17, s[16:19], s29 offen offset:2048
    v_mfma_f32_16x16x32_bf16 v[108:111], a[200:203], a[76:79], v[108:111]
    s_waitcnt lgkmcnt(6)
    v_mfma_f32_16x16x32_bf16 v[112:115], a[204:207], a[64:67], v[112:115]
    ds_read_b64_tr_b16 a[220:221], v207 offset:32768
    v_mfma_f32_16x16x32_bf16 v[116:119], a[204:207], a[68:71], v[116:119]
    ds_read_b64_tr_b16 a[222:223], v207 offset:33792
    v_mfma_f32_16x16x32_bf16 v[120:123], a[204:207], a[72:75], v[120:123]
    buffer_load_dwordx4 a[156:159], v17, s[16:19], s29 offen offset:2304
    v_mfma_f32_16x16x32_bf16 v[124:127], a[204:207], a[76:79], v[124:127]
    s_waitcnt lgkmcnt(6)
    v_mfma_f32_16x16x32_bf16 v[128:131], a[208:211], a[64:67], v[128:131]
    ds_read_b64_tr_b16 a[192:193], v200 offset:40960
    v_mfma_f32_16x16x32_bf16 v[132:135], a[208:211], a[68:71], v[132:135]
    ds_read_b64_tr_b16 a[194:195], v200 offset:41984
    s_add_u32 s28, s28, 131072
    s_add_u32 m0, s30, 81920
    v_mfma_f32_16x16x32_bf16 v[136:139], a[208:211], a[72:75], v[136:139]
    buffer_load_dwordx4 v4, s[12:15], s28 offen offset:0 lds
    v_mfma_f32_16x16x32_bf16 v[140:143], a[208:211], a[76:79], v[140:143]
    s_waitcnt lgkmcnt(6)
    v_mfma_f32_16x16x32_bf16 v[144:147], a[212:215], a[64:67], v[144:147]
    ds_read_b64_tr_b16 a[196:197], v201 offset:40960
    v_mfma_f32_16x16x32_bf16 v[148:151], a[212:215], a[68:71], v[148:151]
    ds_read_b64_tr_b16 a[198:199], v201 offset:41984
    s_mov_b32 s29, 20480
    v_mfma_f32_16x16x32_bf16 v[152:155], a[212:215], a[72:75], v[152:155]
    buffer_load_dwordx4 a[160:163], v16, s[16:19], s29 offen offset:0
    v_mfma_f32_16x16x32_bf16 v[156:159], a[212:215], a[76:79], v[156:159]
    s_waitcnt lgkmcnt(6)
    v_mfma_f32_16x16x32_bf16 v[160:163], a[216:219], a[64:67], v[160:163]
    ds_read_b64_tr_b16 a[200:201], v202 offset:40960
    v_mfma_f32_16x16x32_bf16 v[164:167], a[216:219], a[68:71], v[164:167]
    ds_read_b64_tr_b16 a[202:203], v202 offset:41984
    v_mfma_f32_16x16x32_bf16 v[168:171], a[216:219], a[72:75], v[168:171]
    buffer_load_dwordx4 a[164:167], v16, s[16:19], s29 offen offset:256
    v_mfma_f32_16x16x32_bf16 v[172:175], a[216:219], a[76:79], v[172:175]
    s_waitcnt lgkmcnt(6)
    v_mfma_f32_16x16x32_bf16 v[176:179], a[220:223], a[64:67], v[176:179]
    ds_read_b64_tr_b16 a[204:205], v203 offset:40960
    v_mfma_f32_16x16x32_bf16 v[180:183], a[220:223], a[68:71], v[180:183]
    ds_read_b64_tr_b16 a[206:207], v203 offset:41984
    v_mfma_f32_16x16x32_bf16 v[184:187], a[220:223], a[72:75], v[184:187]
    buffer_load_dwordx4 v5, s[12:15], s28 offen offset:1024 lds
    v_mfma_f32_16x16x32_bf16 v[188:191], a[220:223], a[76:79], v[188:191]
    s_waitcnt lgkmcnt(6)
    v_mfma_f32_16x16x32_bf16 v[64:67], a[192:195], a[80:83], v[64:67]
    ds_read_b64_tr_b16 a[208:209], v204 offset:40960
    v_mfma_f32_16x16x32_bf16 v[68:71], a[192:195], a[84:87], v[68:71]
    ds_read_b64_tr_b16 a[210:211], v204 offset:41984
    v_mfma_f32_16x16x32_bf16 v[72:75], a[192:195], a[88:91], v[72:75]
    buffer_load_dwordx4 a[168:171], v17, s[16:19], s29 offen offset:0
    v_mfma_f32_16x16x32_bf16 v[76:79], a[192:195], a[92:95], v[76:79]
    s_waitcnt lgkmcnt(6)
    v_mfma_f32_16x16x32_bf16 v[80:83], a[196:199], a[80:83], v[80:83]
    ds_read_b64_tr_b16 a[212:213], v205 offset:40960
    v_mfma_f32_16x16x32_bf16 v[84:87], a[196:199], a[84:87], v[84:87]
    ds_read_b64_tr_b16 a[214:215], v205 offset:41984
    v_mfma_f32_16x16x32_bf16 v[88:91], a[196:199], a[88:91], v[88:91]
    buffer_load_dwordx4 a[172:175], v17, s[16:19], s29 offen offset:256
    v_mfma_f32_16x16x32_bf16 v[92:95], a[196:199], a[92:95], v[92:95]
    s_waitcnt lgkmcnt(6)
    v_mfma_f32_16x16x32_bf16 v[96:99], a[200:203], a[80:83], v[96:99]
    ds_read_b64_tr_b16 a[216:217], v206 offset:40960
    v_mfma_f32_16x16x32_bf16 v[100:103], a[200:203], a[84:87], v[100:103]
    ds_read_b64_tr_b16 a[218:219], v206 offset:41984
    v_mfma_f32_16x16x32_bf16 v[104:107], a[200:203], a[88:91], v[104:107]
    buffer_load_dwordx4 v6, s[12:15], s28 offen offset:2048 lds
    v_mfma_f32_16x16x32_bf16 v[108:111], a[200:203], a[92:95], v[108:111]
    s_waitcnt lgkmcnt(6)
    v_mfma_f32_16x16x32_bf16 v[112:115], a[204:207], a[80:83], v[112:115]
    ds_read_b64_tr_b16 a[220:221], v207 offset:40960
    v_mfma_f32_16x16x32_bf16 v[116:119], a[204:207], a[84:87], v[116:119]
    ds_read_b64_tr_b16 a[222:223], v207 offset:41984
    v_mfma_f32_16x16x32_bf16 v[120:123], a[204:207], a[88:91], v[120:123]
    buffer_load_dwordx4 a[176:179], v16, s[16:19], s29 offen offset:2048
    v_mfma_f32_16x16x32_bf16 v[124:127], a[204:207], a[92:95], v[124:127]
    s_waitcnt vmcnt(20) lgkmcnt(0)
    s_barrier
    v_mfma_f32_16x16x32_bf16 v[128:131], a[208:211], a[80:83], v[128:131]
    ds_read_b64_tr_b16 a[192:193], v200 offset:49152
    v_mfma_f32_16x16x32_bf16 v[132:135], a[208:211], a[84:87], v[132:135]
    ds_read_b64_tr_b16 a[194:195], v200 offset:50176
    v_mfma_f32_16x16x32_bf16 v[136:139], a[208:211], a[88:91], v[136:139]
    buffer_load_dwordx4 a[180:183], v16, s[16:19], s29 offen offset:2304
    v_mfma_f32_16x16x32_bf16 v[140:143], a[208:211], a[92:95], v[140:143]
    s_waitcnt lgkmcnt(6)
    v_mfma_f32_16x16x32_bf16 v[144:147], a[212:215], a[80:83], v[144:147]
    ds_read_b64_tr_b16 a[196:197], v201 offset:49152
    v_mfma_f32_16x16x32_bf16 v[148:151], a[212:215], a[84:87], v[148:151]
    ds_read_b64_tr_b16 a[198:199], v201 offset:50176
    v_mfma_f32_16x16x32_bf16 v[152:155], a[212:215], a[88:91], v[152:155]
    buffer_load_dwordx4 v7, s[12:15], s28 offen offset:3072 lds
    v_mfma_f32_16x16x32_bf16 v[156:159], a[212:215], a[92:95], v[156:159]
    s_waitcnt lgkmcnt(6)
    v_mfma_f32_16x16x32_bf16 v[160:163], a[216:219], a[80:83], v[160:163]
    ds_read_b64_tr_b16 a[200:201], v202 offset:49152
    v_mfma_f32_16x16x32_bf16 v[164:167], a[216:219], a[84:87], v[164:167]
    ds_read_b64_tr_b16 a[202:203], v202 offset:50176
    v_mfma_f32_16x16x32_bf16 v[168:171], a[216:219], a[88:91], v[168:171]
    buffer_load_dwordx4 a[184:187], v17, s[16:19], s29 offen offset:2048
    v_mfma_f32_16x16x32_bf16 v[172:175], a[216:219], a[92:95], v[172:175]
    s_waitcnt lgkmcnt(6)
    v_mfma_f32_16x16x32_bf16 v[176:179], a[220:223], a[80:83], v[176:179]
    ds_read_b64_tr_b16 a[204:205], v203 offset:49152
    v_mfma_f32_16x16x32_bf16 v[180:183], a[220:223], a[84:87], v[180:183]
    ds_read_b64_tr_b16 a[206:207], v203 offset:50176
    v_mfma_f32_16x16x32_bf16 v[184:187], a[220:223], a[88:91], v[184:187]
    buffer_load_dwordx4 a[188:191], v17, s[16:19], s29 offen offset:2304
    v_mfma_f32_16x16x32_bf16 v[188:191], a[220:223], a[92:95], v[188:191]
    s_waitcnt lgkmcnt(6)
    v_mfma_f32_16x16x32_bf16 v[64:67], a[192:195], a[96:99], v[64:67]
    ds_read_b64_tr_b16 a[208:209], v204 offset:49152
    v_mfma_f32_16x16x32_bf16 v[68:71], a[192:195], a[100:103], v[68:71]
    ds_read_b64_tr_b16 a[210:211], v204 offset:50176
    s_add_u32 s28, s28, 131072
    s_add_u32 m0, s30, 0
    v_mfma_f32_16x16x32_bf16 v[72:75], a[192:195], a[104:107], v[72:75]
    buffer_load_dwordx4 v4, s[12:15], s28 offen offset:0 lds
    v_mfma_f32_16x16x32_bf16 v[76:79], a[192:195], a[108:111], v[76:79]
    s_waitcnt lgkmcnt(6)
    v_mfma_f32_16x16x32_bf16 v[80:83], a[196:199], a[96:99], v[80:83]
    ds_read_b64_tr_b16 a[212:213], v205 offset:49152
    v_mfma_f32_16x16x32_bf16 v[84:87], a[196:199], a[100:103], v[84:87]
    ds_read_b64_tr_b16 a[214:215], v205 offset:50176
    s_mov_b32 s29, 24576
    v_mfma_f32_16x16x32_bf16 v[88:91], a[196:199], a[104:107], v[88:91]
    buffer_load_dwordx4 a[0:3], v16, s[16:19], s29 offen offset:0
    v_mfma_f32_16x16x32_bf16 v[92:95], a[196:199], a[108:111], v[92:95]
    s_waitcnt lgkmcnt(6)
    v_mfma_f32_16x16x32_bf16 v[96:99], a[200:203], a[96:99], v[96:99]
    ds_read_b64_tr_b16 a[216:217], v206 offset:49152
    v_mfma_f32_16x16x32_bf16 v[100:103], a[200:203], a[100:103], v[100:103]
    ds_read_b64_tr_b16 a[218:219], v206 offset:50176
    v_mfma_f32_16x16x32_bf16 v[104:107], a[200:203], a[104:107], v[104:107]
    buffer_load_dwordx4 a[4:7], v16, s[16:19], s29 offen offset:256
    v_mfma_f32_16x16x32_bf16 v[108:111], a[200:203], a[108:111], v[108:111]
    s_waitcnt lgkmcnt(6)
    v_mfma_f32_16x16x32_bf16 v[112:115], a[204:207], a[96:99], v[112:115]
    ds_read_b64_tr_b16 a[220:221], v207 offset:49152
    v_mfma_f32_16x16x32_bf16 v[116:119], a[204:207], a[100:103], v[116:119]
    ds_read_b64_tr_b16 a[222:223], v207 offset:50176
    v_mfma_f32_16x16x32_bf16 v[120:123], a[204:207], a[104:107], v[120:123]
    buffer_load_dwordx4 v5, s[12:15], s28 offen offset:1024 lds
    v_mfma_f32_16x16x32_bf16 v[124:127], a[204:207], a[108:111], v[124:127]
    s_waitcnt lgkmcnt(6)
    v_mfma_f32_16x16x32_bf16 v[128:131], a[208:211], a[96:99], v[128:131]
    ds_read_b64_tr_b16 a[192:193], v200 offset:57344
    v_mfma_f32_16x16x32_bf16 v[132:135], a[208:211], a[100:103], v[132:135]
    ds_read_b64_tr_b16 a[194:195], v200 offset:58368
    v_mfma_f32_16x16x32_bf16 v[136:139], a[208:211], a[104:107], v[136:139]
    buffer_load_dwordx4 a[8:11], v17, s[16:19], s29 offen offset:0
    v_mfma_f32_16x16x32_bf16 v[140:143], a[208:211], a[108:111], v[140:143]
    s_waitcnt lgkmcnt(6)
    v_mfma_f32_16x16x32_bf16 v[144:147], a[212:215], a[96:99], v[144:147]
    ds_read_b64_tr_b16 a[196:197], v201 offset:57344
    v_mfma_f32_16x16x32_bf16 v[148:151], a[212:215], a[100:103], v[148:151]
    ds_read_b64_tr_b16 a[198:199], v201 offset:58368
    v_mfma_f32_16x16x32_bf16 v[152:155], a[212:215], a[104:107], v[152:155]
    buffer_load_dwordx4 a[12:15], v17, s[16:19], s29 offen offset:256
    v_mfma_f32_16x16x32_bf16 v[156:159], a[212:215], a[108:111], v[156:159]
    s_waitcnt lgkmcnt(6)
    v_mfma_f32_16x16x32_bf16 v[160:163], a[216:219], a[96:99], v[160:163]
    ds_read_b64_tr_b16 a[200:201], v202 offset:57344
    v_mfma_f32_16x16x32_bf16 v[164:167], a[216:219], a[100:103], v[164:167]
    ds_read_b64_tr_b16 a[202:203], v202 offset:58368
    v_mfma_f32_16x16x32_bf16 v[168:171], a[216:219], a[104:107], v[168:171]
    buffer_load_dwordx4 v6, s[12:15], s28 offen offset:2048 lds
    v_mfma_f32_16x16x32_bf16 v[172:175], a[216:219], a[108:111], v[172:175]
    s_waitcnt lgkmcnt(6)
    v_mfma_f32_16x16x32_bf16 v[176:179], a[220:223], a[96:99], v[176:179]
    ds_read_b64_tr_b16 a[204:205], v203 offset:57344
    v_mfma_f32_16x16x32_bf16 v[180:183], a[220:223], a[100:103], v[180:183]
    ds_read_b64_tr_b16 a[206:207], v203 offset:58368
    v_mfma_f32_16x16x32_bf16 v[184:187], a[220:223], a[104:107], v[184:187]
    buffer_load_dwordx4 a[16:19], v16, s[16:19], s29 offen offset:2048
    v_mfma_f32_16x16x32_bf16 v[188:191], a[220:223], a[108:111], v[188:191]
    s_waitcnt lgkmcnt(6)
    v_mfma_f32_16x16x32_bf16 v[64:67], a[192:195], a[112:115], v[64:67]
    ds_read_b64_tr_b16 a[208:209], v204 offset:57344
    v_mfma_f32_16x16x32_bf16 v[68:71], a[192:195], a[116:119], v[68:71]
    ds_read_b64_tr_b16 a[210:211], v204 offset:58368
    v_mfma_f32_16x16x32_bf16 v[72:75], a[192:195], a[120:123], v[72:75]
    buffer_load_dwordx4 a[20:23], v16, s[16:19], s29 offen offset:2304
    v_mfma_f32_16x16x32_bf16 v[76:79], a[192:195], a[124:127], v[76:79]
    s_waitcnt lgkmcnt(6)
    v_mfma_f32_16x16x32_bf16 v[80:83], a[196:199], a[112:115], v[80:83]
    ds_read_b64_tr_b16 a[212:213], v205 offset:57344
    v_mfma_f32_16x16x32_bf16 v[84:87], a[196:199], a[116:119], v[84:87]
    ds_read_b64_tr_b16 a[214:215], v205 offset:58368
    v_mfma_f32_16x16x32_bf16 v[88:91], a[196:199], a[120:123], v[88:91]
    buffer_load_dwordx4 v7, s[12:15], s28 offen offset:3072 lds
    v_mfma_f32_16x16x32_bf16 v[92:95], a[196:199], a[124:127], v[92:95]
    s_waitcnt lgkmcnt(6)
    v_mfma_f32_16x16x32_bf16 v[96:99], a[200:203], a[112:115], v[96:99]
    ds_read_b64_tr_b16 a[216:217], v206 offset:57344
    v_mfma_f32_16x16x32_bf16 v[100:103], a[200:203], a[116:119], v[100:103]
    ds_read_b64_tr_b16 a[218:219], v206 offset:58368
    v_mfma_f32_16x16x32_bf16 v[104:107], a[200:203], a[120:123], v[104:107]
    buffer_load_dwordx4 a[24:27], v17, s[16:19], s29 offen offset:2048
    v_mfma_f32_16x16x32_bf16 v[108:111], a[200:203], a[124:127], v[108:111]
    s_waitcnt lgkmcnt(6)
    v_mfma_f32_16x16x32_bf16 v[112:115], a[204:207], a[112:115], v[112:115]
    ds_read_b64_tr_b16 a[220:221], v207 offset:57344
    v_mfma_f32_16x16x32_bf16 v[116:119], a[204:207], a[116:119], v[116:119]
    ds_read_b64_tr_b16 a[222:223], v207 offset:58368
    v_mfma_f32_16x16x32_bf16 v[120:123], a[204:207], a[120:123], v[120:123]
    buffer_load_dwordx4 a[28:31], v17, s[16:19], s29 offen offset:2304
    v_mfma_f32_16x16x32_bf16 v[124:127], a[204:207], a[124:127], v[124:127]
    s_waitcnt vmcnt(24) lgkmcnt(0)
    s_barrier
    v_mfma_f32_16x16x32_bf16 v[128:131], a[208:211], a[112:115], v[128:131]
    ds_read_b64_tr_b16 a[192:193], v208 offset:0
    v_mfma_f32_16x16x32_bf16 v[132:135], a[208:211], a[116:119], v[132:135]
    ds_read_b64_tr_b16 a[194:195], v208 offset:1024
    s_add_u32 s28, s28, 131072
    s_add_u32 m0, s30, 16384
    v_mfma_f32_16x16x32_bf16 v[136:139], a[208:211], a[120:123], v[136:139]
    buffer_load_dwordx4 v4, s[12:15], s28 offen offset:0 lds
    v_mfma_f32_16x16x32_bf16 v[140:143], a[208:211], a[124:127], v[140:143]
    s_waitcnt lgkmcnt(6)
    v_mfma_f32_16x16x32_bf16 v[144:147], a[212:215], a[112:115], v[144:147]
    ds_read_b64_tr_b16 a[196:197], v209 offset:0
    v_mfma_f32_16x16x32_bf16 v[148:151], a[212:215], a[116:119], v[148:151]
    ds_read_b64_tr_b16 a[198:199], v209 offset:1024
    s_mov_b32 s29, 28672
    v_mfma_f32_16x16x32_bf16 v[152:155], a[212:215], a[120:123], v[152:155]
    buffer_load_dwordx4 a[32:35], v16, s[16:19], s29 offen offset:0
    v_mfma_f32_16x16x32_bf16 v[156:159], a[212:215], a[124:127], v[156:159]
    s_waitcnt lgkmcnt(6)
    v_mfma_f32_16x16x32_bf16 v[160:163], a[216:219], a[112:115], v[160:163]
    ds_read_b64_tr_b16 a[200:201], v210 offset:0
    v_mfma_f32_16x16x32_bf16 v[164:167], a[216:219], a[116:119], v[164:167]
    ds_read_b64_tr_b16 a[202:203], v210 offset:1024
    v_mfma_f32_16x16x32_bf16 v[168:171], a[216:219], a[120:123], v[168:171]
    buffer_load_dwordx4 a[36:39], v16, s[16:19], s29 offen offset:256
    v_mfma_f32_16x16x32_bf16 v[172:175], a[216:219], a[124:127], v[172:175]
    s_waitcnt lgkmcnt(6)
    v_mfma_f32_16x16x32_bf16 v[176:179], a[220:223], a[112:115], v[176:179]
    ds_read_b64_tr_b16 a[204:205], v211 offset:0
    v_mfma_f32_16x16x32_bf16 v[180:183], a[220:223], a[116:119], v[180:183]
    ds_read_b64_tr_b16 a[206:207], v211 offset:1024
    v_mfma_f32_16x16x32_bf16 v[184:187], a[220:223], a[120:123], v[184:187]
    buffer_load_dwordx4 v5, s[12:15], s28 offen offset:1024 lds
    v_mfma_f32_16x16x32_bf16 v[188:191], a[220:223], a[124:127], v[188:191]
    s_waitcnt lgkmcnt(6)
    v_mfma_f32_16x16x32_bf16 v[64:67], a[192:195], a[128:131], v[64:67]
    ds_read_b64_tr_b16 a[208:209], v212 offset:0
    v_mfma_f32_16x16x32_bf16 v[68:71], a[192:195], a[132:135], v[68:71]
    ds_read_b64_tr_b16 a[210:211], v212 offset:1024
    v_mfma_f32_16x16x32_bf16 v[72:75], a[192:195], a[136:139], v[72:75]
    buffer_load_dwordx4 a[40:43], v17, s[16:19], s29 offen offset:0
    v_mfma_f32_16x16x32_bf16 v[76:79], a[192:195], a[140:143], v[76:79]
    s_waitcnt lgkmcnt(6)
    v_mfma_f32_16x16x32_bf16 v[80:83], a[196:199], a[128:131], v[80:83]
    ds_read_b64_tr_b16 a[212:213], v213 offset:0
    v_mfma_f32_16x16x32_bf16 v[84:87], a[196:199], a[132:135], v[84:87]
    ds_read_b64_tr_b16 a[214:215], v213 offset:1024
    v_mfma_f32_16x16x32_bf16 v[88:91], a[196:199], a[136:139], v[88:91]
    buffer_load_dwordx4 a[44:47], v17, s[16:19], s29 offen offset:256
    v_mfma_f32_16x16x32_bf16 v[92:95], a[196:199], a[140:143], v[92:95]
    s_waitcnt lgkmcnt(6)
    v_mfma_f32_16x16x32_bf16 v[96:99], a[200:203], a[128:131], v[96:99]
    ds_read_b64_tr_b16 a[216:217], v214 offset:0
    v_mfma_f32_16x16x32_bf16 v[100:103], a[200:203], a[132:135], v[100:103]
    ds_read_b64_tr_b16 a[218:219], v214 offset:1024
    v_mfma_f32_16x16x32_bf16 v[104:107], a[200:203], a[136:139], v[104:107]
    buffer_load_dwordx4 v6, s[12:15], s28 offen offset:2048 lds
    v_mfma_f32_16x16x32_bf16 v[108:111], a[200:203], a[140:143], v[108:111]
    s_waitcnt lgkmcnt(6)
    v_mfma_f32_16x16x32_bf16 v[112:115], a[204:207], a[128:131], v[112:115]
    ds_read_b64_tr_b16 a[220:221], v215 offset:0
    v_mfma_f32_16x16x32_bf16 v[116:119], a[204:207], a[132:135], v[116:119]
    ds_read_b64_tr_b16 a[222:223], v215 offset:1024
    v_mfma_f32_16x16x32_bf16 v[120:123], a[204:207], a[136:139], v[120:123]
    buffer_load_dwordx4 a[48:51], v16, s[16:19], s29 offen offset:2048
    v_mfma_f32_16x16x32_bf16 v[124:127], a[204:207], a[140:143], v[124:127]
    s_waitcnt lgkmcnt(6)
    v_mfma_f32_16x16x32_bf16 v[128:131], a[208:211], a[128:131], v[128:131]
    ds_read_b64_tr_b16 a[192:193], v208 offset:8192
    v_mfma_f32_16x16x32_bf16 v[132:135], a[208:211], a[132:135], v[132:135]
    ds_read_b64_tr_b16 a[194:195], v208 offset:9216
    v_mfma_f32_16x16x32_bf16 v[136:139], a[208:211], a[136:139], v[136:139]
    buffer_load_dwordx4 a[52:55], v16, s[16:19], s29 offen offset:2304
    v_mfma_f32_16x16x32_bf16 v[140:143], a[208:211], a[140:143], v[140:143]
    s_waitcnt lgkmcnt(6)
    v_mfma_f32_16x16x32_bf16 v[144:147], a[212:215], a[128:131], v[144:147]
    ds_read_b64_tr_b16 a[196:197], v209 offset:8192
    v_mfma_f32_16x16x32_bf16 v[148:151], a[212:215], a[132:135], v[148:151]
    ds_read_b64_tr_b16 a[198:199], v209 offset:9216
    v_mfma_f32_16x16x32_bf16 v[152:155], a[212:215], a[136:139], v[152:155]
    buffer_load_dwordx4 v7, s[12:15], s28 offen offset:3072 lds
    v_mfma_f32_16x16x32_bf16 v[156:159], a[212:215], a[140:143], v[156:159]
    s_waitcnt lgkmcnt(6)
    v_mfma_f32_16x16x32_bf16 v[160:163], a[216:219], a[128:131], v[160:163]
    ds_read_b64_tr_b16 a[200:201], v210 offset:8192
    v_mfma_f32_16x16x32_bf16 v[164:167], a[216:219], a[132:135], v[164:167]
    ds_read_b64_tr_b16 a[202:203], v210 offset:9216
    v_mfma_f32_16x16x32_bf16 v[168:171], a[216:219], a[136:139], v[168:171]
    buffer_load_dwordx4 a[56:59], v17, s[16:19], s29 offen offset:2048
    v_mfma_f32_16x16x32_bf16 v[172:175], a[216:219], a[140:143], v[172:175]
    s_waitcnt lgkmcnt(6)
    v_mfma_f32_16x16x32_bf16 v[176:179], a[220:223], a[128:131], v[176:179]
    ds_read_b64_tr_b16 a[204:205], v211 offset:8192
    v_mfma_f32_16x16x32_bf16 v[180:183], a[220:223], a[132:135], v[180:183]
    ds_read_b64_tr_b16 a[206:207], v211 offset:9216
    v_mfma_f32_16x16x32_bf16 v[184:187], a[220:223], a[136:139], v[184:187]
    buffer_load_dwordx4 a[60:63], v17, s[16:19], s29 offen offset:2304
    v_mfma_f32_16x16x32_bf16 v[188:191], a[220:223], a[140:143], v[188:191]
    s_waitcnt lgkmcnt(6)
    v_mfma_f32_16x16x32_bf16 v[64:67], a[192:195], a[144:147], v[64:67]
    ds_read_b64_tr_b16 a[208:209], v212 offset:8192
    v_mfma_f32_16x16x32_bf16 v[68:71], a[192:195], a[148:151], v[68:71]
    ds_read_b64_tr_b16 a[210:211], v212 offset:9216
    s_add_u32 s28, s28, 131072
    s_add_u32 m0, s30, 32768
    v_mfma_f32_16x16x32_bf16 v[72:75], a[192:195], a[152:155], v[72:75]
    buffer_load_dwordx4 v4, s[12:15], s28 offen offset:0 lds
    v_mfma_f32_16x16x32_bf16 v[76:79], a[192:195], a[156:159], v[76:79]
    s_waitcnt lgkmcnt(6)
    v_mfma_f32_16x16x32_bf16 v[80:83], a[196:199], a[144:147], v[80:83]
    ds_read_b64_tr_b16 a[212:213], v213 offset:8192
    v_mfma_f32_16x16x32_bf16 v[84:87], a[196:199], a[148:151], v[84:87]
    ds_read_b64_tr_b16 a[214:215], v213 offset:9216
    s_mov_b32 s29, 32768
    v_mfma_f32_16x16x32_bf16 v[88:91], a[196:199], a[152:155], v[88:91]
    buffer_load_dwordx4 a[64:67], v16, s[16:19], s29 offen offset:0
    v_mfma_f32_16x16x32_bf16 v[92:95], a[196:199], a[156:159], v[92:95]
    s_waitcnt lgkmcnt(6)
    v_mfma_f32_16x16x32_bf16 v[96:99], a[200:203], a[144:147], v[96:99]
    ds_read_b64_tr_b16 a[216:217], v214 offset:8192
    v_mfma_f32_16x16x32_bf16 v[100:103], a[200:203], a[148:151], v[100:103]
    ds_read_b64_tr_b16 a[218:219], v214 offset:9216
    v_mfma_f32_16x16x32_bf16 v[104:107], a[200:203], a[152:155], v[104:107]
    buffer_load_dwordx4 a[68:71], v16, s[16:19], s29 offen offset:256
    v_mfma_f32_16x16x32_bf16 v[108:111], a[200:203], a[156:159], v[108:111]
    s_waitcnt lgkmcnt(6)
    v_mfma_f32_16x16x32_bf16 v[112:115], a[204:207], a[144:147], v[112:115]
    ds_read_b64_tr_b16 a[220:221], v215 offset:8192
    v_mfma_f32_16x16x32_bf16 v[116:119], a[204:207], a[148:151], v[116:119]
    ds_read_b64_tr_b16 a[222:223], v215 offset:9216
    v_mfma_f32_16x16x32_bf16 v[120:123], a[204:207], a[152:155], v[120:123]
    buffer_load_dwordx4 v5, s[12:15], s28 offen offset:1024 lds
    v_mfma_f32_16x16x32_bf16 v[124:127], a[204:207], a[156:159], v[124:127]
    s_waitcnt vmcnt(28) lgkmcnt(0)
    s_barrier
    v_mfma_f32_16x16x32_bf16 v[128:131], a[208:211], a[144:147], v[128:131]
    ds_read_b64_tr_b16 a[192:193], v208 offset:16384
    v_mfma_f32_16x16x32_bf16 v[132:135], a[208:211], a[148:151], v[132:135]
    ds_read_b64_tr_b16 a[194:195], v208 offset:17408
    v_mfma_f32_16x16x32_bf16 v[136:139], a[208:211], a[152:155], v[136:139]
    buffer_load_dwordx4 a[72:75], v17, s[16:19], s29 offen offset:0
    v_mfma_f32_16x16x32_bf16 v[140:143], a[208:211], a[156:159], v[140:143]
    s_waitcnt lgkmcnt(6)
    v_mfma_f32_16x16x32_bf16 v[144:147], a[212:215], a[144:147], v[144:147]
    ds_read_b64_tr_b16 a[196:197], v209 offset:16384
    v_mfma_f32_16x16x32_bf16 v[148:151], a[212:215], a[148:151], v[148:151]
    ds_read_b64_tr_b16 a[198:199], v209 offset:17408
    v_mfma_f32_16x16x32_bf16 v[152:155], a[212:215], a[152:155], v[152:155]
    buffer_load_dwordx4 a[76:79], v17, s[16:19], s29 offen offset:256
    v_mfma_f32_16x16x32_bf16 v[156:159], a[212:215], a[156:159], v[156:159]
    s_waitcnt lgkmcnt(6)
    v_mfma_f32_16x16x32_bf16 v[160:163], a[216:219], a[144:147], v[160:163]
    ds_read_b64_tr_b16 a[200:201], v210 offset:16384
    v_mfma_f32_16x16x32_bf16 v[164:167], a[216:219], a[148:151], v[164:167]
    ds_read_b64_tr_b16 a[202:203], v210 offset:17408
    v_mfma_f32_16x16x32_bf16 v[168:171], a[216:219], a[152:155], v[168:171]
    buffer_load_dwordx4 v6, s[12:15], s28 offen offset:2048 lds
    v_mfma_f32_16x16x32_bf16 v[172:175], a[216:219], a[156:159], v[172:175]
    s_waitcnt lgkmcnt(6)
    v_mfma_f32_16x16x32_bf16 v[176:179], a[220:223], a[144:147], v[176:179]
    ds_read_b64_tr_b16 a[204:205], v211 offset:16384
    v_mfma_f32_16x16x32_bf16 v[180:183], a[220:223], a[148:151], v[180:183]
    ds_read_b64_tr_b16 a[206:207], v211 offset:17408
    v_mfma_f32_16x16x32_bf16 v[184:187], a[220:223], a[152:155], v[184:187]
    buffer_load_dwordx4 a[80:83], v16, s[16:19], s29 offen offset:2048
    v_mfma_f32_16x16x32_bf16 v[188:191], a[220:223], a[156:159], v[188:191]
    s_waitcnt lgkmcnt(6)
    v_mfma_f32_16x16x32_bf16 v[64:67], a[192:195], a[160:163], v[64:67]
    ds_read_b64_tr_b16 a[208:209], v212 offset:16384
    v_mfma_f32_16x16x32_bf16 v[68:71], a[192:195], a[164:167], v[68:71]
    ds_read_b64_tr_b16 a[210:211], v212 offset:17408
    v_mfma_f32_16x16x32_bf16 v[72:75], a[192:195], a[168:171], v[72:75]
    buffer_load_dwordx4 a[84:87], v16, s[16:19], s29 offen offset:2304
    v_mfma_f32_16x16x32_bf16 v[76:79], a[192:195], a[172:175], v[76:79]
    s_waitcnt lgkmcnt(6)
    v_mfma_f32_16x16x32_bf16 v[80:83], a[196:199], a[160:163], v[80:83]
    ds_read_b64_tr_b16 a[212:213], v213 offset:16384
    v_mfma_f32_16x16x32_bf16 v[84:87], a[196:199], a[164:167], v[84:87]
    ds_read_b64_tr_b16 a[214:215], v213 offset:17408
    v_mfma_f32_16x16x32_bf16 v[88:91], a[196:199], a[168:171], v[88:91]
    buffer_load_dwordx4 v7, s[12:15], s28 offen offset:3072 lds
    v_mfma_f32_16x16x32_bf16 v[92:95], a[196:199], a[172:175], v[92:95]
    s_waitcnt lgkmcnt(6)
    v_mfma_f32_16x16x32_bf16 v[96:99], a[200:203], a[160:163], v[96:99]
    ds_read_b64_tr_b16 a[216:217], v214 offset:16384
    v_mfma_f32_16x16x32_bf16 v[100:103], a[200:203], a[164:167], v[100:103]
    ds_read_b64_tr_b16 a[218:219], v214 offset:17408
    v_mfma_f32_16x16x32_bf16 v[104:107], a[200:203], a[168:171], v[104:107]
    buffer_load_dwordx4 a[88:91], v17, s[16:19], s29 offen offset:2048
    v_mfma_f32_16x16x32_bf16 v[108:111], a[200:203], a[172:175], v[108:111]
    s_waitcnt lgkmcnt(6)
    v_mfma_f32_16x16x32_bf16 v[112:115], a[204:207], a[160:163], v[112:115]
    ds_read_b64_tr_b16 a[220:221], v215 offset:16384
    v_mfma_f32_16x16x32_bf16 v[116:119], a[204:207], a[164:167], v[116:119]
    ds_read_b64_tr_b16 a[222:223], v215 offset:17408
    v_mfma_f32_16x16x32_bf16 v[120:123], a[204:207], a[168:171], v[120:123]
    buffer_load_dwordx4 a[92:95], v17, s[16:19], s29 offen offset:2304
    v_mfma_f32_16x16x32_bf16 v[124:127], a[204:207], a[172:175], v[124:127]
    s_waitcnt lgkmcnt(6)
    v_mfma_f32_16x16x32_bf16 v[128:131], a[208:211], a[160:163], v[128:131]
    ds_read_b64_tr_b16 a[192:193], v208 offset:24576
    v_mfma_f32_16x16x32_bf16 v[132:135], a[208:211], a[164:167], v[132:135]
    ds_read_b64_tr_b16 a[194:195], v208 offset:25600
    s_add_u32 s28, s28, 131072
    s_add_u32 m0, s30, 49152
    v_mfma_f32_16x16x32_bf16 v[136:139], a[208:211], a[168:171], v[136:139]
    buffer_load_dwordx4 v4, s[12:15], s28 offen offset:0 lds
    v_mfma_f32_16x16x32_bf16 v[140:143], a[208:211], a[172:175], v[140:143]
    s_waitcnt lgkmcnt(6)
    v_mfma_f32_16x16x32_bf16 v[144:147], a[212:215], a[160:163], v[144:147]
    ds_read_b64_tr_b16 a[196:197], v209 offset:24576
    v_mfma_f32_16x16x32_bf16 v[148:151], a[212:215], a[164:167], v[148:151]
    ds_read_b64_tr_b16 a[198:199], v209 offset:25600
    s_mov_b32 s29, 36864
    v_mfma_f32_16x16x32_bf16 v[152:155], a[212:215], a[168:171], v[152:155]
    buffer_load_dwordx4 a[96:99], v16, s[16:19], s29 offen offset:0
    v_mfma_f32_16x16x32_bf16 v[156:159], a[212:215], a[172:175], v[156:159]
    s_waitcnt lgkmcnt(6)
    v_mfma_f32_16x16x32_bf16 v[160:163], a[216:219], a[160:163], v[160:163]
    ds_read_b64_tr_b16 a[200:201], v210 offset:24576
    v_mfma_f32_16x16x32_bf16 v[164:167], a[216:219], a[164:167], v[164:167]
    ds_read_b64_tr_b16 a[202:203], v210 offset:25600
    v_mfma_f32_16x16x32_bf16 v[168:171], a[216:219], a[168:171], v[168:171]
    buffer_load_dwordx4 a[100:103], v16, s[16:19], s29 offen offset:256
    v_mfma_f32_16x16x32_bf16 v[172:175], a[216:219], a[172:175], v[172:175]
    s_waitcnt lgkmcnt(6)
    v_mfma_f32_16x16x32_bf16 v[176:179], a[220:223], a[160:163], v[176:179]
    ds_read_b64_tr_b16 a[204:205], v211 offset:24576
    v_mfma_f32_16x16x32_bf16 v[180:183], a[220:223], a[164:167], v[180:183]
    ds_read_b64_tr_b16 a[206:207], v211 offset:25600
    v_mfma_f32_16x16x32_bf16 v[184:187], a[220:223], a[168:171], v[184:187]
    buffer_load_dwordx4 v5, s[12:15], s28 offen offset:1024 lds
    v_mfma_f32_16x16x32_bf16 v[188:191], a[220:223], a[172:175], v[188:191]
    s_waitcnt lgkmcnt(6)
    v_mfma_f32_16x16x32_bf16 v[64:67], a[192:195], a[176:179], v[64:67]
    ds_read_b64_tr_b16 a[208:209], v212 offset:24576
    v_mfma_f32_16x16x32_bf16 v[68:71], a[192:195], a[180:183], v[68:71]
    ds_read_b64_tr_b16 a[210:211], v212 offset:25600
    v_mfma_f32_16x16x32_bf16 v[72:75], a[192:195], a[184:187], v[72:75]
    buffer_load_dwordx4 a[104:107], v17, s[16:19], s29 offen offset:0
    v_mfma_f32_16x16x32_bf16 v[76:79], a[192:195], a[188:191], v[76:79]
    s_waitcnt lgkmcnt(6)
    v_mfma_f32_16x16x32_bf16 v[80:83], a[196:199], a[176:179], v[80:83]
    ds_read_b64_tr_b16 a[212:213], v213 offset:24576
    v_mfma_f32_16x16x32_bf16 v[84:87], a[196:199], a[180:183], v[84:87]
    ds_read_b64_tr_b16 a[214:215], v213 offset:25600
    v_mfma_f32_16x16x32_bf16 v[88:91], a[196:199], a[184:187], v[88:91]
    buffer_load_dwordx4 a[108:111], v17, s[16:19], s29 offen offset:256
    v_mfma_f32_16x16x32_bf16 v[92:95], a[196:199], a[188:191], v[92:95]
    s_waitcnt lgkmcnt(6)
    v_mfma_f32_16x16x32_bf16 v[96:99], a[200:203], a[176:179], v[96:99]
    ds_read_b64_tr_b16 a[216:217], v214 offset:24576
    v_mfma_f32_16x16x32_bf16 v[100:103], a[200:203], a[180:183], v[100:103]
    ds_read_b64_tr_b16 a[218:219], v214 offset:25600
    v_mfma_f32_16x16x32_bf16 v[104:107], a[200:203], a[184:187], v[104:107]
    buffer_load_dwordx4 v6, s[12:15], s28 offen offset:2048 lds
    v_mfma_f32_16x16x32_bf16 v[108:111], a[200:203], a[188:191], v[108:111]
    s_waitcnt lgkmcnt(6)
    v_mfma_f32_16x16x32_bf16 v[112:115], a[204:207], a[176:179], v[112:115]
    ds_read_b64_tr_b16 a[220:221], v215 offset:24576
    v_mfma_f32_16x16x32_bf16 v[116:119], a[204:207], a[180:183], v[116:119]
    ds_read_b64_tr_b16 a[222:223], v215 offset:25600
    v_mfma_f32_16x16x32_bf16 v[120:123], a[204:207], a[184:187], v[120:123]
    buffer_load_dwordx4 a[112:115], v16, s[16:19], s29 offen offset:2048
    v_mfma_f32_16x16x32_bf16 v[124:127], a[204:207], a[188:191], v[124:127]
    s_waitcnt vmcnt(32) lgkmcnt(0)
    s_barrier
    v_mfma_f32_16x16x32_bf16 v[128:131], a[208:211], a[176:179], v[128:131]
    ds_read_b64_tr_b16 a[192:193], v200 offset:0
    v_mfma_f32_16x16x32_bf16 v[132:135], a[208:211], a[180:183], v[132:135]
    ds_read_b64_tr_b16 a[194:195], v200 offset:1024
    v_mfma_f32_16x16x32_bf16 v[136:139], a[208:211], a[184:187], v[136:139]
    buffer_load_dwordx4 a[116:119], v16, s[16:19], s29 offen offset:2304
    v_mfma_f32_16x16x32_bf16 v[140:143], a[208:211], a[188:191], v[140:143]
    s_waitcnt lgkmcnt(6)
    v_mfma_f32_16x16x32_bf16 v[144:147], a[212:215], a[176:179], v[144:147]
    ds_read_b64_tr_b16 a[196:197], v201 offset:0
    v_mfma_f32_16x16x32_bf16 v[148:151], a[212:215], a[180:183], v[148:151]
    ds_read_b64_tr_b16 a[198:199], v201 offset:1024
    v_mfma_f32_16x16x32_bf16 v[152:155], a[212:215], a[184:187], v[152:155]
    buffer_load_dwordx4 v7, s[12:15], s28 offen offset:3072 lds
    v_mfma_f32_16x16x32_bf16 v[156:159], a[212:215], a[188:191], v[156:159]
    s_waitcnt lgkmcnt(6)
    v_mfma_f32_16x16x32_bf16 v[160:163], a[216:219], a[176:179], v[160:163]
    ds_read_b64_tr_b16 a[200:201], v202 offset:0
    v_mfma_f32_16x16x32_bf16 v[164:167], a[216:219], a[180:183], v[164:167]
    ds_read_b64_tr_b16 a[202:203], v202 offset:1024
    v_mfma_f32_16x16x32_bf16 v[168:171], a[216:219], a[184:187], v[168:171]
    buffer_load_dwordx4 a[120:123], v17, s[16:19], s29 offen offset:2048
    v_mfma_f32_16x16x32_bf16 v[172:175], a[216:219], a[188:191], v[172:175]
    s_waitcnt lgkmcnt(6)
    v_mfma_f32_16x16x32_bf16 v[176:179], a[220:223], a[176:179], v[176:179]
    ds_read_b64_tr_b16 a[204:205], v203 offset:0
    v_mfma_f32_16x16x32_bf16 v[180:183], a[220:223], a[180:183], v[180:183]
    ds_read_b64_tr_b16 a[206:207], v203 offset:1024
    v_mfma_f32_16x16x32_bf16 v[184:187], a[220:223], a[184:187], v[184:187]
    buffer_load_dwordx4 a[124:127], v17, s[16:19], s29 offen offset:2304
    v_mfma_f32_16x16x32_bf16 v[188:191], a[220:223], a[188:191], v[188:191]
    s_waitcnt lgkmcnt(6)
    v_mfma_f32_16x16x32_bf16 v[64:67], a[192:195], a[0:3], v[64:67]
    ds_read_b64_tr_b16 a[208:209], v204 offset:0
    v_mfma_f32_16x16x32_bf16 v[68:71], a[192:195], a[4:7], v[68:71]
    ds_read_b64_tr_b16 a[210:211], v204 offset:1024
    s_add_u32 s28, s28, 131072
    s_add_u32 m0, s30, 65536
    v_mfma_f32_16x16x32_bf16 v[72:75], a[192:195], a[8:11], v[72:75]
    buffer_load_dwordx4 v4, s[12:15], s28 offen offset:0 lds
    v_mfma_f32_16x16x32_bf16 v[76:79], a[192:195], a[12:15], v[76:79]
    s_waitcnt lgkmcnt(6)
    v_mfma_f32_16x16x32_bf16 v[80:83], a[196:199], a[0:3], v[80:83]
    ds_read_b64_tr_b16 a[212:213], v205 offset:0
    v_mfma_f32_16x16x32_bf16 v[84:87], a[196:199], a[4:7], v[84:87]
    ds_read_b64_tr_b16 a[214:215], v205 offset:1024
    s_mov_b32 s29, 40960
    v_mfma_f32_16x16x32_bf16 v[88:91], a[196:199], a[8:11], v[88:91]
    buffer_load_dwordx4 a[128:131], v16, s[16:19], s29 offen offset:0
    v_mfma_f32_16x16x32_bf16 v[92:95], a[196:199], a[12:15], v[92:95]
    s_waitcnt lgkmcnt(6)
    v_mfma_f32_16x16x32_bf16 v[96:99], a[200:203], a[0:3], v[96:99]
    ds_read_b64_tr_b16 a[216:217], v206 offset:0
    v_mfma_f32_16x16x32_bf16 v[100:103], a[200:203], a[4:7], v[100:103]
    ds_read_b64_tr_b16 a[218:219], v206 offset:1024
    v_mfma_f32_16x16x32_bf16 v[104:107], a[200:203], a[8:11], v[104:107]
    buffer_load_dwordx4 a[132:135], v16, s[16:19], s29 offen offset:256
    v_mfma_f32_16x16x32_bf16 v[108:111], a[200:203], a[12:15], v[108:111]
    s_waitcnt lgkmcnt(6)
    v_mfma_f32_16x16x32_bf16 v[112:115], a[204:207], a[0:3], v[112:115]
    ds_read_b64_tr_b16 a[220:221], v207 offset:0
    v_mfma_f32_16x16x32_bf16 v[116:119], a[204:207], a[4:7], v[116:119]
    ds_read_b64_tr_b16 a[222:223], v207 offset:1024
    v_mfma_f32_16x16x32_bf16 v[120:123], a[204:207], a[8:11], v[120:123]
    buffer_load_dwordx4 v5, s[12:15], s28 offen offset:1024 lds
    v_mfma_f32_16x16x32_bf16 v[124:127], a[204:207], a[12:15], v[124:127]
    s_waitcnt lgkmcnt(6)
    v_mfma_f32_16x16x32_bf16 v[128:131], a[208:211], a[0:3], v[128:131]
    ds_read_b64_tr_b16 a[192:193], v200 offset:8192
    v_mfma_f32_16x16x32_bf16 v[132:135], a[208:211], a[4:7], v[132:135]
    ds_read_b64_tr_b16 a[194:195], v200 offset:9216
    v_mfma_f32_16x16x32_bf16 v[136:139], a[208:211], a[8:11], v[136:139]
    buffer_load_dwordx4 a[136:139], v17, s[16:19], s29 offen offset:0
    v_mfma_f32_16x16x32_bf16 v[140:143], a[208:211], a[12:15], v[140:143]
    s_waitcnt lgkmcnt(6)
    v_mfma_f32_16x16x32_bf16 v[144:147], a[212:215], a[0:3], v[144:147]
    ds_read_b64_tr_b16 a[196:197], v201 offset:8192
    v_mfma_f32_16x16x32_bf16 v[148:151], a[212:215], a[4:7], v[148:151]
    ds_read_b64_tr_b16 a[198:199], v201 offset:9216
    v_mfma_f32_16x16x32_bf16 v[152:155], a[212:215], a[8:11], v[152:155]
    buffer_load_dwordx4 a[140:143], v17, s[16:19], s29 offen offset:256
    v_mfma_f32_16x16x32_bf16 v[156:159], a[212:215], a[12:15], v[156:159]
    s_waitcnt lgkmcnt(6)
    v_mfma_f32_16x16x32_bf16 v[160:163], a[216:219], a[0:3], v[160:163]
    ds_read_b64_tr_b16 a[200:201], v202 offset:8192
    v_mfma_f32_16x16x32_bf16 v[164:167], a[216:219], a[4:7], v[164:167]
    ds_read_b64_tr_b16 a[202:203], v202 offset:9216
    v_mfma_f32_16x16x32_bf16 v[168:171], a[216:219], a[8:11], v[168:171]
    buffer_load_dwordx4 v6, s[12:15], s28 offen offset:2048 lds
    v_mfma_f32_16x16x32_bf16 v[172:175], a[216:219], a[12:15], v[172:175]
    s_waitcnt lgkmcnt(6)
    v_mfma_f32_16x16x32_bf16 v[176:179], a[220:223], a[0:3], v[176:179]
    ds_read_b64_tr_b16 a[204:205], v203 offset:8192
    v_mfma_f32_16x16x32_bf16 v[180:183], a[220:223], a[4:7], v[180:183]
    ds_read_b64_tr_b16 a[206:207], v203 offset:9216
    v_mfma_f32_16x16x32_bf16 v[184:187], a[220:223], a[8:11], v[184:187]
    buffer_load_dwordx4 a[144:147], v16, s[16:19], s29 offen offset:2048
    v_mfma_f32_16x16x32_bf16 v[188:191], a[220:223], a[12:15], v[188:191]
    s_waitcnt lgkmcnt(6)
    v_mfma_f32_16x16x32_bf16 v[64:67], a[192:195], a[16:19], v[64:67]
    ds_read_b64_tr_b16 a[208:209], v204 offset:8192
    v_mfma_f32_16x16x32_bf16 v[68:71], a[192:195], a[20:23], v[68:71]
    ds_read_b64_tr_b16 a[210:211], v204 offset:9216
    v_mfma_f32_16x16x32_bf16 v[72:75], a[192:195], a[24:27], v[72:75]
    buffer_load_dwordx4 a[148:151], v16, s[16:19], s29 offen offset:2304
    v_mfma_f32_16x16x32_bf16 v[76:79], a[192:195], a[28:31], v[76:79]
    s_waitcnt lgkmcnt(6)
    v_mfma_f32_16x16x32_bf16 v[80:83], a[196:199], a[16:19], v[80:83]
    ds_read_b64_tr_b16 a[212:213], v205 offset:8192
    v_mfma_f32_16x16x32_bf16 v[84:87], a[196:199], a[20:23], v[84:87]
    ds_read_b64_tr_b16 a[214:215], v205 offset:9216
    v_mfma_f32_16x16x32_bf16 v[88:91], a[196:199], a[24:27], v[88:91]
    buffer_load_dwordx4 v7, s[12:15], s28 offen offset:3072 lds
    v_mfma_f32_16x16x32_bf16 v[92:95], a[196:199], a[28:31], v[92:95]
    s_waitcnt lgkmcnt(6)
    v_mfma_f32_16x16x32_bf16 v[96:99], a[200:203], a[16:19], v[96:99]
    ds_read_b64_tr_b16 a[216:217], v206 offset:8192
    v_mfma_f32_16x16x32_bf16 v[100:103], a[200:203], a[20:23], v[100:103]
    ds_read_b64_tr_b16 a[218:219], v206 offset:9216
    v_mfma_f32_16x16x32_bf16 v[104:107], a[200:203], a[24:27], v[104:107]
    buffer_load_dwordx4 a[152:155], v17, s[16:19], s29 offen offset:2048
    v_mfma_f32_16x16x32_bf16 v[108:111], a[200:203], a[28:31], v[108:111]
    s_waitcnt lgkmcnt(6)
    v_mfma_f32_16x16x32_bf16 v[112:115], a[204:207], a[16:19], v[112:115]
    ds_read_b64_tr_b16 a[220:221], v207 offset:8192
    v_mfma_f32_16x16x32_bf16 v[116:119], a[204:207], a[20:23], v[116:119]
    ds_read_b64_tr_b16 a[222:223], v207 offset:9216
    v_mfma_f32_16x16x32_bf16 v[120:123], a[204:207], a[24:27], v[120:123]
    buffer_load_dwordx4 a[156:159], v17, s[16:19], s29 offen offset:2304
    v_mfma_f32_16x16x32_bf16 v[124:127], a[204:207], a[28:31], v[124:127]
    s_waitcnt vmcnt(36) lgkmcnt(0)
    s_barrier
    v_mfma_f32_16x16x32_bf16 v[128:131], a[208:211], a[16:19], v[128:131]
    ds_read_b64_tr_b16 a[192:193], v200 offset:16384
    v_mfma_f32_16x16x32_bf16 v[132:135], a[208:211], a[20:23], v[132:135]
    ds_read_b64_tr_b16 a[194:195], v200 offset:17408
    s_add_u32 s28, s28, 131072
    s_add_u32 m0, s30, 81920
    v_mfma_f32_16x16x32_bf16 v[136:139], a[208:211], a[24:27], v[136:139]
    buffer_load_dwordx4 v4, s[12:15], s28 offen offset:0 lds
    v_mfma_f32_16x16x32_bf16 v[140:143], a[208:211], a[28:31], v[140:143]
    s_waitcnt lgkmcnt(6)
    v_mfma_f32_16x16x32_bf16 v[144:147], a[212:215], a[16:19], v[144:147]
    ds_read_b64_tr_b16 a[196:197], v201 offset:16384
    v_mfma_f32_16x16x32_bf16 v[148:151], a[212:215], a[20:23], v[148:151]
    ds_read_b64_tr_b16 a[198:199], v201 offset:17408
    s_mov_b32 s29, 45056
    v_mfma_f32_16x16x32_bf16 v[152:155], a[212:215], a[24:27], v[152:155]
    buffer_load_dwordx4 a[160:163], v16, s[16:19], s29 offen offset:0
    v_mfma_f32_16x16x32_bf16 v[156:159], a[212:215], a[28:31], v[156:159]
    s_waitcnt lgkmcnt(6)
    v_mfma_f32_16x16x32_bf16 v[160:163], a[216:219], a[16:19], v[160:163]
    ds_read_b64_tr_b16 a[200:201], v202 offset:16384
    v_mfma_f32_16x16x32_bf16 v[164:167], a[216:219], a[20:23], v[164:167]
    ds_read_b64_tr_b16 a[202:203], v202 offset:17408
    v_mfma_f32_16x16x32_bf16 v[168:171], a[216:219], a[24:27], v[168:171]
    buffer_load_dwordx4 a[164:167], v16, s[16:19], s29 offen offset:256
    v_mfma_f32_16x16x32_bf16 v[172:175], a[216:219], a[28:31], v[172:175]
    s_waitcnt lgkmcnt(6)
    v_mfma_f32_16x16x32_bf16 v[176:179], a[220:223], a[16:19], v[176:179]
    ds_read_b64_tr_b16 a[204:205], v203 offset:16384
    v_mfma_f32_16x16x32_bf16 v[180:183], a[220:223], a[20:23], v[180:183]
    ds_read_b64_tr_b16 a[206:207], v203 offset:17408
    v_mfma_f32_16x16x32_bf16 v[184:187], a[220:223], a[24:27], v[184:187]
    buffer_load_dwordx4 v5, s[12:15], s28 offen offset:1024 lds
    v_mfma_f32_16x16x32_bf16 v[188:191], a[220:223], a[28:31], v[188:191]
    s_waitcnt lgkmcnt(6)
    v_mfma_f32_16x16x32_bf16 v[64:67], a[192:195], a[32:35], v[64:67]
    ds_read_b64_tr_b16 a[208:209], v204 offset:16384
    v_mfma_f32_16x16x32_bf16 v[68:71], a[192:195], a[36:39], v[68:71]
    ds_read_b64_tr_b16 a[210:211], v204 offset:17408
    v_mfma_f32_16x16x32_bf16 v[72:75], a[192:195], a[40:43], v[72:75]
    buffer_load_dwordx4 a[168:171], v17, s[16:19], s29 offen offset:0
    v_mfma_f32_16x16x32_bf16 v[76:79], a[192:195], a[44:47], v[76:79]
    s_waitcnt lgkmcnt(6)
    v_mfma_f32_16x16x32_bf16 v[80:83], a[196:199], a[32:35], v[80:83]
    ds_read_b64_tr_b16 a[212:213], v205 offset:16384
    v_mfma_f32_16x16x32_bf16 v[84:87], a[196:199], a[36:39], v[84:87]
    ds_read_b64_tr_b16 a[214:215], v205 offset:17408
    v_mfma_f32_16x16x32_bf16 v[88:91], a[196:199], a[40:43], v[88:91]
    buffer_load_dwordx4 a[172:175], v17, s[16:19], s29 offen offset:256
    v_mfma_f32_16x16x32_bf16 v[92:95], a[196:199], a[44:47], v[92:95]
    s_waitcnt lgkmcnt(6)
    v_mfma_f32_16x16x32_bf16 v[96:99], a[200:203], a[32:35], v[96:99]
    ds_read_b64_tr_b16 a[216:217], v206 offset:16384
    v_mfma_f32_16x16x32_bf16 v[100:103], a[200:203], a[36:39], v[100:103]
    ds_read_b64_tr_b16 a[218:219], v206 offset:17408
    v_mfma_f32_16x16x32_bf16 v[104:107], a[200:203], a[40:43], v[104:107]
    buffer_load_dwordx4 v6, s[12:15], s28 offen offset:2048 lds
    v_mfma_f32_16x16x32_bf16 v[108:111], a[200:203], a[44:47], v[108:111]
    s_waitcnt lgkmcnt(6)
    v_mfma_f32_16x16x32_bf16 v[112:115], a[204:207], a[32:35], v[112:115]
    ds_read_b64_tr_b16 a[220:221], v207 offset:16384
    v_mfma_f32_16x16x32_bf16 v[116:119], a[204:207], a[36:39], v[116:119]
    ds_read_b64_tr_b16 a[222:223], v207 offset:17408
    v_mfma_f32_16x16x32_bf16 v[120:123], a[204:207], a[40:43], v[120:123]
    buffer_load_dwordx4 a[176:179], v16, s[16:19], s29 offen offset:2048
    v_mfma_f32_16x16x32_bf16 v[124:127], a[204:207], a[44:47], v[124:127]
    s_waitcnt lgkmcnt(6)
    v_mfma_f32_16x16x32_bf16 v[128:131], a[208:211], a[32:35], v[128:131]
    ds_read_b64_tr_b16 a[192:193], v200 offset:24576
    v_mfma_f32_16x16x32_bf16 v[132:135], a[208:211], a[36:39], v[132:135]
    ds_read_b64_tr_b16 a[194:195], v200 offset:25600
    v_mfma_f32_16x16x32_bf16 v[136:139], a[208:211], a[40:43], v[136:139]
    buffer_load_dwordx4 a[180:183], v16, s[16:19], s29 offen offset:2304
    v_mfma_f32_16x16x32_bf16 v[140:143], a[208:211], a[44:47], v[140:143]
    s_waitcnt lgkmcnt(6)
    v_mfma_f32_16x16x32_bf16 v[144:147], a[212:215], a[32:35], v[144:147]
    ds_read_b64_tr_b16 a[196:197], v201 offset:24576
    v_mfma_f32_16x16x32_bf16 v[148:151], a[212:215], a[36:39], v[148:151]
    ds_read_b64_tr_b16 a[198:199], v201 offset:25600
    v_mfma_f32_16x16x32_bf16 v[152:155], a[212:215], a[40:43], v[152:155]
    buffer_load_dwordx4 v7, s[12:15], s28 offen offset:3072 lds
    v_mfma_f32_16x16x32_bf16 v[156:159], a[212:215], a[44:47], v[156:159]
    s_waitcnt lgkmcnt(6)
    v_mfma_f32_16x16x32_bf16 v[160:163], a[216:219], a[32:35], v[160:163]
    ds_read_b64_tr_b16 a[200:201], v202 offset:24576
    v_mfma_f32_16x16x32_bf16 v[164:167], a[216:219], a[36:39], v[164:167]
    ds_read_b64_tr_b16 a[202:203], v202 offset:25600
    v_mfma_f32_16x16x32_bf16 v[168:171], a[216:219], a[40:43], v[168:171]
    buffer_load_dwordx4 a[184:187], v17, s[16:19], s29 offen offset:2048
    v_mfma_f32_16x16x32_bf16 v[172:175], a[216:219], a[44:47], v[172:175]
    s_waitcnt lgkmcnt(6)
    v_mfma_f32_16x16x32_bf16 v[176:179], a[220:223], a[32:35], v[176:179]
    ds_read_b64_tr_b16 a[204:205], v203 offset:24576
    v_mfma_f32_16x16x32_bf16 v[180:183], a[220:223], a[36:39], v[180:183]
    ds_read_b64_tr_b16 a[206:207], v203 offset:25600
    v_mfma_f32_16x16x32_bf16 v[184:187], a[220:223], a[40:43], v[184:187]
    buffer_load_dwordx4 a[188:191], v17, s[16:19], s29 offen offset:2304
    v_mfma_f32_16x16x32_bf16 v[188:191], a[220:223], a[44:47], v[188:191]
    s_waitcnt lgkmcnt(6)
    v_mfma_f32_16x16x32_bf16 v[64:67], a[192:195], a[48:51], v[64:67]
    ds_read_b64_tr_b16 a[208:209], v204 offset:24576
    v_mfma_f32_16x16x32_bf16 v[68:71], a[192:195], a[52:55], v[68:71]
    ds_read_b64_tr_b16 a[210:211], v204 offset:25600
    s_add_u32 s28, s28, 131072
    s_add_u32 m0, s30, 0
    v_mfma_f32_16x16x32_bf16 v[72:75], a[192:195], a[56:59], v[72:75]
    buffer_load_dwordx4 v4, s[12:15], s28 offen offset:0 lds
    v_mfma_f32_16x16x32_bf16 v[76:79], a[192:195], a[60:63], v[76:79]
    s_waitcnt lgkmcnt(6)
    v_mfma_f32_16x16x32_bf16 v[80:83], a[196:199], a[48:51], v[80:83]
    ds_read_b64_tr_b16 a[212:213], v205 offset:24576
    v_mfma_f32_16x16x32_bf16 v[84:87], a[196:199], a[52:55], v[84:87]
    ds_read_b64_tr_b16 a[214:215], v205 offset:25600
    s_mov_b32 s29, 49152
    v_mfma_f32_16x16x32_bf16 v[88:91], a[196:199], a[56:59], v[88:91]
    buffer_load_dwordx4 a[0:3], v16, s[16:19], s29 offen offset:0
    v_mfma_f32_16x16x32_bf16 v[92:95], a[196:199], a[60:63], v[92:95]
    s_waitcnt lgkmcnt(6)
    v_mfma_f32_16x16x32_bf16 v[96:99], a[200:203], a[48:51], v[96:99]
    ds_read_b64_tr_b16 a[216:217], v206 offset:24576
    v_mfma_f32_16x16x32_bf16 v[100:103], a[200:203], a[52:55], v[100:103]
    ds_read_b64_tr_b16 a[218:219], v206 offset:25600
    v_mfma_f32_16x16x32_bf16 v[104:107], a[200:203], a[56:59], v[104:107]
    buffer_load_dwordx4 a[4:7], v16, s[16:19], s29 offen offset:256
    v_mfma_f32_16x16x32_bf16 v[108:111], a[200:203], a[60:63], v[108:111]
    s_waitcnt lgkmcnt(6)
    v_mfma_f32_16x16x32_bf16 v[112:115], a[204:207], a[48:51], v[112:115]
    ds_read_b64_tr_b16 a[220:221], v207 offset:24576
    v_mfma_f32_16x16x32_bf16 v[116:119], a[204:207], a[52:55], v[116:119]
    ds_read_b64_tr_b16 a[222:223], v207 offset:25600
    v_mfma_f32_16x16x32_bf16 v[120:123], a[204:207], a[56:59], v[120:123]
    buffer_load_dwordx4 v5, s[12:15], s28 offen offset:1024 lds
    v_mfma_f32_16x16x32_bf16 v[124:127], a[204:207], a[60:63], v[124:127]
    s_waitcnt vmcnt(40) lgkmcnt(0)
    s_barrier
    v_mfma_f32_16x16x32_bf16 v[128:131], a[208:211], a[48:51], v[128:131]
    ds_read_b64_tr_b16 a[192:193], v200 offset:32768
    v_mfma_f32_16x16x32_bf16 v[132:135], a[208:211], a[52:55], v[132:135]
    ds_read_b64_tr_b16 a[194:195], v200 offset:33792
    v_mfma_f32_16x16x32_bf16 v[136:139], a[208:211], a[56:59], v[136:139]
    buffer_load_dwordx4 a[8:11], v17, s[16:19], s29 offen offset:0
    v_mfma_f32_16x16x32_bf16 v[140:143], a[208:211], a[60:63], v[140:143]
    s_waitcnt lgkmcnt(6)
    v_mfma_f32_16x16x32_bf16 v[144:147], a[212:215], a[48:51], v[144:147]
    ds_read_b64_tr_b16 a[196:197], v201 offset:32768
    v_mfma_f32_16x16x32_bf16 v[148:151], a[212:215], a[52:55], v[148:151]
    ds_read_b64_tr_b16 a[198:199], v201 offset:33792
    v_mfma_f32_16x16x32_bf16 v[152:155], a[212:215], a[56:59], v[152:155]
    buffer_load_dwordx4 a[12:15], v17, s[16:19], s29 offen offset:256
    v_mfma_f32_16x16x32_bf16 v[156:159], a[212:215], a[60:63], v[156:159]
    s_waitcnt lgkmcnt(6)
    v_mfma_f32_16x16x32_bf16 v[160:163], a[216:219], a[48:51], v[160:163]
    ds_read_b64_tr_b16 a[200:201], v202 offset:32768
    v_mfma_f32_16x16x32_bf16 v[164:167], a[216:219], a[52:55], v[164:167]
    ds_read_b64_tr_b16 a[202:203], v202 offset:33792
    v_mfma_f32_16x16x32_bf16 v[168:171], a[216:219], a[56:59], v[168:171]
    buffer_load_dwordx4 v6, s[12:15], s28 offen offset:2048 lds
    v_mfma_f32_16x16x32_bf16 v[172:175], a[216:219], a[60:63], v[172:175]
    s_waitcnt lgkmcnt(6)
    v_mfma_f32_16x16x32_bf16 v[176:179], a[220:223], a[48:51], v[176:179]
    ds_read_b64_tr_b16 a[204:205], v203 offset:32768
    v_mfma_f32_16x16x32_bf16 v[180:183], a[220:223], a[52:55], v[180:183]
    ds_read_b64_tr_b16 a[206:207], v203 offset:33792
    v_mfma_f32_16x16x32_bf16 v[184:187], a[220:223], a[56:59], v[184:187]
    buffer_load_dwordx4 a[16:19], v16, s[16:19], s29 offen offset:2048
    v_mfma_f32_16x16x32_bf16 v[188:191], a[220:223], a[60:63], v[188:191]
    s_waitcnt lgkmcnt(6)
    v_mfma_f32_16x16x32_bf16 v[64:67], a[192:195], a[64:67], v[64:67]
    ds_read_b64_tr_b16 a[208:209], v204 offset:32768
    v_mfma_f32_16x16x32_bf16 v[68:71], a[192:195], a[68:71], v[68:71]
    ds_read_b64_tr_b16 a[210:211], v204 offset:33792
    v_mfma_f32_16x16x32_bf16 v[72:75], a[192:195], a[72:75], v[72:75]
    buffer_load_dwordx4 a[20:23], v16, s[16:19], s29 offen offset:2304
    v_mfma_f32_16x16x32_bf16 v[76:79], a[192:195], a[76:79], v[76:79]
    s_waitcnt lgkmcnt(6)
    v_mfma_f32_16x16x32_bf16 v[80:83], a[196:199], a[64:67], v[80:83]
    ds_read_b64_tr_b16 a[212:213], v205 offset:32768
    v_mfma_f32_16x16x32_bf16 v[84:87], a[196:199], a[68:71], v[84:87]
    ds_read_b64_tr_b16 a[214:215], v205 offset:33792
    v_mfma_f32_16x16x32_bf16 v[88:91], a[196:199], a[72:75], v[88:91]
    buffer_load_dwordx4 v7, s[12:15], s28 offen offset:3072 lds
    v_mfma_f32_16x16x32_bf16 v[92:95], a[196:199], a[76:79], v[92:95]
    s_waitcnt lgkmcnt(6)
    v_mfma_f32_16x16x32_bf16 v[96:99], a[200:203], a[64:67], v[96:99]
    ds_read_b64_tr_b16 a[216:217], v206 offset:32768
    v_mfma_f32_16x16x32_bf16 v[100:103], a[200:203], a[68:71], v[100:103]
    ds_read_b64_tr_b16 a[218:219], v206 offset:33792
    v_mfma_f32_16x16x32_bf16 v[104:107], a[200:203], a[72:75], v[104:107]
    buffer_load_dwordx4 a[24:27], v17, s[16:19], s29 offen offset:2048
    v_mfma_f32_16x16x32_bf16 v[108:111], a[200:203], a[76:79], v[108:111]
    s_waitcnt lgkmcnt(6)
    v_mfma_f32_16x16x32_bf16 v[112:115], a[204:207], a[64:67], v[112:115]
    ds_read_b64_tr_b16 a[220:221], v207 offset:32768
    v_mfma_f32_16x16x32_bf16 v[116:119], a[204:207], a[68:71], v[116:119]
    ds_read_b64_tr_b16 a[222:223], v207 offset:33792
    v_mfma_f32_16x16x32_bf16 v[120:123], a[204:207], a[72:75], v[120:123]
    buffer_load_dwordx4 a[28:31], v17, s[16:19], s29 offen offset:2304
    v_mfma_f32_16x16x32_bf16 v[124:127], a[204:207], a[76:79], v[124:127]
    s_waitcnt lgkmcnt(6)
    v_mfma_f32_16x16x32_bf16 v[128:131], a[208:211], a[64:67], v[128:131]
    ds_read_b64_tr_b16 a[192:193], v200 offset:40960
    v_mfma_f32_16x16x32_bf16 v[132:135], a[208:211], a[68:71], v[132:135]
    ds_read_b64_tr_b16 a[194:195], v200 offset:41984
    s_add_u32 s28, s28, 131072
    s_add_u32 m0, s30, 16384
    v_mfma_f32_16x16x32_bf16 v[136:139], a[208:211], a[72:75], v[136:139]
    buffer_load_dwordx4 v4, s[12:15], s28 offen offset:0 lds
    v_mfma_f32_16x16x32_bf16 v[140:143], a[208:211], a[76:79], v[140:143]
    s_waitcnt lgkmcnt(6)
    v_mfma_f32_16x16x32_bf16 v[144:147], a[212:215], a[64:67], v[144:147]
    ds_read_b64_tr_b16 a[196:197], v201 offset:40960
    v_mfma_f32_16x16x32_bf16 v[148:151], a[212:215], a[68:71], v[148:151]
    ds_read_b64_tr_b16 a[198:199], v201 offset:41984
    s_mov_b32 s29, 53248
    v_mfma_f32_16x16x32_bf16 v[152:155], a[212:215], a[72:75], v[152:155]
    buffer_load_dwordx4 a[32:35], v16, s[16:19], s29 offen offset:0
    v_mfma_f32_16x16x32_bf16 v[156:159], a[212:215], a[76:79], v[156:159]
    s_waitcnt lgkmcnt(6)
    v_mfma_f32_16x16x32_bf16 v[160:163], a[216:219], a[64:67], v[160:163]
    ds_read_b64_tr_b16 a[200:201], v202 offset:40960
    v_mfma_f32_16x16x32_bf16 v[164:167], a[216:219], a[68:71], v[164:167]
    ds_read_b64_tr_b16 a[202:203], v202 offset:41984
    v_mfma_f32_16x16x32_bf16 v[168:171], a[216:219], a[72:75], v[168:171]
    buffer_load_dwordx4 a[36:39], v16, s[16:19], s29 offen offset:256
    v_mfma_f32_16x16x32_bf16 v[172:175], a[216:219], a[76:79], v[172:175]
    s_waitcnt lgkmcnt(6)
    v_mfma_f32_16x16x32_bf16 v[176:179], a[220:223], a[64:67], v[176:179]
    ds_read_b64_tr_b16 a[204:205], v203 offset:40960
    v_mfma_f32_16x16x32_bf16 v[180:183], a[220:223], a[68:71], v[180:183]
    ds_read_b64_tr_b16 a[206:207], v203 offset:41984
    v_mfma_f32_16x16x32_bf16 v[184:187], a[220:223], a[72:75], v[184:187]
    buffer_load_dwordx4 v5, s[12:15], s28 offen offset:1024 lds
    v_mfma_f32_16x16x32_bf16 v[188:191], a[220:223], a[76:79], v[188:191]
    s_waitcnt lgkmcnt(6)
    v_mfma_f32_16x16x32_bf16 v[64:67], a[192:195], a[80:83], v[64:67]
    ds_read_b64_tr_b16 a[208:209], v204 offset:40960
    v_mfma_f32_16x16x32_bf16 v[68:71], a[192:195], a[84:87], v[68:71]
    ds_read_b64_tr_b16 a[210:211], v204 offset:41984
    v_mfma_f32_16x16x32_bf16 v[72:75], a[192:195], a[88:91], v[72:75]
    buffer_load_dwordx4 a[40:43], v17, s[16:19], s29 offen offset:0
    v_mfma_f32_16x16x32_bf16 v[76:79], a[192:195], a[92:95], v[76:79]
    s_waitcnt lgkmcnt(6)
    v_mfma_f32_16x16x32_bf16 v[80:83], a[196:199], a[80:83], v[80:83]
    ds_read_b64_tr_b16 a[212:213], v205 offset:40960
    v_mfma_f32_16x16x32_bf16 v[84:87], a[196:199], a[84:87], v[84:87]
    ds_read_b64_tr_b16 a[214:215], v205 offset:41984
    v_mfma_f32_16x16x32_bf16 v[88:91], a[196:199], a[88:91], v[88:91]
    buffer_load_dwordx4 a[44:47], v17, s[16:19], s29 offen offset:256
    v_mfma_f32_16x16x32_bf16 v[92:95], a[196:199], a[92:95], v[92:95]
    s_waitcnt lgkmcnt(6)
    v_mfma_f32_16x16x32_bf16 v[96:99], a[200:203], a[80:83], v[96:99]
    ds_read_b64_tr_b16 a[216:217], v206 offset:40960
    v_mfma_f32_16x16x32_bf16 v[100:103], a[200:203], a[84:87], v[100:103]
    ds_read_b64_tr_b16 a[218:219], v206 offset:41984
    v_mfma_f32_16x16x32_bf16 v[104:107], a[200:203], a[88:91], v[104:107]
    buffer_load_dwordx4 v6, s[12:15], s28 offen offset:2048 lds
    v_mfma_f32_16x16x32_bf16 v[108:111], a[200:203], a[92:95], v[108:111]
    s_waitcnt lgkmcnt(6)
    v_mfma_f32_16x16x32_bf16 v[112:115], a[204:207], a[80:83], v[112:115]
    ds_read_b64_tr_b16 a[220:221], v207 offset:40960
    v_mfma_f32_16x16x32_bf16 v[116:119], a[204:207], a[84:87], v[116:119]
    ds_read_b64_tr_b16 a[222:223], v207 offset:41984
    v_mfma_f32_16x16x32_bf16 v[120:123], a[204:207], a[88:91], v[120:123]
    buffer_load_dwordx4 a[48:51], v16, s[16:19], s29 offen offset:2048
    v_mfma_f32_16x16x32_bf16 v[124:127], a[204:207], a[92:95], v[124:127]
    s_waitcnt vmcnt(44) lgkmcnt(0)
    s_barrier
    v_mfma_f32_16x16x32_bf16 v[128:131], a[208:211], a[80:83], v[128:131]
    ds_read_b64_tr_b16 a[192:193], v200 offset:49152
    v_mfma_f32_16x16x32_bf16 v[132:135], a[208:211], a[84:87], v[132:135]
    ds_read_b64_tr_b16 a[194:195], v200 offset:50176
    v_mfma_f32_16x16x32_bf16 v[136:139], a[208:211], a[88:91], v[136:139]
    buffer_load_dwordx4 a[52:55], v16, s[16:19], s29 offen offset:2304
    v_mfma_f32_16x16x32_bf16 v[140:143], a[208:211], a[92:95], v[140:143]
    s_waitcnt lgkmcnt(6)
    v_mfma_f32_16x16x32_bf16 v[144:147], a[212:215], a[80:83], v[144:147]
    ds_read_b64_tr_b16 a[196:197], v201 offset:49152
    v_mfma_f32_16x16x32_bf16 v[148:151], a[212:215], a[84:87], v[148:151]
    ds_read_b64_tr_b16 a[198:199], v201 offset:50176
    v_mfma_f32_16x16x32_bf16 v[152:155], a[212:215], a[88:91], v[152:155]
    buffer_load_dwordx4 v7, s[12:15], s28 offen offset:3072 lds
    v_mfma_f32_16x16x32_bf16 v[156:159], a[212:215], a[92:95], v[156:159]
    s_waitcnt lgkmcnt(6)
    v_mfma_f32_16x16x32_bf16 v[160:163], a[216:219], a[80:83], v[160:163]
    ds_read_b64_tr_b16 a[200:201], v202 offset:49152
    v_mfma_f32_16x16x32_bf16 v[164:167], a[216:219], a[84:87], v[164:167]
    ds_read_b64_tr_b16 a[202:203], v202 offset:50176
    v_mfma_f32_16x16x32_bf16 v[168:171], a[216:219], a[88:91], v[168:171]
    buffer_load_dwordx4 a[56:59], v17, s[16:19], s29 offen offset:2048
    v_mfma_f32_16x16x32_bf16 v[172:175], a[216:219], a[92:95], v[172:175]
    s_waitcnt lgkmcnt(6)
    v_mfma_f32_16x16x32_bf16 v[176:179], a[220:223], a[80:83], v[176:179]
    ds_read_b64_tr_b16 a[204:205], v203 offset:49152
    v_mfma_f32_16x16x32_bf16 v[180:183], a[220:223], a[84:87], v[180:183]
    ds_read_b64_tr_b16 a[206:207], v203 offset:50176
    v_mfma_f32_16x16x32_bf16 v[184:187], a[220:223], a[88:91], v[184:187]
    buffer_load_dwordx4 a[60:63], v17, s[16:19], s29 offen offset:2304
    v_mfma_f32_16x16x32_bf16 v[188:191], a[220:223], a[92:95], v[188:191]
    s_waitcnt lgkmcnt(6)
    v_mfma_f32_16x16x32_bf16 v[64:67], a[192:195], a[96:99], v[64:67]
    ds_read_b64_tr_b16 a[208:209], v204 offset:49152
    v_mfma_f32_16x16x32_bf16 v[68:71], a[192:195], a[100:103], v[68:71]
    ds_read_b64_tr_b16 a[210:211], v204 offset:50176
    s_add_u32 s28, s28, 131072
    s_add_u32 m0, s30, 32768
    v_mfma_f32_16x16x32_bf16 v[72:75], a[192:195], a[104:107], v[72:75]
    buffer_load_dwordx4 v4, s[12:15], s28 offen offset:0 lds
    v_mfma_f32_16x16x32_bf16 v[76:79], a[192:195], a[108:111], v[76:79]
    s_waitcnt lgkmcnt(6)
    v_mfma_f32_16x16x32_bf16 v[80:83], a[196:199], a[96:99], v[80:83]
    ds_read_b64_tr_b16 a[212:213], v205 offset:49152
    v_mfma_f32_16x16x32_bf16 v[84:87], a[196:199], a[100:103], v[84:87]
    ds_read_b64_tr_b16 a[214:215], v205 offset:50176
    s_mov_b32 s29, 57344
    v_mfma_f32_16x16x32_bf16 v[88:91], a[196:199], a[104:107], v[88:91]
    buffer_load_dwordx4 a[64:67], v16, s[16:19], s29 offen offset:0
    v_mfma_f32_16x16x32_bf16 v[92:95], a[196:199], a[108:111], v[92:95]
    s_waitcnt lgkmcnt(6)
    v_mfma_f32_16x16x32_bf16 v[96:99], a[200:203], a[96:99], v[96:99]
    ds_read_b64_tr_b16 a[216:217], v206 offset:49152
    v_mfma_f32_16x16x32_bf16 v[100:103], a[200:203], a[100:103], v[100:103]
    ds_read_b64_tr_b16 a[218:219], v206 offset:50176
    v_mfma_f32_16x16x32_bf16 v[104:107], a[200:203], a[104:107], v[104:107]
    buffer_load_dwordx4 a[68:71], v16, s[16:19], s29 offen offset:256
    v_mfma_f32_16x16x32_bf16 v[108:111], a[200:203], a[108:111], v[108:111]
    s_waitcnt lgkmcnt(6)
    v_mfma_f32_16x16x32_bf16 v[112:115], a[204:207], a[96:99], v[112:115]
    ds_read_b64_tr_b16 a[220:221], v207 offset:49152
    v_mfma_f32_16x16x32_bf16 v[116:119], a[204:207], a[100:103], v[116:119]
    ds_read_b64_tr_b16 a[222:223], v207 offset:50176
    v_mfma_f32_16x16x32_bf16 v[120:123], a[204:207], a[104:107], v[120:123]
    buffer_load_dwordx4 v5, s[12:15], s28 offen offset:1024 lds
    v_mfma_f32_16x16x32_bf16 v[124:127], a[204:207], a[108:111], v[124:127]
    s_waitcnt lgkmcnt(6)
    v_mfma_f32_16x16x32_bf16 v[128:131], a[208:211], a[96:99], v[128:131]
    ds_read_b64_tr_b16 a[192:193], v200 offset:57344
    v_mfma_f32_16x16x32_bf16 v[132:135], a[208:211], a[100:103], v[132:135]
    ds_read_b64_tr_b16 a[194:195], v200 offset:58368
    v_mfma_f32_16x16x32_bf16 v[136:139], a[208:211], a[104:107], v[136:139]
    buffer_load_dwordx4 a[72:75], v17, s[16:19], s29 offen offset:0
    v_mfma_f32_16x16x32_bf16 v[140:143], a[208:211], a[108:111], v[140:143]
    s_waitcnt lgkmcnt(6)
    v_mfma_f32_16x16x32_bf16 v[144:147], a[212:215], a[96:99], v[144:147]
    ds_read_b64_tr_b16 a[196:197], v201 offset:57344
    v_mfma_f32_16x16x32_bf16 v[148:151], a[212:215], a[100:103], v[148:151]
    ds_read_b64_tr_b16 a[198:199], v201 offset:58368
    v_mfma_f32_16x16x32_bf16 v[152:155], a[212:215], a[104:107], v[152:155]
    buffer_load_dwordx4 a[76:79], v17, s[16:19], s29 offen offset:256
    v_mfma_f32_16x16x32_bf16 v[156:159], a[212:215], a[108:111], v[156:159]
    s_waitcnt lgkmcnt(6)
    v_mfma_f32_16x16x32_bf16 v[160:163], a[216:219], a[96:99], v[160:163]
    ds_read_b64_tr_b16 a[200:201], v202 offset:57344
    v_mfma_f32_16x16x32_bf16 v[164:167], a[216:219], a[100:103], v[164:167]
    ds_read_b64_tr_b16 a[202:203], v202 offset:58368
    v_mfma_f32_16x16x32_bf16 v[168:171], a[216:219], a[104:107], v[168:171]
    buffer_load_dwordx4 v6, s[12:15], s28 offen offset:2048 lds
    v_mfma_f32_16x16x32_bf16 v[172:175], a[216:219], a[108:111], v[172:175]
    s_waitcnt lgkmcnt(6)
    v_mfma_f32_16x16x32_bf16 v[176:179], a[220:223], a[96:99], v[176:179]
    ds_read_b64_tr_b16 a[204:205], v203 offset:57344
    v_mfma_f32_16x16x32_bf16 v[180:183], a[220:223], a[100:103], v[180:183]
    ds_read_b64_tr_b16 a[206:207], v203 offset:58368
    v_mfma_f32_16x16x32_bf16 v[184:187], a[220:223], a[104:107], v[184:187]
    buffer_load_dwordx4 a[80:83], v16, s[16:19], s29 offen offset:2048
    v_mfma_f32_16x16x32_bf16 v[188:191], a[220:223], a[108:111], v[188:191]
    s_waitcnt lgkmcnt(6)
    v_mfma_f32_16x16x32_bf16 v[64:67], a[192:195], a[112:115], v[64:67]
    ds_read_b64_tr_b16 a[208:209], v204 offset:57344
    v_mfma_f32_16x16x32_bf16 v[68:71], a[192:195], a[116:119], v[68:71]
    ds_read_b64_tr_b16 a[210:211], v204 offset:58368
    v_mfma_f32_16x16x32_bf16 v[72:75], a[192:195], a[120:123], v[72:75]
    buffer_load_dwordx4 a[84:87], v16, s[16:19], s29 offen offset:2304
    v_mfma_f32_16x16x32_bf16 v[76:79], a[192:195], a[124:127], v[76:79]
    s_waitcnt lgkmcnt(6)
    v_mfma_f32_16x16x32_bf16 v[80:83], a[196:199], a[112:115], v[80:83]
    ds_read_b64_tr_b16 a[212:213], v205 offset:57344
    v_mfma_f32_16x16x32_bf16 v[84:87], a[196:199], a[116:119], v[84:87]
    ds_read_b64_tr_b16 a[214:215], v205 offset:58368
    v_mfma_f32_16x16x32_bf16 v[88:91], a[196:199], a[120:123], v[88:91]
    buffer_load_dwordx4 v7, s[12:15], s28 offen offset:3072 lds
    v_mfma_f32_16x16x32_bf16 v[92:95], a[196:199], a[124:127], v[92:95]
    s_waitcnt lgkmcnt(6)
    v_mfma_f32_16x16x32_bf16 v[96:99], a[200:203], a[112:115], v[96:99]
    ds_read_b64_tr_b16 a[216:217], v206 offset:57344
    v_mfma_f32_16x16x32_bf16 v[100:103], a[200:203], a[116:119], v[100:103]
    ds_read_b64_tr_b16 a[218:219], v206 offset:58368
    v_mfma_f32_16x16x32_bf16 v[104:107], a[200:203], a[120:123], v[104:107]
    buffer_load_dwordx4 a[88:91], v17, s[16:19], s29 offen offset:2048
    v_mfma_f32_16x16x32_bf16 v[108:111], a[200:203], a[124:127], v[108:111]
    s_waitcnt lgkmcnt(6)
    v_mfma_f32_16x16x32_bf16 v[112:115], a[204:207], a[112:115], v[112:115]
    ds_read_b64_tr_b16 a[220:221], v207 offset:57344
    v_mfma_f32_16x16x32_bf16 v[116:119], a[204:207], a[116:119], v[116:119]
    ds_read_b64_tr_b16 a[222:223], v207 offset:58368
    v_mfma_f32_16x16x32_bf16 v[120:123], a[204:207], a[120:123], v[120:123]
    buffer_load_dwordx4 a[92:95], v17, s[16:19], s29 offen offset:2304
    v_mfma_f32_16x16x32_bf16 v[124:127], a[204:207], a[124:127], v[124:127]
    s_waitcnt vmcnt(48) lgkmcnt(0)
    s_barrier
    v_mfma_f32_16x16x32_bf16 v[128:131], a[208:211], a[112:115], v[128:131]
    ds_read_b64_tr_b16 a[192:193], v208 offset:0
    v_mfma_f32_16x16x32_bf16 v[132:135], a[208:211], a[116:119], v[132:135]
    ds_read_b64_tr_b16 a[194:195], v208 offset:1024
    s_add_u32 s28, s28, 131072
    s_add_u32 m0, s30, 49152
    v_mfma_f32_16x16x32_bf16 v[136:139], a[208:211], a[120:123], v[136:139]
    buffer_load_dwordx4 v4, s[12:15], s28 offen offset:0 lds
    v_mfma_f32_16x16x32_bf16 v[140:143], a[208:211], a[124:127], v[140:143]
    s_waitcnt lgkmcnt(6)
    v_mfma_f32_16x16x32_bf16 v[144:147], a[212:215], a[112:115], v[144:147]
    ds_read_b64_tr_b16 a[196:197], v209 offset:0
    v_mfma_f32_16x16x32_bf16 v[148:151], a[212:215], a[116:119], v[148:151]
    ds_read_b64_tr_b16 a[198:199], v209 offset:1024
    s_mov_b32 s29, 61440
    v_mfma_f32_16x16x32_bf16 v[152:155], a[212:215], a[120:123], v[152:155]
    buffer_load_dwordx4 a[96:99], v16, s[16:19], s29 offen offset:0
    v_mfma_f32_16x16x32_bf16 v[156:159], a[212:215], a[124:127], v[156:159]
    s_waitcnt lgkmcnt(6)
    v_mfma_f32_16x16x32_bf16 v[160:163], a[216:219], a[112:115], v[160:163]
    ds_read_b64_tr_b16 a[200:201], v210 offset:0
    v_mfma_f32_16x16x32_bf16 v[164:167], a[216:219], a[116:119], v[164:167]
    ds_read_b64_tr_b16 a[202:203], v210 offset:1024
    v_mfma_f32_16x16x32_bf16 v[168:171], a[216:219], a[120:123], v[168:171]
    buffer_load_dwordx4 a[100:103], v16, s[16:19], s29 offen offset:256
    v_mfma_f32_16x16x32_bf16 v[172:175], a[216:219], a[124:127], v[172:175]
    s_waitcnt lgkmcnt(6)
    v_mfma_f32_16x16x32_bf16 v[176:179], a[220:223], a[112:115], v[176:179]
    ds_read_b64_tr_b16 a[204:205], v211 offset:0
    v_mfma_f32_16x16x32_bf16 v[180:183], a[220:223], a[116:119], v[180:183]
    ds_read_b64_tr_b16 a[206:207], v211 offset:1024
    v_mfma_f32_16x16x32_bf16 v[184:187], a[220:223], a[120:123], v[184:187]
    buffer_load_dwordx4 v5, s[12:15], s28 offen offset:1024 lds
    v_mfma_f32_16x16x32_bf16 v[188:191], a[220:223], a[124:127], v[188:191]
    s_waitcnt lgkmcnt(6)
    v_mfma_f32_16x16x32_bf16 v[64:67], a[192:195], a[128:131], v[64:67]
    ds_read_b64_tr_b16 a[208:209], v212 offset:0
    v_mfma_f32_16x16x32_bf16 v[68:71], a[192:195], a[132:135], v[68:71]
    ds_read_b64_tr_b16 a[210:211], v212 offset:1024
    v_mfma_f32_16x16x32_bf16 v[72:75], a[192:195], a[136:139], v[72:75]
    buffer_load_dwordx4 a[104:107], v17, s[16:19], s29 offen offset:0
    v_mfma_f32_16x16x32_bf16 v[76:79], a[192:195], a[140:143], v[76:79]
    s_waitcnt lgkmcnt(6)
    v_mfma_f32_16x16x32_bf16 v[80:83], a[196:199], a[128:131], v[80:83]
    ds_read_b64_tr_b16 a[212:213], v213 offset:0
    v_mfma_f32_16x16x32_bf16 v[84:87], a[196:199], a[132:135], v[84:87]
    ds_read_b64_tr_b16 a[214:215], v213 offset:1024
    v_mfma_f32_16x16x32_bf16 v[88:91], a[196:199], a[136:139], v[88:91]
    buffer_load_dwordx4 a[108:111], v17, s[16:19], s29 offen offset:256
    v_mfma_f32_16x16x32_bf16 v[92:95], a[196:199], a[140:143], v[92:95]
    s_waitcnt lgkmcnt(6)
    v_mfma_f32_16x16x32_bf16 v[96:99], a[200:203], a[128:131], v[96:99]
    ds_read_b64_tr_b16 a[216:217], v214 offset:0
    v_mfma_f32_16x16x32_bf16 v[100:103], a[200:203], a[132:135], v[100:103]
    ds_read_b64_tr_b16 a[218:219], v214 offset:1024
    v_mfma_f32_16x16x32_bf16 v[104:107], a[200:203], a[136:139], v[104:107]
    buffer_load_dwordx4 v6, s[12:15], s28 offen offset:2048 lds
    v_mfma_f32_16x16x32_bf16 v[108:111], a[200:203], a[140:143], v[108:111]
    s_waitcnt lgkmcnt(6)
    v_mfma_f32_16x16x32_bf16 v[112:115], a[204:207], a[128:131], v[112:115]
    ds_read_b64_tr_b16 a[220:221], v215 offset:0
    v_mfma_f32_16x16x32_bf16 v[116:119], a[204:207], a[132:135], v[116:119]
    ds_read_b64_tr_b16 a[222:223], v215 offset:1024
    v_mfma_f32_16x16x32_bf16 v[120:123], a[204:207], a[136:139], v[120:123]
    buffer_load_dwordx4 a[112:115], v16, s[16:19], s29 offen offset:2048
    v_mfma_f32_16x16x32_bf16 v[124:127], a[204:207], a[140:143], v[124:127]
    s_waitcnt lgkmcnt(6)
    v_mfma_f32_16x16x32_bf16 v[128:131], a[208:211], a[128:131], v[128:131]
    ds_read_b64_tr_b16 a[192:193], v208 offset:8192
    v_mfma_f32_16x16x32_bf16 v[132:135], a[208:211], a[132:135], v[132:135]
    ds_read_b64_tr_b16 a[194:195], v208 offset:9216
    v_mfma_f32_16x16x32_bf16 v[136:139], a[208:211], a[136:139], v[136:139]
    buffer_load_dwordx4 a[116:119], v16, s[16:19], s29 offen offset:2304
    v_mfma_f32_16x16x32_bf16 v[140:143], a[208:211], a[140:143], v[140:143]
    s_waitcnt lgkmcnt(6)
    v_mfma_f32_16x16x32_bf16 v[144:147], a[212:215], a[128:131], v[144:147]
    ds_read_b64_tr_b16 a[196:197], v209 offset:8192
    v_mfma_f32_16x16x32_bf16 v[148:151], a[212:215], a[132:135], v[148:151]
    ds_read_b64_tr_b16 a[198:199], v209 offset:9216
    v_mfma_f32_16x16x32_bf16 v[152:155], a[212:215], a[136:139], v[152:155]
    buffer_load_dwordx4 v7, s[12:15], s28 offen offset:3072 lds
    v_mfma_f32_16x16x32_bf16 v[156:159], a[212:215], a[140:143], v[156:159]
    s_waitcnt lgkmcnt(6)
    v_mfma_f32_16x16x32_bf16 v[160:163], a[216:219], a[128:131], v[160:163]
    ds_read_b64_tr_b16 a[200:201], v210 offset:8192
    v_mfma_f32_16x16x32_bf16 v[164:167], a[216:219], a[132:135], v[164:167]
    ds_read_b64_tr_b16 a[202:203], v210 offset:9216
    v_mfma_f32_16x16x32_bf16 v[168:171], a[216:219], a[136:139], v[168:171]
    buffer_load_dwordx4 a[120:123], v17, s[16:19], s29 offen offset:2048
    v_mfma_f32_16x16x32_bf16 v[172:175], a[216:219], a[140:143], v[172:175]
    s_waitcnt lgkmcnt(6)
    v_mfma_f32_16x16x32_bf16 v[176:179], a[220:223], a[128:131], v[176:179]
    ds_read_b64_tr_b16 a[204:205], v211 offset:8192
    v_mfma_f32_16x16x32_bf16 v[180:183], a[220:223], a[132:135], v[180:183]
    ds_read_b64_tr_b16 a[206:207], v211 offset:9216
    v_mfma_f32_16x16x32_bf16 v[184:187], a[220:223], a[136:139], v[184:187]
    buffer_load_dwordx4 a[124:127], v17, s[16:19], s29 offen offset:2304
    v_mfma_f32_16x16x32_bf16 v[188:191], a[220:223], a[140:143], v[188:191]
    s_waitcnt lgkmcnt(6)
    v_mfma_f32_16x16x32_bf16 v[64:67], a[192:195], a[144:147], v[64:67]
    ds_read_b64_tr_b16 a[208:209], v212 offset:8192
    v_mfma_f32_16x16x32_bf16 v[68:71], a[192:195], a[148:151], v[68:71]
    ds_read_b64_tr_b16 a[210:211], v212 offset:9216
    v_mfma_f32_16x16x32_bf16 v[72:75], a[192:195], a[152:155], v[72:75]
    v_mfma_f32_16x16x32_bf16 v[76:79], a[192:195], a[156:159], v[76:79]
    s_waitcnt lgkmcnt(6)
    v_mfma_f32_16x16x32_bf16 v[80:83], a[196:199], a[144:147], v[80:83]
    ds_read_b64_tr_b16 a[212:213], v213 offset:8192
    v_mfma_f32_16x16x32_bf16 v[84:87], a[196:199], a[148:151], v[84:87]
    ds_read_b64_tr_b16 a[214:215], v213 offset:9216
    v_mfma_f32_16x16x32_bf16 v[88:91], a[196:199], a[152:155], v[88:91]
    v_mfma_f32_16x16x32_bf16 v[92:95], a[196:199], a[156:159], v[92:95]
    s_waitcnt lgkmcnt(6)
    v_mfma_f32_16x16x32_bf16 v[96:99], a[200:203], a[144:147], v[96:99]
    ds_read_b64_tr_b16 a[216:217], v214 offset:8192
    v_mfma_f32_16x16x32_bf16 v[100:103], a[200:203], a[148:151], v[100:103]
    ds_read_b64_tr_b16 a[218:219], v214 offset:9216
    v_mfma_f32_16x16x32_bf16 v[104:107], a[200:203], a[152:155], v[104:107]
    v_mfma_f32_16x16x32_bf16 v[108:111], a[200:203], a[156:159], v[108:111]
    s_waitcnt lgkmcnt(6)
    v_mfma_f32_16x16x32_bf16 v[112:115], a[204:207], a[144:147], v[112:115]
    ds_read_b64_tr_b16 a[220:221], v215 offset:8192
    v_mfma_f32_16x16x32_bf16 v[116:119], a[204:207], a[148:151], v[116:119]
    ds_read_b64_tr_b16 a[222:223], v215 offset:9216
    v_mfma_f32_16x16x32_bf16 v[120:123], a[204:207], a[152:155], v[120:123]
    v_mfma_f32_16x16x32_bf16 v[124:127], a[204:207], a[156:159], v[124:127]
    s_waitcnt vmcnt(48) lgkmcnt(0)
    s_barrier
    v_mfma_f32_16x16x32_bf16 v[128:131], a[208:211], a[144:147], v[128:131]
    ds_read_b64_tr_b16 a[192:193], v208 offset:16384
    v_mfma_f32_16x16x32_bf16 v[132:135], a[208:211], a[148:151], v[132:135]
    ds_read_b64_tr_b16 a[194:195], v208 offset:17408
    v_mfma_f32_16x16x32_bf16 v[136:139], a[208:211], a[152:155], v[136:139]
    v_mfma_f32_16x16x32_bf16 v[140:143], a[208:211], a[156:159], v[140:143]
    s_waitcnt lgkmcnt(6)
    v_mfma_f32_16x16x32_bf16 v[144:147], a[212:215], a[144:147], v[144:147]
    ds_read_b64_tr_b16 a[196:197], v209 offset:16384
    v_mfma_f32_16x16x32_bf16 v[148:151], a[212:215], a[148:151], v[148:151]
    ds_read_b64_tr_b16 a[198:199], v209 offset:17408
    v_mfma_f32_16x16x32_bf16 v[152:155], a[212:215], a[152:155], v[152:155]
    v_mfma_f32_16x16x32_bf16 v[156:159], a[212:215], a[156:159], v[156:159]
    s_waitcnt lgkmcnt(6)
    v_mfma_f32_16x16x32_bf16 v[160:163], a[216:219], a[144:147], v[160:163]
    ds_read_b64_tr_b16 a[200:201], v210 offset:16384
    v_mfma_f32_16x16x32_bf16 v[164:167], a[216:219], a[148:151], v[164:167]
    ds_read_b64_tr_b16 a[202:203], v210 offset:17408
    v_mfma_f32_16x16x32_bf16 v[168:171], a[216:219], a[152:155], v[168:171]
    v_mfma_f32_16x16x32_bf16 v[172:175], a[216:219], a[156:159], v[172:175]
    s_waitcnt lgkmcnt(6)
    v_mfma_f32_16x16x32_bf16 v[176:179], a[220:223], a[144:147], v[176:179]
    ds_read_b64_tr_b16 a[204:205], v211 offset:16384
    v_mfma_f32_16x16x32_bf16 v[180:183], a[220:223], a[148:151], v[180:183]
    ds_read_b64_tr_b16 a[206:207], v211 offset:17408
    v_mfma_f32_16x16x32_bf16 v[184:187], a[220:223], a[152:155], v[184:187]
    v_mfma_f32_16x16x32_bf16 v[188:191], a[220:223], a[156:159], v[188:191]
    s_waitcnt lgkmcnt(6)
    v_mfma_f32_16x16x32_bf16 v[64:67], a[192:195], a[160:163], v[64:67]
    ds_read_b64_tr_b16 a[208:209], v212 offset:16384
    v_mfma_f32_16x16x32_bf16 v[68:71], a[192:195], a[164:167], v[68:71]
    ds_read_b64_tr_b16 a[210:211], v212 offset:17408
    v_mfma_f32_16x16x32_bf16 v[72:75], a[192:195], a[168:171], v[72:75]
    v_mfma_f32_16x16x32_bf16 v[76:79], a[192:195], a[172:175], v[76:79]
    s_waitcnt lgkmcnt(6)
    v_mfma_f32_16x16x32_bf16 v[80:83], a[196:199], a[160:163], v[80:83]
    ds_read_b64_tr_b16 a[212:213], v213 offset:16384
    v_mfma_f32_16x16x32_bf16 v[84:87], a[196:199], a[164:167], v[84:87]
    ds_read_b64_tr_b16 a[214:215], v213 offset:17408
    v_mfma_f32_16x16x32_bf16 v[88:91], a[196:199], a[168:171], v[88:91]
    v_mfma_f32_16x16x32_bf16 v[92:95], a[196:199], a[172:175], v[92:95]
    s_waitcnt lgkmcnt(6)
    v_mfma_f32_16x16x32_bf16 v[96:99], a[200:203], a[160:163], v[96:99]
    ds_read_b64_tr_b16 a[216:217], v214 offset:16384
    v_mfma_f32_16x16x32_bf16 v[100:103], a[200:203], a[164:167], v[100:103]
    ds_read_b64_tr_b16 a[218:219], v214 offset:17408
    v_mfma_f32_16x16x32_bf16 v[104:107], a[200:203], a[168:171], v[104:107]
    v_mfma_f32_16x16x32_bf16 v[108:111], a[200:203], a[172:175], v[108:111]
    s_waitcnt lgkmcnt(6)
    v_mfma_f32_16x16x32_bf16 v[112:115], a[204:207], a[160:163], v[112:115]
    ds_read_b64_tr_b16 a[220:221], v215 offset:16384
    v_mfma_f32_16x16x32_bf16 v[116:119], a[204:207], a[164:167], v[116:119]
    ds_read_b64_tr_b16 a[222:223], v215 offset:17408
    v_mfma_f32_16x16x32_bf16 v[120:123], a[204:207], a[168:171], v[120:123]
    v_mfma_f32_16x16x32_bf16 v[124:127], a[204:207], a[172:175], v[124:127]
    s_waitcnt lgkmcnt(6)
    v_mfma_f32_16x16x32_bf16 v[128:131], a[208:211], a[160:163], v[128:131]
    ds_read_b64_tr_b16 a[192:193], v208 offset:24576
    v_mfma_f32_16x16x32_bf16 v[132:135], a[208:211], a[164:167], v[132:135]
    ds_read_b64_tr_b16 a[194:195], v208 offset:25600
    v_mfma_f32_16x16x32_bf16 v[136:139], a[208:211], a[168:171], v[136:139]
    v_mfma_f32_16x16x32_bf16 v[140:143], a[208:211], a[172:175], v[140:143]
    s_waitcnt lgkmcnt(6)
    v_mfma_f32_16x16x32_bf16 v[144:147], a[212:215], a[160:163], v[144:147]
    ds_read_b64_tr_b16 a[196:197], v209 offset:24576
    v_mfma_f32_16x16x32_bf16 v[148:151], a[212:215], a[164:167], v[148:151]
    ds_read_b64_tr_b16 a[198:199], v209 offset:25600
    v_mfma_f32_16x16x32_bf16 v[152:155], a[212:215], a[168:171], v[152:155]
    v_mfma_f32_16x16x32_bf16 v[156:159], a[212:215], a[172:175], v[156:159]
    s_waitcnt lgkmcnt(6)
    v_mfma_f32_16x16x32_bf16 v[160:163], a[216:219], a[160:163], v[160:163]
    ds_read_b64_tr_b16 a[200:201], v210 offset:24576
    v_mfma_f32_16x16x32_bf16 v[164:167], a[216:219], a[164:167], v[164:167]
    ds_read_b64_tr_b16 a[202:203], v210 offset:25600
    v_mfma_f32_16x16x32_bf16 v[168:171], a[216:219], a[168:171], v[168:171]
    v_mfma_f32_16x16x32_bf16 v[172:175], a[216:219], a[172:175], v[172:175]
    s_waitcnt lgkmcnt(6)
    v_mfma_f32_16x16x32_bf16 v[176:179], a[220:223], a[160:163], v[176:179]
    ds_read_b64_tr_b16 a[204:205], v211 offset:24576
    v_mfma_f32_16x16x32_bf16 v[180:183], a[220:223], a[164:167], v[180:183]
    ds_read_b64_tr_b16 a[206:207], v211 offset:25600
    v_mfma_f32_16x16x32_bf16 v[184:187], a[220:223], a[168:171], v[184:187]
    v_mfma_f32_16x16x32_bf16 v[188:191], a[220:223], a[172:175], v[188:191]
    s_waitcnt lgkmcnt(6)
    v_mfma_f32_16x16x32_bf16 v[64:67], a[192:195], a[176:179], v[64:67]
    ds_read_b64_tr_b16 a[208:209], v212 offset:24576
    v_mfma_f32_16x16x32_bf16 v[68:71], a[192:195], a[180:183], v[68:71]
    ds_read_b64_tr_b16 a[210:211], v212 offset:25600
    v_mfma_f32_16x16x32_bf16 v[72:75], a[192:195], a[184:187], v[72:75]
    v_mfma_f32_16x16x32_bf16 v[76:79], a[192:195], a[188:191], v[76:79]
    s_waitcnt lgkmcnt(6)
    v_mfma_f32_16x16x32_bf16 v[80:83], a[196:199], a[176:179], v[80:83]
    ds_read_b64_tr_b16 a[212:213], v213 offset:24576
    v_mfma_f32_16x16x32_bf16 v[84:87], a[196:199], a[180:183], v[84:87]
    ds_read_b64_tr_b16 a[214:215], v213 offset:25600
    v_mfma_f32_16x16x32_bf16 v[88:91], a[196:199], a[184:187], v[88:91]
    v_mfma_f32_16x16x32_bf16 v[92:95], a[196:199], a[188:191], v[92:95]
    s_waitcnt lgkmcnt(6)
    v_mfma_f32_16x16x32_bf16 v[96:99], a[200:203], a[176:179], v[96:99]
    ds_read_b64_tr_b16 a[216:217], v214 offset:24576
    v_mfma_f32_16x16x32_bf16 v[100:103], a[200:203], a[180:183], v[100:103]
    ds_read_b64_tr_b16 a[218:219], v214 offset:25600
    v_mfma_f32_16x16x32_bf16 v[104:107], a[200:203], a[184:187], v[104:107]
    v_mfma_f32_16x16x32_bf16 v[108:111], a[200:203], a[188:191], v[108:111]
    s_waitcnt lgkmcnt(6)
    v_mfma_f32_16x16x32_bf16 v[112:115], a[204:207], a[176:179], v[112:115]
    ds_read_b64_tr_b16 a[220:221], v215 offset:24576
    v_mfma_f32_16x16x32_bf16 v[116:119], a[204:207], a[180:183], v[116:119]
    ds_read_b64_tr_b16 a[222:223], v215 offset:25600
    v_mfma_f32_16x16x32_bf16 v[120:123], a[204:207], a[184:187], v[120:123]
    v_mfma_f32_16x16x32_bf16 v[124:127], a[204:207], a[188:191], v[124:127]
    s_waitcnt vmcnt(36) lgkmcnt(0)
    s_barrier
    v_mfma_f32_16x16x32_bf16 v[128:131], a[208:211], a[176:179], v[128:131]
    ds_read_b64_tr_b16 a[192:193], v200 offset:0
    v_mfma_f32_16x16x32_bf16 v[132:135], a[208:211], a[180:183], v[132:135]
    ds_read_b64_tr_b16 a[194:195], v200 offset:1024
    v_mfma_f32_16x16x32_bf16 v[136:139], a[208:211], a[184:187], v[136:139]
    v_mfma_f32_16x16x32_bf16 v[140:143], a[208:211], a[188:191], v[140:143]
    s_waitcnt lgkmcnt(6)
    v_mfma_f32_16x16x32_bf16 v[144:147], a[212:215], a[176:179], v[144:147]
    ds_read_b64_tr_b16 a[196:197], v201 offset:0
    v_mfma_f32_16x16x32_bf16 v[148:151], a[212:215], a[180:183], v[148:151]
    ds_read_b64_tr_b16 a[198:199], v201 offset:1024
    v_mfma_f32_16x16x32_bf16 v[152:155], a[212:215], a[184:187], v[152:155]
    v_mfma_f32_16x16x32_bf16 v[156:159], a[212:215], a[188:191], v[156:159]
    s_waitcnt lgkmcnt(6)
    v_mfma_f32_16x16x32_bf16 v[160:163], a[216:219], a[176:179], v[160:163]
    ds_read_b64_tr_b16 a[200:201], v200 offset:8192
    v_mfma_f32_16x16x32_bf16 v[164:167], a[216:219], a[180:183], v[164:167]
    ds_read_b64_tr_b16 a[202:203], v200 offset:9216
    v_mfma_f32_16x16x32_bf16 v[168:171], a[216:219], a[184:187], v[168:171]
    v_mfma_f32_16x16x32_bf16 v[172:175], a[216:219], a[188:191], v[172:175]
    s_waitcnt lgkmcnt(6)
    v_mfma_f32_16x16x32_bf16 v[176:179], a[220:223], a[176:179], v[176:179]
    ds_read_b64_tr_b16 a[204:205], v201 offset:8192
    v_mfma_f32_16x16x32_bf16 v[180:183], a[220:223], a[180:183], v[180:183]
    ds_read_b64_tr_b16 a[206:207], v201 offset:9216
    v_mfma_f32_16x16x32_bf16 v[184:187], a[220:223], a[184:187], v[184:187]
    v_mfma_f32_16x16x32_bf16 v[188:191], a[220:223], a[188:191], v[188:191]
    s_waitcnt vmcnt(24) lgkmcnt(0)
    s_barrier
    v_mfma_f32_16x16x32_bf16 v[64:67], a[192:195], a[0:3], v[64:67]
    ds_read_b64_tr_b16 a[208:209], v200 offset:16384
    v_mfma_f32_16x16x32_bf16 v[68:71], a[192:195], a[4:7], v[68:71]
    ds_read_b64_tr_b16 a[210:211], v200 offset:17408
    v_mfma_f32_16x16x32_bf16 v[72:75], a[192:195], a[8:11], v[72:75]
    v_mfma_f32_16x16x32_bf16 v[76:79], a[192:195], a[12:15], v[76:79]
    s_waitcnt lgkmcnt(6)
    v_mfma_f32_16x16x32_bf16 v[80:83], a[196:199], a[0:3], v[80:83]
    ds_read_b64_tr_b16 a[212:213], v201 offset:16384
    v_mfma_f32_16x16x32_bf16 v[84:87], a[196:199], a[4:7], v[84:87]
    ds_read_b64_tr_b16 a[214:215], v201 offset:17408
    v_mfma_f32_16x16x32_bf16 v[88:91], a[196:199], a[8:11], v[88:91]
    v_mfma_f32_16x16x32_bf16 v[92:95], a[196:199], a[12:15], v[92:95]
    s_waitcnt lgkmcnt(6)
    v_mfma_f32_16x16x32_bf16 v[64:67], a[200:203], a[16:19], v[64:67]
    ds_read_b64_tr_b16 a[216:217], v200 offset:24576
    v_mfma_f32_16x16x32_bf16 v[68:71], a[200:203], a[20:23], v[68:71]
    ds_read_b64_tr_b16 a[218:219], v200 offset:25600
    v_mfma_f32_16x16x32_bf16 v[72:75], a[200:203], a[24:27], v[72:75]
    v_mfma_f32_16x16x32_bf16 v[76:79], a[200:203], a[28:31], v[76:79]
    s_waitcnt lgkmcnt(6)
    v_mfma_f32_16x16x32_bf16 v[80:83], a[204:207], a[16:19], v[80:83]
    ds_read_b64_tr_b16 a[220:221], v201 offset:24576
    v_mfma_f32_16x16x32_bf16 v[84:87], a[204:207], a[20:23], v[84:87]
    ds_read_b64_tr_b16 a[222:223], v201 offset:25600
    v_mfma_f32_16x16x32_bf16 v[88:91], a[204:207], a[24:27], v[88:91]
    v_mfma_f32_16x16x32_bf16 v[92:95], a[204:207], a[28:31], v[92:95]
    s_waitcnt vmcnt(12) lgkmcnt(0)
    s_barrier
    v_mfma_f32_16x16x32_bf16 v[64:67], a[208:211], a[32:35], v[64:67]
    ds_read_b64_tr_b16 a[192:193], v200 offset:32768
    v_mfma_f32_16x16x32_bf16 v[68:71], a[208:211], a[36:39], v[68:71]
    ds_read_b64_tr_b16 a[194:195], v200 offset:33792
    v_mfma_f32_16x16x32_bf16 v[72:75], a[208:211], a[40:43], v[72:75]
    v_mfma_f32_16x16x32_bf16 v[76:79], a[208:211], a[44:47], v[76:79]
    s_waitcnt lgkmcnt(6)
    v_mfma_f32_16x16x32_bf16 v[80:83], a[212:215], a[32:35], v[80:83]
    ds_read_b64_tr_b16 a[196:197], v201 offset:32768
    v_mfma_f32_16x16x32_bf16 v[84:87], a[212:215], a[36:39], v[84:87]
    ds_read_b64_tr_b16 a[198:199], v201 offset:33792
    v_mfma_f32_16x16x32_bf16 v[88:91], a[212:215], a[40:43], v[88:91]
    v_mfma_f32_16x16x32_bf16 v[92:95], a[212:215], a[44:47], v[92:95]
    s_waitcnt lgkmcnt(6)
    v_mfma_f32_16x16x32_bf16 v[64:67], a[216:219], a[48:51], v[64:67]
    ds_read_b64_tr_b16 a[200:201], v200 offset:40960
    v_mfma_f32_16x16x32_bf16 v[68:71], a[216:219], a[52:55], v[68:71]
    ds_read_b64_tr_b16 a[202:203], v200 offset:41984
    v_mfma_f32_16x16x32_bf16 v[72:75], a[216:219], a[56:59], v[72:75]
    v_mfma_f32_16x16x32_bf16 v[76:79], a[216:219], a[60:63], v[76:79]
    s_waitcnt lgkmcnt(6)
    v_mfma_f32_16x16x32_bf16 v[80:83], a[220:223], a[48:51], v[80:83]
    ds_read_b64_tr_b16 a[204:205], v201 offset:40960
    v_mfma_f32_16x16x32_bf16 v[84:87], a[220:223], a[52:55], v[84:87]
    ds_read_b64_tr_b16 a[206:207], v201 offset:41984
    v_mfma_f32_16x16x32_bf16 v[88:91], a[220:223], a[56:59], v[88:91]
    v_mfma_f32_16x16x32_bf16 v[92:95], a[220:223], a[60:63], v[92:95]
    s_waitcnt vmcnt(0) lgkmcnt(0)
    s_barrier
    v_mfma_f32_16x16x32_bf16 v[64:67], a[192:195], a[64:67], v[64:67]
    ds_read_b64_tr_b16 a[208:209], v200 offset:49152
    v_mfma_f32_16x16x32_bf16 v[68:71], a[192:195], a[68:71], v[68:71]
    ds_read_b64_tr_b16 a[210:211], v200 offset:50176
    v_mfma_f32_16x16x32_bf16 v[72:75], a[192:195], a[72:75], v[72:75]
    v_mfma_f32_16x16x32_bf16 v[76:79], a[192:195], a[76:79], v[76:79]
    s_waitcnt lgkmcnt(6)
    v_mfma_f32_16x16x32_bf16 v[80:83], a[196:199], a[64:67], v[80:83]
    ds_read_b64_tr_b16 a[212:213], v201 offset:49152
    v_mfma_f32_16x16x32_bf16 v[84:87], a[196:199], a[68:71], v[84:87]
    ds_read_b64_tr_b16 a[214:215], v201 offset:50176
    v_mfma_f32_16x16x32_bf16 v[88:91], a[196:199], a[72:75], v[88:91]
    v_mfma_f32_16x16x32_bf16 v[92:95], a[196:199], a[76:79], v[92:95]
    s_waitcnt lgkmcnt(6)
    v_mfma_f32_16x16x32_bf16 v[64:67], a[200:203], a[80:83], v[64:67]
    ds_read_b64_tr_b16 a[216:217], v200 offset:57344
    v_mfma_f32_16x16x32_bf16 v[68:71], a[200:203], a[84:87], v[68:71]
    ds_read_b64_tr_b16 a[218:219], v200 offset:58368
    v_mfma_f32_16x16x32_bf16 v[72:75], a[200:203], a[88:91], v[72:75]
    v_mfma_f32_16x16x32_bf16 v[76:79], a[200:203], a[92:95], v[76:79]
    s_waitcnt lgkmcnt(6)
    v_mfma_f32_16x16x32_bf16 v[80:83], a[204:207], a[80:83], v[80:83]
    ds_read_b64_tr_b16 a[220:221], v201 offset:57344
    v_mfma_f32_16x16x32_bf16 v[84:87], a[204:207], a[84:87], v[84:87]
    ds_read_b64_tr_b16 a[222:223], v201 offset:58368
    v_mfma_f32_16x16x32_bf16 v[88:91], a[204:207], a[88:91], v[88:91]
    v_mfma_f32_16x16x32_bf16 v[92:95], a[204:207], a[92:95], v[92:95]
    s_waitcnt lgkmcnt(6)
    v_mfma_f32_16x16x32_bf16 v[64:67], a[208:211], a[96:99], v[64:67]
    ds_read_b64_tr_b16 a[192:193], v202 offset:0
    v_mfma_f32_16x16x32_bf16 v[68:71], a[208:211], a[100:103], v[68:71]
    ds_read_b64_tr_b16 a[194:195], v202 offset:1024
    v_mfma_f32_16x16x32_bf16 v[72:75], a[208:211], a[104:107], v[72:75]
    v_mfma_f32_16x16x32_bf16 v[76:79], a[208:211], a[108:111], v[76:79]
    s_waitcnt lgkmcnt(6)
    v_mfma_f32_16x16x32_bf16 v[80:83], a[212:215], a[96:99], v[80:83]
    ds_read_b64_tr_b16 a[196:197], v203 offset:0
    v_mfma_f32_16x16x32_bf16 v[84:87], a[212:215], a[100:103], v[84:87]
    ds_read_b64_tr_b16 a[198:199], v203 offset:1024
    v_mfma_f32_16x16x32_bf16 v[88:91], a[212:215], a[104:107], v[88:91]
    v_mfma_f32_16x16x32_bf16 v[92:95], a[212:215], a[108:111], v[92:95]
    s_waitcnt lgkmcnt(6)
    v_mfma_f32_16x16x32_bf16 v[64:67], a[216:219], a[112:115], v[64:67]
    ds_read_b64_tr_b16 a[200:201], v202 offset:8192
    v_mfma_f32_16x16x32_bf16 v[68:71], a[216:219], a[116:119], v[68:71]
    ds_read_b64_tr_b16 a[202:203], v202 offset:9216
    v_mfma_f32_16x16x32_bf16 v[72:75], a[216:219], a[120:123], v[72:75]
    v_mfma_f32_16x16x32_bf16 v[76:79], a[216:219], a[124:127], v[76:79]
    s_waitcnt lgkmcnt(6)
    v_mfma_f32_16x16x32_bf16 v[80:83], a[220:223], a[112:115], v[80:83]
    ds_read_b64_tr_b16 a[204:205], v203 offset:8192
    v_mfma_f32_16x16x32_bf16 v[84:87], a[220:223], a[116:119], v[84:87]
    ds_read_b64_tr_b16 a[206:207], v203 offset:9216
    v_mfma_f32_16x16x32_bf16 v[88:91], a[220:223], a[120:123], v[88:91]
    v_mfma_f32_16x16x32_bf16 v[92:95], a[220:223], a[124:127], v[92:95]
    s_waitcnt lgkmcnt(6)
    v_mfma_f32_16x16x32_bf16 v[96:99], a[192:195], a[0:3], v[96:99]
    ds_read_b64_tr_b16 a[208:209], v202 offset:16384
    v_mfma_f32_16x16x32_bf16 v[100:103], a[192:195], a[4:7], v[100:103]
    ds_read_b64_tr_b16 a[210:211], v202 offset:17408
    v_mfma_f32_16x16x32_bf16 v[104:107], a[192:195], a[8:11], v[104:107]
    v_mfma_f32_16x16x32_bf16 v[108:111], a[192:195], a[12:15], v[108:111]
    s_waitcnt lgkmcnt(6)
    v_mfma_f32_16x16x32_bf16 v[112:115], a[196:199], a[0:3], v[112:115]
    ds_read_b64_tr_b16 a[212:213], v203 offset:16384
    v_mfma_f32_16x16x32_bf16 v[116:119], a[196:199], a[4:7], v[116:119]
    ds_read_b64_tr_b16 a[214:215], v203 offset:17408
    v_mfma_f32_16x16x32_bf16 v[120:123], a[196:199], a[8:11], v[120:123]
    v_mfma_f32_16x16x32_bf16 v[124:127], a[196:199], a[12:15], v[124:127]
    s_waitcnt lgkmcnt(6)
    v_mfma_f32_16x16x32_bf16 v[96:99], a[200:203], a[16:19], v[96:99]
    ds_read_b64_tr_b16 a[216:217], v202 offset:24576
    v_mfma_f32_16x16x32_bf16 v[100:103], a[200:203], a[20:23], v[100:103]
    ds_read_b64_tr_b16 a[218:219], v202 offset:25600
    v_mfma_f32_16x16x32_bf16 v[104:107], a[200:203], a[24:27], v[104:107]
    v_mfma_f32_16x16x32_bf16 v[108:111], a[200:203], a[28:31], v[108:111]
    s_waitcnt lgkmcnt(6)
    v_mfma_f32_16x16x32_bf16 v[112:115], a[204:207], a[16:19], v[112:115]
    ds_read_b64_tr_b16 a[220:221], v203 offset:24576
    v_cvt_pk_bf16_f32 v20, v64, v65
    v_cvt_pk_bf16_f32 v21, v66, v67
    v_mfma_f32_16x16x32_bf16 v[116:119], a[204:207], a[20:23], v[116:119]
    ds_read_b64_tr_b16 a[222:223], v203 offset:25600
    v_mfma_f32_16x16x32_bf16 v[120:123], a[204:207], a[24:27], v[120:123]
    v_mfma_f32_16x16x32_bf16 v[124:127], a[204:207], a[28:31], v[124:127]
    v_cvt_pk_bf16_f32 v22, v68, v69
    v_cvt_pk_bf16_f32 v23, v70, v71
    s_waitcnt lgkmcnt(6)
    v_mfma_f32_16x16x32_bf16 v[96:99], a[208:211], a[32:35], v[96:99]
    ds_read_b64_tr_b16 a[192:193], v202 offset:32768
    s_nop 1
    v_permlane16_swap_b32 v20, v22
    v_mfma_f32_16x16x32_bf16 v[100:103], a[208:211], a[36:39], v[100:103]
    ds_read_b64_tr_b16 a[194:195], v202 offset:33792
    v_mfma_f32_16x16x32_bf16 v[104:107], a[208:211], a[40:43], v[104:107]
    v_mfma_f32_16x16x32_bf16 v[108:111], a[208:211], a[44:47], v[108:111]
    v_permlane16_swap_b32 v21, v23
    s_nop 0
    s_waitcnt lgkmcnt(6)
    v_mfma_f32_16x16x32_bf16 v[112:115], a[212:215], a[32:35], v[112:115]
    ds_read_b64_tr_b16 a[196:197], v203 offset:32768
    buffer_store_dwordx4 v[20:23], v2, s[40:43], s26 offen offset:0 sc1
    v_cvt_pk_bf16_f32 v24, v80, v81
    v_mfma_f32_16x16x32_bf16 v[116:119], a[212:215], a[36:39], v[116:119]
    ds_read_b64_tr_b16 a[198:199], v203 offset:33792
    v_mfma_f32_16x16x32_bf16 v[120:123], a[212:215], a[40:43], v[120:123]
    v_mfma_f32_16x16x32_bf16 v[124:127], a[212:215], a[44:47], v[124:127]
    v_cvt_pk_bf16_f32 v25, v82, v83
    v_cvt_pk_bf16_f32 v26, v84, v85
    s_waitcnt lgkmcnt(6)
    v_mfma_f32_16x16x32_bf16 v[96:99], a[216:219], a[48:51], v[96:99]
    ds_read_b64_tr_b16 a[200:201], v202 offset:40960
    v_cvt_pk_bf16_f32 v27, v86, v87
    s_nop 1
    v_mfma_f32_16x16x32_bf16 v[100:103], a[216:219], a[52:55], v[100:103]
    ds_read_b64_tr_b16 a[202:203], v202 offset:41984
    v_mfma_f32_16x16x32_bf16 v[104:107], a[216:219], a[56:59], v[104:107]
    v_mfma_f32_16x16x32_bf16 v[108:111], a[216:219], a[60:63], v[108:111]
    v_permlane16_swap_b32 v24, v26
    v_permlane16_swap_b32 v25, v27
    s_waitcnt lgkmcnt(6)
    v_mfma_f32_16x16x32_bf16 v[112:115], a[220:223], a[48:51], v[112:115]
    ds_read_b64_tr_b16 a[204:205], v203 offset:40960
    s_nop 0
    buffer_store_dwordx4 v[24:27], v2, s[40:43], s26 offen offset:1024 sc1
    v_mfma_f32_16x16x32_bf16 v[116:119], a[220:223], a[52:55], v[116:119]
    ds_read_b64_tr_b16 a[206:207], v203 offset:41984
    v_mfma_f32_16x16x32_bf16 v[120:123], a[220:223], a[56:59], v[120:123]
    v_mfma_f32_16x16x32_bf16 v[124:127], a[220:223], a[60:63], v[124:127]
    v_cvt_pk_bf16_f32 v28, v72, v73
    v_cvt_pk_bf16_f32 v29, v74, v75
    s_waitcnt lgkmcnt(6)
    v_mfma_f32_16x16x32_bf16 v[96:99], a[192:195], a[64:67], v[96:99]
    ds_read_b64_tr_b16 a[208:209], v202 offset:49152
    v_cvt_pk_bf16_f32 v30, v76, v77
    v_cvt_pk_bf16_f32 v31, v78, v79
    v_mfma_f32_16x16x32_bf16 v[100:103], a[192:195], a[68:71], v[100:103]
    ds_read_b64_tr_b16 a[210:211], v202 offset:50176
    v_mfma_f32_16x16x32_bf16 v[104:107], a[192:195], a[72:75], v[104:107]
    v_mfma_f32_16x16x32_bf16 v[108:111], a[192:195], a[76:79], v[108:111]
    s_nop 1
    v_permlane16_swap_b32 v28, v30
    s_waitcnt lgkmcnt(6)
    v_mfma_f32_16x16x32_bf16 v[112:115], a[196:199], a[64:67], v[112:115]
    ds_read_b64_tr_b16 a[212:213], v203 offset:49152
    v_permlane16_swap_b32 v29, v31
    s_nop 0
    v_mfma_f32_16x16x32_bf16 v[116:119], a[196:199], a[68:71], v[116:119]
    ds_read_b64_tr_b16 a[214:215], v203 offset:50176
    v_mfma_f32_16x16x32_bf16 v[120:123], a[196:199], a[72:75], v[120:123]
    v_mfma_f32_16x16x32_bf16 v[124:127], a[196:199], a[76:79], v[124:127]
    buffer_store_dwordx4 v[28:31], v2, s[40:43], s27 offen offset:0 sc1
    v_cvt_pk_bf16_f32 v32, v88, v89
    s_waitcnt lgkmcnt(6)
    v_mfma_f32_16x16x32_bf16 v[96:99], a[200:203], a[80:83], v[96:99]
    ds_read_b64_tr_b16 a[216:217], v202 offset:57344
    v_cvt_pk_bf16_f32 v33, v90, v91
    v_cvt_pk_bf16_f32 v34, v92, v93
    v_mfma_f32_16x16x32_bf16 v[100:103], a[200:203], a[84:87], v[100:103]
    ds_read_b64_tr_b16 a[218:219], v202 offset:58368
    v_mfma_f32_16x16x32_bf16 v[104:107], a[200:203], a[88:91], v[104:107]
    v_mfma_f32_16x16x32_bf16 v[108:111], a[200:203], a[92:95], v[108:111]
    v_cvt_pk_bf16_f32 v35, v94, v95
    s_nop 1
    s_waitcnt lgkmcnt(6)
    v_mfma_f32_16x16x32_bf16 v[112:115], a[204:207], a[80:83], v[112:115]
    ds_read_b64_tr_b16 a[220:221], v203 offset:57344
    v_permlane16_swap_b32 v32, v34
    v_permlane16_swap_b32 v33, v35
    v_mfma_f32_16x16x32_bf16 v[116:119], a[204:207], a[84:87], v[116:119]
    ds_read_b64_tr_b16 a[222:223], v203 offset:58368
    v_mfma_f32_16x16x32_bf16 v[120:123], a[204:207], a[88:91], v[120:123]
    v_mfma_f32_16x16x32_bf16 v[124:127], a[204:207], a[92:95], v[124:127]
    s_nop 0
    buffer_store_dwordx4 v[32:35], v2, s[40:43], s27 offen offset:1024 sc1
    s_waitcnt lgkmcnt(6)
    v_mfma_f32_16x16x32_bf16 v[96:99], a[208:211], a[96:99], v[96:99]
    ds_read_b64_tr_b16 a[192:193], v204 offset:0
    v_mfma_f32_16x16x32_bf16 v[100:103], a[208:211], a[100:103], v[100:103]
    ds_read_b64_tr_b16 a[194:195], v204 offset:1024
    v_mfma_f32_16x16x32_bf16 v[104:107], a[208:211], a[104:107], v[104:107]
    v_mfma_f32_16x16x32_bf16 v[108:111], a[208:211], a[108:111], v[108:111]
    s_waitcnt lgkmcnt(6)
    v_mfma_f32_16x16x32_bf16 v[112:115], a[212:215], a[96:99], v[112:115]
    ds_read_b64_tr_b16 a[196:197], v205 offset:0
    v_mfma_f32_16x16x32_bf16 v[116:119], a[212:215], a[100:103], v[116:119]
    ds_read_b64_tr_b16 a[198:199], v205 offset:1024
    v_mfma_f32_16x16x32_bf16 v[120:123], a[212:215], a[104:107], v[120:123]
    v_mfma_f32_16x16x32_bf16 v[124:127], a[212:215], a[108:111], v[124:127]
    s_waitcnt lgkmcnt(6)
    v_mfma_f32_16x16x32_bf16 v[96:99], a[216:219], a[112:115], v[96:99]
    ds_read_b64_tr_b16 a[200:201], v204 offset:8192
    v_mfma_f32_16x16x32_bf16 v[100:103], a[216:219], a[116:119], v[100:103]
    ds_read_b64_tr_b16 a[202:203], v204 offset:9216
    v_mfma_f32_16x16x32_bf16 v[104:107], a[216:219], a[120:123], v[104:107]
    v_mfma_f32_16x16x32_bf16 v[108:111], a[216:219], a[124:127], v[108:111]
    s_waitcnt lgkmcnt(6)
    v_mfma_f32_16x16x32_bf16 v[112:115], a[220:223], a[112:115], v[112:115]
    ds_read_b64_tr_b16 a[204:205], v205 offset:8192
    v_mfma_f32_16x16x32_bf16 v[116:119], a[220:223], a[116:119], v[116:119]
    ds_read_b64_tr_b16 a[206:207], v205 offset:9216
    v_mfma_f32_16x16x32_bf16 v[120:123], a[220:223], a[120:123], v[120:123]
    v_mfma_f32_16x16x32_bf16 v[124:127], a[220:223], a[124:127], v[124:127]
    s_waitcnt lgkmcnt(6)
    v_mfma_f32_16x16x32_bf16 v[128:131], a[192:195], a[0:3], v[128:131]
    ds_read_b64_tr_b16 a[208:209], v204 offset:16384
    v_mfma_f32_16x16x32_bf16 v[132:135], a[192:195], a[4:7], v[132:135]
    ds_read_b64_tr_b16 a[210:211], v204 offset:17408
    v_mfma_f32_16x16x32_bf16 v[136:139], a[192:195], a[8:11], v[136:139]
    v_mfma_f32_16x16x32_bf16 v[140:143], a[192:195], a[12:15], v[140:143]
    s_waitcnt lgkmcnt(6)
    v_mfma_f32_16x16x32_bf16 v[144:147], a[196:199], a[0:3], v[144:147]
    ds_read_b64_tr_b16 a[212:213], v205 offset:16384
    v_mfma_f32_16x16x32_bf16 v[148:151], a[196:199], a[4:7], v[148:151]
    ds_read_b64_tr_b16 a[214:215], v205 offset:17408
    v_mfma_f32_16x16x32_bf16 v[152:155], a[196:199], a[8:11], v[152:155]
    v_mfma_f32_16x16x32_bf16 v[156:159], a[196:199], a[12:15], v[156:159]
    s_waitcnt lgkmcnt(6)
    v_mfma_f32_16x16x32_bf16 v[128:131], a[200:203], a[16:19], v[128:131]
    ds_read_b64_tr_b16 a[216:217], v204 offset:24576
    v_mfma_f32_16x16x32_bf16 v[132:135], a[200:203], a[20:23], v[132:135]
    ds_read_b64_tr_b16 a[218:219], v204 offset:25600
    v_mfma_f32_16x16x32_bf16 v[136:139], a[200:203], a[24:27], v[136:139]
    v_mfma_f32_16x16x32_bf16 v[140:143], a[200:203], a[28:31], v[140:143]
    s_waitcnt lgkmcnt(6)
    v_mfma_f32_16x16x32_bf16 v[144:147], a[204:207], a[16:19], v[144:147]
    ds_read_b64_tr_b16 a[220:221], v205 offset:24576
    v_cvt_pk_bf16_f32 v28, v96, v97
    v_cvt_pk_bf16_f32 v29, v98, v99
    v_mfma_f32_16x16x32_bf16 v[148:151], a[204:207], a[20:23], v[148:151]
    ds_read_b64_tr_b16 a[222:223], v205 offset:25600
    v_mfma_f32_16x16x32_bf16 v[152:155], a[204:207], a[24:27], v[152:155]
    v_mfma_f32_16x16x32_bf16 v[156:159], a[204:207], a[28:31], v[156:159]
    v_cvt_pk_bf16_f32 v30, v100, v101
    v_cvt_pk_bf16_f32 v31, v102, v103
    s_waitcnt lgkmcnt(6)
    v_mfma_f32_16x16x32_bf16 v[128:131], a[208:211], a[32:35], v[128:131]
    ds_read_b64_tr_b16 a[192:193], v204 offset:32768
    s_nop 1
    v_permlane16_swap_b32 v28, v30
    v_mfma_f32_16x16x32_bf16 v[132:135], a[208:211], a[36:39], v[132:135]
    ds_read_b64_tr_b16 a[194:195], v204 offset:33792
    v_mfma_f32_16x16x32_bf16 v[136:139], a[208:211], a[40:43], v[136:139]
    v_mfma_f32_16x16x32_bf16 v[140:143], a[208:211], a[44:47], v[140:143]
    v_permlane16_swap_b32 v29, v31
    s_nop 0
    s_waitcnt lgkmcnt(6)
    v_mfma_f32_16x16x32_bf16 v[144:147], a[212:215], a[32:35], v[144:147]
    ds_read_b64_tr_b16 a[196:197], v205 offset:32768
    buffer_store_dwordx4 v[28:31], v2, s[40:43], s26 offen offset:2048 sc1
    v_cvt_pk_bf16_f32 v32, v112, v113
    v_mfma_f32_16x16x32_bf16 v[148:151], a[212:215], a[36:39], v[148:151]
    ds_read_b64_tr_b16 a[198:199], v205 offset:33792
    v_mfma_f32_16x16x32_bf16 v[152:155], a[212:215], a[40:43], v[152:155]
    v_mfma_f32_16x16x32_bf16 v[156:159], a[212:215], a[44:47], v[156:159]
    v_cvt_pk_bf16_f32 v33, v114, v115
    v_cvt_pk_bf16_f32 v34, v116, v117
    s_waitcnt lgkmcnt(6)
    v_mfma_f32_16x16x32_bf16 v[128:131], a[216:219], a[48:51], v[128:131]
    ds_read_b64_tr_b16 a[200:201], v204 offset:40960
    v_cvt_pk_bf16_f32 v35, v118, v119
    s_nop 1
    v_mfma_f32_16x16x32_bf16 v[132:135], a[216:219], a[52:55], v[132:135]
    ds_read_b64_tr_b16 a[202:203], v204 offset:41984
    v_mfma_f32_16x16x32_bf16 v[136:139], a[216:219], a[56:59], v[136:139]
    v_mfma_f32_16x16x32_bf16 v[140:143], a[216:219], a[60:63], v[140:143]
    v_permlane16_swap_b32 v32, v34
    v_permlane16_swap_b32 v33, v35
    s_waitcnt lgkmcnt(6)
    v_mfma_f32_16x16x32_bf16 v[144:147], a[220:223], a[48:51], v[144:147]
    ds_read_b64_tr_b16 a[204:205], v205 offset:40960
    s_nop 0
    buffer_store_dwordx4 v[32:35], v2, s[40:43], s26 offen offset:3072 sc1
    v_mfma_f32_16x16x32_bf16 v[148:151], a[220:223], a[52:55], v[148:151]
    ds_read_b64_tr_b16 a[206:207], v205 offset:41984
    v_mfma_f32_16x16x32_bf16 v[152:155], a[220:223], a[56:59], v[152:155]
    v_mfma_f32_16x16x32_bf16 v[156:159], a[220:223], a[60:63], v[156:159]
    v_cvt_pk_bf16_f32 v20, v104, v105
    v_cvt_pk_bf16_f32 v21, v106, v107
    s_waitcnt lgkmcnt(6)
    v_mfma_f32_16x16x32_bf16 v[128:131], a[192:195], a[64:67], v[128:131]
    ds_read_b64_tr_b16 a[208:209], v204 offset:49152
    v_cvt_pk_bf16_f32 v22, v108, v109
    v_cvt_pk_bf16_f32 v23, v110, v111
    v_mfma_f32_16x16x32_bf16 v[132:135], a[192:195], a[68:71], v[132:135]
    ds_read_b64_tr_b16 a[210:211], v204 offset:50176
    v_mfma_f32_16x16x32_bf16 v[136:139], a[192:195], a[72:75], v[136:139]
    v_mfma_f32_16x16x32_bf16 v[140:143], a[192:195], a[76:79], v[140:143]
    s_nop 1
    v_permlane16_swap_b32 v20, v22
    s_waitcnt lgkmcnt(6)
    v_mfma_f32_16x16x32_bf16 v[144:147], a[196:199], a[64:67], v[144:147]
    ds_read_b64_tr_b16 a[212:213], v205 offset:49152
    v_permlane16_swap_b32 v21, v23
    s_nop 0
    v_mfma_f32_16x16x32_bf16 v[148:151], a[196:199], a[68:71], v[148:151]
    ds_read_b64_tr_b16 a[214:215], v205 offset:50176
    v_mfma_f32_16x16x32_bf16 v[152:155], a[196:199], a[72:75], v[152:155]
    v_mfma_f32_16x16x32_bf16 v[156:159], a[196:199], a[76:79], v[156:159]
    buffer_store_dwordx4 v[20:23], v2, s[40:43], s27 offen offset:2048 sc1
    v_cvt_pk_bf16_f32 v24, v120, v121
    s_waitcnt lgkmcnt(6)
    v_mfma_f32_16x16x32_bf16 v[128:131], a[200:203], a[80:83], v[128:131]
    ds_read_b64_tr_b16 a[216:217], v204 offset:57344
    v_cvt_pk_bf16_f32 v25, v122, v123
    v_cvt_pk_bf16_f32 v26, v124, v125
    v_mfma_f32_16x16x32_bf16 v[132:135], a[200:203], a[84:87], v[132:135]
    ds_read_b64_tr_b16 a[218:219], v204 offset:58368
    v_mfma_f32_16x16x32_bf16 v[136:139], a[200:203], a[88:91], v[136:139]
    v_mfma_f32_16x16x32_bf16 v[140:143], a[200:203], a[92:95], v[140:143]
    v_cvt_pk_bf16_f32 v27, v126, v127
    s_nop 1
    s_waitcnt lgkmcnt(6)
    v_mfma_f32_16x16x32_bf16 v[144:147], a[204:207], a[80:83], v[144:147]
    ds_read_b64_tr_b16 a[220:221], v205 offset:57344
    v_permlane16_swap_b32 v24, v26
    v_permlane16_swap_b32 v25, v27
    v_mfma_f32_16x16x32_bf16 v[148:151], a[204:207], a[84:87], v[148:151]
    ds_read_b64_tr_b16 a[222:223], v205 offset:58368
    v_mfma_f32_16x16x32_bf16 v[152:155], a[204:207], a[88:91], v[152:155]
    v_mfma_f32_16x16x32_bf16 v[156:159], a[204:207], a[92:95], v[156:159]
    s_nop 0
    buffer_store_dwordx4 v[24:27], v2, s[40:43], s27 offen offset:3072 sc1
    s_waitcnt lgkmcnt(6)
    v_mfma_f32_16x16x32_bf16 v[128:131], a[208:211], a[96:99], v[128:131]
    ds_read_b64_tr_b16 a[192:193], v206 offset:0
    v_mfma_f32_16x16x32_bf16 v[132:135], a[208:211], a[100:103], v[132:135]
    ds_read_b64_tr_b16 a[194:195], v206 offset:1024
    v_mfma_f32_16x16x32_bf16 v[136:139], a[208:211], a[104:107], v[136:139]
    v_mfma_f32_16x16x32_bf16 v[140:143], a[208:211], a[108:111], v[140:143]
    s_waitcnt lgkmcnt(6)
    v_mfma_f32_16x16x32_bf16 v[144:147], a[212:215], a[96:99], v[144:147]
    ds_read_b64_tr_b16 a[196:197], v207 offset:0
    v_mfma_f32_16x16x32_bf16 v[148:151], a[212:215], a[100:103], v[148:151]
    ds_read_b64_tr_b16 a[198:199], v207 offset:1024
    v_mfma_f32_16x16x32_bf16 v[152:155], a[212:215], a[104:107], v[152:155]
    v_mfma_f32_16x16x32_bf16 v[156:159], a[212:215], a[108:111], v[156:159]
    s_waitcnt lgkmcnt(6)
    v_mfma_f32_16x16x32_bf16 v[128:131], a[216:219], a[112:115], v[128:131]
    ds_read_b64_tr_b16 a[200:201], v206 offset:8192
    v_mfma_f32_16x16x32_bf16 v[132:135], a[216:219], a[116:119], v[132:135]
    ds_read_b64_tr_b16 a[202:203], v206 offset:9216
    v_mfma_f32_16x16x32_bf16 v[136:139], a[216:219], a[120:123], v[136:139]
    v_mfma_f32_16x16x32_bf16 v[140:143], a[216:219], a[124:127], v[140:143]
    s_waitcnt lgkmcnt(6)
    v_mfma_f32_16x16x32_bf16 v[144:147], a[220:223], a[112:115], v[144:147]
    ds_read_b64_tr_b16 a[204:205], v207 offset:8192
    v_mfma_f32_16x16x32_bf16 v[148:151], a[220:223], a[116:119], v[148:151]
    ds_read_b64_tr_b16 a[206:207], v207 offset:9216
    v_mfma_f32_16x16x32_bf16 v[152:155], a[220:223], a[120:123], v[152:155]
    v_mfma_f32_16x16x32_bf16 v[156:159], a[220:223], a[124:127], v[156:159]
    s_waitcnt lgkmcnt(6)
    v_mfma_f32_16x16x32_bf16 v[160:163], a[192:195], a[0:3], v[160:163]
    ds_read_b64_tr_b16 a[208:209], v206 offset:16384
    v_mfma_f32_16x16x32_bf16 v[164:167], a[192:195], a[4:7], v[164:167]
    ds_read_b64_tr_b16 a[210:211], v206 offset:17408
    v_mfma_f32_16x16x32_bf16 v[168:171], a[192:195], a[8:11], v[168:171]
    v_mfma_f32_16x16x32_bf16 v[172:175], a[192:195], a[12:15], v[172:175]
    s_waitcnt lgkmcnt(6)
    v_mfma_f32_16x16x32_bf16 v[176:179], a[196:199], a[0:3], v[176:179]
    ds_read_b64_tr_b16 a[212:213], v207 offset:16384
    v_mfma_f32_16x16x32_bf16 v[180:183], a[196:199], a[4:7], v[180:183]
    ds_read_b64_tr_b16 a[214:215], v207 offset:17408
    v_mfma_f32_16x16x32_bf16 v[184:187], a[196:199], a[8:11], v[184:187]
    v_mfma_f32_16x16x32_bf16 v[188:191], a[196:199], a[12:15], v[188:191]
    s_waitcnt lgkmcnt(6)
    v_mfma_f32_16x16x32_bf16 v[160:163], a[200:203], a[16:19], v[160:163]
    ds_read_b64_tr_b16 a[216:217], v206 offset:24576
    v_mfma_f32_16x16x32_bf16 v[164:167], a[200:203], a[20:23], v[164:167]
    ds_read_b64_tr_b16 a[218:219], v206 offset:25600
    v_mfma_f32_16x16x32_bf16 v[168:171], a[200:203], a[24:27], v[168:171]
    v_mfma_f32_16x16x32_bf16 v[172:175], a[200:203], a[28:31], v[172:175]
    s_waitcnt lgkmcnt(6)
    v_mfma_f32_16x16x32_bf16 v[176:179], a[204:207], a[16:19], v[176:179]
    ds_read_b64_tr_b16 a[220:221], v207 offset:24576
    v_cvt_pk_bf16_f32 v20, v128, v129
    v_cvt_pk_bf16_f32 v21, v130, v131
    v_mfma_f32_16x16x32_bf16 v[180:183], a[204:207], a[20:23], v[180:183]
    ds_read_b64_tr_b16 a[222:223], v207 offset:25600
    v_mfma_f32_16x16x32_bf16 v[184:187], a[204:207], a[24:27], v[184:187]
    v_mfma_f32_16x16x32_bf16 v[188:191], a[204:207], a[28:31], v[188:191]
    v_cvt_pk_bf16_f32 v22, v132, v133
    v_cvt_pk_bf16_f32 v23, v134, v135
    s_waitcnt lgkmcnt(6)
    v_mfma_f32_16x16x32_bf16 v[160:163], a[208:211], a[32:35], v[160:163]
    ds_read_b64_tr_b16 a[192:193], v206 offset:32768
    s_nop 1
    v_permlane16_swap_b32 v20, v22
    v_mfma_f32_16x16x32_bf16 v[164:167], a[208:211], a[36:39], v[164:167]
    ds_read_b64_tr_b16 a[194:195], v206 offset:33792
    v_mfma_f32_16x16x32_bf16 v[168:171], a[208:211], a[40:43], v[168:171]
    v_mfma_f32_16x16x32_bf16 v[172:175], a[208:211], a[44:47], v[172:175]
    v_permlane16_swap_b32 v21, v23
    s_nop 0
    s_waitcnt lgkmcnt(6)
    v_mfma_f32_16x16x32_bf16 v[176:179], a[212:215], a[32:35], v[176:179]
    ds_read_b64_tr_b16 a[196:197], v207 offset:32768
    buffer_store_dwordx4 v[20:23], v2, s[40:43], s34 offen offset:0 sc1
    v_cvt_pk_bf16_f32 v24, v144, v145
    v_mfma_f32_16x16x32_bf16 v[180:183], a[212:215], a[36:39], v[180:183]
    ds_read_b64_tr_b16 a[198:199], v207 offset:33792
    v_mfma_f32_16x16x32_bf16 v[184:187], a[212:215], a[40:43], v[184:187]
    v_mfma_f32_16x16x32_bf16 v[188:191], a[212:215], a[44:47], v[188:191]
    v_cvt_pk_bf16_f32 v25, v146, v147
    v_cvt_pk_bf16_f32 v26, v148, v149
    s_waitcnt lgkmcnt(6)
    v_mfma_f32_16x16x32_bf16 v[160:163], a[216:219], a[48:51], v[160:163]
    ds_read_b64_tr_b16 a[200:201], v206 offset:40960
    v_cvt_pk_bf16_f32 v27, v150, v151
    s_nop 1
    v_mfma_f32_16x16x32_bf16 v[164:167], a[216:219], a[52:55], v[164:167]
    ds_read_b64_tr_b16 a[202:203], v206 offset:41984
    v_mfma_f32_16x16x32_bf16 v[168:171], a[216:219], a[56:59], v[168:171]
    v_mfma_f32_16x16x32_bf16 v[172:175], a[216:219], a[60:63], v[172:175]
    v_permlane16_swap_b32 v24, v26
    v_permlane16_swap_b32 v25, v27
    s_waitcnt lgkmcnt(6)
    v_mfma_f32_16x16x32_bf16 v[176:179], a[220:223], a[48:51], v[176:179]
    ds_read_b64_tr_b16 a[204:205], v207 offset:40960
    s_nop 0
    buffer_store_dwordx4 v[24:27], v2, s[40:43], s34 offen offset:1024 sc1
    v_mfma_f32_16x16x32_bf16 v[180:183], a[220:223], a[52:55], v[180:183]
    ds_read_b64_tr_b16 a[206:207], v207 offset:41984
    v_mfma_f32_16x16x32_bf16 v[184:187], a[220:223], a[56:59], v[184:187]
    v_mfma_f32_16x16x32_bf16 v[188:191], a[220:223], a[60:63], v[188:191]
    v_cvt_pk_bf16_f32 v28, v136, v137
    v_cvt_pk_bf16_f32 v29, v138, v139
    s_waitcnt lgkmcnt(6)
    v_mfma_f32_16x16x32_bf16 v[160:163], a[192:195], a[64:67], v[160:163]
    ds_read_b64_tr_b16 a[208:209], v206 offset:49152
    v_cvt_pk_bf16_f32 v30, v140, v141
    v_cvt_pk_bf16_f32 v31, v142, v143
    v_mfma_f32_16x16x32_bf16 v[164:167], a[192:195], a[68:71], v[164:167]
    ds_read_b64_tr_b16 a[210:211], v206 offset:50176
    v_mfma_f32_16x16x32_bf16 v[168:171], a[192:195], a[72:75], v[168:171]
    v_mfma_f32_16x16x32_bf16 v[172:175], a[192:195], a[76:79], v[172:175]
    s_nop 1
    v_permlane16_swap_b32 v28, v30
    s_waitcnt lgkmcnt(6)
    v_mfma_f32_16x16x32_bf16 v[176:179], a[196:199], a[64:67], v[176:179]
    ds_read_b64_tr_b16 a[212:213], v207 offset:49152
    v_permlane16_swap_b32 v29, v31
    s_nop 0
    v_mfma_f32_16x16x32_bf16 v[180:183], a[196:199], a[68:71], v[180:183]
    ds_read_b64_tr_b16 a[214:215], v207 offset:50176
    v_mfma_f32_16x16x32_bf16 v[184:187], a[196:199], a[72:75], v[184:187]
    v_mfma_f32_16x16x32_bf16 v[188:191], a[196:199], a[76:79], v[188:191]
    buffer_store_dwordx4 v[28:31], v2, s[40:43], s35 offen offset:0 sc1
    v_cvt_pk_bf16_f32 v32, v152, v153
    s_waitcnt lgkmcnt(6)
    v_mfma_f32_16x16x32_bf16 v[160:163], a[200:203], a[80:83], v[160:163]
    ds_read_b64_tr_b16 a[216:217], v206 offset:57344
    v_cvt_pk_bf16_f32 v33, v154, v155
    v_cvt_pk_bf16_f32 v34, v156, v157
    v_mfma_f32_16x16x32_bf16 v[164:167], a[200:203], a[84:87], v[164:167]
    ds_read_b64_tr_b16 a[218:219], v206 offset:58368
    v_mfma_f32_16x16x32_bf16 v[168:171], a[200:203], a[88:91], v[168:171]
    v_mfma_f32_16x16x32_bf16 v[172:175], a[200:203], a[92:95], v[172:175]
    v_cvt_pk_bf16_f32 v35, v158, v159
    s_nop 1
    s_waitcnt lgkmcnt(6)
    v_mfma_f32_16x16x32_bf16 v[176:179], a[204:207], a[80:83], v[176:179]
    ds_read_b64_tr_b16 a[220:221], v207 offset:57344
    v_permlane16_swap_b32 v32, v34
    v_permlane16_swap_b32 v33, v35
    v_mfma_f32_16x16x32_bf16 v[180:183], a[204:207], a[84:87], v[180:183]
    ds_read_b64_tr_b16 a[222:223], v207 offset:58368
    v_mfma_f32_16x16x32_bf16 v[184:187], a[204:207], a[88:91], v[184:187]
    v_mfma_f32_16x16x32_bf16 v[188:191], a[204:207], a[92:95], v[188:191]
    s_nop 0
    buffer_store_dwordx4 v[32:35], v2, s[40:43], s35 offen offset:1024 sc1
    s_waitcnt lgkmcnt(6)
    v_mfma_f32_16x16x32_bf16 v[160:163], a[208:211], a[96:99], v[160:163]
    v_mfma_f32_16x16x32_bf16 v[164:167], a[208:211], a[100:103], v[164:167]
    v_mfma_f32_16x16x32_bf16 v[168:171], a[208:211], a[104:107], v[168:171]
    v_mfma_f32_16x16x32_bf16 v[172:175], a[208:211], a[108:111], v[172:175]
    s_waitcnt lgkmcnt(4)
    v_mfma_f32_16x16x32_bf16 v[176:179], a[212:215], a[96:99], v[176:179]
    v_mfma_f32_16x16x32_bf16 v[180:183], a[212:215], a[100:103], v[180:183]
    v_mfma_f32_16x16x32_bf16 v[184:187], a[212:215], a[104:107], v[184:187]
    v_mfma_f32_16x16x32_bf16 v[188:191], a[212:215], a[108:111], v[188:191]
    s_waitcnt lgkmcnt(2)
    v_mfma_f32_16x16x32_bf16 v[160:163], a[216:219], a[112:115], v[160:163]
    v_mfma_f32_16x16x32_bf16 v[164:167], a[216:219], a[116:119], v[164:167]
    v_mfma_f32_16x16x32_bf16 v[168:171], a[216:219], a[120:123], v[168:171]
    v_mfma_f32_16x16x32_bf16 v[172:175], a[216:219], a[124:127], v[172:175]
    s_waitcnt lgkmcnt(0)
    v_mfma_f32_16x16x32_bf16 v[176:179], a[220:223], a[112:115], v[176:179]
    v_mfma_f32_16x16x32_bf16 v[180:183], a[220:223], a[116:119], v[180:183]
    v_mfma_f32_16x16x32_bf16 v[184:187], a[220:223], a[120:123], v[184:187]
    v_mfma_f32_16x16x32_bf16 v[188:191], a[220:223], a[124:127], v[188:191]
    s_nop 15
    v_cvt_pk_bf16_f32 v28, v160, v161
    v_cvt_pk_bf16_f32 v29, v162, v163
    v_cvt_pk_bf16_f32 v30, v164, v165
    v_cvt_pk_bf16_f32 v31, v166, v167
    s_nop 1
    v_permlane16_swap_b32 v28, v30
    v_permlane16_swap_b32 v29, v31
    s_nop 0
    buffer_store_dwordx4 v[28:31], v2, s[40:43], s34 offen offset:2048 sc1
    v_cvt_pk_bf16_f32 v32, v176, v177
    v_cvt_pk_bf16_f32 v33, v178, v179
    v_cvt_pk_bf16_f32 v34, v180, v181
    v_cvt_pk_bf16_f32 v35, v182, v183
    s_nop 1
    v_permlane16_swap_b32 v32, v34
    v_permlane16_swap_b32 v33, v35
    s_nop 0
    buffer_store_dwordx4 v[32:35], v2, s[40:43], s34 offen offset:3072 sc1
    v_cvt_pk_bf16_f32 v20, v168, v169
    v_cvt_pk_bf16_f32 v21, v170, v171
    v_cvt_pk_bf16_f32 v22, v172, v173
    v_cvt_pk_bf16_f32 v23, v174, v175
    s_nop 1
    v_permlane16_swap_b32 v20, v22
    v_permlane16_swap_b32 v21, v23
    s_nop 0
    buffer_store_dwordx4 v[20:23], v2, s[40:43], s35 offen offset:2048 sc1
    v_cvt_pk_bf16_f32 v24, v184, v185
    v_cvt_pk_bf16_f32 v25, v186, v187
    v_cvt_pk_bf16_f32 v26, v188, v189
    v_cvt_pk_bf16_f32 v27, v190, v191
    s_nop 1
    v_permlane16_swap_b32 v24, v26
    v_permlane16_swap_b32 v25, v27
    s_nop 0
    buffer_store_dwordx4 v[24:27], v2, s[40:43], s35 offen offset:3072 sc1
L_oproj_kernel_done:
    s_endpgm
.globl ln2_kernel
.p2align 8
.type ln2_kernel,@function
ln2_kernel:
    s_load_dwordx2 s[52:53], s[0:1], 56
    s_cmp_ge_u32 s2, 256
    s_cbranch_scc1 L_ln2_kernel_done
    s_load_dwordx2 s[4:5], s[0:1], 0
    s_load_dwordx2 s[6:7], s[0:1], 80
    s_load_dwordx2 s[8:9], s[0:1], 96
    v_and_b32 v1, 7, v0
    v_lshrrev_b32 v2, 3, v0
    v_and_b32 v3, 7, v2
    v_lshrrev_b32 v4, 6, v0
    v_lshl_add_u32 v5, v4, 4, v3
    s_lshr_b32 s10, s2, 2
    s_and_b32 s11, s2, 3
    s_lshl_b32 s10, s10, 16
    s_lshl_b32 s11, s11, 7
    s_add_u32 s10, s10, s11
    v_lshlrev_b32 v6, 9, v5
    v_lshl_add_u32 v6, v1, 4, v6
    v_add_u32 v6, s10, v6
    v_add_u32 v8, 4096, v6
    v_lshlrev_b32 v9, 5, v5
    s_lshl_b32 s12, s2, 14
    v_lshlrev_b32 v7, 11, v1
    v_lshl_add_u32 v7, v5, 4, v7
    v_add_u32 v7, s12, v7
    s_waitcnt lgkmcnt(0)
    s_add_u32 s16, s8, 131072
    s_addc_u32 s17, s9, 0
    s_mov_b32 s18, 65536
    s_mov_b32 s19, 0x20000
    v_and_b32 v156, 31, v0
    v_lshlrev_b32 v156, 4, v156
    v_lshl_add_u32 v156, v4, 9, v156
    v_bfe_u32 v157, v0, 5, 1
    v_mul_u32_u24 v157, 4096, v157
    v_add_u32 v156, v156, v157
    s_mov_b32 s60, 0
    s_mov_b32 s61, 16384
    s_mov_b32 s62, 32768
    s_mov_b32 s63, 49152
    buffer_load_dwordx4 v[160:163], v156, s[16:19], s60 offen
    buffer_load_dwordx4 v[164:167], v156, s[16:19], s61 offen
    buffer_load_dwordx4 v[168:171], v156, s[16:19], s62 offen
    buffer_load_dwordx4 v[172:175], v156, s[16:19], s63 offen
    v_and_b32 v156, 31, v0
    v_lshlrev_b32 v156, 4, v156
    v_lshl_add_u32 v156, v4, 9, v156
    v_bfe_u32 v157, v0, 5, 1
    v_mul_u32_u24 v157, 0, v157
    v_add_u32 v156, v156, v157
    s_mov_b32 s60, 8192
    s_mov_b32 s61, 24576
    s_mov_b32 s62, 40960
    s_mov_b32 s63, 57344
    buffer_load_dwordx4 v[176:179], v156, s[16:19], s60 offen
    buffer_load_dwordx4 v[180:183], v156, s[16:19], s61 offen
    buffer_load_dwordx4 v[184:187], v156, s[16:19], s62 offen
    buffer_load_dwordx4 v[188:191], v156, s[16:19], s63 offen
    s_add_u32 s24, s8, 83886080
    s_addc_u32 s25, s9, 0
    s_mov_b32 s26, 16777216
    s_mov_b32 s27, 0x20000
    s_mov_b32 s28, 4194304
    s_mov_b32 s29, 8388608
    s_mov_b32 s30, 12582912
    buffer_load_dwordx4 v[100:103], v6, s[24:27], 0 offen
    buffer_load_dwordx4 v[104:107], v8, s[24:27], 0 offen
    buffer_load_dwordx4 v[108:111], v6, s[24:27], s28 offen
    buffer_load_dwordx4 v[112:115], v8, s[24:27], s28 offen
    buffer_load_dwordx4 v[116:119], v6, s[24:27], s29 offen
    buffer_load_dwordx4 v[120:123], v8, s[24:27], s29 offen
    buffer_load_dwordx4 v[124:127], v6, s[24:27], s30 offen
    buffer_load_dwordx4 v[128:131], v8, s[24:27], s30 offen
    s_mov_b32 s12, s4
    s_mov_b32 s13, s5
    s_mov_b32 s14, 4194304
    s_mov_b32 s15, 0x20000
    buffer_load_dwordx4 v[12:15], v7, s[12:15], 0 offen
    buffer_load_dwordx4 v[16:19], v7, s[12:15], 0 offen offset:128
    s_add_u32 s20, s8, 1048576
    s_addc_u32 s21, s9, 0
    s_mov_b32 s22, 4194304
    s_mov_b32 s23, 0x20000
    s_add_u32 s44, s8, 33554432
    s_addc_u32 s45, s9, 0
    s_mov_b32 s46, 4194304
    s_mov_b32 s47, 0x20000
    s_mov_b32 s33, 0xffff0000
    s_waitcnt vmcnt(10)
    v_add_f32 v160, v160, v164
    v_add_f32 v168, v168, v172
    v_add_f32 v161, v161, v165
    v_add_f32 v169, v169, v173
    v_add_f32 v162, v162, v166
    v_add_f32 v170, v170, v174
    v_add_f32 v163, v163, v167
    v_add_f32 v171, v171, v175
    v_add_f32 v160, v160, v168
    v_add_f32 v161, v161, v169
    v_add_f32 v162, v162, v170
    v_add_f32 v163, v163, v171
    v_add_f32 v176, v176, v180
    v_add_f32 v184, v184, v188
    v_add_f32 v177, v177, v181
    v_add_f32 v185, v185, v189
    v_add_f32 v178, v178, v182
    v_add_f32 v186, v186, v190
    v_add_f32 v179, v179, v183
    v_add_f32 v187, v187, v191
    v_add_f32 v176, v176, v184
    v_add_f32 v177, v177, v185
    v_add_f32 v178, v178, v186
    v_add_f32 v179, v179, v187
    v_and_b32 v156, 63, v0
    v_lshlrev_b32 v156, 4, v156
    v_lshl_add_u32 v156, v4, 10, v156
    ds_write_b128 v156, v[160:163] offset:1024
    v_and_b32 v157, 63, v0
    v_lshlrev_b32 v157, 4, v157
    v_lshl_add_u32 v157, v4, 10, v157
    ds_write_b128 v157, v[176:179] offset:9216
    s_waitcnt lgkmcnt(0)
    v_lshlrev_b32 v156, 5, v3
    v_lshl_add_u32 v156, v4, 10, v156
    ds_read_b128 v[132:135], v156 offset:1024
    ds_read_b128 v[136:139], v156 offset:1040
    ds_read_b128 v[140:143], v156 offset:1280
    ds_read_b128 v[144:147], v156 offset:1296
    v_lshlrev_b32 v157, 5, v3
    v_lshl_add_u32 v157, v4, 10, v157
    ds_read_b128 v[68:71], v157 offset:1536
    ds_read_b128 v[72:75], v157 offset:1552
    ds_read_b128 v[76:79], v157 offset:1792
    ds_read_b128 v[80:83], v157 offset:1808
    v_lshlrev_b32 v158, 5, v3
    v_lshl_add_u32 v158, v4, 10, v158
    ds_read_b128 v[52:55], v158 offset:9216
    ds_read_b128 v[56:59], v158 offset:9232
    ds_read_b128 v[60:63], v158 offset:9472
    ds_read_b128 v[64:67], v158 offset:9488
    s_waitcnt vmcnt(0) lgkmcnt(0)
    v_lshlrev_b32 v84, 16, v100
    v_and_b32 v85, s33, v100
    v_lshlrev_b32 v86, 16, v101
    v_and_b32 v87, s33, v101
    v_lshlrev_b32 v88, 16, v102
    v_and_b32 v89, s33, v102
    v_lshlrev_b32 v90, 16, v103
    v_and_b32 v91, s33, v103
    v_lshlrev_b32 v92, 16, v104
    v_and_b32 v93, s33, v104
    v_lshlrev_b32 v94, 16, v105
    v_and_b32 v95, s33, v105
    v_lshlrev_b32 v96, 16, v106
    v_and_b32 v97, s33, v106
    v_lshlrev_b32 v98, 16, v107
    v_and_b32 v99, s33, v107
    v_lshlrev_b32 v40, 16, v108
    v_and_b32 v41, s33, v108
    v_add_f32 v84, v84, v40
    v_add_f32 v85, v85, v41
    v_lshlrev_b32 v40, 16, v109
    v_and_b32 v41, s33, v109
    v_add_f32 v86, v86, v40
    v_add_f32 v87, v87, v41
    v_lshlrev_b32 v40, 16, v110
    v_and_b32 v41, s33, v110
    v_add_f32 v88, v88, v40
    v_add_f32 v89, v89, v41
    v_lshlrev_b32 v40, 16, v111
    v_and_b32 v41, s33, v111
    v_add_f32 v90, v90, v40
    v_add_f32 v91, v91, v41
    v_lshlrev_b32 v40, 16, v112
    v_and_b32 v41, s33, v112
    v_add_f32 v92, v92, v40
    v_add_f32 v93, v93, v41
    v_lshlrev_b32 v40, 16, v113
    v_and_b32 v41, s33, v113
    v_add_f32 v94, v94, v40
    v_add_f32 v95, v95, v41
    v_lshlrev_b32 v40, 16, v114
    v_and_b32 v41, s33, v114
    v_add_f32 v96, v96, v40
    v_add_f32 v97, v97, v41
    v_lshlrev_b32 v40, 16, v115
    v_and_b32 v41, s33, v115
    v_add_f32 v98, v98, v40
    v_add_f32 v99, v99, v41
    v_lshlrev_b32 v40, 16, v116
    v_and_b32 v41, s33, v116
    v_add_f32 v84, v84, v40
    v_add_f32 v85, v85, v41
    v_lshlrev_b32 v40, 16, v117
    v_and_b32 v41, s33, v117
    v_add_f32 v86, v86, v40
    v_add_f32 v87, v87, v41
    v_lshlrev_b32 v40, 16, v118
    v_and_b32 v41, s33, v118
    v_add_f32 v88, v88, v40
    v_add_f32 v89, v89, v41
    v_lshlrev_b32 v40, 16, v119
    v_and_b32 v41, s33, v119
    v_add_f32 v90, v90, v40
    v_add_f32 v91, v91, v41
    v_lshlrev_b32 v40, 16, v120
    v_and_b32 v41, s33, v120
    v_add_f32 v92, v92, v40
    v_add_f32 v93, v93, v41
    v_lshlrev_b32 v40, 16, v121
    v_and_b32 v41, s33, v121
    v_add_f32 v94, v94, v40
    v_add_f32 v95, v95, v41
    v_lshlrev_b32 v40, 16, v122
    v_and_b32 v41, s33, v122
    v_add_f32 v96, v96, v40
    v_add_f32 v97, v97, v41
    v_lshlrev_b32 v40, 16, v123
    v_and_b32 v41, s33, v123
    v_add_f32 v98, v98, v40
    v_add_f32 v99, v99, v41
    v_lshlrev_b32 v40, 16, v124
    v_and_b32 v41, s33, v124
    v_add_f32 v84, v84, v40
    v_add_f32 v85, v85, v41
    v_lshlrev_b32 v40, 16, v125
    v_and_b32 v41, s33, v125
    v_add_f32 v86, v86, v40
    v_add_f32 v87, v87, v41
    v_lshlrev_b32 v40, 16, v126
    v_and_b32 v41, s33, v126
    v_add_f32 v88, v88, v40
    v_add_f32 v89, v89, v41
    v_lshlrev_b32 v40, 16, v127
    v_and_b32 v41, s33, v127
    v_add_f32 v90, v90, v40
    v_add_f32 v91, v91, v41
    v_lshlrev_b32 v40, 16, v128
    v_and_b32 v41, s33, v128
    v_add_f32 v92, v92, v40
    v_add_f32 v93, v93, v41
    v_lshlrev_b32 v40, 16, v129
    v_and_b32 v41, s33, v129
    v_add_f32 v94, v94, v40
    v_add_f32 v95, v95, v41
    v_lshlrev_b32 v40, 16, v130
    v_and_b32 v41, s33, v130
    v_add_f32 v96, v96, v40
    v_add_f32 v97, v97, v41
    v_lshlrev_b32 v40, 16, v131
    v_and_b32 v41, s33, v131
    v_add_f32 v98, v98, v40
    v_add_f32 v99, v99, v41
    v_lshlrev_b32 v20, 16, v12
    v_and_b32 v21, s33, v12
    v_lshlrev_b32 v22, 16, v13
    v_and_b32 v23, s33, v13
    v_lshlrev_b32 v24, 16, v14
    v_and_b32 v25, s33, v14
    v_lshlrev_b32 v26, 16, v15
    v_and_b32 v27, s33, v15
    v_lshlrev_b32 v28, 16, v16
    v_and_b32 v29, s33, v16
    v_lshlrev_b32 v30, 16, v17
    v_and_b32 v31, s33, v17
    v_lshlrev_b32 v32, 16, v18
    v_and_b32 v33, s33, v18
    v_lshlrev_b32 v34, 16, v19
    v_and_b32 v35, s33, v19
    v_fmac_f32 v20, v132, v84
    v_fmac_f32 v21, v133, v85
    v_fmac_f32 v22, v134, v86
    v_fmac_f32 v23, v135, v87
    v_fmac_f32 v24, v136, v88
    v_fmac_f32 v25, v137, v89
    v_fmac_f32 v26, v138, v90
    v_fmac_f32 v27, v139, v91
    v_fmac_f32 v28, v140, v92
    v_fmac_f32 v29, v141, v93
    v_fmac_f32 v30, v142, v94
    v_fmac_f32 v31, v143, v95
    v_fmac_f32 v32, v144, v96
    v_fmac_f32 v33, v145, v97
    v_fmac_f32 v34, v146, v98
    v_fmac_f32 v35, v147, v99
    v_cvt_pk_bf16_f32 v12, v20, v21
    v_cvt_pk_bf16_f32 v13, v22, v23
    v_cvt_pk_bf16_f32 v14, v24, v25
    v_cvt_pk_bf16_f32 v15, v26, v27
    v_cvt_pk_bf16_f32 v16, v28, v29
    v_cvt_pk_bf16_f32 v17, v30, v31
    v_cvt_pk_bf16_f32 v18, v32, v33
    v_cvt_pk_bf16_f32 v19, v34, v35
    buffer_store_dwordx4 v[12:15], v6, s[44:47], 0 offen sc1
    buffer_store_dwordx4 v[16:19], v8, s[44:47], 0 offen sc1
    v_add_f32 v36, v20, v21
    v_add_f32 v37, v22, v23
    v_add_f32 v36, v36, v24
    v_add_f32 v36, v36, v25
    v_add_f32 v37, v37, v26
    v_add_f32 v37, v37, v27
    v_add_f32 v36, v36, v28
    v_add_f32 v36, v36, v29
    v_add_f32 v37, v37, v30
    v_add_f32 v37, v37, v31
    v_add_f32 v36, v36, v32
    v_add_f32 v36, v36, v33
    v_add_f32 v37, v37, v34
    v_add_f32 v37, v37, v35
    v_add_f32 v36, v36, v37
    s_nop 1
    v_add_f32_dpp v36, v36, v36 row_ror:8 row_mask:0xf bank_mask:0xf
    v_mov_b32 v38, v36
    s_nop 1
    v_permlane16_swap_b32 v36, v38
    s_nop 1
    v_add_f32 v36, v36, v38
    v_mov_b32 v38, v36
    s_nop 1
    v_permlane32_swap_b32 v36, v38
    s_nop 1
    v_add_f32 v36, v36, v38
    v_mul_f32 v36, 0x3c000000, v36
    v_sub_f32 v84, v20, v36
    v_sub_f32 v85, v21, v36
    v_sub_f32 v86, v22, v36
    v_sub_f32 v87, v23, v36
    v_sub_f32 v88, v24, v36
    v_sub_f32 v89, v25, v36
    v_sub_f32 v90, v26, v36
    v_sub_f32 v91, v27, v36
    v_sub_f32 v92, v28, v36
    v_sub_f32 v93, v29, v36
    v_sub_f32 v94, v30, v36
    v_sub_f32 v95, v31, v36
    v_sub_f32 v96, v32, v36
    v_sub_f32 v97, v33, v36
    v_sub_f32 v98, v34, v36
    v_sub_f32 v99, v35, v36
    v_mul_f32 v37, v84, v84
    v_mul_f32 v39, v85, v85
    v_fmac_f32 v37, v86, v86
    v_fmac_f32 v39, v87, v87
    v_fmac_f32 v37, v88, v88
    v_fmac_f32 v39, v89, v89
    v_fmac_f32 v37, v90, v90
    v_fmac_f32 v39, v91, v91
    v_fmac_f32 v37, v92, v92
    v_fmac_f32 v39, v93, v93
    v_fmac_f32 v37, v94, v94
    v_fmac_f32 v39, v95, v95
    v_fmac_f32 v37, v96, v96
    v_fmac_f32 v39, v97, v97
    v_fmac_f32 v37, v98, v98
    v_fmac_f32 v39, v99, v99
    v_add_f32 v37, v37, v39
    s_nop 1
    v_add_f32_dpp v37, v37, v37 row_ror:8 row_mask:0xf bank_mask:0xf
    v_mov_b32 v38, v37
    s_nop 1
    v_permlane16_swap_b32 v37, v38
    s_nop 1
    v_add_f32 v37, v37, v38
    v_mov_b32 v38, v37
    s_nop 1
    v_permlane32_swap_b32 v37, v38
    s_nop 1
    v_add_f32 v37, v37, v38
    v_lshlrev_b32 v40, 6, v1
    v_lshl_add_u32 v41, v4, 3, v40
    v_and_b32 v42, 63, v0
    v_cmp_gt_u32 vcc, 8, v42
    s_and_saveexec_b64 s[30:31], vcc
    ds_write_b64 v41, v[36:37]
    s_mov_b64 exec, s[30:31]
    s_waitcnt lgkmcnt(0)
    s_barrier
    ds_read_b128 v[84:87], v40
    ds_read_b128 v[88:91], v40 offset:16
    ds_read_b128 v[92:95], v40 offset:32
    ds_read_b128 v[96:99], v40 offset:48
    s_waitcnt lgkmcnt(0)
    v_add_f32 v36, v84, v86
    v_add_f32 v36, v36, v88
    v_add_f32 v36, v36, v90
    v_add_f32 v36, v36, v92
    v_add_f32 v36, v36, v94
    v_add_f32 v36, v36, v96
    v_add_f32 v36, v36, v98
    v_mul_f32 v36, 0x3e000000, v36
    v_add_f32 v37, v85, v87
    v_add_f32 v37, v37, v89
    v_add_f32 v37, v37, v91
    v_add_f32 v37, v37, v93
    v_add_f32 v37, v37, v95
    v_add_f32 v37, v37, v97
    v_add_f32 v37, v37, v99
    v_sub_f32 v84, v84, v36
    v_sub_f32 v86, v86, v36
    v_sub_f32 v88, v88, v36
    v_sub_f32 v90, v90, v36
    v_sub_f32 v92, v92, v36
    v_sub_f32 v94, v94, v36
    v_sub_f32 v96, v96, v36
    v_sub_f32 v98, v98, v36
    v_mul_f32 v38, v84, v84
    v_fmac_f32 v38, v86, v86
    v_fmac_f32 v38, v88, v88
    v_fmac_f32 v38, v90, v90
    v_fmac_f32 v38, v92, v92
    v_fmac_f32 v38, v94, v94
    v_fmac_f32 v38, v96, v96
    v_fmac_f32 v38, v98, v98
    v_mov_b32 v39, 0x43000000
    v_fmac_f32 v37, v39, v38
    v_mov_b32 v39, 0x3727c5ac
    v_fmac_f32 v39, 0x3a800000, v37
    v_rsq_f32 v39, v39
    s_nop 0
    v_sub_f32 v20, v20, v36
    v_sub_f32 v21, v21, v36
    v_sub_f32 v22, v22, v36
    v_sub_f32 v23, v23, v36
    v_sub_f32 v24, v24, v36
    v_sub_f32 v25, v25, v36
    v_sub_f32 v26, v26, v36
    v_sub_f32 v27, v27, v36
    v_sub_f32 v28, v28, v36
    v_sub_f32 v29, v29, v36
    v_sub_f32 v30, v30, v36
    v_sub_f32 v31, v31, v36
    v_sub_f32 v32, v32, v36
    v_sub_f32 v33, v33, v36
    v_sub_f32 v34, v34, v36
    v_sub_f32 v35, v35, v36
    v_add_f32 v52, 1.0, v52
    v_add_f32 v53, 1.0, v53
    v_add_f32 v54, 1.0, v54
    v_add_f32 v55, 1.0, v55
    v_add_f32 v56, 1.0, v56
    v_add_f32 v57, 1.0, v57
    v_add_f32 v58, 1.0, v58
    v_add_f32 v59, 1.0, v59
    v_add_f32 v60, 1.0, v60
    v_add_f32 v61, 1.0, v61
    v_add_f32 v62, 1.0, v62
    v_add_f32 v63, 1.0, v63
    v_add_f32 v64, 1.0, v64
    v_add_f32 v65, 1.0, v65
    v_add_f32 v66, 1.0, v66
    v_add_f32 v67, 1.0, v67
    v_mul_f32 v20, v20, v39
    v_mul_f32 v21, v21, v39
    v_mul_f32 v22, v22, v39
    v_mul_f32 v23, v23, v39
    v_mul_f32 v24, v24, v39
    v_mul_f32 v25, v25, v39
    v_mul_f32 v26, v26, v39
    v_mul_f32 v27, v27, v39
    v_mul_f32 v28, v28, v39
    v_mul_f32 v29, v29, v39
    v_mul_f32 v30, v30, v39
    v_mul_f32 v31, v31, v39
    v_mul_f32 v32, v32, v39
    v_mul_f32 v33, v33, v39
    v_mul_f32 v34, v34, v39
    v_mul_f32 v35, v35, v39
    v_fmac_f32 v68, v20, v52
    v_fmac_f32 v69, v21, v53
    v_fmac_f32 v70, v22, v54
    v_fmac_f32 v71, v23, v55
    v_fmac_f32 v72, v24, v56
    v_fmac_f32 v73, v25, v57
    v_fmac_f32 v74, v26, v58
    v_fmac_f32 v75, v27, v59
    v_fmac_f32 v76, v28, v60
    v_fmac_f32 v77, v29, v61
    v_fmac_f32 v78, v30, v62
    v_fmac_f32 v79, v31, v63
    v_fmac_f32 v80, v32, v64
    v_fmac_f32 v81, v33, v65
    v_fmac_f32 v82, v34, v66
    v_fmac_f32 v83, v35, v67
    v_cvt_pk_bf16_f32 v12, v68, v69
    v_cvt_pk_bf16_f32 v13, v70, v71
    v_cvt_pk_bf16_f32 v14, v72, v73
    v_cvt_pk_bf16_f32 v15, v74, v75
    v_cvt_pk_bf16_f32 v16, v76, v77
    v_cvt_pk_bf16_f32 v17, v78, v79
    v_cvt_pk_bf16_f32 v18, v80, v81
    v_cvt_pk_bf16_f32 v19, v82, v83
    buffer_store_dwordx4 v[12:15], v6, s[20:23], 0 offen sc1
    buffer_store_dwordx4 v[16:19], v8, s[20:23], 0 offen sc1
    s_cmp_lg_u32 s2, 0
    s_cbranch_scc1 L_ln2_kernel_nofin
    v_and_b32 v156, 31, v0
    v_lshlrev_b32 v156, 4, v156
    v_lshl_add_u32 v156, v4, 9, v156
    v_bfe_u32 v157, v0, 5, 1
    v_mul_u32_u24 v157, 0, v157
    v_add_u32 v156, v156, v157
    s_mov_b32 s60, 12288
    s_mov_b32 s61, 28672
    s_mov_b32 s62, 45056
    s_mov_b32 s63, 61440
    buffer_load_dwordx4 v[160:163], v156, s[16:19], s60 offen
    buffer_load_dwordx4 v[164:167], v156, s[16:19], s61 offen
    buffer_load_dwordx4 v[168:171], v156, s[16:19], s62 offen
    buffer_load_dwordx4 v[172:175], v156, s[16:19], s63 offen
    s_add_u32 s48, s8, 245760
    s_addc_u32 s49, s9, 0
    s_mov_b32 s50, 4096
    s_mov_b32 s51, 0x20000
    s_add_u32 s52, s8, 229376
    s_addc_u32 s53, s9, 0
    s_mov_b32 s54, 16384
    s_mov_b32 s55, 0x20000
    s_waitcnt vmcnt(0)
    v_add_f32 v160, v160, v164
    v_add_f32 v168, v168, v172
    v_add_f32 v161, v161, v165
    v_add_f32 v169, v169, v173
    v_add_f32 v162, v162, v166
    v_add_f32 v170, v170, v174
    v_add_f32 v163, v163, v167
    v_add_f32 v171, v171, v175
    v_add_f32 v160, v160, v168
    v_add_f32 v161, v161, v169
    v_add_f32 v162, v162, v170
    v_add_f32 v163, v163, v171
    v_and_b32 v156, 31, v0
    v_lshlrev_b32 v156, 4, v156
    v_lshl_add_u32 v156, v4, 9, v156
    buffer_store_dwordx4 v[160:163], v156, s[48:51], 0 offen
    v_mov_b32 v164, 0
    v_mov_b32 v165, 0
    v_mov_b32 v166, 0
    v_mov_b32 v167, 0
    v_lshlrev_b32 v157, 4, v0
    buffer_store_dwordx4 v[164:167], v157, s[52:55], 0 offen
    v_add_u32 v157, 8192, v157
    buffer_store_dwordx4 v[164:167], v157, s[52:55], 0 offen
L_ln2_kernel_nofin:
L_ln2_kernel_done:
    s_endpgm
.globl ffn1_kernel
.p2align 8
.type ffn1_kernel,@function
ffn1_kernel:
    s_cmp_ge_u32 s2, 224
    s_cbranch_scc1 L_ffn1_kernel_done
    s_load_dwordx2 s[4:5], s[0:1], 48
    s_load_dwordx2 s[6:7], s[0:1], 96
    s_load_dwordx4 s[60:63], s[0:1], 48
    s_load_dwordx2 s[8:9], s[0:1], 80
    v_lshrrev_b32 v2, 6, v0
    v_and_b32 v1, 63, v0
    v_readfirstlane_b32 s20, v2
    v_lshlrev_b32 v2, 4, v1
    s_and_b32 s21, s2, 7
    s_lshr_b32 s22, s2, 3
    s_and_b32 s23, s21, 3
    s_lshr_b32 s24, s21, 2
    s_lshl_b32 s24, s24, 2
    s_mul_i32 s25, s22, 37
    s_lshr_b32 s25, s25, 8
    s_add_u32 s24, s24, s25
    s_mul_i32 s25, s25, 7
    s_sub_u32 s25, s22, s25
    s_mul_i32 s26, s23, 7
    s_add_u32 s25, s25, s26
    s_mov_b32 s26, 0
    s_mov_b32 s27, 0
    s_lshl_b32 s24, s24, 3
    s_lshl_b32 s31, s20, 1
    s_add_u32 s24, s24, s31
    v_add_u32 v3, 65536, v2
    v_lshrrev_b32 v32, 4, v1
    v_and_b32 v33, 15, v1
    v_lshlrev_b32 v34, 1, v32
    v_xor_b32 v34, v33, v34
    v_xor_b32 v36, 8, v34
    v_lshlrev_b32 v34, 4, v34
    v_lshlrev_b32 v36, 4, v36
    v_mul_u32_u24 v35, 7168, v32
    v_add_u32 v4, v35, v34
    v_add_u32 v5, 27648, v4
    v_add_u32 v6, v35, v36
    v_add_u32 v7, 82944, v6
    v_add_u32 v6, 55296, v6
    v_lshrrev_b32 v16, 4, v1
    v_lshlrev_b32 v16, 9, v16
    v_and_b32 v17, 15, v1
    v_lshl_add_u32 v16, v17, 4, v16
    v_add_u32 v17, 65536, v16
    s_waitcnt lgkmcnt(0)
    s_mov_b32 s12, s4
    s_mov_b32 s13, s5
    s_mov_b32 s14, 7340032
    s_mov_b32 s15, 0x20000
    s_mul_i32 s31, s24, 65536
    s_add_u32 s31, s31, s27
    s_add_u32 s31, s31, 1048576
    s_add_u32 s16, s6, s31
    s_addc_u32 s17, s7, 0
    s_mov_b32 s18, 131072
    s_mov_b32 s19, 0x20000
    s_lshl_b32 s31, s20, 4
    s_add_u32 s31, s31, s26
    s_mul_i32 s28, s31, 7168
    s_lshl_b32 s31, s25, 8
    s_add_u32 s28, s28, s31
    s_mov_b32 s29, 0
    s_lshl_b32 s30, s20, 12
    s_add_u32 m0, s30, 0
    s_nop 0
    buffer_load_dwordx4 v4, s[12:15], s28 offen offset:0 lds
    buffer_load_dwordx4 a[0:3], v16, s[16:19], s29 offen offset:0
    buffer_load_dwordx4 a[4:7], v16, s[16:19], s29 offen offset:256
    buffer_load_dwordx4 v5, s[12:15], s28 offen offset:1024 lds
    buffer_load_dwordx4 a[8:11], v17, s[16:19], s29 offen offset:0
    buffer_load_dwordx4 a[12:15], v17, s[16:19], s29 offen offset:256
    buffer_load_dwordx4 v6, s[12:15], s28 offen offset:2048 lds
    buffer_load_dwordx4 a[16:19], v16, s[16:19], s29 offen offset:2048
    buffer_load_dwordx4 a[20:23], v16, s[16:19], s29 offen offset:2304
    buffer_load_dwordx4 v7, s[12:15], s28 offen offset:3072 lds
    buffer_load_dwordx4 a[24:27], v17, s[16:19], s29 offen offset:2048
    buffer_load_dwordx4 a[28:31], v17, s[16:19], s29 offen offset:2304
    v_lshrrev_b32 v32, 4, v1
    v_bfe_u32 v33, v1, 2, 2
    v_lshl_add_u32 v34, v32, 3, v33
    v_and_b32 v35, 1, v32
    v_lshl_or_b32 v35, v35, 2, v33
    v_bfe_u32 v36, v1, 1, 1
    v_lshlrev_b32 v36, 4, v36
    v_and_b32 v37, 1, v1
    v_lshl_or_b32 v36, v37, 3, v36
    v_lshl_add_u32 v36, v34, 8, v36
    v_xor_b32 v37, 0, v35
    v_lshl_add_u32 v200, v37, 5, v36
    v_add_u32 v208, 65536, v200
    v_xor_b32 v37, 1, v35
    v_lshl_add_u32 v201, v37, 5, v36
    v_add_u32 v209, 65536, v201
    v_xor_b32 v37, 2, v35
    v_lshl_add_u32 v202, v37, 5, v36
    v_add_u32 v210, 65536, v202
    v_xor_b32 v37, 3, v35
    v_lshl_add_u32 v203, v37, 5, v36
    v_add_u32 v211, 65536, v203
    v_xor_b32 v37, 4, v35
    v_lshl_add_u32 v204, v37, 5, v36
    v_add_u32 v212, 65536, v204
    v_xor_b32 v37, 5, v35
    v_lshl_add_u32 v205, v37, 5, v36
    v_add_u32 v213, 65536, v205
    v_xor_b32 v37, 6, v35
    v_lshl_add_u32 v206, v37, 5, v36
    v_add_u32 v214, 65536, v206
    v_xor_b32 v37, 7, v35
    v_lshl_add_u32 v207, v37, 5, v36
    v_add_u32 v215, 65536, v207
    s_add_u32 s28, s28, 458752
    s_add_u32 m0, s30, 16384
    s_nop 0
    buffer_load_dwordx4 v4, s[12:15], s28 offen offset:0 lds
    s_mov_b32 s29, 4096
    buffer_load_dwordx4 a[32:35], v16, s[16:19], s29 offen offset:0
    buffer_load_dwordx4 a[36:39], v16, s[16:19], s29 offen offset:256
    buffer_load_dwordx4 v5, s[12:15], s28 offen offset:1024 lds
    buffer_load_dwordx4 a[40:43], v17, s[16:19], s29 offen offset:0
    buffer_load_dwordx4 a[44:47], v17, s[16:19], s29 offen offset:256
    buffer_load_dwordx4 v6, s[12:15], s28 offen offset:2048 lds
    buffer_load_dwordx4 a[48:51], v16, s[16:19], s29 offen offset:2048
    buffer_load_dwordx4 a[52:55], v16, s[16:19], s29 offen offset:2304
    buffer_load_dwordx4 v7, s[12:15], s28 offen offset:3072 lds
    buffer_load_dwordx4 a[56:59], v17, s[16:19], s29 offen offset:2048
    buffer_load_dwordx4 a[60:63], v17, s[16:19], s29 offen offset:2304
    v_mov_b32 v64, 0
    v_mov_b32 v65, 0
    v_mov_b32 v66, 0
    v_mov_b32 v67, 0
    v_mov_b32 v68, 0
    v_mov_b32 v69, 0
    v_mov_b32 v70, 0
    v_mov_b32 v71, 0
    v_mov_b32 v72, 0
    v_mov_b32 v73, 0
    v_mov_b32 v74, 0
    v_mov_b32 v75, 0
    v_mov_b32 v76, 0
    v_mov_b32 v77, 0
    v_mov_b32 v78, 0
    v_mov_b32 v79, 0
    v_mov_b32 v80, 0
    v_mov_b32 v81, 0
    v_mov_b32 v82, 0
    v_mov_b32 v83, 0
    v_mov_b32 v84, 0
    v_mov_b32 v85, 0
    v_mov_b32 v86, 0
    v_mov_b32 v87, 0
    v_mov_b32 v88, 0
    v_mov_b32 v89, 0
    v_mov_b32 v90, 0
    v_mov_b32 v91, 0
    v_mov_b32 v92, 0
    v_mov_b32 v93, 0
    v_mov_b32 v94, 0
    v_mov_b32 v95, 0
    v_mov_b32 v96, 0
    v_mov_b32 v97, 0
    v_mov_b32 v98, 0
    v_mov_b32 v99, 0
    v_mov_b32 v100, 0
    v_mov_b32 v101, 0
    v_mov_b32 v102, 0
    v_mov_b32 v103, 0
    v_mov_b32 v104, 0
    v_mov_b32 v105, 0
    v_mov_b32 v106, 0
    v_mov_b32 v107, 0
    v_mov_b32 v108, 0
    v_mov_b32 v109, 0
    v_mov_b32 v110, 0
    v_mov_b32 v111, 0
    v_mov_b32 v112, 0
    v_mov_b32 v113, 0
    v_mov_b32 v114, 0
    v_mov_b32 v115, 0
    v_mov_b32 v116, 0
    v_mov_b32 v117, 0
    v_mov_b32 v118, 0
    v_mov_b32 v119, 0
    v_mov_b32 v120, 0
    v_mov_b32 v121, 0
    v_mov_b32 v122, 0
    v_mov_b32 v123, 0
    v_mov_b32 v124, 0
    v_mov_b32 v125, 0
    v_mov_b32 v126, 0
    v_mov_b32 v127, 0
    v_mov_b32 v128, 0
    v_mov_b32 v129, 0
    v_mov_b32 v130, 0
    v_mov_b32 v131, 0
    v_mov_b32 v132, 0
    v_mov_b32 v133, 0
    v_mov_b32 v134, 0
    v_mov_b32 v135, 0
    v_mov_b32 v136, 0
    v_mov_b32 v137, 0
    v_mov_b32 v138, 0
    v_mov_b32 v139, 0
    v_mov_b32 v140, 0
    v_mov_b32 v141, 0
    v_mov_b32 v142, 0
    v_mov_b32 v143, 0
    v_mov_b32 v144, 0
    v_mov_b32 v145, 0
    v_mov_b32 v146, 0
    v_mov_b32 v147, 0
    v_mov_b32 v148, 0
    v_mov_b32 v149, 0
    v_mov_b32 v150, 0
    v_mov_b32 v151, 0
    v_mov_b32 v152, 0
    v_mov_b32 v153, 0
    v_mov_b32 v154, 0
    v_mov_b32 v155, 0
    v_mov_b32 v156, 0
    v_mov_b32 v157, 0
    v_mov_b32 v158, 0
    v_mov_b32 v159, 0
    v_mov_b32 v160, 0
    v_mov_b32 v161, 0
    v_mov_b32 v162, 0
    v_mov_b32 v163, 0
    v_mov_b32 v164, 0
    v_mov_b32 v165, 0
    v_mov_b32 v166, 0
    v_mov_b32 v167, 0
    v_mov_b32 v168, 0
    v_mov_b32 v169, 0
    v_mov_b32 v170, 0
    v_mov_b32 v171, 0
    v_mov_b32 v172, 0
    v_mov_b32 v173, 0
    v_mov_b32 v174, 0
    v_mov_b32 v175, 0
    v_mov_b32 v176, 0
    v_mov_b32 v177, 0
    v_mov_b32 v178, 0
    v_mov_b32 v179, 0
    v_mov_b32 v180, 0
    v_mov_b32 v181, 0
    v_mov_b32 v182, 0
    v_mov_b32 v183, 0
    v_mov_b32 v184, 0
    v_mov_b32 v185, 0
    v_mov_b32 v186, 0
    v_mov_b32 v187, 0
    v_mov_b32 v188, 0
    v_mov_b32 v189, 0
    v_mov_b32 v190, 0
    v_mov_b32 v191, 0
    s_add_u32 s40, s6, 16777216
    s_addc_u32 s41, s7, 0
    s_mov_b32 s42, 14680064
    s_mov_b32 s43, 0x20000
    s_mul_i32 s26, s24, 229376
    s_lshl_b32 s27, s25, 13
    s_add_u32 s26, s26, s27
    s_add_u32 s27, s26, 229376
    s_add_u32 s34, s26, 4096
    s_add_u32 s35, s27, 4096
    s_waitcnt vmcnt(12)
    s_barrier
    ds_read_b64_tr_b16 a[192:193], v200 offset:0
    ds_read_b64_tr_b16 a[194:195], v200 offset:1024
    ds_read_b64_tr_b16 a[196:197], v201 offset:0
    ds_read_b64_tr_b16 a[198:199], v201 offset:1024
    ds_read_b64_tr_b16 a[200:201], v202 offset:0
    ds_read_b64_tr_b16 a[202:203], v202 offset:1024
    ds_read_b64_tr_b16 a[204:205], v203 offset:0
    ds_read_b64_tr_b16 a[206:207], v203 offset:1024
    s_waitcnt lgkmcnt(6)
    v_mfma_f32_16x16x32_bf16 v[64:67], a[192:195], a[0:3], v[64:67]
    ds_read_b64_tr_b16 a[208:209], v204 offset:0
    v_mfma_f32_16x16x32_bf16 v[68:71], a[192:195], a[4:7], v[68:71]
    ds_read_b64_tr_b16 a[210:211], v204 offset:1024
    s_add_u32 s28, s28, 458752
    s_add_u32 m0, s30, 32768
    v_mfma_f32_16x16x32_bf16 v[72:75], a[192:195], a[8:11], v[72:75]
    buffer_load_dwordx4 v4, s[12:15], s28 offen offset:0 lds
    v_mfma_f32_16x16x32_bf16 v[76:79], a[192:195], a[12:15], v[76:79]
    s_waitcnt lgkmcnt(6)
    v_mfma_f32_16x16x32_bf16 v[80:83], a[196:199], a[0:3], v[80:83]
    ds_read_b64_tr_b16 a[212:213], v205 offset:0
    v_mfma_f32_16x16x32_bf16 v[84:87], a[196:199], a[4:7], v[84:87]
    ds_read_b64_tr_b16 a[214:215], v205 offset:1024
    s_mov_b32 s29, 8192
    v_mfma_f32_16x16x32_bf16 v[88:91], a[196:199], a[8:11], v[88:91]
    buffer_load_dwordx4 a[64:67], v16, s[16:19], s29 offen offset:0
    v_mfma_f32_16x16x32_bf16 v[92:95], a[196:199], a[12:15], v[92:95]
    s_waitcnt lgkmcnt(6)
    v_mfma_f32_16x16x32_bf16 v[96:99], a[200:203], a[0:3], v[96:99]
    ds_read_b64_tr_b16 a[216:217], v206 offset:0
    v_mfma_f32_16x16x32_bf16 v[100:103], a[200:203], a[4:7], v[100:103]
    ds_read_b64_tr_b16 a[218:219], v206 offset:1024
    v_mfma_f32_16x16x32_bf16 v[104:107], a[200:203], a[8:11], v[104:107]
    buffer_load_dwordx4 a[68:71], v16, s[16:19], s29 offen offset:256
    v_mfma_f32_16x16x32_bf16 v[108:111], a[200:203], a[12:15], v[108:111]
    s_waitcnt lgkmcnt(6)
    v_mfma_f32_16x16x32_bf16 v[112:115], a[204:207], a[0:3], v[112:115]
    ds_read_b64_tr_b16 a[220:221], v207 offset:0
    v_mfma_f32_16x16x32_bf16 v[116:119], a[204:207], a[4:7], v[116:119]
    ds_read_b64_tr_b16 a[222:223], v207 offset:1024
    v_mfma_f32_16x16x32_bf16 v[120:123], a[204:207], a[8:11], v[120:123]
    buffer_load_dwordx4 v5, s[12:15], s28 offen offset:1024 lds
    v_mfma_f32_16x16x32_bf16 v[124:127], a[204:207], a[12:15], v[124:127]
    s_waitcnt lgkmcnt(6)
    v_mfma_f32_16x16x32_bf16 v[128:131], a[208:211], a[0:3], v[128:131]
    ds_read_b64_tr_b16 a[192:193], v200 offset:8192
    v_mfma_f32_16x16x32_bf16 v[132:135], a[208:211], a[4:7], v[132:135]
    ds_read_b64_tr_b16 a[194:195], v200 offset:9216
    v_mfma_f32_16x16x32_bf16 v[136:139], a[208:211], a[8:11], v[136:139]
    buffer_load_dwordx4 a[72:75], v17, s[16:19], s29 offen offset:0
    v_mfma_f32_16x16x32_bf16 v[140:143], a[208:211], a[12:15], v[140:143]
    s_waitcnt lgkmcnt(6)
    v_mfma_f32_16x16x32_bf16 v[144:147], a[212:215], a[0:3], v[144:147]
    ds_read_b64_tr_b16 a[196:197], v201 offset:8192
    v_mfma_f32_16x16x32_bf16 v[148:151], a[212:215], a[4:7], v[148:151]
    ds_read_b64_tr_b16 a[198:199], v201 offset:9216
    v_mfma_f32_16x16x32_bf16 v[152:155], a[212:215], a[8:11], v[152:155]
    buffer_load_dwordx4 a[76:79], v17, s[16:19], s29 offen offset:256
    v_mfma_f32_16x16x32_bf16 v[156:159], a[212:215], a[12:15], v[156:159]
    s_waitcnt lgkmcnt(6)
    v_mfma_f32_16x16x32_bf16 v[160:163], a[216:219], a[0:3], v[160:163]
    ds_read_b64_tr_b16 a[200:201], v202 offset:8192
    v_mfma_f32_16x16x32_bf16 v[164:167], a[216:219], a[4:7], v[164:167]
    ds_read_b64_tr_b16 a[202:203], v202 offset:9216
    v_mfma_f32_16x16x32_bf16 v[168:171], a[216:219], a[8:11], v[168:171]
    buffer_load_dwordx4 v6, s[12:15], s28 offen offset:2048 lds
    v_mfma_f32_16x16x32_bf16 v[172:175], a[216:219], a[12:15], v[172:175]
    s_waitcnt lgkmcnt(6)
    v_mfma_f32_16x16x32_bf16 v[176:179], a[220:223], a[0:3], v[176:179]
    ds_read_b64_tr_b16 a[204:205], v203 offset:8192
    v_mfma_f32_16x16x32_bf16 v[180:183], a[220:223], a[4:7], v[180:183]
    ds_read_b64_tr_b16 a[206:207], v203 offset:9216
    v_mfma_f32_16x16x32_bf16 v[184:187], a[220:223], a[8:11], v[184:187]
    buffer_load_dwordx4 a[80:83], v16, s[16:19], s29 offen offset:2048
    v_mfma_f32_16x16x32_bf16 v[188:191], a[220:223], a[12:15], v[188:191]
    s_waitcnt lgkmcnt(6)
    v_mfma_f32_16x16x32_bf16 v[64:67], a[192:195], a[16:19], v[64:67]
    ds_read_b64_tr_b16 a[208:209], v204 offset:8192
    v_mfma_f32_16x16x32_bf16 v[68:71], a[192:195], a[20:23], v[68:71]
    ds_read_b64_tr_b16 a[210:211], v204 offset:9216
    v_mfma_f32_16x16x32_bf16 v[72:75], a[192:195], a[24:27], v[72:75]
    buffer_load_dwordx4 a[84:87], v16, s[16:19], s29 offen offset:2304
    v_mfma_f32_16x16x32_bf16 v[76:79], a[192:195], a[28:31], v[76:79]
    s_waitcnt lgkmcnt(6)
    v_mfma_f32_16x16x32_bf16 v[80:83], a[196:199], a[16:19], v[80:83]
    ds_read_b64_tr_b16 a[212:213], v205 offset:8192
    v_mfma_f32_16x16x32_bf16 v[84:87], a[196:199], a[20:23], v[84:87]
    ds_read_b64_tr_b16 a[214:215], v205 offset:9216
    v_mfma_f32_16x16x32_bf16 v[88:91], a[196:199], a[24:27], v[88:91]
    buffer_load_dwordx4 v7, s[12:15], s28 offen offset:3072 lds
    v_mfma_f32_16x16x32_bf16 v[92:95], a[196:199], a[28:31], v[92:95]
    s_waitcnt lgkmcnt(6)
    v_mfma_f32_16x16x32_bf16 v[96:99], a[200:203], a[16:19], v[96:99]
    ds_read_b64_tr_b16 a[216:217], v206 offset:8192
    v_mfma_f32_16x16x32_bf16 v[100:103], a[200:203], a[20:23], v[100:103]
    ds_read_b64_tr_b16 a[218:219], v206 offset:9216
    v_mfma_f32_16x16x32_bf16 v[104:107], a[200:203], a[24:27], v[104:107]
    buffer_load_dwordx4 a[88:91], v17, s[16:19], s29 offen offset:2048
    v_mfma_f32_16x16x32_bf16 v[108:111], a[200:203], a[28:31], v[108:111]
    s_waitcnt lgkmcnt(6)
    v_mfma_f32_16x16x32_bf16 v[112:115], a[204:207], a[16:19], v[112:115]
    ds_read_b64_tr_b16 a[220:221], v207 offset:8192
    v_mfma_f32_16x16x32_bf16 v[116:119], a[204:207], a[20:23], v[116:119]
    ds_read_b64_tr_b16 a[222:223], v207 offset:9216
    v_mfma_f32_16x16x32_bf16 v[120:123], a[204:207], a[24:27], v[120:123]
    buffer_load_dwordx4 a[92:95], v17, s[16:19], s29 offen offset:2304
    v_mfma_f32_16x16x32_bf16 v[124:127], a[204:207], a[28:31], v[124:127]
    s_waitcnt vmcnt(12) lgkmcnt(0)
    s_barrier
    v_mfma_f32_16x16x32_bf16 v[128:131], a[208:211], a[16:19], v[128:131]
    ds_read_b64_tr_b16 a[192:193], v200 offset:16384
    v_mfma_f32_16x16x32_bf16 v[132:135], a[208:211], a[20:23], v[132:135]
    ds_read_b64_tr_b16 a[194:195], v200 offset:17408
    s_add_u32 s28, s28, 458752
    s_add_u32 m0, s30, 49152
    v_mfma_f32_16x16x32_bf16 v[136:139], a[208:211], a[24:27], v[136:139]
    buffer_load_dwordx4 v4, s[12:15], s28 offen offset:0 lds
    v_mfma_f32_16x16x32_bf16 v[140:143], a[208:211], a[28:31], v[140:143]
    s_waitcnt lgkmcnt(6)
    v_mfma_f32_16x16x32_bf16 v[144:147], a[212:215], a[16:19], v[144:147]
    ds_read_b64_tr_b16 a[196:197], v201 offset:16384
    v_mfma_f32_16x16x32_bf16 v[148:151], a[212:215], a[20:23], v[148:151]
    ds_read_b64_tr_b16 a[198:199], v201 offset:17408
    s_mov_b32 s29, 12288
    v_mfma_f32_16x16x32_bf16 v[152:155], a[212:215], a[24:27], v[152:155]
    buffer_load_dwordx4 a[96:99], v16, s[16:19], s29 offen offset:0
    v_mfma_f32_16x16x32_bf16 v[156:159], a[212:215], a[28:31], v[156:159]
    s_waitcnt lgkmcnt(6)
    v_mfma_f32_16x16x32_bf16 v[160:163], a[216:219], a[16:19], v[160:163]
    ds_read_b64_tr_b16 a[200:201], v202 offset:16384
    v_mfma_f32_16x16x32_bf16 v[164:167], a[216:219], a[20:23], v[164:167]
    ds_read_b64_tr_b16 a[202:203], v202 offset:17408
    v_mfma_f32_16x16x32_bf16 v[168:171], a[216:219], a[24:27], v[168:171]
    buffer_load_dwordx4 a[100:103], v16, s[16:19], s29 offen offset:256
    v_mfma_f32_16x16x32_bf16 v[172:175], a[216:219], a[28:31], v[172:175]
    s_waitcnt lgkmcnt(6)
    v_mfma_f32_16x16x32_bf16 v[176:179], a[220:223], a[16:19], v[176:179]
    ds_read_b64_tr_b16 a[204:205], v203 offset:16384
    v_mfma_f32_16x16x32_bf16 v[180:183], a[220:223], a[20:23], v[180:183]
    ds_read_b64_tr_b16 a[206:207], v203 offset:17408
    v_mfma_f32_16x16x32_bf16 v[184:187], a[220:223], a[24:27], v[184:187]
    buffer_load_dwordx4 v5, s[12:15], s28 offen offset:1024 lds
    v_mfma_f32_16x16x32_bf16 v[188:191], a[220:223], a[28:31], v[188:191]
    s_waitcnt lgkmcnt(6)
    v_mfma_f32_16x16x32_bf16 v[64:67], a[192:195], a[32:35], v[64:67]
    ds_read_b64_tr_b16 a[208:209], v204 offset:16384
    v_mfma_f32_16x16x32_bf16 v[68:71], a[192:195], a[36:39], v[68:71]
    ds_read_b64_tr_b16 a[210:211], v204 offset:17408
    v_mfma_f32_16x16x32_bf16 v[72:75], a[192:195], a[40:43], v[72:75]
    buffer_load_dwordx4 a[104:107], v17, s[16:19], s29 offen offset:0
    v_mfma_f32_16x16x32_bf16 v[76:79], a[192:195], a[44:47], v[76:79]
    s_waitcnt lgkmcnt(6)
    v_mfma_f32_16x16x32_bf16 v[80:83], a[196:199], a[32:35], v[80:83]
    ds_read_b64_tr_b16 a[212:213], v205 offset:16384
    v_mfma_f32_16x16x32_bf16 v[84:87], a[196:199], a[36:39], v[84:87]
    ds_read_b64_tr_b16 a[214:215], v205 offset:17408
    v_mfma_f32_16x16x32_bf16 v[88:91], a[196:199], a[40:43], v[88:91]
    buffer_load_dwordx4 a[108:111], v17, s[16:19], s29 offen offset:256
    v_mfma_f32_16x16x32_bf16 v[92:95], a[196:199], a[44:47], v[92:95]
    s_waitcnt lgkmcnt(6)
    v_mfma_f32_16x16x32_bf16 v[96:99], a[200:203], a[32:35], v[96:99]
    ds_read_b64_tr_b16 a[216:217], v206 offset:16384
    v_mfma_f32_16x16x32_bf16 v[100:103], a[200:203], a[36:39], v[100:103]
    ds_read_b64_tr_b16 a[218:219], v206 offset:17408
    v_mfma_f32_16x16x32_bf16 v[104:107], a[200:203], a[40:43], v[104:107]
    buffer_load_dwordx4 v6, s[12:15], s28 offen offset:2048 lds
    v_mfma_f32_16x16x32_bf16 v[108:111], a[200:203], a[44:47], v[108:111]
    s_waitcnt lgkmcnt(6)
    v_mfma_f32_16x16x32_bf16 v[112:115], a[204:207], a[32:35], v[112:115]
    ds_read_b64_tr_b16 a[220:221], v207 offset:16384
    v_mfma_f32_16x16x32_bf16 v[116:119], a[204:207], a[36:39], v[116:119]
    ds_read_b64_tr_b16 a[222:223], v207 offset:17408
    v_mfma_f32_16x16x32_bf16 v[120:123], a[204:207], a[40:43], v[120:123]
    buffer_load_dwordx4 a[112:115], v16, s[16:19], s29 offen offset:2048
    v_mfma_f32_16x16x32_bf16 v[124:127], a[204:207], a[44:47], v[124:127]
    s_waitcnt lgkmcnt(6)
    v_mfma_f32_16x16x32_bf16 v[128:131], a[208:211], a[32:35], v[128:131]
    ds_read_b64_tr_b16 a[192:193], v200 offset:24576
    v_mfma_f32_16x16x32_bf16 v[132:135], a[208:211], a[36:39], v[132:135]
    ds_read_b64_tr_b16 a[194:195], v200 offset:25600
    v_mfma_f32_16x16x32_bf16 v[136:139], a[208:211], a[40:43], v[136:139]
    buffer_load_dwordx4 a[116:119], v16, s[16:19], s29 offen offset:2304
    v_mfma_f32_16x16x32_bf16 v[140:143], a[208:211], a[44:47], v[140:143]
    s_waitcnt lgkmcnt(6)
    v_mfma_f32_16x16x32_bf16 v[144:147], a[212:215], a[32:35], v[144:147]
    ds_read_b64_tr_b16 a[196:197], v201 offset:24576
    v_mfma_f32_16x16x32_bf16 v[148:151], a[212:215], a[36:39], v[148:151]
    ds_read_b64_tr_b16 a[198:199], v201 offset:25600
    v_mfma_f32_16x16x32_bf16 v[152:155], a[212:215], a[40:43], v[152:155]
    buffer_load_dwordx4 v7, s[12:15], s28 offen offset:3072 lds
    v_mfma_f32_16x16x32_bf16 v[156:159], a[212:215], a[44:47], v[156:159]
    s_waitcnt lgkmcnt(6)
    v_mfma_f32_16x16x32_bf16 v[160:163], a[216:219], a[32:35], v[160:163]
    ds_read_b64_tr_b16 a[200:201], v202 offset:24576
    v_mfma_f32_16x16x32_bf16 v[164:167], a[216:219], a[36:39], v[164:167]
    ds_read_b64_tr_b16 a[202:203], v202 offset:25600
    v_mfma_f32_16x16x32_bf16 v[168:171], a[216:219], a[40:43], v[168:171]
    buffer_load_dwordx4 a[120:123], v17, s[16:19], s29 offen offset:2048
    v_mfma_f32_16x16x32_bf16 v[172:175], a[216:219], a[44:47], v[172:175]
    s_waitcnt lgkmcnt(6)
    v_mfma_f32_16x16x32_bf16 v[176:179], a[220:223], a[32:35], v[176:179]
    ds_read_b64_tr_b16 a[204:205], v203 offset:24576
    v_mfma_f32_16x16x32_bf16 v[180:183], a[220:223], a[36:39], v[180:183]
    ds_read_b64_tr_b16 a[206:207], v203 offset:25600
    v_mfma_f32_16x16x32_bf16 v[184:187], a[220:223], a[40:43], v[184:187]
    buffer_load_dwordx4 a[124:127], v17, s[16:19], s29 offen offset:2304
    v_mfma_f32_16x16x32_bf16 v[188:191], a[220:223], a[44:47], v[188:191]
    s_waitcnt lgkmcnt(6)
    v_mfma_f32_16x16x32_bf16 v[64:67], a[192:195], a[48:51], v[64:67]
    ds_read_b64_tr_b16 a[208:209], v204 offset:24576
    v_mfma_f32_16x16x32_bf16 v[68:71], a[192:195], a[52:55], v[68:71]
    ds_read_b64_tr_b16 a[210:211], v204 offset:25600
    s_add_u32 s28, s28, 458752
    s_add_u32 m0, s30, 65536
    v_mfma_f32_16x16x32_bf16 v[72:75], a[192:195], a[56:59], v[72:75]
    buffer_load_dwordx4 v4, s[12:15], s28 offen offset:0 lds
    v_mfma_f32_16x16x32_bf16 v[76:79], a[192:195], a[60:63], v[76:79]
    s_waitcnt lgkmcnt(6)
    v_mfma_f32_16x16x32_bf16 v[80:83], a[196:199], a[48:51], v[80:83]
    ds_read_b64_tr_b16 a[212:213], v205 offset:24576
    v_mfma_f32_16x16x32_bf16 v[84:87], a[196:199], a[52:55], v[84:87]
    ds_read_b64_tr_b16 a[214:215], v205 offset:25600
    s_mov_b32 s29, 16384
    v_mfma_f32_16x16x32_bf16 v[88:91], a[196:199], a[56:59], v[88:91]
    buffer_load_dwordx4 a[128:131], v16, s[16:19], s29 offen offset:0
    v_mfma_f32_16x16x32_bf16 v[92:95], a[196:199], a[60:63], v[92:95]
    s_waitcnt lgkmcnt(6)
    v_mfma_f32_16x16x32_bf16 v[96:99], a[200:203], a[48:51], v[96:99]
    ds_read_b64_tr_b16 a[216:217], v206 offset:24576
    v_mfma_f32_16x16x32_bf16 v[100:103], a[200:203], a[52:55], v[100:103]
    ds_read_b64_tr_b16 a[218:219], v206 offset:25600
    v_mfma_f32_16x16x32_bf16 v[104:107], a[200:203], a[56:59], v[104:107]
    buffer_load_dwordx4 a[132:135], v16, s[16:19], s29 offen offset:256
    v_mfma_f32_16x16x32_bf16 v[108:111], a[200:203], a[60:63], v[108:111]
    s_waitcnt lgkmcnt(6)
    v_mfma_f32_16x16x32_bf16 v[112:115], a[204:207], a[48:51], v[112:115]
    ds_read_b64_tr_b16 a[220:221], v207 offset:24576
    v_mfma_f32_16x16x32_bf16 v[116:119], a[204:207], a[52:55], v[116:119]
    ds_read_b64_tr_b16 a[222:223], v207 offset:25600
    v_mfma_f32_16x16x32_bf16 v[120:123], a[204:207], a[56:59], v[120:123]
    buffer_load_dwordx4 v5, s[12:15], s28 offen offset:1024 lds
    v_mfma_f32_16x16x32_bf16 v[124:127], a[204:207], a[60:63], v[124:127]
    s_waitcnt vmcnt(16) lgkmcnt(0)
    s_barrier
    v_mfma_f32_16x16x32_bf16 v[128:131], a[208:211], a[48:51], v[128:131]
    ds_read_b64_tr_b16 a[192:193], v200 offset:32768
    v_mfma_f32_16x16x32_bf16 v[132:135], a[208:211], a[52:55], v[132:135]
    ds_read_b64_tr_b16 a[194:195], v200 offset:33792
    v_mfma_f32_16x16x32_bf16 v[136:139], a[208:211], a[56:59], v[136:139]
    buffer_load_dwordx4 a[136:139], v17, s[16:19], s29 offen offset:0
    v_mfma_f32_16x16x32_bf16 v[140:143], a[208:211], a[60:63], v[140:143]
    s_waitcnt lgkmcnt(6)
    v_mfma_f32_16x16x32_bf16 v[144:147], a[212:215], a[48:51], v[144:147]
    ds_read_b64_tr_b16 a[196:197], v201 offset:32768
    v_mfma_f32_16x16x32_bf16 v[148:151], a[212:215], a[52:55], v[148:151]
    ds_read_b64_tr_b16 a[198:199], v201 offset:33792
    v_mfma_f32_16x16x32_bf16 v[152:155], a[212:215], a[56:59], v[152:155]
    buffer_load_dwordx4 a[140:143], v17, s[16:19], s29 offen offset:256
    v_mfma_f32_16x16x32_bf16 v[156:159], a[212:215], a[60:63], v[156:159]
    s_waitcnt lgkmcnt(6)
    v_mfma_f32_16x16x32_bf16 v[160:163], a[216:219], a[48:51], v[160:163]
    ds_read_b64_tr_b16 a[200:201], v202 offset:32768
    v_mfma_f32_16x16x32_bf16 v[164:167], a[216:219], a[52:55], v[164:167]
    ds_read_b64_tr_b16 a[202:203], v202 offset:33792
    v_mfma_f32_16x16x32_bf16 v[168:171], a[216:219], a[56:59], v[168:171]
    buffer_load_dwordx4 v6, s[12:15], s28 offen offset:2048 lds
    v_mfma_f32_16x16x32_bf16 v[172:175], a[216:219], a[60:63], v[172:175]
    s_waitcnt lgkmcnt(6)
    v_mfma_f32_16x16x32_bf16 v[176:179], a[220:223], a[48:51], v[176:179]
    ds_read_b64_tr_b16 a[204:205], v203 offset:32768
    v_mfma_f32_16x16x32_bf16 v[180:183], a[220:223], a[52:55], v[180:183]
    ds_read_b64_tr_b16 a[206:207], v203 offset:33792
    v_mfma_f32_16x16x32_bf16 v[184:187], a[220:223], a[56:59], v[184:187]
    buffer_load_dwordx4 a[144:147], v16, s[16:19], s29 offen offset:2048
    v_mfma_f32_16x16x32_bf16 v[188:191], a[220:223], a[60:63], v[188:191]
    s_waitcnt lgkmcnt(6)
    v_mfma_f32_16x16x32_bf16 v[64:67], a[192:195], a[64:67], v[64:67]
    ds_read_b64_tr_b16 a[208:209], v204 offset:32768
    v_mfma_f32_16x16x32_bf16 v[68:71], a[192:195], a[68:71], v[68:71]
    ds_read_b64_tr_b16 a[210:211], v204 offset:33792
    v_mfma_f32_16x16x32_bf16 v[72:75], a[192:195], a[72:75], v[72:75]
    buffer_load_dwordx4 a[148:151], v16, s[16:19], s29 offen offset:2304
    v_mfma_f32_16x16x32_bf16 v[76:79], a[192:195], a[76:79], v[76:79]
    s_waitcnt lgkmcnt(6)
    v_mfma_f32_16x16x32_bf16 v[80:83], a[196:199], a[64:67], v[80:83]
    ds_read_b64_tr_b16 a[212:213], v205 offset:32768
    v_mfma_f32_16x16x32_bf16 v[84:87], a[196:199], a[68:71], v[84:87]
    ds_read_b64_tr_b16 a[214:215], v205 offset:33792
    v_mfma_f32_16x16x32_bf16 v[88:91], a[196:199], a[72:75], v[88:91]
    buffer_load_dwordx4 v7, s[12:15], s28 offen offset:3072 lds
    v_mfma_f32_16x16x32_bf16 v[92:95], a[196:199], a[76:79], v[92:95]
    s_waitcnt lgkmcnt(6)
    v_mfma_f32_16x16x32_bf16 v[96:99], a[200:203], a[64:67], v[96:99]
    ds_read_b64_tr_b16 a[216:217], v206 offset:32768
    v_mfma_f32_16x16x32_bf16 v[100:103], a[200:203], a[68:71], v[100:103]
    ds_read_b64_tr_b16 a[218:219], v206 offset:33792
    v_mfma_f32_16x16x32_bf16 v[104:107], a[200:203], a[72:75], v[104:107]
    buffer_load_dwordx4 a[152:155], v17, s[16:19], s29 offen offset:2048
    v_mfma_f32_16x16x32_bf16 v[108:111], a[200:203], a[76:79], v[108:111]
    s_waitcnt lgkmcnt(6)
    v_mfma_f32_16x16x32_bf16 v[112:115], a[204:207], a[64:67], v[112:115]
    ds_read_b64_tr_b16 a[220:221], v207 offset:32768
    v_mfma_f32_16x16x32_bf16 v[116:119], a[204:207], a[68:71], v[116:119]
    ds_read_b64_tr_b16 a[222:223], v207 offset:33792
    v_mfma_f32_16x16x32_bf16 v[120:123], a[204:207], a[72:75], v[120:123]
    buffer_load_dwordx4 a[156:159], v17, s[16:19], s29 offen offset:2304
    v_mfma_f32_16x16x32_bf16 v[124:127], a[204:207], a[76:79], v[124:127]
    s_waitcnt lgkmcnt(6)
    v_mfma_f32_16x16x32_bf16 v[128:131], a[208:211], a[64:67], v[128:131]
    ds_read_b64_tr_b16 a[192:193], v200 offset:40960
    v_mfma_f32_16x16x32_bf16 v[132:135], a[208:211], a[68:71], v[132:135]
    ds_read_b64_tr_b16 a[194:195], v200 offset:41984
    s_add_u32 s28, s28, 458752
    s_add_u32 m0, s30, 81920
    v_mfma_f32_16x16x32_bf16 v[136:139], a[208:211], a[72:75], v[136:139]
    buffer_load_dwordx4 v4, s[12:15], s28 offen offset:0 lds
    v_mfma_f32_16x16x32_bf16 v[140:143], a[208:211], a[76:79], v[140:143]
    s_waitcnt lgkmcnt(6)
    v_mfma_f32_16x16x32_bf16 v[144:147], a[212:215], a[64:67], v[144:147]
    ds_read_b64_tr_b16 a[196:197], v201 offset:40960
    v_mfma_f32_16x16x32_bf16 v[148:151], a[212:215], a[68:71], v[148:151]
    ds_read_b64_tr_b16 a[198:199], v201 offset:41984
    s_mov_b32 s29, 20480
    v_mfma_f32_16x16x32_bf16 v[152:155], a[212:215], a[72:75], v[152:155]
    buffer_load_dwordx4 a[160:163], v16, s[16:19], s29 offen offset:0
    v_mfma_f32_16x16x32_bf16 v[156:159], a[212:215], a[76:79], v[156:159]
    s_waitcnt lgkmcnt(6)
    v_mfma_f32_16x16x32_bf16 v[160:163], a[216:219], a[64:67], v[160:163]
    ds_read_b64_tr_b16 a[200:201], v202 offset:40960
    v_mfma_f32_16x16x32_bf16 v[164:167], a[216:219], a[68:71], v[164:167]
    ds_read_b64_tr_b16 a[202:203], v202 offset:41984
    v_mfma_f32_16x16x32_bf16 v[168:171], a[216:219], a[72:75], v[168:171]
    buffer_load_dwordx4 a[164:167], v16, s[16:19], s29 offen offset:256
    v_mfma_f32_16x16x32_bf16 v[172:175], a[216:219], a[76:79], v[172:175]
    s_waitcnt lgkmcnt(6)
    v_mfma_f32_16x16x32_bf16 v[176:179], a[220:223], a[64:67], v[176:179]
    ds_read_b64_tr_b16 a[204:205], v203 offset:40960
    v_mfma_f32_16x16x32_bf16 v[180:183], a[220:223], a[68:71], v[180:183]
    ds_read_b64_tr_b16 a[206:207], v203 offset:41984
    v_mfma_f32_16x16x32_bf16 v[184:187], a[220:223], a[72:75], v[184:187]
    buffer_load_dwordx4 v5, s[12:15], s28 offen offset:1024 lds
    v_mfma_f32_16x16x32_bf16 v[188:191], a[220:223], a[76:79], v[188:191]
    s_waitcnt lgkmcnt(6)
    v_mfma_f32_16x16x32_bf16 v[64:67], a[192:195], a[80:83], v[64:67]
    ds_read_b64_tr_b16 a[208:209], v204 offset:40960
    v_mfma_f32_16x16x32_bf16 v[68:71], a[192:195], a[84:87], v[68:71]
    ds_read_b64_tr_b16 a[210:211], v204 offset:41984
    v_mfma_f32_16x16x32_bf16 v[72:75], a[192:195], a[88:91], v[72:75]
    buffer_load_dwordx4 a[168:171], v17, s[16:19], s29 offen offset:0
    v_mfma_f32_16x16x32_bf16 v[76:79], a[192:195], a[92:95], v[76:79]
    s_waitcnt lgkmcnt(6)
    v_mfma_f32_16x16x32_bf16 v[80:83], a[196:199], a[80:83], v[80:83]
    ds_read_b64_tr_b16 a[212:213], v205 offset:40960
    v_mfma_f32_16x16x32_bf16 v[84:87], a[196:199], a[84:87], v[84:87]
    ds_read_b64_tr_b16 a[214:215], v205 offset:41984
    v_mfma_f32_16x16x32_bf16 v[88:91], a[196:199], a[88:91], v[88:91]
    buffer_load_dwordx4 a[172:175], v17, s[16:19], s29 offen offset:256
    v_mfma_f32_16x16x32_bf16 v[92:95], a[196:199], a[92:95], v[92:95]
    s_waitcnt lgkmcnt(6)
    v_mfma_f32_16x16x32_bf16 v[96:99], a[200:203], a[80:83], v[96:99]
    ds_read_b64_tr_b16 a[216:217], v206 offset:40960
    v_mfma_f32_16x16x32_bf16 v[100:103], a[200:203], a[84:87], v[100:103]
    ds_read_b64_tr_b16 a[218:219], v206 offset:41984
    v_mfma_f32_16x16x32_bf16 v[104:107], a[200:203], a[88:91], v[104:107]
    buffer_load_dwordx4 v6, s[12:15], s28 offen offset:2048 lds
    v_mfma_f32_16x16x32_bf16 v[108:111], a[200:203], a[92:95], v[108:111]
    s_waitcnt lgkmcnt(6)
    v_mfma_f32_16x16x32_bf16 v[112:115], a[204:207], a[80:83], v[112:115]
    ds_read_b64_tr_b16 a[220:221], v207 offset:40960
    v_mfma_f32_16x16x32_bf16 v[116:119], a[204:207], a[84:87], v[116:119]
    ds_read_b64_tr_b16 a[222:223], v207 offset:41984
    v_mfma_f32_16x16x32_bf16 v[120:123], a[204:207], a[88:91], v[120:123]
    buffer_load_dwordx4 a[176:179], v16, s[16:19], s29 offen offset:2048
    v_mfma_f32_16x16x32_bf16 v[124:127], a[204:207], a[92:95], v[124:127]
    s_waitcnt vmcnt(20) lgkmcnt(0)
    s_barrier
    v_mfma_f32_16x16x32_bf16 v[128:131], a[208:211], a[80:83], v[128:131]
    ds_read_b64_tr_b16 a[192:193], v200 offset:49152
    v_mfma_f32_16x16x32_bf16 v[132:135], a[208:211], a[84:87], v[132:135]
    ds_read_b64_tr_b16 a[194:195], v200 offset:50176
    v_mfma_f32_16x16x32_bf16 v[136:139], a[208:211], a[88:91], v[136:139]
    buffer_load_dwordx4 a[180:183], v16, s[16:19], s29 offen offset:2304
    v_mfma_f32_16x16x32_bf16 v[140:143], a[208:211], a[92:95], v[140:143]
    s_waitcnt lgkmcnt(6)
    v_mfma_f32_16x16x32_bf16 v[144:147], a[212:215], a[80:83], v[144:147]
    ds_read_b64_tr_b16 a[196:197], v201 offset:49152
    v_mfma_f32_16x16x32_bf16 v[148:151], a[212:215], a[84:87], v[148:151]
    ds_read_b64_tr_b16 a[198:199], v201 offset:50176
    v_mfma_f32_16x16x32_bf16 v[152:155], a[212:215], a[88:91], v[152:155]
    buffer_load_dwordx4 v7, s[12:15], s28 offen offset:3072 lds
    v_mfma_f32_16x16x32_bf16 v[156:159], a[212:215], a[92:95], v[156:159]
    s_waitcnt lgkmcnt(6)
    v_mfma_f32_16x16x32_bf16 v[160:163], a[216:219], a[80:83], v[160:163]
    ds_read_b64_tr_b16 a[200:201], v202 offset:49152
    v_mfma_f32_16x16x32_bf16 v[164:167], a[216:219], a[84:87], v[164:167]
    ds_read_b64_tr_b16 a[202:203], v202 offset:50176
    v_mfma_f32_16x16x32_bf16 v[168:171], a[216:219], a[88:91], v[168:171]
    buffer_load_dwordx4 a[184:187], v17, s[16:19], s29 offen offset:2048
    v_mfma_f32_16x16x32_bf16 v[172:175], a[216:219], a[92:95], v[172:175]
    s_waitcnt lgkmcnt(6)
    v_mfma_f32_16x16x32_bf16 v[176:179], a[220:223], a[80:83], v[176:179]
    ds_read_b64_tr_b16 a[204:205], v203 offset:49152
    v_mfma_f32_16x16x32_bf16 v[180:183], a[220:223], a[84:87], v[180:183]
    ds_read_b64_tr_b16 a[206:207], v203 offset:50176
    v_mfma_f32_16x16x32_bf16 v[184:187], a[220:223], a[88:91], v[184:187]
    buffer_load_dwordx4 a[188:191], v17, s[16:19], s29 offen offset:2304
    v_mfma_f32_16x16x32_bf16 v[188:191], a[220:223], a[92:95], v[188:191]
    s_waitcnt lgkmcnt(6)
    v_mfma_f32_16x16x32_bf16 v[64:67], a[192:195], a[96:99], v[64:67]
    ds_read_b64_tr_b16 a[208:209], v204 offset:49152
    v_mfma_f32_16x16x32_bf16 v[68:71], a[192:195], a[100:103], v[68:71]
    ds_read_b64_tr_b16 a[210:211], v204 offset:50176
    s_add_u32 s28, s28, 458752
    s_add_u32 m0, s30, 0
    v_mfma_f32_16x16x32_bf16 v[72:75], a[192:195], a[104:107], v[72:75]
    buffer_load_dwordx4 v4, s[12:15], s28 offen offset:0 lds
    v_mfma_f32_16x16x32_bf16 v[76:79], a[192:195], a[108:111], v[76:79]
    s_waitcnt lgkmcnt(6)
    v_mfma_f32_16x16x32_bf16 v[80:83], a[196:199], a[96:99], v[80:83]
    ds_read_b64_tr_b16 a[212:213], v205 offset:49152
    v_mfma_f32_16x16x32_bf16 v[84:87], a[196:199], a[100:103], v[84:87]
    ds_read_b64_tr_b16 a[214:215], v205 offset:50176
    s_mov_b32 s29, 24576
    v_mfma_f32_16x16x32_bf16 v[88:91], a[196:199], a[104:107], v[88:91]
    buffer_load_dwordx4 a[0:3], v16, s[16:19], s29 offen offset:0
    v_mfma_f32_16x16x32_bf16 v[92:95], a[196:199], a[108:111], v[92:95]
    s_waitcnt lgkmcnt(6)
    v_mfma_f32_16x16x32_bf16 v[96:99], a[200:203], a[96:99], v[96:99]
    ds_read_b64_tr_b16 a[216:217], v206 offset:49152
    v_mfma_f32_16x16x32_bf16 v[100:103], a[200:203], a[100:103], v[100:103]
    ds_read_b64_tr_b16 a[218:219], v206 offset:50176
    v_mfma_f32_16x16x32_bf16 v[104:107], a[200:203], a[104:107], v[104:107]
    buffer_load_dwordx4 a[4:7], v16, s[16:19], s29 offen offset:256
    v_mfma_f32_16x16x32_bf16 v[108:111], a[200:203], a[108:111], v[108:111]
    s_waitcnt lgkmcnt(6)
    v_mfma_f32_16x16x32_bf16 v[112:115], a[204:207], a[96:99], v[112:115]
    ds_read_b64_tr_b16 a[220:221], v207 offset:49152
    v_mfma_f32_16x16x32_bf16 v[116:119], a[204:207], a[100:103], v[116:119]
    ds_read_b64_tr_b16 a[222:223], v207 offset:50176
    v_mfma_f32_16x16x32_bf16 v[120:123], a[204:207], a[104:107], v[120:123]
    buffer_load_dwordx4 v5, s[12:15], s28 offen offset:1024 lds
    v_mfma_f32_16x16x32_bf16 v[124:127], a[204:207], a[108:111], v[124:127]
    s_waitcnt lgkmcnt(6)
    v_mfma_f32_16x16x32_bf16 v[128:131], a[208:211], a[96:99], v[128:131]
    ds_read_b64_tr_b16 a[192:193], v200 offset:57344
    v_mfma_f32_16x16x32_bf16 v[132:135], a[208:211], a[100:103], v[132:135]
    ds_read_b64_tr_b16 a[194:195], v200 offset:58368
    v_mfma_f32_16x16x32_bf16 v[136:139], a[208:211], a[104:107], v[136:139]
    buffer_load_dwordx4 a[8:11], v17, s[16:19], s29 offen offset:0
    v_mfma_f32_16x16x32_bf16 v[140:143], a[208:211], a[108:111], v[140:143]
    s_waitcnt lgkmcnt(6)
    v_mfma_f32_16x16x32_bf16 v[144:147], a[212:215], a[96:99], v[144:147]
    ds_read_b64_tr_b16 a[196:197], v201 offset:57344
    v_mfma_f32_16x16x32_bf16 v[148:151], a[212:215], a[100:103], v[148:151]
    ds_read_b64_tr_b16 a[198:199], v201 offset:58368
    v_mfma_f32_16x16x32_bf16 v[152:155], a[212:215], a[104:107], v[152:155]
    buffer_load_dwordx4 a[12:15], v17, s[16:19], s29 offen offset:256
    v_mfma_f32_16x16x32_bf16 v[156:159], a[212:215], a[108:111], v[156:159]
    s_waitcnt lgkmcnt(6)
    v_mfma_f32_16x16x32_bf16 v[160:163], a[216:219], a[96:99], v[160:163]
    ds_read_b64_tr_b16 a[200:201], v202 offset:57344
    v_mfma_f32_16x16x32_bf16 v[164:167], a[216:219], a[100:103], v[164:167]
    ds_read_b64_tr_b16 a[202:203], v202 offset:58368
    v_mfma_f32_16x16x32_bf16 v[168:171], a[216:219], a[104:107], v[168:171]
    buffer_load_dwordx4 v6, s[12:15], s28 offen offset:2048 lds
    v_mfma_f32_16x16x32_bf16 v[172:175], a[216:219], a[108:111], v[172:175]
    s_waitcnt lgkmcnt(6)
    v_mfma_f32_16x16x32_bf16 v[176:179], a[220:223], a[96:99], v[176:179]
    ds_read_b64_tr_b16 a[204:205], v203 offset:57344
    v_mfma_f32_16x16x32_bf16 v[180:183], a[220:223], a[100:103], v[180:183]
    ds_read_b64_tr_b16 a[206:207], v203 offset:58368
    v_mfma_f32_16x16x32_bf16 v[184:187], a[220:223], a[104:107], v[184:187]
    buffer_load_dwordx4 a[16:19], v16, s[16:19], s29 offen offset:2048
    v_mfma_f32_16x16x32_bf16 v[188:191], a[220:223], a[108:111], v[188:191]
    s_waitcnt lgkmcnt(6)
    v_mfma_f32_16x16x32_bf16 v[64:67], a[192:195], a[112:115], v[64:67]
    ds_read_b64_tr_b16 a[208:209], v204 offset:57344
    v_mfma_f32_16x16x32_bf16 v[68:71], a[192:195], a[116:119], v[68:71]
    ds_read_b64_tr_b16 a[210:211], v204 offset:58368
    v_mfma_f32_16x16x32_bf16 v[72:75], a[192:195], a[120:123], v[72:75]
    buffer_load_dwordx4 a[20:23], v16, s[16:19], s29 offen offset:2304
    v_mfma_f32_16x16x32_bf16 v[76:79], a[192:195], a[124:127], v[76:79]
    s_waitcnt lgkmcnt(6)
    v_mfma_f32_16x16x32_bf16 v[80:83], a[196:199], a[112:115], v[80:83]
    ds_read_b64_tr_b16 a[212:213], v205 offset:57344
    v_mfma_f32_16x16x32_bf16 v[84:87], a[196:199], a[116:119], v[84:87]
    ds_read_b64_tr_b16 a[214:215], v205 offset:58368
    v_mfma_f32_16x16x32_bf16 v[88:91], a[196:199], a[120:123], v[88:91]
    buffer_load_dwordx4 v7, s[12:15], s28 offen offset:3072 lds
    v_mfma_f32_16x16x32_bf16 v[92:95], a[196:199], a[124:127], v[92:95]
    s_waitcnt lgkmcnt(6)
    v_mfma_f32_16x16x32_bf16 v[96:99], a[200:203], a[112:115], v[96:99]
    ds_read_b64_tr_b16 a[216:217], v206 offset:57344
    v_mfma_f32_16x16x32_bf16 v[100:103], a[200:203], a[116:119], v[100:103]
    ds_read_b64_tr_b16 a[218:219], v206 offset:58368
    v_mfma_f32_16x16x32_bf16 v[104:107], a[200:203], a[120:123], v[104:107]
    buffer_load_dwordx4 a[24:27], v17, s[16:19], s29 offen offset:2048
    v_mfma_f32_16x16x32_bf16 v[108:111], a[200:203], a[124:127], v[108:111]
    s_waitcnt lgkmcnt(6)
    v_mfma_f32_16x16x32_bf16 v[112:115], a[204:207], a[112:115], v[112:115]
    ds_read_b64_tr_b16 a[220:221], v207 offset:57344
    v_mfma_f32_16x16x32_bf16 v[116:119], a[204:207], a[116:119], v[116:119]
    ds_read_b64_tr_b16 a[222:223], v207 offset:58368
    v_mfma_f32_16x16x32_bf16 v[120:123], a[204:207], a[120:123], v[120:123]
    buffer_load_dwordx4 a[28:31], v17, s[16:19], s29 offen offset:2304
    v_mfma_f32_16x16x32_bf16 v[124:127], a[204:207], a[124:127], v[124:127]
    s_waitcnt vmcnt(24) lgkmcnt(0)
    s_barrier
    v_mfma_f32_16x16x32_bf16 v[128:131], a[208:211], a[112:115], v[128:131]
    ds_read_b64_tr_b16 a[192:193], v208 offset:0
    v_mfma_f32_16x16x32_bf16 v[132:135], a[208:211], a[116:119], v[132:135]
    ds_read_b64_tr_b16 a[194:195], v208 offset:1024
    s_add_u32 s28, s28, 458752
    s_add_u32 m0, s30, 16384
    v_mfma_f32_16x16x32_bf16 v[136:139], a[208:211], a[120:123], v[136:139]
    buffer_load_dwordx4 v4, s[12:15], s28 offen offset:0 lds
    v_mfma_f32_16x16x32_bf16 v[140:143], a[208:211], a[124:127], v[140:143]
    s_waitcnt lgkmcnt(6)
    v_mfma_f32_16x16x32_bf16 v[144:147], a[212:215], a[112:115], v[144:147]
    ds_read_b64_tr_b16 a[196:197], v209 offset:0
    v_mfma_f32_16x16x32_bf16 v[148:151], a[212:215], a[116:119], v[148:151]
    ds_read_b64_tr_b16 a[198:199], v209 offset:1024
    s_mov_b32 s29, 28672
    v_mfma_f32_16x16x32_bf16 v[152:155], a[212:215], a[120:123], v[152:155]
    buffer_load_dwordx4 a[32:35], v16, s[16:19], s29 offen offset:0
    v_mfma_f32_16x16x32_bf16 v[156:159], a[212:215], a[124:127], v[156:159]
    s_waitcnt lgkmcnt(6)
    v_mfma_f32_16x16x32_bf16 v[160:163], a[216:219], a[112:115], v[160:163]
    ds_read_b64_tr_b16 a[200:201], v210 offset:0
    v_mfma_f32_16x16x32_bf16 v[164:167], a[216:219], a[116:119], v[164:167]
    ds_read_b64_tr_b16 a[202:203], v210 offset:1024
    v_mfma_f32_16x16x32_bf16 v[168:171], a[216:219], a[120:123], v[168:171]
    buffer_load_dwordx4 a[36:39], v16, s[16:19], s29 offen offset:256
    v_mfma_f32_16x16x32_bf16 v[172:175], a[216:219], a[124:127], v[172:175]
    s_waitcnt lgkmcnt(6)
    v_mfma_f32_16x16x32_bf16 v[176:179], a[220:223], a[112:115], v[176:179]
    ds_read_b64_tr_b16 a[204:205], v211 offset:0
    v_mfma_f32_16x16x32_bf16 v[180:183], a[220:223], a[116:119], v[180:183]
    ds_read_b64_tr_b16 a[206:207], v211 offset:1024
    v_mfma_f32_16x16x32_bf16 v[184:187], a[220:223], a[120:123], v[184:187]
    buffer_load_dwordx4 v5, s[12:15], s28 offen offset:1024 lds
    v_mfma_f32_16x16x32_bf16 v[188:191], a[220:223], a[124:127], v[188:191]
    s_waitcnt lgkmcnt(6)
    v_mfma_f32_16x16x32_bf16 v[64:67], a[192:195], a[128:131], v[64:67]
    ds_read_b64_tr_b16 a[208:209], v212 offset:0
    v_mfma_f32_16x16x32_bf16 v[68:71], a[192:195], a[132:135], v[68:71]
    ds_read_b64_tr_b16 a[210:211], v212 offset:1024
    v_mfma_f32_16x16x32_bf16 v[72:75], a[192:195], a[136:139], v[72:75]
    buffer_load_dwordx4 a[40:43], v17, s[16:19], s29 offen offset:0
    v_mfma_f32_16x16x32_bf16 v[76:79], a[192:195], a[140:143], v[76:79]
    s_waitcnt lgkmcnt(6)
    v_mfma_f32_16x16x32_bf16 v[80:83], a[196:199], a[128:131], v[80:83]
    ds_read_b64_tr_b16 a[212:213], v213 offset:0
    v_mfma_f32_16x16x32_bf16 v[84:87], a[196:199], a[132:135], v[84:87]
    ds_read_b64_tr_b16 a[214:215], v213 offset:1024
    v_mfma_f32_16x16x32_bf16 v[88:91], a[196:199], a[136:139], v[88:91]
    buffer_load_dwordx4 a[44:47], v17, s[16:19], s29 offen offset:256
    v_mfma_f32_16x16x32_bf16 v[92:95], a[196:199], a[140:143], v[92:95]
    s_waitcnt lgkmcnt(6)
    v_mfma_f32_16x16x32_bf16 v[96:99], a[200:203], a[128:131], v[96:99]
    ds_read_b64_tr_b16 a[216:217], v214 offset:0
    v_mfma_f32_16x16x32_bf16 v[100:103], a[200:203], a[132:135], v[100:103]
    ds_read_b64_tr_b16 a[218:219], v214 offset:1024
    v_mfma_f32_16x16x32_bf16 v[104:107], a[200:203], a[136:139], v[104:107]
    buffer_load_dwordx4 v6, s[12:15], s28 offen offset:2048 lds
    v_mfma_f32_16x16x32_bf16 v[108:111], a[200:203], a[140:143], v[108:111]
    s_waitcnt lgkmcnt(6)
    v_mfma_f32_16x16x32_bf16 v[112:115], a[204:207], a[128:131], v[112:115]
    ds_read_b64_tr_b16 a[220:221], v215 offset:0
    v_mfma_f32_16x16x32_bf16 v[116:119], a[204:207], a[132:135], v[116:119]
    ds_read_b64_tr_b16 a[222:223], v215 offset:1024
    v_mfma_f32_16x16x32_bf16 v[120:123], a[204:207], a[136:139], v[120:123]
    buffer_load_dwordx4 a[48:51], v16, s[16:19], s29 offen offset:2048
    v_mfma_f32_16x16x32_bf16 v[124:127], a[204:207], a[140:143], v[124:127]
    s_waitcnt lgkmcnt(6)
    v_mfma_f32_16x16x32_bf16 v[128:131], a[208:211], a[128:131], v[128:131]
    ds_read_b64_tr_b16 a[192:193], v208 offset:8192
    v_mfma_f32_16x16x32_bf16 v[132:135], a[208:211], a[132:135], v[132:135]
    ds_read_b64_tr_b16 a[194:195], v208 offset:9216
    v_mfma_f32_16x16x32_bf16 v[136:139], a[208:211], a[136:139], v[136:139]
    buffer_load_dwordx4 a[52:55], v16, s[16:19], s29 offen offset:2304
    v_mfma_f32_16x16x32_bf16 v[140:143], a[208:211], a[140:143], v[140:143]
    s_waitcnt lgkmcnt(6)
    v_mfma_f32_16x16x32_bf16 v[144:147], a[212:215], a[128:131], v[144:147]
    ds_read_b64_tr_b16 a[196:197], v209 offset:8192
    v_mfma_f32_16x16x32_bf16 v[148:151], a[212:215], a[132:135], v[148:151]
    ds_read_b64_tr_b16 a[198:199], v209 offset:9216
    v_mfma_f32_16x16x32_bf16 v[152:155], a[212:215], a[136:139], v[152:155]
    buffer_load_dwordx4 v7, s[12:15], s28 offen offset:3072 lds
    v_mfma_f32_16x16x32_bf16 v[156:159], a[212:215], a[140:143], v[156:159]
    s_waitcnt lgkmcnt(6)
    v_mfma_f32_16x16x32_bf16 v[160:163], a[216:219], a[128:131], v[160:163]
    ds_read_b64_tr_b16 a[200:201], v210 offset:8192
    v_mfma_f32_16x16x32_bf16 v[164:167], a[216:219], a[132:135], v[164:167]
    ds_read_b64_tr_b16 a[202:203], v210 offset:9216
    v_mfma_f32_16x16x32_bf16 v[168:171], a[216:219], a[136:139], v[168:171]
    buffer_load_dwordx4 a[56:59], v17, s[16:19], s29 offen offset:2048
    v_mfma_f32_16x16x32_bf16 v[172:175], a[216:219], a[140:143], v[172:175]
    s_waitcnt lgkmcnt(6)
    v_mfma_f32_16x16x32_bf16 v[176:179], a[220:223], a[128:131], v[176:179]
    ds_read_b64_tr_b16 a[204:205], v211 offset:8192
    v_mfma_f32_16x16x32_bf16 v[180:183], a[220:223], a[132:135], v[180:183]
    ds_read_b64_tr_b16 a[206:207], v211 offset:9216
    v_mfma_f32_16x16x32_bf16 v[184:187], a[220:223], a[136:139], v[184:187]
    buffer_load_dwordx4 a[60:63], v17, s[16:19], s29 offen offset:2304
    v_mfma_f32_16x16x32_bf16 v[188:191], a[220:223], a[140:143], v[188:191]
    s_waitcnt lgkmcnt(6)
    v_mfma_f32_16x16x32_bf16 v[64:67], a[192:195], a[144:147], v[64:67]
    ds_read_b64_tr_b16 a[208:209], v212 offset:8192
    v_mfma_f32_16x16x32_bf16 v[68:71], a[192:195], a[148:151], v[68:71]
    ds_read_b64_tr_b16 a[210:211], v212 offset:9216
    s_add_u32 s28, s28, 458752
    s_add_u32 m0, s30, 32768
    v_mfma_f32_16x16x32_bf16 v[72:75], a[192:195], a[152:155], v[72:75]
    buffer_load_dwordx4 v4, s[12:15], s28 offen offset:0 lds
    v_mfma_f32_16x16x32_bf16 v[76:79], a[192:195], a[156:159], v[76:79]
    s_waitcnt lgkmcnt(6)
    v_mfma_f32_16x16x32_bf16 v[80:83], a[196:199], a[144:147], v[80:83]
    ds_read_b64_tr_b16 a[212:213], v213 offset:8192
    v_mfma_f32_16x16x32_bf16 v[84:87], a[196:199], a[148:151], v[84:87]
    ds_read_b64_tr_b16 a[214:215], v213 offset:9216
    s_mov_b32 s29, 32768
    v_mfma_f32_16x16x32_bf16 v[88:91], a[196:199], a[152:155], v[88:91]
    buffer_load_dwordx4 a[64:67], v16, s[16:19], s29 offen offset:0
    v_mfma_f32_16x16x32_bf16 v[92:95], a[196:199], a[156:159], v[92:95]
    s_waitcnt lgkmcnt(6)
    v_mfma_f32_16x16x32_bf16 v[96:99], a[200:203], a[144:147], v[96:99]
    ds_read_b64_tr_b16 a[216:217], v214 offset:8192
    v_mfma_f32_16x16x32_bf16 v[100:103], a[200:203], a[148:151], v[100:103]
    ds_read_b64_tr_b16 a[218:219], v214 offset:9216
    v_mfma_f32_16x16x32_bf16 v[104:107], a[200:203], a[152:155], v[104:107]
    buffer_load_dwordx4 a[68:71], v16, s[16:19], s29 offen offset:256
    v_mfma_f32_16x16x32_bf16 v[108:111], a[200:203], a[156:159], v[108:111]
    s_waitcnt lgkmcnt(6)
    v_mfma_f32_16x16x32_bf16 v[112:115], a[204:207], a[144:147], v[112:115]
    ds_read_b64_tr_b16 a[220:221], v215 offset:8192
    v_mfma_f32_16x16x32_bf16 v[116:119], a[204:207], a[148:151], v[116:119]
    ds_read_b64_tr_b16 a[222:223], v215 offset:9216
    v_mfma_f32_16x16x32_bf16 v[120:123], a[204:207], a[152:155], v[120:123]
    buffer_load_dwordx4 v5, s[12:15], s28 offen offset:1024 lds
    v_mfma_f32_16x16x32_bf16 v[124:127], a[204:207], a[156:159], v[124:127]
    s_waitcnt vmcnt(28) lgkmcnt(0)
    s_barrier
    v_mfma_f32_16x16x32_bf16 v[128:131], a[208:211], a[144:147], v[128:131]
    ds_read_b64_tr_b16 a[192:193], v208 offset:16384
    v_mfma_f32_16x16x32_bf16 v[132:135], a[208:211], a[148:151], v[132:135]
    ds_read_b64_tr_b16 a[194:195], v208 offset:17408
    v_mfma_f32_16x16x32_bf16 v[136:139], a[208:211], a[152:155], v[136:139]
    buffer_load_dwordx4 a[72:75], v17, s[16:19], s29 offen offset:0
    v_mfma_f32_16x16x32_bf16 v[140:143], a[208:211], a[156:159], v[140:143]
    s_waitcnt lgkmcnt(6)
    v_mfma_f32_16x16x32_bf16 v[144:147], a[212:215], a[144:147], v[144:147]
    ds_read_b64_tr_b16 a[196:197], v209 offset:16384
    v_mfma_f32_16x16x32_bf16 v[148:151], a[212:215], a[148:151], v[148:151]
    ds_read_b64_tr_b16 a[198:199], v209 offset:17408
    v_mfma_f32_16x16x32_bf16 v[152:155], a[212:215], a[152:155], v[152:155]
    buffer_load_dwordx4 a[76:79], v17, s[16:19], s29 offen offset:256
    v_mfma_f32_16x16x32_bf16 v[156:159], a[212:215], a[156:159], v[156:159]
    s_waitcnt lgkmcnt(6)
    v_mfma_f32_16x16x32_bf16 v[160:163], a[216:219], a[144:147], v[160:163]
    ds_read_b64_tr_b16 a[200:201], v210 offset:16384
    v_mfma_f32_16x16x32_bf16 v[164:167], a[216:219], a[148:151], v[164:167]
    ds_read_b64_tr_b16 a[202:203], v210 offset:17408
    v_mfma_f32_16x16x32_bf16 v[168:171], a[216:219], a[152:155], v[168:171]
    buffer_load_dwordx4 v6, s[12:15], s28 offen offset:2048 lds
    v_mfma_f32_16x16x32_bf16 v[172:175], a[216:219], a[156:159], v[172:175]
    s_waitcnt lgkmcnt(6)
    v_mfma_f32_16x16x32_bf16 v[176:179], a[220:223], a[144:147], v[176:179]
    ds_read_b64_tr_b16 a[204:205], v211 offset:16384
    v_mfma_f32_16x16x32_bf16 v[180:183], a[220:223], a[148:151], v[180:183]
    ds_read_b64_tr_b16 a[206:207], v211 offset:17408
    v_mfma_f32_16x16x32_bf16 v[184:187], a[220:223], a[152:155], v[184:187]
    buffer_load_dwordx4 a[80:83], v16, s[16:19], s29 offen offset:2048
    v_mfma_f32_16x16x32_bf16 v[188:191], a[220:223], a[156:159], v[188:191]
    s_waitcnt lgkmcnt(6)
    v_mfma_f32_16x16x32_bf16 v[64:67], a[192:195], a[160:163], v[64:67]
    ds_read_b64_tr_b16 a[208:209], v212 offset:16384
    v_mfma_f32_16x16x32_bf16 v[68:71], a[192:195], a[164:167], v[68:71]
    ds_read_b64_tr_b16 a[210:211], v212 offset:17408
    v_mfma_f32_16x16x32_bf16 v[72:75], a[192:195], a[168:171], v[72:75]
    buffer_load_dwordx4 a[84:87], v16, s[16:19], s29 offen offset:2304
    v_mfma_f32_16x16x32_bf16 v[76:79], a[192:195], a[172:175], v[76:79]
    s_waitcnt lgkmcnt(6)
    v_mfma_f32_16x16x32_bf16 v[80:83], a[196:199], a[160:163], v[80:83]
    ds_read_b64_tr_b16 a[212:213], v213 offset:16384
    v_mfma_f32_16x16x32_bf16 v[84:87], a[196:199], a[164:167], v[84:87]
    ds_read_b64_tr_b16 a[214:215], v213 offset:17408
    v_mfma_f32_16x16x32_bf16 v[88:91], a[196:199], a[168:171], v[88:91]
    buffer_load_dwordx4 v7, s[12:15], s28 offen offset:3072 lds
    v_mfma_f32_16x16x32_bf16 v[92:95], a[196:199], a[172:175], v[92:95]
    s_waitcnt lgkmcnt(6)
    v_mfma_f32_16x16x32_bf16 v[96:99], a[200:203], a[160:163], v[96:99]
    ds_read_b64_tr_b16 a[216:217], v214 offset:16384
    v_mfma_f32_16x16x32_bf16 v[100:103], a[200:203], a[164:167], v[100:103]
    ds_read_b64_tr_b16 a[218:219], v214 offset:17408
    v_mfma_f32_16x16x32_bf16 v[104:107], a[200:203], a[168:171], v[104:107]
    buffer_load_dwordx4 a[88:91], v17, s[16:19], s29 offen offset:2048
    v_mfma_f32_16x16x32_bf16 v[108:111], a[200:203], a[172:175], v[108:111]
    s_waitcnt lgkmcnt(6)
    v_mfma_f32_16x16x32_bf16 v[112:115], a[204:207], a[160:163], v[112:115]
    ds_read_b64_tr_b16 a[220:221], v215 offset:16384
    v_mfma_f32_16x16x32_bf16 v[116:119], a[204:207], a[164:167], v[116:119]
    ds_read_b64_tr_b16 a[222:223], v215 offset:17408
    v_mfma_f32_16x16x32_bf16 v[120:123], a[204:207], a[168:171], v[120:123]
    buffer_load_dwordx4 a[92:95], v17, s[16:19], s29 offen offset:2304
    v_mfma_f32_16x16x32_bf16 v[124:127], a[204:207], a[172:175], v[124:127]
    s_waitcnt lgkmcnt(6)
    v_mfma_f32_16x16x32_bf16 v[128:131], a[208:211], a[160:163], v[128:131]
    ds_read_b64_tr_b16 a[192:193], v208 offset:24576
    v_mfma_f32_16x16x32_bf16 v[132:135], a[208:211], a[164:167], v[132:135]
    ds_read_b64_tr_b16 a[194:195], v208 offset:25600
    s_add_u32 s28, s28, 458752
    s_add_u32 m0, s30, 49152
    v_mfma_f32_16x16x32_bf16 v[136:139], a[208:211], a[168:171], v[136:139]
    buffer_load_dwordx4 v4, s[12:15], s28 offen offset:0 lds
    v_mfma_f32_16x16x32_bf16 v[140:143], a[208:211], a[172:175], v[140:143]
    s_waitcnt lgkmcnt(6)
    v_mfma_f32_16x16x32_bf16 v[144:147], a[212:215], a[160:163], v[144:147]
    ds_read_b64_tr_b16 a[196:197], v209 offset:24576
    v_mfma_f32_16x16x32_bf16 v[148:151], a[212:215], a[164:167], v[148:151]
    ds_read_b64_tr_b16 a[198:199], v209 offset:25600
    s_mov_b32 s29, 36864
    v_mfma_f32_16x16x32_bf16 v[152:155], a[212:215], a[168:171], v[152:155]
    buffer_load_dwordx4 a[96:99], v16, s[16:19], s29 offen offset:0
    v_mfma_f32_16x16x32_bf16 v[156:159], a[212:215], a[172:175], v[156:159]
    s_waitcnt lgkmcnt(6)
    v_mfma_f32_16x16x32_bf16 v[160:163], a[216:219], a[160:163], v[160:163]
    ds_read_b64_tr_b16 a[200:201], v210 offset:24576
    v_mfma_f32_16x16x32_bf16 v[164:167], a[216:219], a[164:167], v[164:167]
    ds_read_b64_tr_b16 a[202:203], v210 offset:25600
    v_mfma_f32_16x16x32_bf16 v[168:171], a[216:219], a[168:171], v[168:171]
    buffer_load_dwordx4 a[100:103], v16, s[16:19], s29 offen offset:256
    v_mfma_f32_16x16x32_bf16 v[172:175], a[216:219], a[172:175], v[172:175]
    s_waitcnt lgkmcnt(6)
    v_mfma_f32_16x16x32_bf16 v[176:179], a[220:223], a[160:163], v[176:179]
    ds_read_b64_tr_b16 a[204:205], v211 offset:24576
    v_mfma_f32_16x16x32_bf16 v[180:183], a[220:223], a[164:167], v[180:183]
    ds_read_b64_tr_b16 a[206:207], v211 offset:25600
    v_mfma_f32_16x16x32_bf16 v[184:187], a[220:223], a[168:171], v[184:187]
    buffer_load_dwordx4 v5, s[12:15], s28 offen offset:1024 lds
    v_mfma_f32_16x16x32_bf16 v[188:191], a[220:223], a[172:175], v[188:191]
    s_waitcnt lgkmcnt(6)
    v_mfma_f32_16x16x32_bf16 v[64:67], a[192:195], a[176:179], v[64:67]
    ds_read_b64_tr_b16 a[208:209], v212 offset:24576
    v_mfma_f32_16x16x32_bf16 v[68:71], a[192:195], a[180:183], v[68:71]
    ds_read_b64_tr_b16 a[210:211], v212 offset:25600
    v_mfma_f32_16x16x32_bf16 v[72:75], a[192:195], a[184:187], v[72:75]
    buffer_load_dwordx4 a[104:107], v17, s[16:19], s29 offen offset:0
    v_mfma_f32_16x16x32_bf16 v[76:79], a[192:195], a[188:191], v[76:79]
    s_waitcnt lgkmcnt(6)
    v_mfma_f32_16x16x32_bf16 v[80:83], a[196:199], a[176:179], v[80:83]
    ds_read_b64_tr_b16 a[212:213], v213 offset:24576
    v_mfma_f32_16x16x32_bf16 v[84:87], a[196:199], a[180:183], v[84:87]
    ds_read_b64_tr_b16 a[214:215], v213 offset:25600
    v_mfma_f32_16x16x32_bf16 v[88:91], a[196:199], a[184:187], v[88:91]
    buffer_load_dwordx4 a[108:111], v17, s[16:19], s29 offen offset:256
    v_mfma_f32_16x16x32_bf16 v[92:95], a[196:199], a[188:191], v[92:95]
    s_waitcnt lgkmcnt(6)
    v_mfma_f32_16x16x32_bf16 v[96:99], a[200:203], a[176:179], v[96:99]
    ds_read_b64_tr_b16 a[216:217], v214 offset:24576
    v_mfma_f32_16x16x32_bf16 v[100:103], a[200:203], a[180:183], v[100:103]
    ds_read_b64_tr_b16 a[218:219], v214 offset:25600
    v_mfma_f32_16x16x32_bf16 v[104:107], a[200:203], a[184:187], v[104:107]
    buffer_load_dwordx4 v6, s[12:15], s28 offen offset:2048 lds
    v_mfma_f32_16x16x32_bf16 v[108:111], a[200:203], a[188:191], v[108:111]
    s_waitcnt lgkmcnt(6)
    v_mfma_f32_16x16x32_bf16 v[112:115], a[204:207], a[176:179], v[112:115]
    ds_read_b64_tr_b16 a[220:221], v215 offset:24576
    v_mfma_f32_16x16x32_bf16 v[116:119], a[204:207], a[180:183], v[116:119]
    ds_read_b64_tr_b16 a[222:223], v215 offset:25600
    v_mfma_f32_16x16x32_bf16 v[120:123], a[204:207], a[184:187], v[120:123]
    buffer_load_dwordx4 a[112:115], v16, s[16:19], s29 offen offset:2048
    v_mfma_f32_16x16x32_bf16 v[124:127], a[204:207], a[188:191], v[124:127]
    s_waitcnt vmcnt(32) lgkmcnt(0)
    s_barrier
    v_mfma_f32_16x16x32_bf16 v[128:131], a[208:211], a[176:179], v[128:131]
    ds_read_b64_tr_b16 a[192:193], v200 offset:0
    v_mfma_f32_16x16x32_bf16 v[132:135], a[208:211], a[180:183], v[132:135]
    ds_read_b64_tr_b16 a[194:195], v200 offset:1024
    v_mfma_f32_16x16x32_bf16 v[136:139], a[208:211], a[184:187], v[136:139]
    buffer_load_dwordx4 a[116:119], v16, s[16:19], s29 offen offset:2304
    v_mfma_f32_16x16x32_bf16 v[140:143], a[208:211], a[188:191], v[140:143]
    s_waitcnt lgkmcnt(6)
    v_mfma_f32_16x16x32_bf16 v[144:147], a[212:215], a[176:179], v[144:147]
    ds_read_b64_tr_b16 a[196:197], v201 offset:0
    v_mfma_f32_16x16x32_bf16 v[148:151], a[212:215], a[180:183], v[148:151]
    ds_read_b64_tr_b16 a[198:199], v201 offset:1024
    v_mfma_f32_16x16x32_bf16 v[152:155], a[212:215], a[184:187], v[152:155]
    buffer_load_dwordx4 v7, s[12:15], s28 offen offset:3072 lds
    v_mfma_f32_16x16x32_bf16 v[156:159], a[212:215], a[188:191], v[156:159]
    s_waitcnt lgkmcnt(6)
    v_mfma_f32_16x16x32_bf16 v[160:163], a[216:219], a[176:179], v[160:163]
    ds_read_b64_tr_b16 a[200:201], v202 offset:0
    v_mfma_f32_16x16x32_bf16 v[164:167], a[216:219], a[180:183], v[164:167]
    ds_read_b64_tr_b16 a[202:203], v202 offset:1024
    v_mfma_f32_16x16x32_bf16 v[168:171], a[216:219], a[184:187], v[168:171]
    buffer_load_dwordx4 a[120:123], v17, s[16:19], s29 offen offset:2048
    v_mfma_f32_16x16x32_bf16 v[172:175], a[216:219], a[188:191], v[172:175]
    s_waitcnt lgkmcnt(6)
    v_mfma_f32_16x16x32_bf16 v[176:179], a[220:223], a[176:179], v[176:179]
    ds_read_b64_tr_b16 a[204:205], v203 offset:0
    v_mfma_f32_16x16x32_bf16 v[180:183], a[220:223], a[180:183], v[180:183]
    ds_read_b64_tr_b16 a[206:207], v203 offset:1024
    v_mfma_f32_16x16x32_bf16 v[184:187], a[220:223], a[184:187], v[184:187]
    buffer_load_dwordx4 a[124:127], v17, s[16:19], s29 offen offset:2304
    v_mfma_f32_16x16x32_bf16 v[188:191], a[220:223], a[188:191], v[188:191]
    s_waitcnt lgkmcnt(6)
    v_mfma_f32_16x16x32_bf16 v[64:67], a[192:195], a[0:3], v[64:67]
    ds_read_b64_tr_b16 a[208:209], v204 offset:0
    v_mfma_f32_16x16x32_bf16 v[68:71], a[192:195], a[4:7], v[68:71]
    ds_read_b64_tr_b16 a[210:211], v204 offset:1024
    s_add_u32 s28, s28, 458752
    s_add_u32 m0, s30, 65536
    v_mfma_f32_16x16x32_bf16 v[72:75], a[192:195], a[8:11], v[72:75]
    buffer_load_dwordx4 v4, s[12:15], s28 offen offset:0 lds
    v_mfma_f32_16x16x32_bf16 v[76:79], a[192:195], a[12:15], v[76:79]
    s_waitcnt lgkmcnt(6)
    v_mfma_f32_16x16x32_bf16 v[80:83], a[196:199], a[0:3], v[80:83]
    ds_read_b64_tr_b16 a[212:213], v205 offset:0
    v_mfma_f32_16x16x32_bf16 v[84:87], a[196:199], a[4:7], v[84:87]
    ds_read_b64_tr_b16 a[214:215], v205 offset:1024
    s_mov_b32 s29, 40960
    v_mfma_f32_16x16x32_bf16 v[88:91], a[196:199], a[8:11], v[88:91]
    buffer_load_dwordx4 a[128:131], v16, s[16:19], s29 offen offset:0
    v_mfma_f32_16x16x32_bf16 v[92:95], a[196:199], a[12:15], v[92:95]
    s_waitcnt lgkmcnt(6)
    v_mfma_f32_16x16x32_bf16 v[96:99], a[200:203], a[0:3], v[96:99]
    ds_read_b64_tr_b16 a[216:217], v206 offset:0
    v_mfma_f32_16x16x32_bf16 v[100:103], a[200:203], a[4:7], v[100:103]
    ds_read_b64_tr_b16 a[218:219], v206 offset:1024
    v_mfma_f32_16x16x32_bf16 v[104:107], a[200:203], a[8:11], v[104:107]
    buffer_load_dwordx4 a[132:135], v16, s[16:19], s29 offen offset:256
    v_mfma_f32_16x16x32_bf16 v[108:111], a[200:203], a[12:15], v[108:111]
    s_waitcnt lgkmcnt(6)
    v_mfma_f32_16x16x32_bf16 v[112:115], a[204:207], a[0:3], v[112:115]
    ds_read_b64_tr_b16 a[220:221], v207 offset:0
    v_mfma_f32_16x16x32_bf16 v[116:119], a[204:207], a[4:7], v[116:119]
    ds_read_b64_tr_b16 a[222:223], v207 offset:1024
    v_mfma_f32_16x16x32_bf16 v[120:123], a[204:207], a[8:11], v[120:123]
    buffer_load_dwordx4 v5, s[12:15], s28 offen offset:1024 lds
    v_mfma_f32_16x16x32_bf16 v[124:127], a[204:207], a[12:15], v[124:127]
    s_waitcnt lgkmcnt(6)
    v_mfma_f32_16x16x32_bf16 v[128:131], a[208:211], a[0:3], v[128:131]
    ds_read_b64_tr_b16 a[192:193], v200 offset:8192
    v_mfma_f32_16x16x32_bf16 v[132:135], a[208:211], a[4:7], v[132:135]
    ds_read_b64_tr_b16 a[194:195], v200 offset:9216
    v_mfma_f32_16x16x32_bf16 v[136:139], a[208:211], a[8:11], v[136:139]
    buffer_load_dwordx4 a[136:139], v17, s[16:19], s29 offen offset:0
    v_mfma_f32_16x16x32_bf16 v[140:143], a[208:211], a[12:15], v[140:143]
    s_waitcnt lgkmcnt(6)
    v_mfma_f32_16x16x32_bf16 v[144:147], a[212:215], a[0:3], v[144:147]
    ds_read_b64_tr_b16 a[196:197], v201 offset:8192
    v_mfma_f32_16x16x32_bf16 v[148:151], a[212:215], a[4:7], v[148:151]
    ds_read_b64_tr_b16 a[198:199], v201 offset:9216
    v_mfma_f32_16x16x32_bf16 v[152:155], a[212:215], a[8:11], v[152:155]
    buffer_load_dwordx4 a[140:143], v17, s[16:19], s29 offen offset:256
    v_mfma_f32_16x16x32_bf16 v[156:159], a[212:215], a[12:15], v[156:159]
    s_waitcnt lgkmcnt(6)
    v_mfma_f32_16x16x32_bf16 v[160:163], a[216:219], a[0:3], v[160:163]
    ds_read_b64_tr_b16 a[200:201], v202 offset:8192
    v_mfma_f32_16x16x32_bf16 v[164:167], a[216:219], a[4:7], v[164:167]
    ds_read_b64_tr_b16 a[202:203], v202 offset:9216
    v_mfma_f32_16x16x32_bf16 v[168:171], a[216:219], a[8:11], v[168:171]
    buffer_load_dwordx4 v6, s[12:15], s28 offen offset:2048 lds
    v_mfma_f32_16x16x32_bf16 v[172:175], a[216:219], a[12:15], v[172:175]
    s_waitcnt lgkmcnt(6)
    v_mfma_f32_16x16x32_bf16 v[176:179], a[220:223], a[0:3], v[176:179]
    ds_read_b64_tr_b16 a[204:205], v203 offset:8192
    v_mfma_f32_16x16x32_bf16 v[180:183], a[220:223], a[4:7], v[180:183]
    ds_read_b64_tr_b16 a[206:207], v203 offset:9216
    v_mfma_f32_16x16x32_bf16 v[184:187], a[220:223], a[8:11], v[184:187]
    buffer_load_dwordx4 a[144:147], v16, s[16:19], s29 offen offset:2048
    v_mfma_f32_16x16x32_bf16 v[188:191], a[220:223], a[12:15], v[188:191]
    s_waitcnt lgkmcnt(6)
    v_mfma_f32_16x16x32_bf16 v[64:67], a[192:195], a[16:19], v[64:67]
    ds_read_b64_tr_b16 a[208:209], v204 offset:8192
    v_mfma_f32_16x16x32_bf16 v[68:71], a[192:195], a[20:23], v[68:71]
    ds_read_b64_tr_b16 a[210:211], v204 offset:9216
    v_mfma_f32_16x16x32_bf16 v[72:75], a[192:195], a[24:27], v[72:75]
    buffer_load_dwordx4 a[148:151], v16, s[16:19], s29 offen offset:2304
    v_mfma_f32_16x16x32_bf16 v[76:79], a[192:195], a[28:31], v[76:79]
    s_waitcnt lgkmcnt(6)
    v_mfma_f32_16x16x32_bf16 v[80:83], a[196:199], a[16:19], v[80:83]
    ds_read_b64_tr_b16 a[212:213], v205 offset:8192
    v_mfma_f32_16x16x32_bf16 v[84:87], a[196:199], a[20:23], v[84:87]
    ds_read_b64_tr_b16 a[214:215], v205 offset:9216
    v_mfma_f32_16x16x32_bf16 v[88:91], a[196:199], a[24:27], v[88:91]
    buffer_load_dwordx4 v7, s[12:15], s28 offen offset:3072 lds
    v_mfma_f32_16x16x32_bf16 v[92:95], a[196:199], a[28:31], v[92:95]
    s_waitcnt lgkmcnt(6)
    v_mfma_f32_16x16x32_bf16 v[96:99], a[200:203], a[16:19], v[96:99]
    ds_read_b64_tr_b16 a[216:217], v206 offset:8192
    v_mfma_f32_16x16x32_bf16 v[100:103], a[200:203], a[20:23], v[100:103]
    ds_read_b64_tr_b16 a[218:219], v206 offset:9216
    v_mfma_f32_16x16x32_bf16 v[104:107], a[200:203], a[24:27], v[104:107]
    buffer_load_dwordx4 a[152:155], v17, s[16:19], s29 offen offset:2048
    v_mfma_f32_16x16x32_bf16 v[108:111], a[200:203], a[28:31], v[108:111]
    s_waitcnt lgkmcnt(6)
    v_mfma_f32_16x16x32_bf16 v[112:115], a[204:207], a[16:19], v[112:115]
    ds_read_b64_tr_b16 a[220:221], v207 offset:8192
    v_mfma_f32_16x16x32_bf16 v[116:119], a[204:207], a[20:23], v[116:119]
    ds_read_b64_tr_b16 a[222:223], v207 offset:9216
    v_mfma_f32_16x16x32_bf16 v[120:123], a[204:207], a[24:27], v[120:123]
    buffer_load_dwordx4 a[156:159], v17, s[16:19], s29 offen offset:2304
    v_mfma_f32_16x16x32_bf16 v[124:127], a[204:207], a[28:31], v[124:127]
    s_waitcnt vmcnt(36) lgkmcnt(0)
    s_barrier
    v_mfma_f32_16x16x32_bf16 v[128:131], a[208:211], a[16:19], v[128:131]
    ds_read_b64_tr_b16 a[192:193], v200 offset:16384
    v_mfma_f32_16x16x32_bf16 v[132:135], a[208:211], a[20:23], v[132:135]
    ds_read_b64_tr_b16 a[194:195], v200 offset:17408
    s_add_u32 s28, s28, 458752
    s_add_u32 m0, s30, 81920
    v_mfma_f32_16x16x32_bf16 v[136:139], a[208:211], a[24:27], v[136:139]
    buffer_load_dwordx4 v4, s[12:15], s28 offen offset:0 lds
    v_mfma_f32_16x16x32_bf16 v[140:143], a[208:211], a[28:31], v[140:143]
    s_waitcnt lgkmcnt(6)
    v_mfma_f32_16x16x32_bf16 v[144:147], a[212:215], a[16:19], v[144:147]
    ds_read_b64_tr_b16 a[196:197], v201 offset:16384
    v_mfma_f32_16x16x32_bf16 v[148:151], a[212:215], a[20:23], v[148:151]
    ds_read_b64_tr_b16 a[198:199], v201 offset:17408
    s_mov_b32 s29, 45056
    v_mfma_f32_16x16x32_bf16 v[152:155], a[212:215], a[24:27], v[152:155]
    buffer_load_dwordx4 a[160:163], v16, s[16:19], s29 offen offset:0
    v_mfma_f32_16x16x32_bf16 v[156:159], a[212:215], a[28:31], v[156:159]
    s_waitcnt lgkmcnt(6)
    v_mfma_f32_16x16x32_bf16 v[160:163], a[216:219], a[16:19], v[160:163]
    ds_read_b64_tr_b16 a[200:201], v202 offset:16384
    v_mfma_f32_16x16x32_bf16 v[164:167], a[216:219], a[20:23], v[164:167]
    ds_read_b64_tr_b16 a[202:203], v202 offset:17408
    v_mfma_f32_16x16x32_bf16 v[168:171], a[216:219], a[24:27], v[168:171]
    buffer_load_dwordx4 a[164:167], v16, s[16:19], s29 offen offset:256
    v_mfma_f32_16x16x32_bf16 v[172:175], a[216:219], a[28:31], v[172:175]
    s_waitcnt lgkmcnt(6)
    v_mfma_f32_16x16x32_bf16 v[176:179], a[220:223], a[16:19], v[176:179]
    ds_read_b64_tr_b16 a[204:205], v203 offset:16384
    v_mfma_f32_16x16x32_bf16 v[180:183], a[220:223], a[20:23], v[180:183]
    ds_read_b64_tr_b16 a[206:207], v203 offset:17408
    v_mfma_f32_16x16x32_bf16 v[184:187], a[220:223], a[24:27], v[184:187]
    buffer_load_dwordx4 v5, s[12:15], s28 offen offset:1024 lds
    v_mfma_f32_16x16x32_bf16 v[188:191], a[220:223], a[28:31], v[188:191]
    s_waitcnt lgkmcnt(6)
    v_mfma_f32_16x16x32_bf16 v[64:67], a[192:195], a[32:35], v[64:67]
    ds_read_b64_tr_b16 a[208:209], v204 offset:16384
    v_mfma_f32_16x16x32_bf16 v[68:71], a[192:195], a[36:39], v[68:71]
    ds_read_b64_tr_b16 a[210:211], v204 offset:17408
    v_mfma_f32_16x16x32_bf16 v[72:75], a[192:195], a[40:43], v[72:75]
    buffer_load_dwordx4 a[168:171], v17, s[16:19], s29 offen offset:0
    v_mfma_f32_16x16x32_bf16 v[76:79], a[192:195], a[44:47], v[76:79]
    s_waitcnt lgkmcnt(6)
    v_mfma_f32_16x16x32_bf16 v[80:83], a[196:199], a[32:35], v[80:83]
    ds_read_b64_tr_b16 a[212:213], v205 offset:16384
    v_mfma_f32_16x16x32_bf16 v[84:87], a[196:199], a[36:39], v[84:87]
    ds_read_b64_tr_b16 a[214:215], v205 offset:17408
    v_mfma_f32_16x16x32_bf16 v[88:91], a[196:199], a[40:43], v[88:91]
    buffer_load_dwordx4 a[172:175], v17, s[16:19], s29 offen offset:256
    v_mfma_f32_16x16x32_bf16 v[92:95], a[196:199], a[44:47], v[92:95]
    s_waitcnt lgkmcnt(6)
    v_mfma_f32_16x16x32_bf16 v[96:99], a[200:203], a[32:35], v[96:99]
    ds_read_b64_tr_b16 a[216:217], v206 offset:16384
    v_mfma_f32_16x16x32_bf16 v[100:103], a[200:203], a[36:39], v[100:103]
    ds_read_b64_tr_b16 a[218:219], v206 offset:17408
    v_mfma_f32_16x16x32_bf16 v[104:107], a[200:203], a[40:43], v[104:107]
    buffer_load_dwordx4 v6, s[12:15], s28 offen offset:2048 lds
    v_mfma_f32_16x16x32_bf16 v[108:111], a[200:203], a[44:47], v[108:111]
    s_waitcnt lgkmcnt(6)
    v_mfma_f32_16x16x32_bf16 v[112:115], a[204:207], a[32:35], v[112:115]
    ds_read_b64_tr_b16 a[220:221], v207 offset:16384
    v_mfma_f32_16x16x32_bf16 v[116:119], a[204:207], a[36:39], v[116:119]
    ds_read_b64_tr_b16 a[222:223], v207 offset:17408
    v_mfma_f32_16x16x32_bf16 v[120:123], a[204:207], a[40:43], v[120:123]
    buffer_load_dwordx4 a[176:179], v16, s[16:19], s29 offen offset:2048
    v_mfma_f32_16x16x32_bf16 v[124:127], a[204:207], a[44:47], v[124:127]
    s_waitcnt lgkmcnt(6)
    v_mfma_f32_16x16x32_bf16 v[128:131], a[208:211], a[32:35], v[128:131]
    ds_read_b64_tr_b16 a[192:193], v200 offset:24576
    v_mfma_f32_16x16x32_bf16 v[132:135], a[208:211], a[36:39], v[132:135]
    ds_read_b64_tr_b16 a[194:195], v200 offset:25600
    v_mfma_f32_16x16x32_bf16 v[136:139], a[208:211], a[40:43], v[136:139]
    buffer_load_dwordx4 a[180:183], v16, s[16:19], s29 offen offset:2304
    v_mfma_f32_16x16x32_bf16 v[140:143], a[208:211], a[44:47], v[140:143]
    s_waitcnt lgkmcnt(6)
    v_mfma_f32_16x16x32_bf16 v[144:147], a[212:215], a[32:35], v[144:147]
    ds_read_b64_tr_b16 a[196:197], v201 offset:24576
    v_mfma_f32_16x16x32_bf16 v[148:151], a[212:215], a[36:39], v[148:151]
    ds_read_b64_tr_b16 a[198:199], v201 offset:25600
    v_mfma_f32_16x16x32_bf16 v[152:155], a[212:215], a[40:43], v[152:155]
    buffer_load_dwordx4 v7, s[12:15], s28 offen offset:3072 lds
    v_mfma_f32_16x16x32_bf16 v[156:159], a[212:215], a[44:47], v[156:159]
    s_waitcnt lgkmcnt(6)
    v_mfma_f32_16x16x32_bf16 v[160:163], a[216:219], a[32:35], v[160:163]
    ds_read_b64_tr_b16 a[200:201], v202 offset:24576
    v_mfma_f32_16x16x32_bf16 v[164:167], a[216:219], a[36:39], v[164:167]
    ds_read_b64_tr_b16 a[202:203], v202 offset:25600
    v_mfma_f32_16x16x32_bf16 v[168:171], a[216:219], a[40:43], v[168:171]
    buffer_load_dwordx4 a[184:187], v17, s[16:19], s29 offen offset:2048
    v_mfma_f32_16x16x32_bf16 v[172:175], a[216:219], a[44:47], v[172:175]
    s_waitcnt lgkmcnt(6)
    v_mfma_f32_16x16x32_bf16 v[176:179], a[220:223], a[32:35], v[176:179]
    ds_read_b64_tr_b16 a[204:205], v203 offset:24576
    v_mfma_f32_16x16x32_bf16 v[180:183], a[220:223], a[36:39], v[180:183]
    ds_read_b64_tr_b16 a[206:207], v203 offset:25600
    v_mfma_f32_16x16x32_bf16 v[184:187], a[220:223], a[40:43], v[184:187]
    buffer_load_dwordx4 a[188:191], v17, s[16:19], s29 offen offset:2304
    v_mfma_f32_16x16x32_bf16 v[188:191], a[220:223], a[44:47], v[188:191]
    s_waitcnt lgkmcnt(6)
    v_mfma_f32_16x16x32_bf16 v[64:67], a[192:195], a[48:51], v[64:67]
    ds_read_b64_tr_b16 a[208:209], v204 offset:24576
    v_mfma_f32_16x16x32_bf16 v[68:71], a[192:195], a[52:55], v[68:71]
    ds_read_b64_tr_b16 a[210:211], v204 offset:25600
    s_add_u32 s28, s28, 458752
    s_add_u32 m0, s30, 0
    v_mfma_f32_16x16x32_bf16 v[72:75], a[192:195], a[56:59], v[72:75]
    buffer_load_dwordx4 v4, s[12:15], s28 offen offset:0 lds
    v_mfma_f32_16x16x32_bf16 v[76:79], a[192:195], a[60:63], v[76:79]
    s_waitcnt lgkmcnt(6)
    v_mfma_f32_16x16x32_bf16 v[80:83], a[196:199], a[48:51], v[80:83]
    ds_read_b64_tr_b16 a[212:213], v205 offset:24576
    v_mfma_f32_16x16x32_bf16 v[84:87], a[196:199], a[52:55], v[84:87]
    ds_read_b64_tr_b16 a[214:215], v205 offset:25600
    s_mov_b32 s29, 49152
    v_mfma_f32_16x16x32_bf16 v[88:91], a[196:199], a[56:59], v[88:91]
    buffer_load_dwordx4 a[0:3], v16, s[16:19], s29 offen offset:0
    v_mfma_f32_16x16x32_bf16 v[92:95], a[196:199], a[60:63], v[92:95]
    s_waitcnt lgkmcnt(6)
    v_mfma_f32_16x16x32_bf16 v[96:99], a[200:203], a[48:51], v[96:99]
    ds_read_b64_tr_b16 a[216:217], v206 offset:24576
    v_mfma_f32_16x16x32_bf16 v[100:103], a[200:203], a[52:55], v[100:103]
    ds_read_b64_tr_b16 a[218:219], v206 offset:25600
    v_mfma_f32_16x16x32_bf16 v[104:107], a[200:203], a[56:59], v[104:107]
    buffer_load_dwordx4 a[4:7], v16, s[16:19], s29 offen offset:256
    v_mfma_f32_16x16x32_bf16 v[108:111], a[200:203], a[60:63], v[108:111]
    s_waitcnt lgkmcnt(6)
    v_mfma_f32_16x16x32_bf16 v[112:115], a[204:207], a[48:51], v[112:115]
    ds_read_b64_tr_b16 a[220:221], v207 offset:24576
    v_mfma_f32_16x16x32_bf16 v[116:119], a[204:207], a[52:55], v[116:119]
    ds_read_b64_tr_b16 a[222:223], v207 offset:25600
    v_mfma_f32_16x16x32_bf16 v[120:123], a[204:207], a[56:59], v[120:123]
    buffer_load_dwordx4 v5, s[12:15], s28 offen offset:1024 lds
    v_mfma_f32_16x16x32_bf16 v[124:127], a[204:207], a[60:63], v[124:127]
    s_waitcnt vmcnt(40) lgkmcnt(0)
    s_barrier
    v_mfma_f32_16x16x32_bf16 v[128:131], a[208:211], a[48:51], v[128:131]
    ds_read_b64_tr_b16 a[192:193], v200 offset:32768
    v_mfma_f32_16x16x32_bf16 v[132:135], a[208:211], a[52:55], v[132:135]
    ds_read_b64_tr_b16 a[194:195], v200 offset:33792
    v_mfma_f32_16x16x32_bf16 v[136:139], a[208:211], a[56:59], v[136:139]
    buffer_load_dwordx4 a[8:11], v17, s[16:19], s29 offen offset:0
    v_mfma_f32_16x16x32_bf16 v[140:143], a[208:211], a[60:63], v[140:143]
    s_waitcnt lgkmcnt(6)
    v_mfma_f32_16x16x32_bf16 v[144:147], a[212:215], a[48:51], v[144:147]
    ds_read_b64_tr_b16 a[196:197], v201 offset:32768
    v_mfma_f32_16x16x32_bf16 v[148:151], a[212:215], a[52:55], v[148:151]
    ds_read_b64_tr_b16 a[198:199], v201 offset:33792
    v_mfma_f32_16x16x32_bf16 v[152:155], a[212:215], a[56:59], v[152:155]
    buffer_load_dwordx4 a[12:15], v17, s[16:19], s29 offen offset:256
    v_mfma_f32_16x16x32_bf16 v[156:159], a[212:215], a[60:63], v[156:159]
    s_waitcnt lgkmcnt(6)
    v_mfma_f32_16x16x32_bf16 v[160:163], a[216:219], a[48:51], v[160:163]
    ds_read_b64_tr_b16 a[200:201], v202 offset:32768
    v_mfma_f32_16x16x32_bf16 v[164:167], a[216:219], a[52:55], v[164:167]
    ds_read_b64_tr_b16 a[202:203], v202 offset:33792
    v_mfma_f32_16x16x32_bf16 v[168:171], a[216:219], a[56:59], v[168:171]
    buffer_load_dwordx4 v6, s[12:15], s28 offen offset:2048 lds
    v_mfma_f32_16x16x32_bf16 v[172:175], a[216:219], a[60:63], v[172:175]
    s_waitcnt lgkmcnt(6)
    v_mfma_f32_16x16x32_bf16 v[176:179], a[220:223], a[48:51], v[176:179]
    ds_read_b64_tr_b16 a[204:205], v203 offset:32768
    v_mfma_f32_16x16x32_bf16 v[180:183], a[220:223], a[52:55], v[180:183]
    ds_read_b64_tr_b16 a[206:207], v203 offset:33792
    v_mfma_f32_16x16x32_bf16 v[184:187], a[220:223], a[56:59], v[184:187]
    buffer_load_dwordx4 a[16:19], v16, s[16:19], s29 offen offset:2048
    v_mfma_f32_16x16x32_bf16 v[188:191], a[220:223], a[60:63], v[188:191]
    s_waitcnt lgkmcnt(6)
    v_mfma_f32_16x16x32_bf16 v[64:67], a[192:195], a[64:67], v[64:67]
    ds_read_b64_tr_b16 a[208:209], v204 offset:32768
    v_mfma_f32_16x16x32_bf16 v[68:71], a[192:195], a[68:71], v[68:71]
    ds_read_b64_tr_b16 a[210:211], v204 offset:33792
    v_mfma_f32_16x16x32_bf16 v[72:75], a[192:195], a[72:75], v[72:75]
    buffer_load_dwordx4 a[20:23], v16, s[16:19], s29 offen offset:2304
    v_mfma_f32_16x16x32_bf16 v[76:79], a[192:195], a[76:79], v[76:79]
    s_waitcnt lgkmcnt(6)
    v_mfma_f32_16x16x32_bf16 v[80:83], a[196:199], a[64:67], v[80:83]
    ds_read_b64_tr_b16 a[212:213], v205 offset:32768
    v_mfma_f32_16x16x32_bf16 v[84:87], a[196:199], a[68:71], v[84:87]
    ds_read_b64_tr_b16 a[214:215], v205 offset:33792
    v_mfma_f32_16x16x32_bf16 v[88:91], a[196:199], a[72:75], v[88:91]
    buffer_load_dwordx4 v7, s[12:15], s28 offen offset:3072 lds
    v_mfma_f32_16x16x32_bf16 v[92:95], a[196:199], a[76:79], v[92:95]
    s_waitcnt lgkmcnt(6)
    v_mfma_f32_16x16x32_bf16 v[96:99], a[200:203], a[64:67], v[96:99]
    ds_read_b64_tr_b16 a[216:217], v206 offset:32768
    v_mfma_f32_16x16x32_bf16 v[100:103], a[200:203], a[68:71], v[100:103]
    ds_read_b64_tr_b16 a[218:219], v206 offset:33792
    v_mfma_f32_16x16x32_bf16 v[104:107], a[200:203], a[72:75], v[104:107]
    buffer_load_dwordx4 a[24:27], v17, s[16:19], s29 offen offset:2048
    v_mfma_f32_16x16x32_bf16 v[108:111], a[200:203], a[76:79], v[108:111]
    s_waitcnt lgkmcnt(6)
    v_mfma_f32_16x16x32_bf16 v[112:115], a[204:207], a[64:67], v[112:115]
    ds_read_b64_tr_b16 a[220:221], v207 offset:32768
    v_mfma_f32_16x16x32_bf16 v[116:119], a[204:207], a[68:71], v[116:119]
    ds_read_b64_tr_b16 a[222:223], v207 offset:33792
    v_mfma_f32_16x16x32_bf16 v[120:123], a[204:207], a[72:75], v[120:123]
    buffer_load_dwordx4 a[28:31], v17, s[16:19], s29 offen offset:2304
    v_mfma_f32_16x16x32_bf16 v[124:127], a[204:207], a[76:79], v[124:127]
    s_waitcnt lgkmcnt(6)
    v_mfma_f32_16x16x32_bf16 v[128:131], a[208:211], a[64:67], v[128:131]
    ds_read_b64_tr_b16 a[192:193], v200 offset:40960
    v_mfma_f32_16x16x32_bf16 v[132:135], a[208:211], a[68:71], v[132:135]
    ds_read_b64_tr_b16 a[194:195], v200 offset:41984
    s_add_u32 s28, s28, 458752
    s_add_u32 m0, s30, 16384
    v_mfma_f32_16x16x32_bf16 v[136:139], a[208:211], a[72:75], v[136:139]
    buffer_load_dwordx4 v4, s[12:15], s28 offen offset:0 lds
    v_mfma_f32_16x16x32_bf16 v[140:143], a[208:211], a[76:79], v[140:143]
    s_waitcnt lgkmcnt(6)
    v_mfma_f32_16x16x32_bf16 v[144:147], a[212:215], a[64:67], v[144:147]
    ds_read_b64_tr_b16 a[196:197], v201 offset:40960
    v_mfma_f32_16x16x32_bf16 v[148:151], a[212:215], a[68:71], v[148:151]
    ds_read_b64_tr_b16 a[198:199], v201 offset:41984
    s_mov_b32 s29, 53248
    v_mfma_f32_16x16x32_bf16 v[152:155], a[212:215], a[72:75], v[152:155]
    buffer_load_dwordx4 a[32:35], v16, s[16:19], s29 offen offset:0
    v_mfma_f32_16x16x32_bf16 v[156:159], a[212:215], a[76:79], v[156:159]
    s_waitcnt lgkmcnt(6)
    v_mfma_f32_16x16x32_bf16 v[160:163], a[216:219], a[64:67], v[160:163]
    ds_read_b64_tr_b16 a[200:201], v202 offset:40960
    v_mfma_f32_16x16x32_bf16 v[164:167], a[216:219], a[68:71], v[164:167]
    ds_read_b64_tr_b16 a[202:203], v202 offset:41984
    v_mfma_f32_16x16x32_bf16 v[168:171], a[216:219], a[72:75], v[168:171]
    buffer_load_dwordx4 a[36:39], v16, s[16:19], s29 offen offset:256
    v_mfma_f32_16x16x32_bf16 v[172:175], a[216:219], a[76:79], v[172:175]
    s_waitcnt lgkmcnt(6)
    v_mfma_f32_16x16x32_bf16 v[176:179], a[220:223], a[64:67], v[176:179]
    ds_read_b64_tr_b16 a[204:205], v203 offset:40960
    v_mfma_f32_16x16x32_bf16 v[180:183], a[220:223], a[68:71], v[180:183]
    ds_read_b64_tr_b16 a[206:207], v203 offset:41984
    v_mfma_f32_16x16x32_bf16 v[184:187], a[220:223], a[72:75], v[184:187]
    buffer_load_dwordx4 v5, s[12:15], s28 offen offset:1024 lds
    v_mfma_f32_16x16x32_bf16 v[188:191], a[220:223], a[76:79], v[188:191]
    s_waitcnt lgkmcnt(6)
    v_mfma_f32_16x16x32_bf16 v[64:67], a[192:195], a[80:83], v[64:67]
    ds_read_b64_tr_b16 a[208:209], v204 offset:40960
    v_mfma_f32_16x16x32_bf16 v[68:71], a[192:195], a[84:87], v[68:71]
    ds_read_b64_tr_b16 a[210:211], v204 offset:41984
    v_mfma_f32_16x16x32_bf16 v[72:75], a[192:195], a[88:91], v[72:75]
    buffer_load_dwordx4 a[40:43], v17, s[16:19], s29 offen offset:0
    v_mfma_f32_16x16x32_bf16 v[76:79], a[192:195], a[92:95], v[76:79]
    s_waitcnt lgkmcnt(6)
    v_mfma_f32_16x16x32_bf16 v[80:83], a[196:199], a[80:83], v[80:83]
    ds_read_b64_tr_b16 a[212:213], v205 offset:40960
    v_mfma_f32_16x16x32_bf16 v[84:87], a[196:199], a[84:87], v[84:87]
    ds_read_b64_tr_b16 a[214:215], v205 offset:41984
    v_mfma_f32_16x16x32_bf16 v[88:91], a[196:199], a[88:91], v[88:91]
    buffer_load_dwordx4 a[44:47], v17, s[16:19], s29 offen offset:256
    v_mfma_f32_16x16x32_bf16 v[92:95], a[196:199], a[92:95], v[92:95]
    s_waitcnt lgkmcnt(6)
    v_mfma_f32_16x16x32_bf16 v[96:99], a[200:203], a[80:83], v[96:99]
    ds_read_b64_tr_b16 a[216:217], v206 offset:40960
    v_mfma_f32_16x16x32_bf16 v[100:103], a[200:203], a[84:87], v[100:103]
    ds_read_b64_tr_b16 a[218:219], v206 offset:41984
    v_mfma_f32_16x16x32_bf16 v[104:107], a[200:203], a[88:91], v[104:107]
    buffer_load_dwordx4 v6, s[12:15], s28 offen offset:2048 lds
    v_mfma_f32_16x16x32_bf16 v[108:111], a[200:203], a[92:95], v[108:111]
    s_waitcnt lgkmcnt(6)
    v_mfma_f32_16x16x32_bf16 v[112:115], a[204:207], a[80:83], v[112:115]
    ds_read_b64_tr_b16 a[220:221], v207 offset:40960
    v_mfma_f32_16x16x32_bf16 v[116:119], a[204:207], a[84:87], v[116:119]
    ds_read_b64_tr_b16 a[222:223], v207 offset:41984
    v_mfma_f32_16x16x32_bf16 v[120:123], a[204:207], a[88:91], v[120:123]
    buffer_load_dwordx4 a[48:51], v16, s[16:19], s29 offen offset:2048
    v_mfma_f32_16x16x32_bf16 v[124:127], a[204:207], a[92:95], v[124:127]
    s_waitcnt vmcnt(44) lgkmcnt(0)
    s_barrier
    v_mfma_f32_16x16x32_bf16 v[128:131], a[208:211], a[80:83], v[128:131]
    ds_read_b64_tr_b16 a[192:193], v200 offset:49152
    v_mfma_f32_16x16x32_bf16 v[132:135], a[208:211], a[84:87], v[132:135]
    ds_read_b64_tr_b16 a[194:195], v200 offset:50176
    v_mfma_f32_16x16x32_bf16 v[136:139], a[208:211], a[88:91], v[136:139]
    buffer_load_dwordx4 a[52:55], v16, s[16:19], s29 offen offset:2304
    v_mfma_f32_16x16x32_bf16 v[140:143], a[208:211], a[92:95], v[140:143]
    s_waitcnt lgkmcnt(6)
    v_mfma_f32_16x16x32_bf16 v[144:147], a[212:215], a[80:83], v[144:147]
    ds_read_b64_tr_b16 a[196:197], v201 offset:49152
    v_mfma_f32_16x16x32_bf16 v[148:151], a[212:215], a[84:87], v[148:151]
    ds_read_b64_tr_b16 a[198:199], v201 offset:50176
    v_mfma_f32_16x16x32_bf16 v[152:155], a[212:215], a[88:91], v[152:155]
    buffer_load_dwordx4 v7, s[12:15], s28 offen offset:3072 lds
    v_mfma_f32_16x16x32_bf16 v[156:159], a[212:215], a[92:95], v[156:159]
    s_waitcnt lgkmcnt(6)
    v_mfma_f32_16x16x32_bf16 v[160:163], a[216:219], a[80:83], v[160:163]
    ds_read_b64_tr_b16 a[200:201], v202 offset:49152
    v_mfma_f32_16x16x32_bf16 v[164:167], a[216:219], a[84:87], v[164:167]
    ds_read_b64_tr_b16 a[202:203], v202 offset:50176
    v_mfma_f32_16x16x32_bf16 v[168:171], a[216:219], a[88:91], v[168:171]
    buffer_load_dwordx4 a[56:59], v17, s[16:19], s29 offen offset:2048
    v_mfma_f32_16x16x32_bf16 v[172:175], a[216:219], a[92:95], v[172:175]
    s_waitcnt lgkmcnt(6)
    v_mfma_f32_16x16x32_bf16 v[176:179], a[220:223], a[80:83], v[176:179]
    ds_read_b64_tr_b16 a[204:205], v203 offset:49152
    v_mfma_f32_16x16x32_bf16 v[180:183], a[220:223], a[84:87], v[180:183]
    ds_read_b64_tr_b16 a[206:207], v203 offset:50176
    v_mfma_f32_16x16x32_bf16 v[184:187], a[220:223], a[88:91], v[184:187]
    buffer_load_dwordx4 a[60:63], v17, s[16:19], s29 offen offset:2304
    v_mfma_f32_16x16x32_bf16 v[188:191], a[220:223], a[92:95], v[188:191]
    s_waitcnt lgkmcnt(6)
    v_mfma_f32_16x16x32_bf16 v[64:67], a[192:195], a[96:99], v[64:67]
    ds_read_b64_tr_b16 a[208:209], v204 offset:49152
    v_mfma_f32_16x16x32_bf16 v[68:71], a[192:195], a[100:103], v[68:71]
    ds_read_b64_tr_b16 a[210:211], v204 offset:50176
    s_add_u32 s28, s28, 458752
    s_add_u32 m0, s30, 32768
    v_mfma_f32_16x16x32_bf16 v[72:75], a[192:195], a[104:107], v[72:75]
    buffer_load_dwordx4 v4, s[12:15], s28 offen offset:0 lds
    v_mfma_f32_16x16x32_bf16 v[76:79], a[192:195], a[108:111], v[76:79]
    s_waitcnt lgkmcnt(6)
    v_mfma_f32_16x16x32_bf16 v[80:83], a[196:199], a[96:99], v[80:83]
    ds_read_b64_tr_b16 a[212:213], v205 offset:49152
    v_mfma_f32_16x16x32_bf16 v[84:87], a[196:199], a[100:103], v[84:87]
    ds_read_b64_tr_b16 a[214:215], v205 offset:50176
    s_mov_b32 s29, 57344
    v_mfma_f32_16x16x32_bf16 v[88:91], a[196:199], a[104:107], v[88:91]
    buffer_load_dwordx4 a[64:67], v16, s[16:19], s29 offen offset:0
    v_mfma_f32_16x16x32_bf16 v[92:95], a[196:199], a[108:111], v[92:95]
    s_waitcnt lgkmcnt(6)
    v_mfma_f32_16x16x32_bf16 v[96:99], a[200:203], a[96:99], v[96:99]
    ds_read_b64_tr_b16 a[216:217], v206 offset:49152
    v_mfma_f32_16x16x32_bf16 v[100:103], a[200:203], a[100:103], v[100:103]
    ds_read_b64_tr_b16 a[218:219], v206 offset:50176
    v_mfma_f32_16x16x32_bf16 v[104:107], a[200:203], a[104:107], v[104:107]
    buffer_load_dwordx4 a[68:71], v16, s[16:19], s29 offen offset:256
    v_mfma_f32_16x16x32_bf16 v[108:111], a[200:203], a[108:111], v[108:111]
    s_waitcnt lgkmcnt(6)
    v_mfma_f32_16x16x32_bf16 v[112:115], a[204:207], a[96:99], v[112:115]
    ds_read_b64_tr_b16 a[220:221], v207 offset:49152
    v_mfma_f32_16x16x32_bf16 v[116:119], a[204:207], a[100:103], v[116:119]
    ds_read_b64_tr_b16 a[222:223], v207 offset:50176
    v_mfma_f32_16x16x32_bf16 v[120:123], a[204:207], a[104:107], v[120:123]
    buffer_load_dwordx4 v5, s[12:15], s28 offen offset:1024 lds
    v_mfma_f32_16x16x32_bf16 v[124:127], a[204:207], a[108:111], v[124:127]
    s_waitcnt lgkmcnt(6)
    v_mfma_f32_16x16x32_bf16 v[128:131], a[208:211], a[96:99], v[128:131]
    ds_read_b64_tr_b16 a[192:193], v200 offset:57344
    v_mfma_f32_16x16x32_bf16 v[132:135], a[208:211], a[100:103], v[132:135]
    ds_read_b64_tr_b16 a[194:195], v200 offset:58368
    v_mfma_f32_16x16x32_bf16 v[136:139], a[208:211], a[104:107], v[136:139]
    buffer_load_dwordx4 a[72:75], v17, s[16:19], s29 offen offset:0
    v_mfma_f32_16x16x32_bf16 v[140:143], a[208:211], a[108:111], v[140:143]
    s_waitcnt lgkmcnt(6)
    v_mfma_f32_16x16x32_bf16 v[144:147], a[212:215], a[96:99], v[144:147]
    ds_read_b64_tr_b16 a[196:197], v201 offset:57344
    v_mfma_f32_16x16x32_bf16 v[148:151], a[212:215], a[100:103], v[148:151]
    ds_read_b64_tr_b16 a[198:199], v201 offset:58368
    v_mfma_f32_16x16x32_bf16 v[152:155], a[212:215], a[104:107], v[152:155]
    buffer_load_dwordx4 a[76:79], v17, s[16:19], s29 offen offset:256
    v_mfma_f32_16x16x32_bf16 v[156:159], a[212:215], a[108:111], v[156:159]
    s_waitcnt lgkmcnt(6)
    v_mfma_f32_16x16x32_bf16 v[160:163], a[216:219], a[96:99], v[160:163]
    ds_read_b64_tr_b16 a[200:201], v202 offset:57344
    v_mfma_f32_16x16x32_bf16 v[164:167], a[216:219], a[100:103], v[164:167]
    ds_read_b64_tr_b16 a[202:203], v202 offset:58368
    v_mfma_f32_16x16x32_bf16 v[168:171], a[216:219], a[104:107], v[168:171]
    buffer_load_dwordx4 v6, s[12:15], s28 offen offset:2048 lds
    v_mfma_f32_16x16x32_bf16 v[172:175], a[216:219], a[108:111], v[172:175]
    s_waitcnt lgkmcnt(6)
    v_mfma_f32_16x16x32_bf16 v[176:179], a[220:223], a[96:99], v[176:179]
    ds_read_b64_tr_b16 a[204:205], v203 offset:57344
    v_mfma_f32_16x16x32_bf16 v[180:183], a[220:223], a[100:103], v[180:183]
    ds_read_b64_tr_b16 a[206:207], v203 offset:58368
    v_mfma_f32_16x16x32_bf16 v[184:187], a[220:223], a[104:107], v[184:187]
    buffer_load_dwordx4 a[80:83], v16, s[16:19], s29 offen offset:2048
    v_mfma_f32_16x16x32_bf16 v[188:191], a[220:223], a[108:111], v[188:191]
    s_waitcnt lgkmcnt(6)
    v_mfma_f32_16x16x32_bf16 v[64:67], a[192:195], a[112:115], v[64:67]
    ds_read_b64_tr_b16 a[208:209], v204 offset:57344
    v_mfma_f32_16x16x32_bf16 v[68:71], a[192:195], a[116:119], v[68:71]
    ds_read_b64_tr_b16 a[210:211], v204 offset:58368
    v_mfma_f32_16x16x32_bf16 v[72:75], a[192:195], a[120:123], v[72:75]
    buffer_load_dwordx4 a[84:87], v16, s[16:19], s29 offen offset:2304
    v_mfma_f32_16x16x32_bf16 v[76:79], a[192:195], a[124:127], v[76:79]
    s_waitcnt lgkmcnt(6)
    v_mfma_f32_16x16x32_bf16 v[80:83], a[196:199], a[112:115], v[80:83]
    ds_read_b64_tr_b16 a[212:213], v205 offset:57344
    v_mfma_f32_16x16x32_bf16 v[84:87], a[196:199], a[116:119], v[84:87]
    ds_read_b64_tr_b16 a[214:215], v205 offset:58368
    v_mfma_f32_16x16x32_bf16 v[88:91], a[196:199], a[120:123], v[88:91]
    buffer_load_dwordx4 v7, s[12:15], s28 offen offset:3072 lds
    v_mfma_f32_16x16x32_bf16 v[92:95], a[196:199], a[124:127], v[92:95]
    s_waitcnt lgkmcnt(6)
    v_mfma_f32_16x16x32_bf16 v[96:99], a[200:203], a[112:115], v[96:99]
    ds_read_b64_tr_b16 a[216:217], v206 offset:57344
    v_mfma_f32_16x16x32_bf16 v[100:103], a[200:203], a[116:119], v[100:103]
    ds_read_b64_tr_b16 a[218:219], v206 offset:58368
    v_mfma_f32_16x16x32_bf16 v[104:107], a[200:203], a[120:123], v[104:107]
    buffer_load_dwordx4 a[88:91], v17, s[16:19], s29 offen offset:2048
    v_mfma_f32_16x16x32_bf16 v[108:111], a[200:203], a[124:127], v[108:111]
    s_waitcnt lgkmcnt(6)
    v_mfma_f32_16x16x32_bf16 v[112:115], a[204:207], a[112:115], v[112:115]
    ds_read_b64_tr_b16 a[220:221], v207 offset:57344
    v_mfma_f32_16x16x32_bf16 v[116:119], a[204:207], a[116:119], v[116:119]
    ds_read_b64_tr_b16 a[222:223], v207 offset:58368
    v_mfma_f32_16x16x32_bf16 v[120:123], a[204:207], a[120:123], v[120:123]
    buffer_load_dwordx4 a[92:95], v17, s[16:19], s29 offen offset:2304
    v_mfma_f32_16x16x32_bf16 v[124:127], a[204:207], a[124:127], v[124:127]
    s_waitcnt vmcnt(48) lgkmcnt(0)
    s_barrier
    v_mfma_f32_16x16x32_bf16 v[128:131], a[208:211], a[112:115], v[128:131]
    ds_read_b64_tr_b16 a[192:193], v208 offset:0
    v_mfma_f32_16x16x32_bf16 v[132:135], a[208:211], a[116:119], v[132:135]
    ds_read_b64_tr_b16 a[194:195], v208 offset:1024
    s_add_u32 s28, s28, 458752
    s_add_u32 m0, s30, 49152
    v_mfma_f32_16x16x32_bf16 v[136:139], a[208:211], a[120:123], v[136:139]
    buffer_load_dwordx4 v4, s[12:15], s28 offen offset:0 lds
    v_mfma_f32_16x16x32_bf16 v[140:143], a[208:211], a[124:127], v[140:143]
    s_waitcnt lgkmcnt(6)
    v_mfma_f32_16x16x32_bf16 v[144:147], a[212:215], a[112:115], v[144:147]
    ds_read_b64_tr_b16 a[196:197], v209 offset:0
    v_mfma_f32_16x16x32_bf16 v[148:151], a[212:215], a[116:119], v[148:151]
    ds_read_b64_tr_b16 a[198:199], v209 offset:1024
    s_mov_b32 s29, 61440
    v_mfma_f32_16x16x32_bf16 v[152:155], a[212:215], a[120:123], v[152:155]
    buffer_load_dwordx4 a[96:99], v16, s[16:19], s29 offen offset:0
    v_mfma_f32_16x16x32_bf16 v[156:159], a[212:215], a[124:127], v[156:159]
    s_waitcnt lgkmcnt(6)
    v_mfma_f32_16x16x32_bf16 v[160:163], a[216:219], a[112:115], v[160:163]
    ds_read_b64_tr_b16 a[200:201], v210 offset:0
    v_mfma_f32_16x16x32_bf16 v[164:167], a[216:219], a[116:119], v[164:167]
    ds_read_b64_tr_b16 a[202:203], v210 offset:1024
    v_mfma_f32_16x16x32_bf16 v[168:171], a[216:219], a[120:123], v[168:171]
    buffer_load_dwordx4 a[100:103], v16, s[16:19], s29 offen offset:256
    v_mfma_f32_16x16x32_bf16 v[172:175], a[216:219], a[124:127], v[172:175]
    s_waitcnt lgkmcnt(6)
    v_mfma_f32_16x16x32_bf16 v[176:179], a[220:223], a[112:115], v[176:179]
    ds_read_b64_tr_b16 a[204:205], v211 offset:0
    v_mfma_f32_16x16x32_bf16 v[180:183], a[220:223], a[116:119], v[180:183]
    ds_read_b64_tr_b16 a[206:207], v211 offset:1024
    v_mfma_f32_16x16x32_bf16 v[184:187], a[220:223], a[120:123], v[184:187]
    buffer_load_dwordx4 v5, s[12:15], s28 offen offset:1024 lds
    v_mfma_f32_16x16x32_bf16 v[188:191], a[220:223], a[124:127], v[188:191]
    s_waitcnt lgkmcnt(6)
    v_mfma_f32_16x16x32_bf16 v[64:67], a[192:195], a[128:131], v[64:67]
    ds_read_b64_tr_b16 a[208:209], v212 offset:0
    v_mfma_f32_16x16x32_bf16 v[68:71], a[192:195], a[132:135], v[68:71]
    ds_read_b64_tr_b16 a[210:211], v212 offset:1024
    v_mfma_f32_16x16x32_bf16 v[72:75], a[192:195], a[136:139], v[72:75]
    buffer_load_dwordx4 a[104:107], v17, s[16:19], s29 offen offset:0
    v_mfma_f32_16x16x32_bf16 v[76:79], a[192:195], a[140:143], v[76:79]
    s_waitcnt lgkmcnt(6)
    v_mfma_f32_16x16x32_bf16 v[80:83], a[196:199], a[128:131], v[80:83]
    ds_read_b64_tr_b16 a[212:213], v213 offset:0
    v_mfma_f32_16x16x32_bf16 v[84:87], a[196:199], a[132:135], v[84:87]
    ds_read_b64_tr_b16 a[214:215], v213 offset:1024
    v_mfma_f32_16x16x32_bf16 v[88:91], a[196:199], a[136:139], v[88:91]
    buffer_load_dwordx4 a[108:111], v17, s[16:19], s29 offen offset:256
    v_mfma_f32_16x16x32_bf16 v[92:95], a[196:199], a[140:143], v[92:95]
    s_waitcnt lgkmcnt(6)
    v_mfma_f32_16x16x32_bf16 v[96:99], a[200:203], a[128:131], v[96:99]
    ds_read_b64_tr_b16 a[216:217], v214 offset:0
    v_mfma_f32_16x16x32_bf16 v[100:103], a[200:203], a[132:135], v[100:103]
    ds_read_b64_tr_b16 a[218:219], v214 offset:1024
    v_mfma_f32_16x16x32_bf16 v[104:107], a[200:203], a[136:139], v[104:107]
    buffer_load_dwordx4 v6, s[12:15], s28 offen offset:2048 lds
    v_mfma_f32_16x16x32_bf16 v[108:111], a[200:203], a[140:143], v[108:111]
    s_waitcnt lgkmcnt(6)
    v_mfma_f32_16x16x32_bf16 v[112:115], a[204:207], a[128:131], v[112:115]
    ds_read_b64_tr_b16 a[220:221], v215 offset:0
    v_mfma_f32_16x16x32_bf16 v[116:119], a[204:207], a[132:135], v[116:119]
    ds_read_b64_tr_b16 a[222:223], v215 offset:1024
    v_mfma_f32_16x16x32_bf16 v[120:123], a[204:207], a[136:139], v[120:123]
    buffer_load_dwordx4 a[112:115], v16, s[16:19], s29 offen offset:2048
    v_mfma_f32_16x16x32_bf16 v[124:127], a[204:207], a[140:143], v[124:127]
    s_waitcnt lgkmcnt(6)
    v_mfma_f32_16x16x32_bf16 v[128:131], a[208:211], a[128:131], v[128:131]
    ds_read_b64_tr_b16 a[192:193], v208 offset:8192
    v_mfma_f32_16x16x32_bf16 v[132:135], a[208:211], a[132:135], v[132:135]
    ds_read_b64_tr_b16 a[194:195], v208 offset:9216
    v_mfma_f32_16x16x32_bf16 v[136:139], a[208:211], a[136:139], v[136:139]
    buffer_load_dwordx4 a[116:119], v16, s[16:19], s29 offen offset:2304
    v_mfma_f32_16x16x32_bf16 v[140:143], a[208:211], a[140:143], v[140:143]
    s_waitcnt lgkmcnt(6)
    v_mfma_f32_16x16x32_bf16 v[144:147], a[212:215], a[128:131], v[144:147]
    ds_read_b64_tr_b16 a[196:197], v209 offset:8192
    v_mfma_f32_16x16x32_bf16 v[148:151], a[212:215], a[132:135], v[148:151]
    ds_read_b64_tr_b16 a[198:199], v209 offset:9216
    v_mfma_f32_16x16x32_bf16 v[152:155], a[212:215], a[136:139], v[152:155]
    buffer_load_dwordx4 v7, s[12:15], s28 offen offset:3072 lds
    v_mfma_f32_16x16x32_bf16 v[156:159], a[212:215], a[140:143], v[156:159]
    s_waitcnt lgkmcnt(6)
    v_mfma_f32_16x16x32_bf16 v[160:163], a[216:219], a[128:131], v[160:163]
    ds_read_b64_tr_b16 a[200:201], v210 offset:8192
    v_mfma_f32_16x16x32_bf16 v[164:167], a[216:219], a[132:135], v[164:167]
    ds_read_b64_tr_b16 a[202:203], v210 offset:9216
    v_mfma_f32_16x16x32_bf16 v[168:171], a[216:219], a[136:139], v[168:171]
    buffer_load_dwordx4 a[120:123], v17, s[16:19], s29 offen offset:2048
    v_mfma_f32_16x16x32_bf16 v[172:175], a[216:219], a[140:143], v[172:175]
    s_waitcnt lgkmcnt(6)
    v_mfma_f32_16x16x32_bf16 v[176:179], a[220:223], a[128:131], v[176:179]
    ds_read_b64_tr_b16 a[204:205], v211 offset:8192
    v_mfma_f32_16x16x32_bf16 v[180:183], a[220:223], a[132:135], v[180:183]
    ds_read_b64_tr_b16 a[206:207], v211 offset:9216
    v_mfma_f32_16x16x32_bf16 v[184:187], a[220:223], a[136:139], v[184:187]
    buffer_load_dwordx4 a[124:127], v17, s[16:19], s29 offen offset:2304
    v_mfma_f32_16x16x32_bf16 v[188:191], a[220:223], a[140:143], v[188:191]
    s_waitcnt lgkmcnt(6)
    v_mfma_f32_16x16x32_bf16 v[64:67], a[192:195], a[144:147], v[64:67]
    ds_read_b64_tr_b16 a[208:209], v212 offset:8192
    v_mfma_f32_16x16x32_bf16 v[68:71], a[192:195], a[148:151], v[68:71]
    ds_read_b64_tr_b16 a[210:211], v212 offset:9216
    v_mfma_f32_16x16x32_bf16 v[72:75], a[192:195], a[152:155], v[72:75]
    v_mfma_f32_16x16x32_bf16 v[76:79], a[192:195], a[156:159], v[76:79]
    s_waitcnt lgkmcnt(6)
    v_mfma_f32_16x16x32_bf16 v[80:83], a[196:199], a[144:147], v[80:83]
    ds_read_b64_tr_b16 a[212:213], v213 offset:8192
    v_mfma_f32_16x16x32_bf16 v[84:87], a[196:199], a[148:151], v[84:87]
    ds_read_b64_tr_b16 a[214:215], v213 offset:9216
    v_mfma_f32_16x16x32_bf16 v[88:91], a[196:199], a[152:155], v[88:91]
    v_mfma_f32_16x16x32_bf16 v[92:95], a[196:199], a[156:159], v[92:95]
    s_waitcnt lgkmcnt(6)
    v_mfma_f32_16x16x32_bf16 v[96:99], a[200:203], a[144:147], v[96:99]
    ds_read_b64_tr_b16 a[216:217], v214 offset:8192
    v_mfma_f32_16x16x32_bf16 v[100:103], a[200:203], a[148:151], v[100:103]
    ds_read_b64_tr_b16 a[218:219], v214 offset:9216
    v_mfma_f32_16x16x32_bf16 v[104:107], a[200:203], a[152:155], v[104:107]
    v_mfma_f32_16x16x32_bf16 v[108:111], a[200:203], a[156:159], v[108:111]
    s_waitcnt lgkmcnt(6)
    v_mfma_f32_16x16x32_bf16 v[112:115], a[204:207], a[144:147], v[112:115]
    ds_read_b64_tr_b16 a[220:221], v215 offset:8192
    v_mfma_f32_16x16x32_bf16 v[116:119], a[204:207], a[148:151], v[116:119]
    ds_read_b64_tr_b16 a[222:223], v215 offset:9216
    v_mfma_f32_16x16x32_bf16 v[120:123], a[204:207], a[152:155], v[120:123]
    v_mfma_f32_16x16x32_bf16 v[124:127], a[204:207], a[156:159], v[124:127]
    s_waitcnt vmcnt(48) lgkmcnt(0)
    s_barrier
    v_mfma_f32_16x16x32_bf16 v[128:131], a[208:211], a[144:147], v[128:131]
    ds_read_b64_tr_b16 a[192:193], v208 offset:16384
    v_mfma_f32_16x16x32_bf16 v[132:135], a[208:211], a[148:151], v[132:135]
    ds_read_b64_tr_b16 a[194:195], v208 offset:17408
    v_mfma_f32_16x16x32_bf16 v[136:139], a[208:211], a[152:155], v[136:139]
    v_mfma_f32_16x16x32_bf16 v[140:143], a[208:211], a[156:159], v[140:143]
    s_waitcnt lgkmcnt(6)
    v_mfma_f32_16x16x32_bf16 v[144:147], a[212:215], a[144:147], v[144:147]
    ds_read_b64_tr_b16 a[196:197], v209 offset:16384
    v_mfma_f32_16x16x32_bf16 v[148:151], a[212:215], a[148:151], v[148:151]
    ds_read_b64_tr_b16 a[198:199], v209 offset:17408
    v_mfma_f32_16x16x32_bf16 v[152:155], a[212:215], a[152:155], v[152:155]
    v_mfma_f32_16x16x32_bf16 v[156:159], a[212:215], a[156:159], v[156:159]
    s_waitcnt lgkmcnt(6)
    v_mfma_f32_16x16x32_bf16 v[160:163], a[216:219], a[144:147], v[160:163]
    ds_read_b64_tr_b16 a[200:201], v210 offset:16384
    v_mfma_f32_16x16x32_bf16 v[164:167], a[216:219], a[148:151], v[164:167]
    ds_read_b64_tr_b16 a[202:203], v210 offset:17408
    v_mfma_f32_16x16x32_bf16 v[168:171], a[216:219], a[152:155], v[168:171]
    v_mfma_f32_16x16x32_bf16 v[172:175], a[216:219], a[156:159], v[172:175]
    s_waitcnt lgkmcnt(6)
    v_mfma_f32_16x16x32_bf16 v[176:179], a[220:223], a[144:147], v[176:179]
    ds_read_b64_tr_b16 a[204:205], v211 offset:16384
    v_mfma_f32_16x16x32_bf16 v[180:183], a[220:223], a[148:151], v[180:183]
    ds_read_b64_tr_b16 a[206:207], v211 offset:17408
    v_mfma_f32_16x16x32_bf16 v[184:187], a[220:223], a[152:155], v[184:187]
    v_mfma_f32_16x16x32_bf16 v[188:191], a[220:223], a[156:159], v[188:191]
    s_waitcnt lgkmcnt(6)
    v_mfma_f32_16x16x32_bf16 v[64:67], a[192:195], a[160:163], v[64:67]
    ds_read_b64_tr_b16 a[208:209], v212 offset:16384
    v_mfma_f32_16x16x32_bf16 v[68:71], a[192:195], a[164:167], v[68:71]
    ds_read_b64_tr_b16 a[210:211], v212 offset:17408
    v_mfma_f32_16x16x32_bf16 v[72:75], a[192:195], a[168:171], v[72:75]
    v_mfma_f32_16x16x32_bf16 v[76:79], a[192:195], a[172:175], v[76:79]
    s_waitcnt lgkmcnt(6)
    v_mfma_f32_16x16x32_bf16 v[80:83], a[196:199], a[160:163], v[80:83]
    ds_read_b64_tr_b16 a[212:213], v213 offset:16384
    v_mfma_f32_16x16x32_bf16 v[84:87], a[196:199], a[164:167], v[84:87]
    ds_read_b64_tr_b16 a[214:215], v213 offset:17408
    v_mfma_f32_16x16x32_bf16 v[88:91], a[196:199], a[168:171], v[88:91]
    v_mfma_f32_16x16x32_bf16 v[92:95], a[196:199], a[172:175], v[92:95]
    s_waitcnt lgkmcnt(6)
    v_mfma_f32_16x16x32_bf16 v[96:99], a[200:203], a[160:163], v[96:99]
    ds_read_b64_tr_b16 a[216:217], v214 offset:16384
    v_mfma_f32_16x16x32_bf16 v[100:103], a[200:203], a[164:167], v[100:103]
    ds_read_b64_tr_b16 a[218:219], v214 offset:17408
    v_mfma_f32_16x16x32_bf16 v[104:107], a[200:203], a[168:171], v[104:107]
    v_mfma_f32_16x16x32_bf16 v[108:111], a[200:203], a[172:175], v[108:111]
    s_waitcnt lgkmcnt(6)
    v_mfma_f32_16x16x32_bf16 v[112:115], a[204:207], a[160:163], v[112:115]
    ds_read_b64_tr_b16 a[220:221], v215 offset:16384
    v_mfma_f32_16x16x32_bf16 v[116:119], a[204:207], a[164:167], v[116:119]
    ds_read_b64_tr_b16 a[222:223], v215 offset:17408
    v_mfma_f32_16x16x32_bf16 v[120:123], a[204:207], a[168:171], v[120:123]
    v_mfma_f32_16x16x32_bf16 v[124:127], a[204:207], a[172:175], v[124:127]
    s_waitcnt lgkmcnt(6)
    v_mfma_f32_16x16x32_bf16 v[128:131], a[208:211], a[160:163], v[128:131]
    ds_read_b64_tr_b16 a[192:193], v208 offset:24576
    v_mfma_f32_16x16x32_bf16 v[132:135], a[208:211], a[164:167], v[132:135]
    ds_read_b64_tr_b16 a[194:195], v208 offset:25600
    v_mfma_f32_16x16x32_bf16 v[136:139], a[208:211], a[168:171], v[136:139]
    v_mfma_f32_16x16x32_bf16 v[140:143], a[208:211], a[172:175], v[140:143]
    s_waitcnt lgkmcnt(6)
    v_mfma_f32_16x16x32_bf16 v[144:147], a[212:215], a[160:163], v[144:147]
    ds_read_b64_tr_b16 a[196:197], v209 offset:24576
    v_mfma_f32_16x16x32_bf16 v[148:151], a[212:215], a[164:167], v[148:151]
    ds_read_b64_tr_b16 a[198:199], v209 offset:25600
    v_mfma_f32_16x16x32_bf16 v[152:155], a[212:215], a[168:171], v[152:155]
    v_mfma_f32_16x16x32_bf16 v[156:159], a[212:215], a[172:175], v[156:159]
    s_waitcnt lgkmcnt(6)
    v_mfma_f32_16x16x32_bf16 v[160:163], a[216:219], a[160:163], v[160:163]
    ds_read_b64_tr_b16 a[200:201], v210 offset:24576
    v_mfma_f32_16x16x32_bf16 v[164:167], a[216:219], a[164:167], v[164:167]
    ds_read_b64_tr_b16 a[202:203], v210 offset:25600
    v_mfma_f32_16x16x32_bf16 v[168:171], a[216:219], a[168:171], v[168:171]
    v_mfma_f32_16x16x32_bf16 v[172:175], a[216:219], a[172:175], v[172:175]
    s_waitcnt lgkmcnt(6)
    v_mfma_f32_16x16x32_bf16 v[176:179], a[220:223], a[160:163], v[176:179]
    ds_read_b64_tr_b16 a[204:205], v211 offset:24576
    v_mfma_f32_16x16x32_bf16 v[180:183], a[220:223], a[164:167], v[180:183]
    ds_read_b64_tr_b16 a[206:207], v211 offset:25600
    v_mfma_f32_16x16x32_bf16 v[184:187], a[220:223], a[168:171], v[184:187]
    v_mfma_f32_16x16x32_bf16 v[188:191], a[220:223], a[172:175], v[188:191]
    s_waitcnt lgkmcnt(6)
    v_mfma_f32_16x16x32_bf16 v[64:67], a[192:195], a[176:179], v[64:67]
    ds_read_b64_tr_b16 a[208:209], v212 offset:24576
    v_mfma_f32_16x16x32_bf16 v[68:71], a[192:195], a[180:183], v[68:71]
    ds_read_b64_tr_b16 a[210:211], v212 offset:25600
    v_mfma_f32_16x16x32_bf16 v[72:75], a[192:195], a[184:187], v[72:75]
    v_mfma_f32_16x16x32_bf16 v[76:79], a[192:195], a[188:191], v[76:79]
    s_waitcnt lgkmcnt(6)
    v_mfma_f32_16x16x32_bf16 v[80:83], a[196:199], a[176:179], v[80:83]
    ds_read_b64_tr_b16 a[212:213], v213 offset:24576
    v_mfma_f32_16x16x32_bf16 v[84:87], a[196:199], a[180:183], v[84:87]
    ds_read_b64_tr_b16 a[214:215], v213 offset:25600
    v_mfma_f32_16x16x32_bf16 v[88:91], a[196:199], a[184:187], v[88:91]
    v_mfma_f32_16x16x32_bf16 v[92:95], a[196:199], a[188:191], v[92:95]
    s_waitcnt lgkmcnt(6)
    v_mfma_f32_16x16x32_bf16 v[96:99], a[200:203], a[176:179], v[96:99]
    ds_read_b64_tr_b16 a[216:217], v214 offset:24576
    v_mfma_f32_16x16x32_bf16 v[100:103], a[200:203], a[180:183], v[100:103]
    ds_read_b64_tr_b16 a[218:219], v214 offset:25600
    v_mfma_f32_16x16x32_bf16 v[104:107], a[200:203], a[184:187], v[104:107]
    v_mfma_f32_16x16x32_bf16 v[108:111], a[200:203], a[188:191], v[108:111]
    s_waitcnt lgkmcnt(6)
    v_mfma_f32_16x16x32_bf16 v[112:115], a[204:207], a[176:179], v[112:115]
    ds_read_b64_tr_b16 a[220:221], v215 offset:24576
    v_mfma_f32_16x16x32_bf16 v[116:119], a[204:207], a[180:183], v[116:119]
    ds_read_b64_tr_b16 a[222:223], v215 offset:25600
    v_mfma_f32_16x16x32_bf16 v[120:123], a[204:207], a[184:187], v[120:123]
    v_mfma_f32_16x16x32_bf16 v[124:127], a[204:207], a[188:191], v[124:127]
    s_waitcnt vmcnt(36) lgkmcnt(0)
    s_barrier
    v_mfma_f32_16x16x32_bf16 v[128:131], a[208:211], a[176:179], v[128:131]
    ds_read_b64_tr_b16 a[192:193], v200 offset:0
    v_mfma_f32_16x16x32_bf16 v[132:135], a[208:211], a[180:183], v[132:135]
    ds_read_b64_tr_b16 a[194:195], v200 offset:1024
    v_mfma_f32_16x16x32_bf16 v[136:139], a[208:211], a[184:187], v[136:139]
    v_mfma_f32_16x16x32_bf16 v[140:143], a[208:211], a[188:191], v[140:143]
    s_waitcnt lgkmcnt(6)
    v_mfma_f32_16x16x32_bf16 v[144:147], a[212:215], a[176:179], v[144:147]
    ds_read_b64_tr_b16 a[196:197], v201 offset:0
    v_mfma_f32_16x16x32_bf16 v[148:151], a[212:215], a[180:183], v[148:151]
    ds_read_b64_tr_b16 a[198:199], v201 offset:1024
    v_mfma_f32_16x16x32_bf16 v[152:155], a[212:215], a[184:187], v[152:155]
    v_mfma_f32_16x16x32_bf16 v[156:159], a[212:215], a[188:191], v[156:159]
    s_waitcnt lgkmcnt(6)
    v_mfma_f32_16x16x32_bf16 v[160:163], a[216:219], a[176:179], v[160:163]
    ds_read_b64_tr_b16 a[200:201], v200 offset:8192
    v_mfma_f32_16x16x32_bf16 v[164:167], a[216:219], a[180:183], v[164:167]
    ds_read_b64_tr_b16 a[202:203], v200 offset:9216
    v_mfma_f32_16x16x32_bf16 v[168:171], a[216:219], a[184:187], v[168:171]
    v_mfma_f32_16x16x32_bf16 v[172:175], a[216:219], a[188:191], v[172:175]
    s_waitcnt lgkmcnt(6)
    v_mfma_f32_16x16x32_bf16 v[176:179], a[220:223], a[176:179], v[176:179]
    ds_read_b64_tr_b16 a[204:205], v201 offset:8192
    v_mfma_f32_16x16x32_bf16 v[180:183], a[220:223], a[180:183], v[180:183]
    ds_read_b64_tr_b16 a[206:207], v201 offset:9216
    v_mfma_f32_16x16x32_bf16 v[184:187], a[220:223], a[184:187], v[184:187]
    v_mfma_f32_16x16x32_bf16 v[188:191], a[220:223], a[188:191], v[188:191]
    s_waitcnt vmcnt(24) lgkmcnt(0)
    s_barrier
    v_mfma_f32_16x16x32_bf16 v[64:67], a[192:195], a[0:3], v[64:67]
    ds_read_b64_tr_b16 a[208:209], v200 offset:16384
    v_mfma_f32_16x16x32_bf16 v[68:71], a[192:195], a[4:7], v[68:71]
    ds_read_b64_tr_b16 a[210:211], v200 offset:17408
    v_mfma_f32_16x16x32_bf16 v[72:75], a[192:195], a[8:11], v[72:75]
    v_mfma_f32_16x16x32_bf16 v[76:79], a[192:195], a[12:15], v[76:79]
    s_waitcnt lgkmcnt(6)
    v_mfma_f32_16x16x32_bf16 v[80:83], a[196:199], a[0:3], v[80:83]
    ds_read_b64_tr_b16 a[212:213], v201 offset:16384
    v_mfma_f32_16x16x32_bf16 v[84:87], a[196:199], a[4:7], v[84:87]
    ds_read_b64_tr_b16 a[214:215], v201 offset:17408
    v_mfma_f32_16x16x32_bf16 v[88:91], a[196:199], a[8:11], v[88:91]
    v_mfma_f32_16x16x32_bf16 v[92:95], a[196:199], a[12:15], v[92:95]
    s_waitcnt lgkmcnt(6)
    v_mfma_f32_16x16x32_bf16 v[64:67], a[200:203], a[16:19], v[64:67]
    ds_read_b64_tr_b16 a[216:217], v200 offset:24576
    v_mfma_f32_16x16x32_bf16 v[68:71], a[200:203], a[20:23], v[68:71]
    ds_read_b64_tr_b16 a[218:219], v200 offset:25600
    v_mfma_f32_16x16x32_bf16 v[72:75], a[200:203], a[24:27], v[72:75]
    v_mfma_f32_16x16x32_bf16 v[76:79], a[200:203], a[28:31], v[76:79]
    s_waitcnt lgkmcnt(6)
    v_mfma_f32_16x16x32_bf16 v[80:83], a[204:207], a[16:19], v[80:83]
    ds_read_b64_tr_b16 a[220:221], v201 offset:24576
    v_mfma_f32_16x16x32_bf16 v[84:87], a[204:207], a[20:23], v[84:87]
    ds_read_b64_tr_b16 a[222:223], v201 offset:25600
    v_mfma_f32_16x16x32_bf16 v[88:91], a[204:207], a[24:27], v[88:91]
    v_mfma_f32_16x16x32_bf16 v[92:95], a[204:207], a[28:31], v[92:95]
    s_waitcnt vmcnt(12) lgkmcnt(0)
    s_barrier
    v_mfma_f32_16x16x32_bf16 v[64:67], a[208:211], a[32:35], v[64:67]
    ds_read_b64_tr_b16 a[192:193], v200 offset:32768
    v_mfma_f32_16x16x32_bf16 v[68:71], a[208:211], a[36:39], v[68:71]
    ds_read_b64_tr_b16 a[194:195], v200 offset:33792
    v_mfma_f32_16x16x32_bf16 v[72:75], a[208:211], a[40:43], v[72:75]
    v_mfma_f32_16x16x32_bf16 v[76:79], a[208:211], a[44:47], v[76:79]
    s_waitcnt lgkmcnt(6)
    v_mfma_f32_16x16x32_bf16 v[80:83], a[212:215], a[32:35], v[80:83]
    ds_read_b64_tr_b16 a[196:197], v201 offset:32768
    v_mfma_f32_16x16x32_bf16 v[84:87], a[212:215], a[36:39], v[84:87]
    ds_read_b64_tr_b16 a[198:199], v201 offset:33792
    v_mfma_f32_16x16x32_bf16 v[88:91], a[212:215], a[40:43], v[88:91]
    v_mfma_f32_16x16x32_bf16 v[92:95], a[212:215], a[44:47], v[92:95]
    s_waitcnt lgkmcnt(6)
    v_mfma_f32_16x16x32_bf16 v[64:67], a[216:219], a[48:51], v[64:67]
    ds_read_b64_tr_b16 a[200:201], v200 offset:40960
    v_mfma_f32_16x16x32_bf16 v[68:71], a[216:219], a[52:55], v[68:71]
    ds_read_b64_tr_b16 a[202:203], v200 offset:41984
    v_mfma_f32_16x16x32_bf16 v[72:75], a[216:219], a[56:59], v[72:75]
    v_mfma_f32_16x16x32_bf16 v[76:79], a[216:219], a[60:63], v[76:79]
    s_waitcnt lgkmcnt(6)
    v_mfma_f32_16x16x32_bf16 v[80:83], a[220:223], a[48:51], v[80:83]
    ds_read_b64_tr_b16 a[204:205], v201 offset:40960
    v_mfma_f32_16x16x32_bf16 v[84:87], a[220:223], a[52:55], v[84:87]
    ds_read_b64_tr_b16 a[206:207], v201 offset:41984
    v_mfma_f32_16x16x32_bf16 v[88:91], a[220:223], a[56:59], v[88:91]
    v_mfma_f32_16x16x32_bf16 v[92:95], a[220:223], a[60:63], v[92:95]
    s_waitcnt vmcnt(0) lgkmcnt(0)
    s_barrier
    v_mfma_f32_16x16x32_bf16 v[64:67], a[192:195], a[64:67], v[64:67]
    ds_read_b64_tr_b16 a[208:209], v200 offset:49152
    v_mfma_f32_16x16x32_bf16 v[68:71], a[192:195], a[68:71], v[68:71]
    ds_read_b64_tr_b16 a[210:211], v200 offset:50176
    v_mfma_f32_16x16x32_bf16 v[72:75], a[192:195], a[72:75], v[72:75]
    v_mfma_f32_16x16x32_bf16 v[76:79], a[192:195], a[76:79], v[76:79]
    s_waitcnt lgkmcnt(6)
    v_mfma_f32_16x16x32_bf16 v[80:83], a[196:199], a[64:67], v[80:83]
    ds_read_b64_tr_b16 a[212:213], v201 offset:49152
    v_mfma_f32_16x16x32_bf16 v[84:87], a[196:199], a[68:71], v[84:87]
    ds_read_b64_tr_b16 a[214:215], v201 offset:50176
    v_mfma_f32_16x16x32_bf16 v[88:91], a[196:199], a[72:75], v[88:91]
    v_mfma_f32_16x16x32_bf16 v[92:95], a[196:199], a[76:79], v[92:95]
    s_waitcnt lgkmcnt(6)
    v_mfma_f32_16x16x32_bf16 v[64:67], a[200:203], a[80:83], v[64:67]
    ds_read_b64_tr_b16 a[216:217], v200 offset:57344
    v_mfma_f32_16x16x32_bf16 v[68:71], a[200:203], a[84:87], v[68:71]
    ds_read_b64_tr_b16 a[218:219], v200 offset:58368
    v_mfma_f32_16x16x32_bf16 v[72:75], a[200:203], a[88:91], v[72:75]
    v_mfma_f32_16x16x32_bf16 v[76:79], a[200:203], a[92:95], v[76:79]
    s_waitcnt lgkmcnt(6)
    v_mfma_f32_16x16x32_bf16 v[80:83], a[204:207], a[80:83], v[80:83]
    ds_read_b64_tr_b16 a[220:221], v201 offset:57344
    v_mfma_f32_16x16x32_bf16 v[84:87], a[204:207], a[84:87], v[84:87]
    ds_read_b64_tr_b16 a[222:223], v201 offset:58368
    v_mfma_f32_16x16x32_bf16 v[88:91], a[204:207], a[88:91], v[88:91]
    v_mfma_f32_16x16x32_bf16 v[92:95], a[204:207], a[92:95], v[92:95]
    s_waitcnt lgkmcnt(6)
    v_mfma_f32_16x16x32_bf16 v[64:67], a[208:211], a[96:99], v[64:67]
    ds_read_b64_tr_b16 a[192:193], v202 offset:0
    v_mfma_f32_16x16x32_bf16 v[68:71], a[208:211], a[100:103], v[68:71]
    ds_read_b64_tr_b16 a[194:195], v202 offset:1024
    v_mfma_f32_16x16x32_bf16 v[72:75], a[208:211], a[104:107], v[72:75]
    v_mfma_f32_16x16x32_bf16 v[76:79], a[208:211], a[108:111], v[76:79]
    s_waitcnt lgkmcnt(6)
    v_mfma_f32_16x16x32_bf16 v[80:83], a[212:215], a[96:99], v[80:83]
    ds_read_b64_tr_b16 a[196:197], v203 offset:0
    v_mfma_f32_16x16x32_bf16 v[84:87], a[212:215], a[100:103], v[84:87]
    ds_read_b64_tr_b16 a[198:199], v203 offset:1024
    v_mfma_f32_16x16x32_bf16 v[88:91], a[212:215], a[104:107], v[88:91]
    v_mfma_f32_16x16x32_bf16 v[92:95], a[212:215], a[108:111], v[92:95]
    s_waitcnt lgkmcnt(6)
    v_mfma_f32_16x16x32_bf16 v[64:67], a[216:219], a[112:115], v[64:67]
    ds_read_b64_tr_b16 a[200:201], v202 offset:8192
    v_mfma_f32_16x16x32_bf16 v[68:71], a[216:219], a[116:119], v[68:71]
    ds_read_b64_tr_b16 a[202:203], v202 offset:9216
    v_mfma_f32_16x16x32_bf16 v[72:75], a[216:219], a[120:123], v[72:75]
    v_mfma_f32_16x16x32_bf16 v[76:79], a[216:219], a[124:127], v[76:79]
    s_waitcnt lgkmcnt(6)
    v_mfma_f32_16x16x32_bf16 v[80:83], a[220:223], a[112:115], v[80:83]
    ds_read_b64_tr_b16 a[204:205], v203 offset:8192
    v_mfma_f32_16x16x32_bf16 v[84:87], a[220:223], a[116:119], v[84:87]
    ds_read_b64_tr_b16 a[206:207], v203 offset:9216
    v_mfma_f32_16x16x32_bf16 v[88:91], a[220:223], a[120:123], v[88:91]
    v_mfma_f32_16x16x32_bf16 v[92:95], a[220:223], a[124:127], v[92:95]
    s_waitcnt lgkmcnt(6)
    v_mfma_f32_16x16x32_bf16 v[96:99], a[192:195], a[0:3], v[96:99]
    ds_read_b64_tr_b16 a[208:209], v202 offset:16384
    v_mfma_f32_16x16x32_bf16 v[100:103], a[192:195], a[4:7], v[100:103]
    ds_read_b64_tr_b16 a[210:211], v202 offset:17408
    v_mfma_f32_16x16x32_bf16 v[104:107], a[192:195], a[8:11], v[104:107]
    v_mfma_f32_16x16x32_bf16 v[108:111], a[192:195], a[12:15], v[108:111]
    s_waitcnt lgkmcnt(6)
    v_mfma_f32_16x16x32_bf16 v[112:115], a[196:199], a[0:3], v[112:115]
    ds_read_b64_tr_b16 a[212:213], v203 offset:16384
    v_mfma_f32_16x16x32_bf16 v[116:119], a[196:199], a[4:7], v[116:119]
    ds_read_b64_tr_b16 a[214:215], v203 offset:17408
    v_mfma_f32_16x16x32_bf16 v[120:123], a[196:199], a[8:11], v[120:123]
    v_mfma_f32_16x16x32_bf16 v[124:127], a[196:199], a[12:15], v[124:127]
    s_waitcnt lgkmcnt(6)
    v_mfma_f32_16x16x32_bf16 v[96:99], a[200:203], a[16:19], v[96:99]
    ds_read_b64_tr_b16 a[216:217], v202 offset:24576
    v_mfma_f32_16x16x32_bf16 v[100:103], a[200:203], a[20:23], v[100:103]
    ds_read_b64_tr_b16 a[218:219], v202 offset:25600
    v_mfma_f32_16x16x32_bf16 v[104:107], a[200:203], a[24:27], v[104:107]
    v_mfma_f32_16x16x32_bf16 v[108:111], a[200:203], a[28:31], v[108:111]
    s_waitcnt lgkmcnt(6)
    v_mfma_f32_16x16x32_bf16 v[112:115], a[204:207], a[16:19], v[112:115]
    ds_read_b64_tr_b16 a[220:221], v203 offset:24576
    v_cvt_pk_bf16_f32 v20, v64, v65
    v_cvt_pk_bf16_f32 v21, v66, v67
    v_cvt_pk_bf16_f32 v22, v68, v69
    v_mfma_f32_16x16x32_bf16 v[116:119], a[204:207], a[20:23], v[116:119]
    ds_read_b64_tr_b16 a[222:223], v203 offset:25600
    v_mfma_f32_16x16x32_bf16 v[120:123], a[204:207], a[24:27], v[120:123]
    v_mfma_f32_16x16x32_bf16 v[124:127], a[204:207], a[28:31], v[124:127]
    v_cvt_pk_bf16_f32 v23, v70, v71
    v_pk_max_i16 v20, v20, 0
    v_pk_max_i16 v21, v21, 0
    s_waitcnt lgkmcnt(6)
    v_mfma_f32_16x16x32_bf16 v[96:99], a[208:211], a[32:35], v[96:99]
    ds_read_b64_tr_b16 a[192:193], v202 offset:32768
    v_pk_max_i16 v22, v22, 0
    v_pk_max_i16 v23, v23, 0
    s_nop 1
    v_mfma_f32_16x16x32_bf16 v[100:103], a[208:211], a[36:39], v[100:103]
    ds_read_b64_tr_b16 a[194:195], v202 offset:33792
    v_mfma_f32_16x16x32_bf16 v[104:107], a[208:211], a[40:43], v[104:107]
    v_mfma_f32_16x16x32_bf16 v[108:111], a[208:211], a[44:47], v[108:111]
    v_permlane16_swap_b32 v20, v22
    v_permlane16_swap_b32 v21, v23
    s_nop 0
    s_waitcnt lgkmcnt(6)
    v_mfma_f32_16x16x32_bf16 v[112:115], a[212:215], a[32:35], v[112:115]
    ds_read_b64_tr_b16 a[196:197], v203 offset:32768
    buffer_store_dwordx4 v[20:23], v2, s[40:43], s26 offen offset:0 sc1
    v_cvt_pk_bf16_f32 v24, v80, v81
    v_cvt_pk_bf16_f32 v25, v82, v83
    v_mfma_f32_16x16x32_bf16 v[116:119], a[212:215], a[36:39], v[116:119]
    ds_read_b64_tr_b16 a[198:199], v203 offset:33792
    v_mfma_f32_16x16x32_bf16 v[120:123], a[212:215], a[40:43], v[120:123]
    v_mfma_f32_16x16x32_bf16 v[124:127], a[212:215], a[44:47], v[124:127]
    v_cvt_pk_bf16_f32 v26, v84, v85
    v_cvt_pk_bf16_f32 v27, v86, v87
    v_pk_max_i16 v24, v24, 0
    s_waitcnt lgkmcnt(6)
    v_mfma_f32_16x16x32_bf16 v[96:99], a[216:219], a[48:51], v[96:99]
    ds_read_b64_tr_b16 a[200:201], v202 offset:40960
    v_pk_max_i16 v25, v25, 0
    v_pk_max_i16 v26, v26, 0
    v_pk_max_i16 v27, v27, 0
    v_mfma_f32_16x16x32_bf16 v[100:103], a[216:219], a[52:55], v[100:103]
    ds_read_b64_tr_b16 a[202:203], v202 offset:41984
    v_mfma_f32_16x16x32_bf16 v[104:107], a[216:219], a[56:59], v[104:107]
    v_mfma_f32_16x16x32_bf16 v[108:111], a[216:219], a[60:63], v[108:111]
    s_nop 1
    v_permlane16_swap_b32 v24, v26
    v_permlane16_swap_b32 v25, v27
    s_waitcnt lgkmcnt(6)
    v_mfma_f32_16x16x32_bf16 v[112:115], a[220:223], a[48:51], v[112:115]
    ds_read_b64_tr_b16 a[204:205], v203 offset:40960
    s_nop 0
    buffer_store_dwordx4 v[24:27], v2, s[40:43], s26 offen offset:1024 sc1
    v_cvt_pk_bf16_f32 v28, v72, v73
    v_mfma_f32_16x16x32_bf16 v[116:119], a[220:223], a[52:55], v[116:119]
    ds_read_b64_tr_b16 a[206:207], v203 offset:41984
    v_mfma_f32_16x16x32_bf16 v[120:123], a[220:223], a[56:59], v[120:123]
    v_mfma_f32_16x16x32_bf16 v[124:127], a[220:223], a[60:63], v[124:127]
    v_cvt_pk_bf16_f32 v29, v74, v75
    v_cvt_pk_bf16_f32 v30, v76, v77
    v_cvt_pk_bf16_f32 v31, v78, v79
    s_waitcnt lgkmcnt(6)
    v_mfma_f32_16x16x32_bf16 v[96:99], a[192:195], a[64:67], v[96:99]
    ds_read_b64_tr_b16 a[208:209], v202 offset:49152
    v_pk_max_i16 v28, v28, 0
    v_pk_max_i16 v29, v29, 0
    v_pk_max_i16 v30, v30, 0
    v_mfma_f32_16x16x32_bf16 v[100:103], a[192:195], a[68:71], v[100:103]
    ds_read_b64_tr_b16 a[210:211], v202 offset:50176
    v_mfma_f32_16x16x32_bf16 v[104:107], a[192:195], a[72:75], v[104:107]
    v_mfma_f32_16x16x32_bf16 v[108:111], a[192:195], a[76:79], v[108:111]
    v_pk_max_i16 v31, v31, 0
    s_nop 1
    v_permlane16_swap_b32 v28, v30
    s_waitcnt lgkmcnt(6)
    v_mfma_f32_16x16x32_bf16 v[112:115], a[196:199], a[64:67], v[112:115]
    ds_read_b64_tr_b16 a[212:213], v203 offset:49152
    v_permlane16_swap_b32 v29, v31
    s_nop 0
    buffer_store_dwordx4 v[28:31], v2, s[40:43], s27 offen offset:0 sc1
    v_mfma_f32_16x16x32_bf16 v[116:119], a[196:199], a[68:71], v[116:119]
    ds_read_b64_tr_b16 a[214:215], v203 offset:50176
    v_mfma_f32_16x16x32_bf16 v[120:123], a[196:199], a[72:75], v[120:123]
    v_mfma_f32_16x16x32_bf16 v[124:127], a[196:199], a[76:79], v[124:127]
    v_cvt_pk_bf16_f32 v32, v88, v89
    v_cvt_pk_bf16_f32 v33, v90, v91
    v_cvt_pk_bf16_f32 v34, v92, v93
    s_waitcnt lgkmcnt(6)
    v_mfma_f32_16x16x32_bf16 v[96:99], a[200:203], a[80:83], v[96:99]
    ds_read_b64_tr_b16 a[216:217], v202 offset:57344
    v_cvt_pk_bf16_f32 v35, v94, v95
    v_pk_max_i16 v32, v32, 0
    v_pk_max_i16 v33, v33, 0
    v_mfma_f32_16x16x32_bf16 v[100:103], a[200:203], a[84:87], v[100:103]
    ds_read_b64_tr_b16 a[218:219], v202 offset:58368
    v_mfma_f32_16x16x32_bf16 v[104:107], a[200:203], a[88:91], v[104:107]
    v_mfma_f32_16x16x32_bf16 v[108:111], a[200:203], a[92:95], v[108:111]
    v_pk_max_i16 v34, v34, 0
    v_pk_max_i16 v35, v35, 0
    s_nop 1
    s_waitcnt lgkmcnt(6)
    v_mfma_f32_16x16x32_bf16 v[112:115], a[204:207], a[80:83], v[112:115]
    ds_read_b64_tr_b16 a[220:221], v203 offset:57344
    v_permlane16_swap_b32 v32, v34
    v_permlane16_swap_b32 v33, v35
    s_nop 0
    v_mfma_f32_16x16x32_bf16 v[116:119], a[204:207], a[84:87], v[116:119]
    ds_read_b64_tr_b16 a[222:223], v203 offset:58368
    v_mfma_f32_16x16x32_bf16 v[120:123], a[204:207], a[88:91], v[120:123]
    v_mfma_f32_16x16x32_bf16 v[124:127], a[204:207], a[92:95], v[124:127]
    buffer_store_dwordx4 v[32:35], v2, s[40:43], s27 offen offset:1024 sc1
    s_waitcnt lgkmcnt(6)
    v_mfma_f32_16x16x32_bf16 v[96:99], a[208:211], a[96:99], v[96:99]
    ds_read_b64_tr_b16 a[192:193], v204 offset:0
    v_mfma_f32_16x16x32_bf16 v[100:103], a[208:211], a[100:103], v[100:103]
    ds_read_b64_tr_b16 a[194:195], v204 offset:1024
    v_mfma_f32_16x16x32_bf16 v[104:107], a[208:211], a[104:107], v[104:107]
    v_mfma_f32_16x16x32_bf16 v[108:111], a[208:211], a[108:111], v[108:111]
    s_waitcnt lgkmcnt(6)
    v_mfma_f32_16x16x32_bf16 v[112:115], a[212:215], a[96:99], v[112:115]
    ds_read_b64_tr_b16 a[196:197], v205 offset:0
    v_mfma_f32_16x16x32_bf16 v[116:119], a[212:215], a[100:103], v[116:119]
    ds_read_b64_tr_b16 a[198:199], v205 offset:1024
    v_mfma_f32_16x16x32_bf16 v[120:123], a[212:215], a[104:107], v[120:123]
    v_mfma_f32_16x16x32_bf16 v[124:127], a[212:215], a[108:111], v[124:127]
    s_waitcnt lgkmcnt(6)
    v_mfma_f32_16x16x32_bf16 v[96:99], a[216:219], a[112:115], v[96:99]
    ds_read_b64_tr_b16 a[200:201], v204 offset:8192
    v_mfma_f32_16x16x32_bf16 v[100:103], a[216:219], a[116:119], v[100:103]
    ds_read_b64_tr_b16 a[202:203], v204 offset:9216
    v_mfma_f32_16x16x32_bf16 v[104:107], a[216:219], a[120:123], v[104:107]
    v_mfma_f32_16x16x32_bf16 v[108:111], a[216:219], a[124:127], v[108:111]
    s_waitcnt lgkmcnt(6)
    v_mfma_f32_16x16x32_bf16 v[112:115], a[220:223], a[112:115], v[112:115]
    ds_read_b64_tr_b16 a[204:205], v205 offset:8192
    v_mfma_f32_16x16x32_bf16 v[116:119], a[220:223], a[116:119], v[116:119]
    ds_read_b64_tr_b16 a[206:207], v205 offset:9216
    v_mfma_f32_16x16x32_bf16 v[120:123], a[220:223], a[120:123], v[120:123]
    v_mfma_f32_16x16x32_bf16 v[124:127], a[220:223], a[124:127], v[124:127]
    s_waitcnt lgkmcnt(6)
    v_mfma_f32_16x16x32_bf16 v[128:131], a[192:195], a[0:3], v[128:131]
    ds_read_b64_tr_b16 a[208:209], v204 offset:16384
    v_mfma_f32_16x16x32_bf16 v[132:135], a[192:195], a[4:7], v[132:135]
    ds_read_b64_tr_b16 a[210:211], v204 offset:17408
    v_mfma_f32_16x16x32_bf16 v[136:139], a[192:195], a[8:11], v[136:139]
    v_mfma_f32_16x16x32_bf16 v[140:143], a[192:195], a[12:15], v[140:143]
    s_waitcnt lgkmcnt(6)
    v_mfma_f32_16x16x32_bf16 v[144:147], a[196:199], a[0:3], v[144:147]
    ds_read_b64_tr_b16 a[212:213], v205 offset:16384
    v_mfma_f32_16x16x32_bf16 v[148:151], a[196:199], a[4:7], v[148:151]
    ds_read_b64_tr_b16 a[214:215], v205 offset:17408
    v_mfma_f32_16x16x32_bf16 v[152:155], a[196:199], a[8:11], v[152:155]
    v_mfma_f32_16x16x32_bf16 v[156:159], a[196:199], a[12:15], v[156:159]
    s_waitcnt lgkmcnt(6)
    v_mfma_f32_16x16x32_bf16 v[128:131], a[200:203], a[16:19], v[128:131]
    ds_read_b64_tr_b16 a[216:217], v204 offset:24576
    v_mfma_f32_16x16x32_bf16 v[132:135], a[200:203], a[20:23], v[132:135]
    ds_read_b64_tr_b16 a[218:219], v204 offset:25600
    v_mfma_f32_16x16x32_bf16 v[136:139], a[200:203], a[24:27], v[136:139]
    v_mfma_f32_16x16x32_bf16 v[140:143], a[200:203], a[28:31], v[140:143]
    s_waitcnt lgkmcnt(6)
    v_mfma_f32_16x16x32_bf16 v[144:147], a[204:207], a[16:19], v[144:147]
    ds_read_b64_tr_b16 a[220:221], v205 offset:24576
    v_cvt_pk_bf16_f32 v28, v96, v97
    v_cvt_pk_bf16_f32 v29, v98, v99
    v_cvt_pk_bf16_f32 v30, v100, v101
    v_mfma_f32_16x16x32_bf16 v[148:151], a[204:207], a[20:23], v[148:151]
    ds_read_b64_tr_b16 a[222:223], v205 offset:25600
    v_mfma_f32_16x16x32_bf16 v[152:155], a[204:207], a[24:27], v[152:155]
    v_mfma_f32_16x16x32_bf16 v[156:159], a[204:207], a[28:31], v[156:159]
    v_cvt_pk_bf16_f32 v31, v102, v103
    v_pk_max_i16 v28, v28, 0
    v_pk_max_i16 v29, v29, 0
    s_waitcnt lgkmcnt(6)
    v_mfma_f32_16x16x32_bf16 v[128:131], a[208:211], a[32:35], v[128:131]
    ds_read_b64_tr_b16 a[192:193], v204 offset:32768
    v_pk_max_i16 v30, v30, 0
    v_pk_max_i16 v31, v31, 0
    s_nop 1
    v_mfma_f32_16x16x32_bf16 v[132:135], a[208:211], a[36:39], v[132:135]
    ds_read_b64_tr_b16 a[194:195], v204 offset:33792
    v_mfma_f32_16x16x32_bf16 v[136:139], a[208:211], a[40:43], v[136:139]
    v_mfma_f32_16x16x32_bf16 v[140:143], a[208:211], a[44:47], v[140:143]
    v_permlane16_swap_b32 v28, v30
    v_permlane16_swap_b32 v29, v31
    s_nop 0
    s_waitcnt lgkmcnt(6)
    v_mfma_f32_16x16x32_bf16 v[144:147], a[212:215], a[32:35], v[144:147]
    ds_read_b64_tr_b16 a[196:197], v205 offset:32768
    buffer_store_dwordx4 v[28:31], v2, s[40:43], s26 offen offset:2048 sc1
    v_cvt_pk_bf16_f32 v32, v112, v113
    v_cvt_pk_bf16_f32 v33, v114, v115
    v_mfma_f32_16x16x32_bf16 v[148:151], a[212:215], a[36:39], v[148:151]
    ds_read_b64_tr_b16 a[198:199], v205 offset:33792
    v_mfma_f32_16x16x32_bf16 v[152:155], a[212:215], a[40:43], v[152:155]
    v_mfma_f32_16x16x32_bf16 v[156:159], a[212:215], a[44:47], v[156:159]
    v_cvt_pk_bf16_f32 v34, v116, v117
    v_cvt_pk_bf16_f32 v35, v118, v119
    v_pk_max_i16 v32, v32, 0
    s_waitcnt lgkmcnt(6)
    v_mfma_f32_16x16x32_bf16 v[128:131], a[216:219], a[48:51], v[128:131]
    ds_read_b64_tr_b16 a[200:201], v204 offset:40960
    v_pk_max_i16 v33, v33, 0
    v_pk_max_i16 v34, v34, 0
    v_pk_max_i16 v35, v35, 0
    v_mfma_f32_16x16x32_bf16 v[132:135], a[216:219], a[52:55], v[132:135]
    ds_read_b64_tr_b16 a[202:203], v204 offset:41984
    v_mfma_f32_16x16x32_bf16 v[136:139], a[216:219], a[56:59], v[136:139]
    v_mfma_f32_16x16x32_bf16 v[140:143], a[216:219], a[60:63], v[140:143]
    s_nop 1
    v_permlane16_swap_b32 v32, v34
    v_permlane16_swap_b32 v33, v35
    s_waitcnt lgkmcnt(6)
    v_mfma_f32_16x16x32_bf16 v[144:147], a[220:223], a[48:51], v[144:147]
    ds_read_b64_tr_b16 a[204:205], v205 offset:40960
    s_nop 0
    buffer_store_dwordx4 v[32:35], v2, s[40:43], s26 offen offset:3072 sc1
    v_cvt_pk_bf16_f32 v20, v104, v105
    v_mfma_f32_16x16x32_bf16 v[148:151], a[220:223], a[52:55], v[148:151]
    ds_read_b64_tr_b16 a[206:207], v205 offset:41984
    v_mfma_f32_16x16x32_bf16 v[152:155], a[220:223], a[56:59], v[152:155]
    v_mfma_f32_16x16x32_bf16 v[156:159], a[220:223], a[60:63], v[156:159]
    v_cvt_pk_bf16_f32 v21, v106, v107
    v_cvt_pk_bf16_f32 v22, v108, v109
    v_cvt_pk_bf16_f32 v23, v110, v111
    s_waitcnt lgkmcnt(6)
    v_mfma_f32_16x16x32_bf16 v[128:131], a[192:195], a[64:67], v[128:131]
    ds_read_b64_tr_b16 a[208:209], v204 offset:49152
    v_pk_max_i16 v20, v20, 0
    v_pk_max_i16 v21, v21, 0
    v_pk_max_i16 v22, v22, 0
    v_mfma_f32_16x16x32_bf16 v[132:135], a[192:195], a[68:71], v[132:135]
    ds_read_b64_tr_b16 a[210:211], v204 offset:50176
    v_mfma_f32_16x16x32_bf16 v[136:139], a[192:195], a[72:75], v[136:139]
    v_mfma_f32_16x16x32_bf16 v[140:143], a[192:195], a[76:79], v[140:143]
    v_pk_max_i16 v23, v23, 0
    s_nop 1
    v_permlane16_swap_b32 v20, v22
    s_waitcnt lgkmcnt(6)
    v_mfma_f32_16x16x32_bf16 v[144:147], a[196:199], a[64:67], v[144:147]
    ds_read_b64_tr_b16 a[212:213], v205 offset:49152
    v_permlane16_swap_b32 v21, v23
    s_nop 0
    buffer_store_dwordx4 v[20:23], v2, s[40:43], s27 offen offset:2048 sc1
    v_mfma_f32_16x16x32_bf16 v[148:151], a[196:199], a[68:71], v[148:151]
    ds_read_b64_tr_b16 a[214:215], v205 offset:50176
    v_mfma_f32_16x16x32_bf16 v[152:155], a[196:199], a[72:75], v[152:155]
    v_mfma_f32_16x16x32_bf16 v[156:159], a[196:199], a[76:79], v[156:159]
    v_cvt_pk_bf16_f32 v24, v120, v121
    v_cvt_pk_bf16_f32 v25, v122, v123
    v_cvt_pk_bf16_f32 v26, v124, v125
    s_waitcnt lgkmcnt(6)
    v_mfma_f32_16x16x32_bf16 v[128:131], a[200:203], a[80:83], v[128:131]
    ds_read_b64_tr_b16 a[216:217], v204 offset:57344
    v_cvt_pk_bf16_f32 v27, v126, v127
    v_pk_max_i16 v24, v24, 0
    v_pk_max_i16 v25, v25, 0
    v_mfma_f32_16x16x32_bf16 v[132:135], a[200:203], a[84:87], v[132:135]
    ds_read_b64_tr_b16 a[218:219], v204 offset:58368
    v_mfma_f32_16x16x32_bf16 v[136:139], a[200:203], a[88:91], v[136:139]
    v_mfma_f32_16x16x32_bf16 v[140:143], a[200:203], a[92:95], v[140:143]
    v_pk_max_i16 v26, v26, 0
    v_pk_max_i16 v27, v27, 0
    s_nop 1
    s_waitcnt lgkmcnt(6)
    v_mfma_f32_16x16x32_bf16 v[144:147], a[204:207], a[80:83], v[144:147]
    ds_read_b64_tr_b16 a[220:221], v205 offset:57344
    v_permlane16_swap_b32 v24, v26
    v_permlane16_swap_b32 v25, v27
    s_nop 0
    v_mfma_f32_16x16x32_bf16 v[148:151], a[204:207], a[84:87], v[148:151]
    ds_read_b64_tr_b16 a[222:223], v205 offset:58368
    v_mfma_f32_16x16x32_bf16 v[152:155], a[204:207], a[88:91], v[152:155]
    v_mfma_f32_16x16x32_bf16 v[156:159], a[204:207], a[92:95], v[156:159]
    buffer_store_dwordx4 v[24:27], v2, s[40:43], s27 offen offset:3072 sc1
    s_waitcnt lgkmcnt(6)
    v_mfma_f32_16x16x32_bf16 v[128:131], a[208:211], a[96:99], v[128:131]
    ds_read_b64_tr_b16 a[192:193], v206 offset:0
    v_mfma_f32_16x16x32_bf16 v[132:135], a[208:211], a[100:103], v[132:135]
    ds_read_b64_tr_b16 a[194:195], v206 offset:1024
    v_mfma_f32_16x16x32_bf16 v[136:139], a[208:211], a[104:107], v[136:139]
    v_mfma_f32_16x16x32_bf16 v[140:143], a[208:211], a[108:111], v[140:143]
    s_waitcnt lgkmcnt(6)
    v_mfma_f32_16x16x32_bf16 v[144:147], a[212:215], a[96:99], v[144:147]
    ds_read_b64_tr_b16 a[196:197], v207 offset:0
    v_mfma_f32_16x16x32_bf16 v[148:151], a[212:215], a[100:103], v[148:151]
    ds_read_b64_tr_b16 a[198:199], v207 offset:1024
    v_mfma_f32_16x16x32_bf16 v[152:155], a[212:215], a[104:107], v[152:155]
    v_mfma_f32_16x16x32_bf16 v[156:159], a[212:215], a[108:111], v[156:159]
    s_waitcnt lgkmcnt(6)
    v_mfma_f32_16x16x32_bf16 v[128:131], a[216:219], a[112:115], v[128:131]
    ds_read_b64_tr_b16 a[200:201], v206 offset:8192
    v_mfma_f32_16x16x32_bf16 v[132:135], a[216:219], a[116:119], v[132:135]
    ds_read_b64_tr_b16 a[202:203], v206 offset:9216
    v_mfma_f32_16x16x32_bf16 v[136:139], a[216:219], a[120:123], v[136:139]
    v_mfma_f32_16x16x32_bf16 v[140:143], a[216:219], a[124:127], v[140:143]
    s_waitcnt lgkmcnt(6)
    v_mfma_f32_16x16x32_bf16 v[144:147], a[220:223], a[112:115], v[144:147]
    ds_read_b64_tr_b16 a[204:205], v207 offset:8192
    v_mfma_f32_16x16x32_bf16 v[148:151], a[220:223], a[116:119], v[148:151]
    ds_read_b64_tr_b16 a[206:207], v207 offset:9216
    v_mfma_f32_16x16x32_bf16 v[152:155], a[220:223], a[120:123], v[152:155]
    v_mfma_f32_16x16x32_bf16 v[156:159], a[220:223], a[124:127], v[156:159]
    s_waitcnt lgkmcnt(6)
    v_mfma_f32_16x16x32_bf16 v[160:163], a[192:195], a[0:3], v[160:163]
    ds_read_b64_tr_b16 a[208:209], v206 offset:16384
    v_mfma_f32_16x16x32_bf16 v[164:167], a[192:195], a[4:7], v[164:167]
    ds_read_b64_tr_b16 a[210:211], v206 offset:17408
    v_mfma_f32_16x16x32_bf16 v[168:171], a[192:195], a[8:11], v[168:171]
    v_mfma_f32_16x16x32_bf16 v[172:175], a[192:195], a[12:15], v[172:175]
    s_waitcnt lgkmcnt(6)
    v_mfma_f32_16x16x32_bf16 v[176:179], a[196:199], a[0:3], v[176:179]
    ds_read_b64_tr_b16 a[212:213], v207 offset:16384
    v_mfma_f32_16x16x32_bf16 v[180:183], a[196:199], a[4:7], v[180:183]
    ds_read_b64_tr_b16 a[214:215], v207 offset:17408
    v_mfma_f32_16x16x32_bf16 v[184:187], a[196:199], a[8:11], v[184:187]
    v_mfma_f32_16x16x32_bf16 v[188:191], a[196:199], a[12:15], v[188:191]
    s_waitcnt lgkmcnt(6)
    v_mfma_f32_16x16x32_bf16 v[160:163], a[200:203], a[16:19], v[160:163]
    ds_read_b64_tr_b16 a[216:217], v206 offset:24576
    v_mfma_f32_16x16x32_bf16 v[164:167], a[200:203], a[20:23], v[164:167]
    ds_read_b64_tr_b16 a[218:219], v206 offset:25600
    v_mfma_f32_16x16x32_bf16 v[168:171], a[200:203], a[24:27], v[168:171]
    v_mfma_f32_16x16x32_bf16 v[172:175], a[200:203], a[28:31], v[172:175]
    s_waitcnt lgkmcnt(6)
    v_mfma_f32_16x16x32_bf16 v[176:179], a[204:207], a[16:19], v[176:179]
    ds_read_b64_tr_b16 a[220:221], v207 offset:24576
    v_cvt_pk_bf16_f32 v20, v128, v129
    v_cvt_pk_bf16_f32 v21, v130, v131
    v_cvt_pk_bf16_f32 v22, v132, v133
    v_mfma_f32_16x16x32_bf16 v[180:183], a[204:207], a[20:23], v[180:183]
    ds_read_b64_tr_b16 a[222:223], v207 offset:25600
    v_mfma_f32_16x16x32_bf16 v[184:187], a[204:207], a[24:27], v[184:187]
    v_mfma_f32_16x16x32_bf16 v[188:191], a[204:207], a[28:31], v[188:191]
    v_cvt_pk_bf16_f32 v23, v134, v135
    v_pk_max_i16 v20, v20, 0
    v_pk_max_i16 v21, v21, 0
    s_waitcnt lgkmcnt(6)
    v_mfma_f32_16x16x32_bf16 v[160:163], a[208:211], a[32:35], v[160:163]
    ds_read_b64_tr_b16 a[192:193], v206 offset:32768
    v_pk_max_i16 v22, v22, 0
    v_pk_max_i16 v23, v23, 0
    s_nop 1
    v_mfma_f32_16x16x32_bf16 v[164:167], a[208:211], a[36:39], v[164:167]
    ds_read_b64_tr_b16 a[194:195], v206 offset:33792
    v_mfma_f32_16x16x32_bf16 v[168:171], a[208:211], a[40:43], v[168:171]
    v_mfma_f32_16x16x32_bf16 v[172:175], a[208:211], a[44:47], v[172:175]
    v_permlane16_swap_b32 v20, v22
    v_permlane16_swap_b32 v21, v23
    s_nop 0
    s_waitcnt lgkmcnt(6)
    v_mfma_f32_16x16x32_bf16 v[176:179], a[212:215], a[32:35], v[176:179]
    ds_read_b64_tr_b16 a[196:197], v207 offset:32768
    buffer_store_dwordx4 v[20:23], v2, s[40:43], s34 offen offset:0 sc1
    v_cvt_pk_bf16_f32 v24, v144, v145
    v_cvt_pk_bf16_f32 v25, v146, v147
    v_mfma_f32_16x16x32_bf16 v[180:183], a[212:215], a[36:39], v[180:183]
    ds_read_b64_tr_b16 a[198:199], v207 offset:33792
    v_mfma_f32_16x16x32_bf16 v[184:187], a[212:215], a[40:43], v[184:187]
    v_mfma_f32_16x16x32_bf16 v[188:191], a[212:215], a[44:47], v[188:191]
    v_cvt_pk_bf16_f32 v26, v148, v149
    v_cvt_pk_bf16_f32 v27, v150, v151
    v_pk_max_i16 v24, v24, 0
    s_waitcnt lgkmcnt(6)
    v_mfma_f32_16x16x32_bf16 v[160:163], a[216:219], a[48:51], v[160:163]
    ds_read_b64_tr_b16 a[200:201], v206 offset:40960
    v_pk_max_i16 v25, v25, 0
    v_pk_max_i16 v26, v26, 0
    v_pk_max_i16 v27, v27, 0
    v_mfma_f32_16x16x32_bf16 v[164:167], a[216:219], a[52:55], v[164:167]
    ds_read_b64_tr_b16 a[202:203], v206 offset:41984
    v_mfma_f32_16x16x32_bf16 v[168:171], a[216:219], a[56:59], v[168:171]
    v_mfma_f32_16x16x32_bf16 v[172:175], a[216:219], a[60:63], v[172:175]
    s_nop 1
    v_permlane16_swap_b32 v24, v26
    v_permlane16_swap_b32 v25, v27
    s_waitcnt lgkmcnt(6)
    v_mfma_f32_16x16x32_bf16 v[176:179], a[220:223], a[48:51], v[176:179]
    ds_read_b64_tr_b16 a[204:205], v207 offset:40960
    s_nop 0
    buffer_store_dwordx4 v[24:27], v2, s[40:43], s34 offen offset:1024 sc1
    v_cvt_pk_bf16_f32 v28, v136, v137
    v_mfma_f32_16x16x32_bf16 v[180:183], a[220:223], a[52:55], v[180:183]
    ds_read_b64_tr_b16 a[206:207], v207 offset:41984
    v_mfma_f32_16x16x32_bf16 v[184:187], a[220:223], a[56:59], v[184:187]
    v_mfma_f32_16x16x32_bf16 v[188:191], a[220:223], a[60:63], v[188:191]
    v_cvt_pk_bf16_f32 v29, v138, v139
    v_cvt_pk_bf16_f32 v30, v140, v141
    v_cvt_pk_bf16_f32 v31, v142, v143
    s_waitcnt lgkmcnt(6)
    v_mfma_f32_16x16x32_bf16 v[160:163], a[192:195], a[64:67], v[160:163]
    ds_read_b64_tr_b16 a[208:209], v206 offset:49152
    v_pk_max_i16 v28, v28, 0
    v_pk_max_i16 v29, v29, 0
    v_pk_max_i16 v30, v30, 0
    v_mfma_f32_16x16x32_bf16 v[164:167], a[192:195], a[68:71], v[164:167]
    ds_read_b64_tr_b16 a[210:211], v206 offset:50176
    v_mfma_f32_16x16x32_bf16 v[168:171], a[192:195], a[72:75], v[168:171]
    v_mfma_f32_16x16x32_bf16 v[172:175], a[192:195], a[76:79], v[172:175]
    v_pk_max_i16 v31, v31, 0
    s_nop 1
    v_permlane16_swap_b32 v28, v30
    s_waitcnt lgkmcnt(6)
    v_mfma_f32_16x16x32_bf16 v[176:179], a[196:199], a[64:67], v[176:179]
    ds_read_b64_tr_b16 a[212:213], v207 offset:49152
    v_permlane16_swap_b32 v29, v31
    s_nop 0
    buffer_store_dwordx4 v[28:31], v2, s[40:43], s35 offen offset:0 sc1
    v_mfma_f32_16x16x32_bf16 v[180:183], a[196:199], a[68:71], v[180:183]
    ds_read_b64_tr_b16 a[214:215], v207 offset:50176
    v_mfma_f32_16x16x32_bf16 v[184:187], a[196:199], a[72:75], v[184:187]
    v_mfma_f32_16x16x32_bf16 v[188:191], a[196:199], a[76:79], v[188:191]
    v_cvt_pk_bf16_f32 v32, v152, v153
    v_cvt_pk_bf16_f32 v33, v154, v155
    v_cvt_pk_bf16_f32 v34, v156, v157
    s_waitcnt lgkmcnt(6)
    v_mfma_f32_16x16x32_bf16 v[160:163], a[200:203], a[80:83], v[160:163]
    ds_read_b64_tr_b16 a[216:217], v206 offset:57344
    v_cvt_pk_bf16_f32 v35, v158, v159
    v_pk_max_i16 v32, v32, 0
    v_pk_max_i16 v33, v33, 0
    v_mfma_f32_16x16x32_bf16 v[164:167], a[200:203], a[84:87], v[164:167]
    ds_read_b64_tr_b16 a[218:219], v206 offset:58368
    v_mfma_f32_16x16x32_bf16 v[168:171], a[200:203], a[88:91], v[168:171]
    v_mfma_f32_16x16x32_bf16 v[172:175], a[200:203], a[92:95], v[172:175]
    v_pk_max_i16 v34, v34, 0
    v_pk_max_i16 v35, v35, 0
    s_nop 1
    s_waitcnt lgkmcnt(6)
    v_mfma_f32_16x16x32_bf16 v[176:179], a[204:207], a[80:83], v[176:179]
    ds_read_b64_tr_b16 a[220:221], v207 offset:57344
    v_permlane16_swap_b32 v32, v34
    v_permlane16_swap_b32 v33, v35
    s_nop 0
    v_mfma_f32_16x16x32_bf16 v[180:183], a[204:207], a[84:87], v[180:183]
    ds_read_b64_tr_b16 a[222:223], v207 offset:58368
    v_mfma_f32_16x16x32_bf16 v[184:187], a[204:207], a[88:91], v[184:187]
    v_mfma_f32_16x16x32_bf16 v[188:191], a[204:207], a[92:95], v[188:191]
    buffer_store_dwordx4 v[32:35], v2, s[40:43], s35 offen offset:1024 sc1
    s_waitcnt lgkmcnt(6)
    v_mfma_f32_16x16x32_bf16 v[160:163], a[208:211], a[96:99], v[160:163]
    v_mfma_f32_16x16x32_bf16 v[164:167], a[208:211], a[100:103], v[164:167]
    v_mfma_f32_16x16x32_bf16 v[168:171], a[208:211], a[104:107], v[168:171]
    v_mfma_f32_16x16x32_bf16 v[172:175], a[208:211], a[108:111], v[172:175]
    s_waitcnt lgkmcnt(4)
    v_mfma_f32_16x16x32_bf16 v[176:179], a[212:215], a[96:99], v[176:179]
    v_mfma_f32_16x16x32_bf16 v[180:183], a[212:215], a[100:103], v[180:183]
    v_mfma_f32_16x16x32_bf16 v[184:187], a[212:215], a[104:107], v[184:187]
    v_mfma_f32_16x16x32_bf16 v[188:191], a[212:215], a[108:111], v[188:191]
    s_waitcnt lgkmcnt(2)
    v_mfma_f32_16x16x32_bf16 v[160:163], a[216:219], a[112:115], v[160:163]
    v_mfma_f32_16x16x32_bf16 v[164:167], a[216:219], a[116:119], v[164:167]
    v_mfma_f32_16x16x32_bf16 v[168:171], a[216:219], a[120:123], v[168:171]
    v_mfma_f32_16x16x32_bf16 v[172:175], a[216:219], a[124:127], v[172:175]
    s_waitcnt lgkmcnt(0)
    v_mfma_f32_16x16x32_bf16 v[176:179], a[220:223], a[112:115], v[176:179]
    v_mfma_f32_16x16x32_bf16 v[180:183], a[220:223], a[116:119], v[180:183]
    v_mfma_f32_16x16x32_bf16 v[184:187], a[220:223], a[120:123], v[184:187]
    v_mfma_f32_16x16x32_bf16 v[188:191], a[220:223], a[124:127], v[188:191]
    s_nop 15
    v_cvt_pk_bf16_f32 v28, v160, v161
    v_cvt_pk_bf16_f32 v29, v162, v163
    v_cvt_pk_bf16_f32 v30, v164, v165
    v_cvt_pk_bf16_f32 v31, v166, v167
    v_pk_max_i16 v28, v28, 0
    v_pk_max_i16 v29, v29, 0
    v_pk_max_i16 v30, v30, 0
    v_pk_max_i16 v31, v31, 0
    s_nop 1
    v_permlane16_swap_b32 v28, v30
    v_permlane16_swap_b32 v29, v31
    s_nop 0
    buffer_store_dwordx4 v[28:31], v2, s[40:43], s34 offen offset:2048 sc1
    v_cvt_pk_bf16_f32 v32, v176, v177
    v_cvt_pk_bf16_f32 v33, v178, v179
    v_cvt_pk_bf16_f32 v34, v180, v181
    v_cvt_pk_bf16_f32 v35, v182, v183
    v_pk_max_i16 v32, v32, 0
    v_pk_max_i16 v33, v33, 0
    v_pk_max_i16 v34, v34, 0
    v_pk_max_i16 v35, v35, 0
    s_nop 1
    v_permlane16_swap_b32 v32, v34
    v_permlane16_swap_b32 v33, v35
    s_nop 0
    buffer_store_dwordx4 v[32:35], v2, s[40:43], s34 offen offset:3072 sc1
    v_cvt_pk_bf16_f32 v20, v168, v169
    v_cvt_pk_bf16_f32 v21, v170, v171
    v_cvt_pk_bf16_f32 v22, v172, v173
    v_cvt_pk_bf16_f32 v23, v174, v175
    v_pk_max_i16 v20, v20, 0
    v_pk_max_i16 v21, v21, 0
    v_pk_max_i16 v22, v22, 0
    v_pk_max_i16 v23, v23, 0
    s_nop 1
    v_permlane16_swap_b32 v20, v22
    v_permlane16_swap_b32 v21, v23
    s_nop 0
    buffer_store_dwordx4 v[20:23], v2, s[40:43], s35 offen offset:2048 sc1
    v_cvt_pk_bf16_f32 v24, v184, v185
    v_cvt_pk_bf16_f32 v25, v186, v187
    v_cvt_pk_bf16_f32 v26, v188, v189
    v_cvt_pk_bf16_f32 v27, v190, v191
    v_pk_max_i16 v24, v24, 0
    v_pk_max_i16 v25, v25, 0
    v_pk_max_i16 v26, v26, 0
    v_pk_max_i16 v27, v27, 0
    s_nop 1
    v_permlane16_swap_b32 v24, v26
    v_permlane16_swap_b32 v25, v27
    s_nop 0
    buffer_store_dwordx4 v[24:27], v2, s[40:43], s35 offen offset:3072 sc1
L_ffn1_kernel_done:
    s_endpgm
.globl ffn2_kernel
.p2align 8
.type ffn2_kernel,@function
ffn2_kernel:
    s_cmp_ge_u32 s2, 256
    s_cbranch_scc1 L_ffn2_kernel_done
    s_load_dwordx2 s[4:5], s[0:1], 56
    s_load_dwordx2 s[6:7], s[0:1], 96
    s_load_dwordx4 s[60:63], s[0:1], 48
    s_load_dwordx2 s[8:9], s[0:1], 80
    v_lshrrev_b32 v2, 6, v0
    v_and_b32 v1, 63, v0
    v_readfirstlane_b32 s20, v2
    v_lshlrev_b32 v2, 4, v1
    s_and_b32 s21, s2, 7
    s_lshr_b32 s22, s2, 3
    s_and_b32 s23, s21, 3
    s_lshr_b32 s24, s21, 2
    s_lshl_b32 s24, s24, 2
    s_lshr_b32 s25, s22, 3
    s_add_u32 s24, s24, s25
    s_and_b32 s25, s22, 7
    s_mul_i32 s26, s23, 896
    s_mul_i32 s27, s23, 57344
    s_lshl_b32 s36, s24, 3
    s_add_u32 s36, s36, s25
    s_lshl_b32 s24, s24, 3
    s_lshl_b32 s31, s20, 1
    s_add_u32 s24, s24, s31
    v_add_u32 v3, 229376, v2
    v_lshrrev_b32 v32, 4, v1
    v_and_b32 v33, 15, v1
    v_lshlrev_b32 v34, 1, v32
    v_xor_b32 v34, v33, v34
    v_xor_b32 v36, 8, v34
    v_lshlrev_b32 v34, 4, v34
    v_lshlrev_b32 v36, 4, v36
    v_mul_u32_u24 v35, 2048, v32
    v_add_u32 v4, v35, v34
    v_add_u32 v5, 7168, v4
    v_add_u32 v6, v35, v36
    v_add_u32 v7, 21504, v6
    v_add_u32 v6, 14336, v6
    v_lshrrev_b32 v16, 4, v1
    v_lshlrev_b32 v16, 9, v16
    v_and_b32 v17, 15, v1
    v_lshl_add_u32 v16, v17, 4, v16
    v_add_u32 v17, 229376, v16
    s_waitcnt lgkmcnt(0)
    s_mov_b32 s12, s4
    s_mov_b32 s13, s5
    s_mov_b32 s14, 7340032
    s_mov_b32 s15, 0x20000
    s_mul_i32 s31, s24, 229376
    s_add_u32 s31, s31, s27
    s_add_u32 s31, s31, 16777216
    s_add_u32 s16, s6, s31
    s_addc_u32 s17, s7, 0
    s_mov_b32 s18, 286720
    s_mov_b32 s19, 0x20000
    s_lshl_b32 s31, s20, 4
    s_add_u32 s31, s31, s26
    s_mul_i32 s28, s31, 2048
    s_lshl_b32 s31, s25, 8
    s_add_u32 s28, s28, s31
    s_mov_b32 s29, 0
    s_lshl_b32 s30, s20, 12
    s_add_u32 m0, s30, 0
    s_nop 0
    buffer_load_dwordx4 v4, s[12:15], s28 offen offset:0 lds
    buffer_load_dwordx4 a[0:3], v16, s[16:19], s29 offen offset:0
    buffer_load_dwordx4 a[4:7], v16, s[16:19], s29 offen offset:256
    buffer_load_dwordx4 v5, s[12:15], s28 offen offset:1024 lds
    buffer_load_dwordx4 a[8:11], v17, s[16:19], s29 offen offset:0
    buffer_load_dwordx4 a[12:15], v17, s[16:19], s29 offen offset:256
    buffer_load_dwordx4 v6, s[12:15], s28 offen offset:2048 lds
    buffer_load_dwordx4 a[16:19], v16, s[16:19], s29 offen offset:2048
    buffer_load_dwordx4 a[20:23], v16, s[16:19], s29 offen offset:2304
    buffer_load_dwordx4 v7, s[12:15], s28 offen offset:3072 lds
    buffer_load_dwordx4 a[24:27], v17, s[16:19], s29 offen offset:2048
    buffer_load_dwordx4 a[28:31], v17, s[16:19], s29 offen offset:2304
    v_lshrrev_b32 v32, 4, v1
    v_bfe_u32 v33, v1, 2, 2
    v_lshl_add_u32 v34, v32, 3, v33
    v_and_b32 v35, 1, v32
    v_lshl_or_b32 v35, v35, 2, v33
    v_bfe_u32 v36, v1, 1, 1
    v_lshlrev_b32 v36, 4, v36
    v_and_b32 v37, 1, v1
    v_lshl_or_b32 v36, v37, 3, v36
    v_lshl_add_u32 v36, v34, 8, v36
    s_add_u32 s45, s23, 1
    s_and_b32 s45, s45, 3
    s_lshl_b32 s45, s45, 1
    s_or_b32 s45, s45, 0
    v_xor_b32 v37, s45, v35
    v_lshl_add_u32 v200, v37, 5, v36
    v_add_u32 v208, 65536, v200
    s_add_u32 s45, s23, 1
    s_and_b32 s45, s45, 3
    s_lshl_b32 s45, s45, 1
    s_or_b32 s45, s45, 1
    v_xor_b32 v37, s45, v35
    v_lshl_add_u32 v201, v37, 5, v36
    v_add_u32 v209, 65536, v201
    s_add_u32 s45, s23, 2
    s_and_b32 s45, s45, 3
    s_lshl_b32 s45, s45, 1
    s_or_b32 s45, s45, 0
    v_xor_b32 v37, s45, v35
    v_lshl_add_u32 v202, v37, 5, v36
    v_add_u32 v210, 65536, v202
    s_add_u32 s45, s23, 2
    s_and_b32 s45, s45, 3
    s_lshl_b32 s45, s45, 1
    s_or_b32 s45, s45, 1
    v_xor_b32 v37, s45, v35
    v_lshl_add_u32 v203, v37, 5, v36
    v_add_u32 v211, 65536, v203
    s_add_u32 s45, s23, 3
    s_and_b32 s45, s45, 3
    s_lshl_b32 s45, s45, 1
    s_or_b32 s45, s45, 0
    v_xor_b32 v37, s45, v35
    v_lshl_add_u32 v204, v37, 5, v36
    v_add_u32 v212, 65536, v204
    s_add_u32 s45, s23, 3
    s_and_b32 s45, s45, 3
    s_lshl_b32 s45, s45, 1
    s_or_b32 s45, s45, 1
    v_xor_b32 v37, s45, v35
    v_lshl_add_u32 v205, v37, 5, v36
    v_add_u32 v213, 65536, v205
    s_add_u32 s45, s23, 4
    s_and_b32 s45, s45, 3
    s_lshl_b32 s45, s45, 1
    s_or_b32 s45, s45, 0
    v_xor_b32 v37, s45, v35
    v_lshl_add_u32 v206, v37, 5, v36
    v_add_u32 v214, 65536, v206
    s_add_u32 s45, s23, 4
    s_and_b32 s45, s45, 3
    s_lshl_b32 s45, s45, 1
    s_or_b32 s45, s45, 1
    v_xor_b32 v37, s45, v35
    v_lshl_add_u32 v207, v37, 5, v36
    v_add_u32 v215, 65536, v207
    s_add_u32 s28, s28, 131072
    s_add_u32 m0, s30, 16384
    s_nop 0
    buffer_load_dwordx4 v4, s[12:15], s28 offen offset:0 lds
    s_mov_b32 s29, 4096
    buffer_load_dwordx4 a[32:35], v16, s[16:19], s29 offen offset:0
    buffer_load_dwordx4 a[36:39], v16, s[16:19], s29 offen offset:256
    buffer_load_dwordx4 v5, s[12:15], s28 offen offset:1024 lds
    buffer_load_dwordx4 a[40:43], v17, s[16:19], s29 offen offset:0
    buffer_load_dwordx4 a[44:47], v17, s[16:19], s29 offen offset:256
    buffer_load_dwordx4 v6, s[12:15], s28 offen offset:2048 lds
    buffer_load_dwordx4 a[48:51], v16, s[16:19], s29 offen offset:2048
    buffer_load_dwordx4 a[52:55], v16, s[16:19], s29 offen offset:2304
    buffer_load_dwordx4 v7, s[12:15], s28 offen offset:3072 lds
    buffer_load_dwordx4 a[56:59], v17, s[16:19], s29 offen offset:2048
    buffer_load_dwordx4 a[60:63], v17, s[16:19], s29 offen offset:2304
    v_mov_b32 v64, 0
    v_mov_b32 v65, 0
    v_mov_b32 v66, 0
    v_mov_b32 v67, 0
    v_mov_b32 v68, 0
    v_mov_b32 v69, 0
    v_mov_b32 v70, 0
    v_mov_b32 v71, 0
    v_mov_b32 v72, 0
    v_mov_b32 v73, 0
    v_mov_b32 v74, 0
    v_mov_b32 v75, 0
    v_mov_b32 v76, 0
    v_mov_b32 v77, 0
    v_mov_b32 v78, 0
    v_mov_b32 v79, 0
    v_mov_b32 v80, 0
    v_mov_b32 v81, 0
    v_mov_b32 v82, 0
    v_mov_b32 v83, 0
    v_mov_b32 v84, 0
    v_mov_b32 v85, 0
    v_mov_b32 v86, 0
    v_mov_b32 v87, 0
    v_mov_b32 v88, 0
    v_mov_b32 v89, 0
    v_mov_b32 v90, 0
    v_mov_b32 v91, 0
    v_mov_b32 v92, 0
    v_mov_b32 v93, 0
    v_mov_b32 v94, 0
    v_mov_b32 v95, 0
    v_mov_b32 v96, 0
    v_mov_b32 v97, 0
    v_mov_b32 v98, 0
    v_mov_b32 v99, 0
    v_mov_b32 v100, 0
    v_mov_b32 v101, 0
    v_mov_b32 v102, 0
    v_mov_b32 v103, 0
    v_mov_b32 v104, 0
    v_mov_b32 v105, 0
    v_mov_b32 v106, 0
    v_mov_b32 v107, 0
    v_mov_b32 v108, 0
    v_mov_b32 v109, 0
    v_mov_b32 v110, 0
    v_mov_b32 v111, 0
    v_mov_b32 v112, 0
    v_mov_b32 v113, 0
    v_mov_b32 v114, 0
    v_mov_b32 v115, 0
    v_mov_b32 v116, 0
    v_mov_b32 v117, 0
    v_mov_b32 v118, 0
    v_mov_b32 v119, 0
    v_mov_b32 v120, 0
    v_mov_b32 v121, 0
    v_mov_b32 v122, 0
    v_mov_b32 v123, 0
    v_mov_b32 v124, 0
    v_mov_b32 v125, 0
    v_mov_b32 v126, 0
    v_mov_b32 v127, 0
    v_mov_b32 v128, 0
    v_mov_b32 v129, 0
    v_mov_b32 v130, 0
    v_mov_b32 v131, 0
    v_mov_b32 v132, 0
    v_mov_b32 v133, 0
    v_mov_b32 v134, 0
    v_mov_b32 v135, 0
    v_mov_b32 v136, 0
    v_mov_b32 v137, 0
    v_mov_b32 v138, 0
    v_mov_b32 v139, 0
    v_mov_b32 v140, 0
    v_mov_b32 v141, 0
    v_mov_b32 v142, 0
    v_mov_b32 v143, 0
    v_mov_b32 v144, 0
    v_mov_b32 v145, 0
    v_mov_b32 v146, 0
    v_mov_b32 v147, 0
    v_mov_b32 v148, 0
    v_mov_b32 v149, 0
    v_mov_b32 v150, 0
    v_mov_b32 v151, 0
    v_mov_b32 v152, 0
    v_mov_b32 v153, 0
    v_mov_b32 v154, 0
    v_mov_b32 v155, 0
    v_mov_b32 v156, 0
    v_mov_b32 v157, 0
    v_mov_b32 v158, 0
    v_mov_b32 v159, 0
    v_mov_b32 v160, 0
    v_mov_b32 v161, 0
    v_mov_b32 v162, 0
    v_mov_b32 v163, 0
    v_mov_b32 v164, 0
    v_mov_b32 v165, 0
    v_mov_b32 v166, 0
    v_mov_b32 v167, 0
    v_mov_b32 v168, 0
    v_mov_b32 v169, 0
    v_mov_b32 v170, 0
    v_mov_b32 v171, 0
    v_mov_b32 v172, 0
    v_mov_b32 v173, 0
    v_mov_b32 v174, 0
    v_mov_b32 v175, 0
    v_mov_b32 v176, 0
    v_mov_b32 v177, 0
    v_mov_b32 v178, 0
    v_mov_b32 v179, 0
    v_mov_b32 v180, 0
    v_mov_b32 v181, 0
    v_mov_b32 v182, 0
    v_mov_b32 v183, 0
    v_mov_b32 v184, 0
    v_mov_b32 v185, 0
    v_mov_b32 v186, 0
    v_mov_b32 v187, 0
    v_mov_b32 v188, 0
    v_mov_b32 v189, 0
    v_mov_b32 v190, 0
    v_mov_b32 v191, 0
    s_mul_i32 s31, s23, 4194304
    s_add_u32 s31, s31, 83886080
    s_add_u32 s40, s6, s31
    s_addc_u32 s41, s7, 0
    s_mov_b32 s42, 4194304
    s_mov_b32 s43, 0x20000
    s_lshl_b32 s26, s24, 16
    s_lshl_b32 s27, s25, 13
    s_add_u32 s26, s26, s27
    s_add_u32 s27, s26, 65536
    s_add_u32 s34, s26, 4096
    s_add_u32 s35, s27, 4096
    s_add_u32 s40, s6, 83886080
    s_addc_u32 s41, s7, 0
    s_mov_b32 s42, 16777216
    s_mov_b32 s43, 0x20000
    s_add_u32 s44, s6, 33554432
    s_addc_u32 s45, s7, 0
    s_mov_b32 s46, 4194304
    s_mov_b32 s47, 0x20000
    s_add_u32 s48, s6, 245760
    s_addc_u32 s49, s7, 0
    s_mov_b32 s50, 4096
    s_mov_b32 s51, 0x20000
    s_mov_b32 s52, s8
    s_mov_b32 s53, s9
    s_mov_b32 s54, 4194304
    s_mov_b32 s55, 0x20000
    s_add_u32 s56, s6, 229376
    s_addc_u32 s57, s7, 0
    s_lshl_b32 s58, s20, 12
    s_add_u32 s31, s23, 1
    s_and_b32 s31, s31, 3
    s_lshl_b32 s59, s36, 2
    s_add_u32 s59, s59, s31
    s_lshl_b32 s59, s59, 2
    s_add_u32 s59, s59, s23
    s_lshl_b32 s59, s59, 14
    s_add_u32 s37, s59, s58
    s_add_u32 s31, s23, 2
    s_and_b32 s31, s31, 3
    s_lshl_b32 s59, s36, 2
    s_add_u32 s59, s59, s31
    s_lshl_b32 s59, s59, 2
    s_add_u32 s59, s59, s23
    s_lshl_b32 s59, s59, 14
    s_add_u32 s38, s59, s58
    s_add_u32 s31, s23, 3
    s_and_b32 s31, s31, 3
    s_lshl_b32 s59, s36, 2
    s_add_u32 s59, s59, s31
    s_lshl_b32 s59, s59, 2
    s_add_u32 s59, s59, s23
    s_lshl_b32 s59, s59, 14
    s_add_u32 s39, s59, s58
    s_add_u32 s31, s23, 1
    s_and_b32 s31, s31, 3
    s_lshl_b32 s59, s36, 2
    s_add_u32 s59, s59, s23
    s_lshl_b32 s59, s59, 2
    s_add_u32 s59, s59, s31
    s_lshl_b32 s59, s59, 14
    s_add_u32 s64, s59, s58
    s_add_u32 s31, s23, 2
    s_and_b32 s31, s31, 3
    s_lshl_b32 s59, s36, 2
    s_add_u32 s59, s59, s23
    s_lshl_b32 s59, s59, 2
    s_add_u32 s59, s59, s31
    s_lshl_b32 s59, s59, 14
    s_add_u32 s65, s59, s58
    s_add_u32 s31, s23, 3
    s_and_b32 s31, s31, 3
    s_lshl_b32 s59, s36, 2
    s_add_u32 s59, s59, s23
    s_lshl_b32 s59, s59, 2
    s_add_u32 s59, s59, s31
    s_lshl_b32 s59, s59, 14
    s_add_u32 s66, s59, s58
    s_lshl_b32 s31, s24, 16
    s_lshl_b32 s59, s25, 13
    s_add_u32 s31, s31, s59
    s_lshl_b32 s59, s23, 11
    s_add_u32 s67, s31, s59
    s_add_u32 s31, s67, 65536
    buffer_load_dwordx4 v[216:219], v2, s[44:47], s67 offen
    buffer_load_dwordx4 v[220:223], v2, s[44:47], s67 offen offset:1024
    buffer_load_dwordx4 v[224:227], v2, s[44:47], s31 offen
    buffer_load_dwordx4 v[228:231], v2, s[44:47], s31 offen offset:1024
    v_lshrrev_b32 v248, 5, v1
    v_lshlrev_b32 v248, 5, v248
    s_lshl_b32 s31, s25, 9
    s_lshl_b32 s59, s23, 7
    s_add_u32 s31, s31, s59
    buffer_load_dwordx4 v[232:235], v248, s[48:51], s31 offen
    buffer_load_dwordx4 v[236:239], v248, s[48:51], s31 offen offset:16
    buffer_load_dwordx4 v[240:243], v248, s[48:51], s31 offen offset:64
    buffer_load_dwordx4 v[244:247], v248, s[48:51], s31 offen offset:80
    s_add_u32 s31, s23, 1
    s_and_b32 s31, s31, 3
    s_lshl_b32 s59, s36, 2
    s_add_u32 s59, s59, s31
    s_lshl_b32 s59, s59, 2
    s_add_u32 s59, s59, s20
    s_lshl_b32 s59, s59, 2
    s_add_u32 s59, s59, s23
    s_lshl_b32 s59, s59, 2
    v_mov_b32 v250, s59
    s_add_u32 s31, s23, 2
    s_and_b32 s31, s31, 3
    s_lshl_b32 s59, s36, 2
    s_add_u32 s59, s59, s31
    s_lshl_b32 s59, s59, 2
    s_add_u32 s59, s59, s20
    s_lshl_b32 s59, s59, 2
    s_add_u32 s59, s59, s23
    s_lshl_b32 s59, s59, 2
    v_mov_b32 v39, s59
    s_add_u32 s31, s23, 3
    s_and_b32 s31, s31, 3
    s_lshl_b32 s59, s36, 2
    s_add_u32 s59, s59, s31
    s_lshl_b32 s59, s59, 2
    s_add_u32 s59, s59, s20
    s_lshl_b32 s59, s59, 2
    s_add_u32 s59, s59, s23
    s_lshl_b32 s59, s59, 2
    v_mov_b32 v251, s59
    s_lshl_b32 s59, s36, 2
    s_add_u32 s59, s59, s23
    s_lshl_b32 s59, s59, 2
    s_add_u32 s59, s59, s20
    s_lshl_b32 s59, s59, 4
    v_mov_b32 v252, s59
    v_mov_b32 v249, 1
    s_add_u32 s31, s23, 1
    s_and_b32 s31, s31, 3
    s_cmp_eq_u32 s23, 0
    s_cselect_b32 s58, 1, 0
    v_mov_b32 v48, s58
    s_cmp_eq_u32 s31, 0
    s_cselect_b32 s58, 1, s58
    v_mov_b32 v44, s58
    s_cmp_eq_u32 s23, 1
    s_cselect_b32 s58, 1, 0
    v_mov_b32 v49, s58
    s_cmp_eq_u32 s31, 1
    s_cselect_b32 s58, 1, s58
    v_mov_b32 v45, s58
    s_cmp_eq_u32 s23, 2
    s_cselect_b32 s58, 1, 0
    v_mov_b32 v50, s58
    s_cmp_eq_u32 s31, 2
    s_cselect_b32 s58, 1, s58
    v_mov_b32 v46, s58
    s_cmp_eq_u32 s23, 3
    s_cselect_b32 s58, 1, 0
    v_mov_b32 v51, s58
    s_cmp_eq_u32 s31, 3
    s_cselect_b32 s58, 1, s58
    v_mov_b32 v47, s58
    s_waitcnt vmcnt(20)
    s_barrier
    ds_read_b64_tr_b16 a[192:193], v200 offset:0
    ds_read_b64_tr_b16 a[194:195], v200 offset:1024
    ds_read_b64_tr_b16 a[196:197], v201 offset:0
    ds_read_b64_tr_b16 a[198:199], v201 offset:1024
    ds_read_b64_tr_b16 a[200:201], v202 offset:0
    ds_read_b64_tr_b16 a[202:203], v202 offset:1024
    ds_read_b64_tr_b16 a[204:205], v203 offset:0
    ds_read_b64_tr_b16 a[206:207], v203 offset:1024
    s_waitcnt lgkmcnt(6)
    v_mfma_f32_16x16x32_bf16 v[64:67], a[192:195], a[0:3], v[64:67]
    ds_read_b64_tr_b16 a[208:209], v204 offset:0
    v_mfma_f32_16x16x32_bf16 v[68:71], a[192:195], a[4:7], v[68:71]
    ds_read_b64_tr_b16 a[210:211], v204 offset:1024
    s_add_u32 s28, s28, 131072
    s_add_u32 m0, s30, 32768
    v_mfma_f32_16x16x32_bf16 v[72:75], a[192:195], a[8:11], v[72:75]
    buffer_load_dwordx4 v4, s[12:15], s28 offen offset:0 lds
    v_mfma_f32_16x16x32_bf16 v[76:79], a[192:195], a[12:15], v[76:79]
    s_waitcnt lgkmcnt(6)
    v_mfma_f32_16x16x32_bf16 v[80:83], a[196:199], a[0:3], v[80:83]
    ds_read_b64_tr_b16 a[212:213], v205 offset:0
    v_mfma_f32_16x16x32_bf16 v[84:87], a[196:199], a[4:7], v[84:87]
    ds_read_b64_tr_b16 a[214:215], v205 offset:1024
    s_mov_b32 s29, 8192
    v_mfma_f32_16x16x32_bf16 v[88:91], a[196:199], a[8:11], v[88:91]
    buffer_load_dwordx4 a[64:67], v16, s[16:19], s29 offen offset:0
    v_mfma_f32_16x16x32_bf16 v[92:95], a[196:199], a[12:15], v[92:95]
    s_waitcnt lgkmcnt(6)
    v_mfma_f32_16x16x32_bf16 v[96:99], a[200:203], a[0:3], v[96:99]
    ds_read_b64_tr_b16 a[216:217], v206 offset:0
    v_mfma_f32_16x16x32_bf16 v[100:103], a[200:203], a[4:7], v[100:103]
    ds_read_b64_tr_b16 a[218:219], v206 offset:1024
    v_mfma_f32_16x16x32_bf16 v[104:107], a[200:203], a[8:11], v[104:107]
    buffer_load_dwordx4 a[68:71], v16, s[16:19], s29 offen offset:256
    v_mfma_f32_16x16x32_bf16 v[108:111], a[200:203], a[12:15], v[108:111]
    s_waitcnt lgkmcnt(6)
    v_mfma_f32_16x16x32_bf16 v[112:115], a[204:207], a[0:3], v[112:115]
    ds_read_b64_tr_b16 a[220:221], v207 offset:0
    v_mfma_f32_16x16x32_bf16 v[116:119], a[204:207], a[4:7], v[116:119]
    ds_read_b64_tr_b16 a[222:223], v207 offset:1024
    v_mfma_f32_16x16x32_bf16 v[120:123], a[204:207], a[8:11], v[120:123]
    buffer_load_dwordx4 v5, s[12:15], s28 offen offset:1024 lds
    v_mfma_f32_16x16x32_bf16 v[124:127], a[204:207], a[12:15], v[124:127]
    s_waitcnt lgkmcnt(6)
    v_mfma_f32_16x16x32_bf16 v[128:131], a[208:211], a[0:3], v[128:131]
    ds_read_b64_tr_b16 a[192:193], v200 offset:8192
    v_mfma_f32_16x16x32_bf16 v[132:135], a[208:211], a[4:7], v[132:135]
    ds_read_b64_tr_b16 a[194:195], v200 offset:9216
    v_mfma_f32_16x16x32_bf16 v[136:139], a[208:211], a[8:11], v[136:139]
    buffer_load_dwordx4 a[72:75], v17, s[16:19], s29 offen offset:0
    v_mfma_f32_16x16x32_bf16 v[140:143], a[208:211], a[12:15], v[140:143]
    s_waitcnt lgkmcnt(6)
    v_mfma_f32_16x16x32_bf16 v[144:147], a[212:215], a[0:3], v[144:147]
    ds_read_b64_tr_b16 a[196:197], v201 offset:8192
    v_mfma_f32_16x16x32_bf16 v[148:151], a[212:215], a[4:7], v[148:151]
    ds_read_b64_tr_b16 a[198:199], v201 offset:9216
    v_mfma_f32_16x16x32_bf16 v[152:155], a[212:215], a[8:11], v[152:155]
    buffer_load_dwordx4 a[76:79], v17, s[16:19], s29 offen offset:256
    v_mfma_f32_16x16x32_bf16 v[156:159], a[212:215], a[12:15], v[156:159]
    s_waitcnt lgkmcnt(6)
    v_mfma_f32_16x16x32_bf16 v[160:163], a[216:219], a[0:3], v[160:163]
    ds_read_b64_tr_b16 a[200:201], v202 offset:8192
    v_mfma_f32_16x16x32_bf16 v[164:167], a[216:219], a[4:7], v[164:167]
    ds_read_b64_tr_b16 a[202:203], v202 offset:9216
    v_mfma_f32_16x16x32_bf16 v[168:171], a[216:219], a[8:11], v[168:171]
    buffer_load_dwordx4 v6, s[12:15], s28 offen offset:2048 lds
    v_mfma_f32_16x16x32_bf16 v[172:175], a[216:219], a[12:15], v[172:175]
    s_waitcnt lgkmcnt(6)
    v_mfma_f32_16x16x32_bf16 v[176:179], a[220:223], a[0:3], v[176:179]
    ds_read_b64_tr_b16 a[204:205], v203 offset:8192
    v_mfma_f32_16x16x32_bf16 v[180:183], a[220:223], a[4:7], v[180:183]
    ds_read_b64_tr_b16 a[206:207], v203 offset:9216
    v_mfma_f32_16x16x32_bf16 v[184:187], a[220:223], a[8:11], v[184:187]
    buffer_load_dwordx4 a[80:83], v16, s[16:19], s29 offen offset:2048
    v_mfma_f32_16x16x32_bf16 v[188:191], a[220:223], a[12:15], v[188:191]
    s_waitcnt lgkmcnt(6)
    v_mfma_f32_16x16x32_bf16 v[64:67], a[192:195], a[16:19], v[64:67]
    ds_read_b64_tr_b16 a[208:209], v204 offset:8192
    v_mfma_f32_16x16x32_bf16 v[68:71], a[192:195], a[20:23], v[68:71]
    ds_read_b64_tr_b16 a[210:211], v204 offset:9216
    v_mfma_f32_16x16x32_bf16 v[72:75], a[192:195], a[24:27], v[72:75]
    buffer_load_dwordx4 a[84:87], v16, s[16:19], s29 offen offset:2304
    v_mfma_f32_16x16x32_bf16 v[76:79], a[192:195], a[28:31], v[76:79]
    s_waitcnt lgkmcnt(6)
    v_mfma_f32_16x16x32_bf16 v[80:83], a[196:199], a[16:19], v[80:83]
    ds_read_b64_tr_b16 a[212:213], v205 offset:8192
    v_mfma_f32_16x16x32_bf16 v[84:87], a[196:199], a[20:23], v[84:87]
    ds_read_b64_tr_b16 a[214:215], v205 offset:9216
    v_mfma_f32_16x16x32_bf16 v[88:91], a[196:199], a[24:27], v[88:91]
    buffer_load_dwordx4 v7, s[12:15], s28 offen offset:3072 lds
    v_mfma_f32_16x16x32_bf16 v[92:95], a[196:199], a[28:31], v[92:95]
    s_waitcnt lgkmcnt(6)
    v_mfma_f32_16x16x32_bf16 v[96:99], a[200:203], a[16:19], v[96:99]
    ds_read_b64_tr_b16 a[216:217], v206 offset:8192
    v_mfma_f32_16x16x32_bf16 v[100:103], a[200:203], a[20:23], v[100:103]
    ds_read_b64_tr_b16 a[218:219], v206 offset:9216
    v_mfma_f32_16x16x32_bf16 v[104:107], a[200:203], a[24:27], v[104:107]
    buffer_load_dwordx4 a[88:91], v17, s[16:19], s29 offen offset:2048
    v_mfma_f32_16x16x32_bf16 v[108:111], a[200:203], a[28:31], v[108:111]
    s_waitcnt lgkmcnt(6)
    v_mfma_f32_16x16x32_bf16 v[112:115], a[204:207], a[16:19], v[112:115]
    ds_read_b64_tr_b16 a[220:221], v207 offset:8192
    v_mfma_f32_16x16x32_bf16 v[116:119], a[204:207], a[20:23], v[116:119]
    ds_read_b64_tr_b16 a[222:223], v207 offset:9216
    v_mfma_f32_16x16x32_bf16 v[120:123], a[204:207], a[24:27], v[120:123]
    buffer_load_dwordx4 a[92:95], v17, s[16:19], s29 offen offset:2304
    v_mfma_f32_16x16x32_bf16 v[124:127], a[204:207], a[28:31], v[124:127]
    s_waitcnt vmcnt(20) lgkmcnt(0)
    s_barrier
    v_mfma_f32_16x16x32_bf16 v[128:131], a[208:211], a[16:19], v[128:131]
    ds_read_b64_tr_b16 a[192:193], v200 offset:16384
    v_mfma_f32_16x16x32_bf16 v[132:135], a[208:211], a[20:23], v[132:135]
    ds_read_b64_tr_b16 a[194:195], v200 offset:17408
    s_add_u32 s28, s28, 131072
    s_add_u32 m0, s30, 49152
    v_mfma_f32_16x16x32_bf16 v[136:139], a[208:211], a[24:27], v[136:139]
    buffer_load_dwordx4 v4, s[12:15], s28 offen offset:0 lds
    v_mfma_f32_16x16x32_bf16 v[140:143], a[208:211], a[28:31], v[140:143]
    s_waitcnt lgkmcnt(6)
    v_mfma_f32_16x16x32_bf16 v[144:147], a[212:215], a[16:19], v[144:147]
    ds_read_b64_tr_b16 a[196:197], v201 offset:16384
    v_mfma_f32_16x16x32_bf16 v[148:151], a[212:215], a[20:23], v[148:151]
    ds_read_b64_tr_b16 a[198:199], v201 offset:17408
    s_mov_b32 s29, 12288
    v_mfma_f32_16x16x32_bf16 v[152:155], a[212:215], a[24:27], v[152:155]
    buffer_load_dwordx4 a[96:99], v16, s[16:19], s29 offen offset:0
    v_mfma_f32_16x16x32_bf16 v[156:159], a[212:215], a[28:31], v[156:159]
    s_waitcnt lgkmcnt(6)
    v_mfma_f32_16x16x32_bf16 v[160:163], a[216:219], a[16:19], v[160:163]
    ds_read_b64_tr_b16 a[200:201], v202 offset:16384
    v_mfma_f32_16x16x32_bf16 v[164:167], a[216:219], a[20:23], v[164:167]
    ds_read_b64_tr_b16 a[202:203], v202 offset:17408
    v_mfma_f32_16x16x32_bf16 v[168:171], a[216:219], a[24:27], v[168:171]
    buffer_load_dwordx4 a[100:103], v16, s[16:19], s29 offen offset:256
    v_mfma_f32_16x16x32_bf16 v[172:175], a[216:219], a[28:31], v[172:175]
    s_waitcnt lgkmcnt(6)
    v_mfma_f32_16x16x32_bf16 v[176:179], a[220:223], a[16:19], v[176:179]
    ds_read_b64_tr_b16 a[204:205], v203 offset:16384
    v_mfma_f32_16x16x32_bf16 v[180:183], a[220:223], a[20:23], v[180:183]
    ds_read_b64_tr_b16 a[206:207], v203 offset:17408
    v_mfma_f32_16x16x32_bf16 v[184:187], a[220:223], a[24:27], v[184:187]
    buffer_load_dwordx4 v5, s[12:15], s28 offen offset:1024 lds
    v_mfma_f32_16x16x32_bf16 v[188:191], a[220:223], a[28:31], v[188:191]
    s_waitcnt lgkmcnt(6)
    v_mfma_f32_16x16x32_bf16 v[64:67], a[192:195], a[32:35], v[64:67]
    ds_read_b64_tr_b16 a[208:209], v204 offset:16384
    v_mfma_f32_16x16x32_bf16 v[68:71], a[192:195], a[36:39], v[68:71]
    ds_read_b64_tr_b16 a[210:211], v204 offset:17408
    v_mfma_f32_16x16x32_bf16 v[72:75], a[192:195], a[40:43], v[72:75]
    buffer_load_dwordx4 a[104:107], v17, s[16:19], s29 offen offset:0
    v_mfma_f32_16x16x32_bf16 v[76:79], a[192:195], a[44:47], v[76:79]
    s_waitcnt lgkmcnt(6)
    v_mfma_f32_16x16x32_bf16 v[80:83], a[196:199], a[32:35], v[80:83]
    ds_read_b64_tr_b16 a[212:213], v205 offset:16384
    v_mfma_f32_16x16x32_bf16 v[84:87], a[196:199], a[36:39], v[84:87]
    ds_read_b64_tr_b16 a[214:215], v205 offset:17408
    v_mfma_f32_16x16x32_bf16 v[88:91], a[196:199], a[40:43], v[88:91]
    buffer_load_dwordx4 a[108:111], v17, s[16:19], s29 offen offset:256
    v_mfma_f32_16x16x32_bf16 v[92:95], a[196:199], a[44:47], v[92:95]
    s_waitcnt lgkmcnt(6)
    v_mfma_f32_16x16x32_bf16 v[96:99], a[200:203], a[32:35], v[96:99]
    ds_read_b64_tr_b16 a[216:217], v206 offset:16384
    v_mfma_f32_16x16x32_bf16 v[100:103], a[200:203], a[36:39], v[100:103]
    ds_read_b64_tr_b16 a[218:219], v206 offset:17408
    v_mfma_f32_16x16x32_bf16 v[104:107], a[200:203], a[40:43], v[104:107]
    buffer_load_dwordx4 v6, s[12:15], s28 offen offset:2048 lds
    v_mfma_f32_16x16x32_bf16 v[108:111], a[200:203], a[44:47], v[108:111]
    s_waitcnt lgkmcnt(6)
    v_mfma_f32_16x16x32_bf16 v[112:115], a[204:207], a[32:35], v[112:115]
    ds_read_b64_tr_b16 a[220:221], v207 offset:16384
    v_mfma_f32_16x16x32_bf16 v[116:119], a[204:207], a[36:39], v[116:119]
    ds_read_b64_tr_b16 a[222:223], v207 offset:17408
    v_mfma_f32_16x16x32_bf16 v[120:123], a[204:207], a[40:43], v[120:123]
    buffer_load_dwordx4 a[112:115], v16, s[16:19], s29 offen offset:2048
    v_mfma_f32_16x16x32_bf16 v[124:127], a[204:207], a[44:47], v[124:127]
    s_waitcnt lgkmcnt(6)
    v_mfma_f32_16x16x32_bf16 v[128:131], a[208:211], a[32:35], v[128:131]
    ds_read_b64_tr_b16 a[192:193], v200 offset:24576
    v_mfma_f32_16x16x32_bf16 v[132:135], a[208:211], a[36:39], v[132:135]
    ds_read_b64_tr_b16 a[194:195], v200 offset:25600
    v_mfma_f32_16x16x32_bf16 v[136:139], a[208:211], a[40:43], v[136:139]
    buffer_load_dwordx4 a[116:119], v16, s[16:19], s29 offen offset:2304
    v_mfma_f32_16x16x32_bf16 v[140:143], a[208:211], a[44:47], v[140:143]
    s_waitcnt lgkmcnt(6)
    v_mfma_f32_16x16x32_bf16 v[144:147], a[212:215], a[32:35], v[144:147]
    ds_read_b64_tr_b16 a[196:197], v201 offset:24576
    v_mfma_f32_16x16x32_bf16 v[148:151], a[212:215], a[36:39], v[148:151]
    ds_read_b64_tr_b16 a[198:199], v201 offset:25600
    v_mfma_f32_16x16x32_bf16 v[152:155], a[212:215], a[40:43], v[152:155]
    buffer_load_dwordx4 v7, s[12:15], s28 offen offset:3072 lds
    v_mfma_f32_16x16x32_bf16 v[156:159], a[212:215], a[44:47], v[156:159]
    s_waitcnt lgkmcnt(6)
    v_mfma_f32_16x16x32_bf16 v[160:163], a[216:219], a[32:35], v[160:163]
    ds_read_b64_tr_b16 a[200:201], v202 offset:24576
    v_mfma_f32_16x16x32_bf16 v[164:167], a[216:219], a[36:39], v[164:167]
    ds_read_b64_tr_b16 a[202:203], v202 offset:25600
    v_mfma_f32_16x16x32_bf16 v[168:171], a[216:219], a[40:43], v[168:171]
    buffer_load_dwordx4 a[120:123], v17, s[16:19], s29 offen offset:2048
    v_mfma_f32_16x16x32_bf16 v[172:175], a[216:219], a[44:47], v[172:175]
    s_waitcnt lgkmcnt(6)
    v_mfma_f32_16x16x32_bf16 v[176:179], a[220:223], a[32:35], v[176:179]
    ds_read_b64_tr_b16 a[204:205], v203 offset:24576
    v_mfma_f32_16x16x32_bf16 v[180:183], a[220:223], a[36:39], v[180:183]
    ds_read_b64_tr_b16 a[206:207], v203 offset:25600
    v_mfma_f32_16x16x32_bf16 v[184:187], a[220:223], a[40:43], v[184:187]
    buffer_load_dwordx4 a[124:127], v17, s[16:19], s29 offen offset:2304
    v_mfma_f32_16x16x32_bf16 v[188:191], a[220:223], a[44:47], v[188:191]
    s_waitcnt lgkmcnt(6)
    v_mfma_f32_16x16x32_bf16 v[64:67], a[192:195], a[48:51], v[64:67]
    ds_read_b64_tr_b16 a[208:209], v204 offset:24576
    v_mfma_f32_16x16x32_bf16 v[68:71], a[192:195], a[52:55], v[68:71]
    ds_read_b64_tr_b16 a[210:211], v204 offset:25600
    s_add_u32 s28, s28, 131072
    s_add_u32 m0, s30, 65536
    v_mfma_f32_16x16x32_bf16 v[72:75], a[192:195], a[56:59], v[72:75]
    buffer_load_dwordx4 v4, s[12:15], s28 offen offset:0 lds
    v_mfma_f32_16x16x32_bf16 v[76:79], a[192:195], a[60:63], v[76:79]
    s_waitcnt lgkmcnt(6)
    v_mfma_f32_16x16x32_bf16 v[80:83], a[196:199], a[48:51], v[80:83]
    ds_read_b64_tr_b16 a[212:213], v205 offset:24576
    v_mfma_f32_16x16x32_bf16 v[84:87], a[196:199], a[52:55], v[84:87]
    ds_read_b64_tr_b16 a[214:215], v205 offset:25600
    s_mov_b32 s29, 16384
    v_mfma_f32_16x16x32_bf16 v[88:91], a[196:199], a[56:59], v[88:91]
    buffer_load_dwordx4 a[128:131], v16, s[16:19], s29 offen offset:0
    v_mfma_f32_16x16x32_bf16 v[92:95], a[196:199], a[60:63], v[92:95]
    s_waitcnt lgkmcnt(6)
    v_mfma_f32_16x16x32_bf16 v[96:99], a[200:203], a[48:51], v[96:99]
    ds_read_b64_tr_b16 a[216:217], v206 offset:24576
    v_mfma_f32_16x16x32_bf16 v[100:103], a[200:203], a[52:55], v[100:103]
    ds_read_b64_tr_b16 a[218:219], v206 offset:25600
    v_mfma_f32_16x16x32_bf16 v[104:107], a[200:203], a[56:59], v[104:107]
    buffer_load_dwordx4 a[132:135], v16, s[16:19], s29 offen offset:256
    v_mfma_f32_16x16x32_bf16 v[108:111], a[200:203], a[60:63], v[108:111]
    s_waitcnt lgkmcnt(6)
    v_mfma_f32_16x16x32_bf16 v[112:115], a[204:207], a[48:51], v[112:115]
    ds_read_b64_tr_b16 a[220:221], v207 offset:24576
    v_mfma_f32_16x16x32_bf16 v[116:119], a[204:207], a[52:55], v[116:119]
    ds_read_b64_tr_b16 a[222:223], v207 offset:25600
    v_mfma_f32_16x16x32_bf16 v[120:123], a[204:207], a[56:59], v[120:123]
    buffer_load_dwordx4 v5, s[12:15], s28 offen offset:1024 lds
    v_mfma_f32_16x16x32_bf16 v[124:127], a[204:207], a[60:63], v[124:127]
    s_waitcnt vmcnt(16) lgkmcnt(0)
    s_barrier
    v_mfma_f32_16x16x32_bf16 v[128:131], a[208:211], a[48:51], v[128:131]
    ds_read_b64_tr_b16 a[192:193], v200 offset:32768
    v_mfma_f32_16x16x32_bf16 v[132:135], a[208:211], a[52:55], v[132:135]
    ds_read_b64_tr_b16 a[194:195], v200 offset:33792
    v_mfma_f32_16x16x32_bf16 v[136:139], a[208:211], a[56:59], v[136:139]
    buffer_load_dwordx4 a[136:139], v17, s[16:19], s29 offen offset:0
    v_mfma_f32_16x16x32_bf16 v[140:143], a[208:211], a[60:63], v[140:143]
    s_waitcnt lgkmcnt(6)
    v_mfma_f32_16x16x32_bf16 v[144:147], a[212:215], a[48:51], v[144:147]
    ds_read_b64_tr_b16 a[196:197], v201 offset:32768
    v_mfma_f32_16x16x32_bf16 v[148:151], a[212:215], a[52:55], v[148:151]
    ds_read_b64_tr_b16 a[198:199], v201 offset:33792
    v_mfma_f32_16x16x32_bf16 v[152:155], a[212:215], a[56:59], v[152:155]
    buffer_load_dwordx4 a[140:143], v17, s[16:19], s29 offen offset:256
    v_mfma_f32_16x16x32_bf16 v[156:159], a[212:215], a[60:63], v[156:159]
    s_waitcnt lgkmcnt(6)
    v_mfma_f32_16x16x32_bf16 v[160:163], a[216:219], a[48:51], v[160:163]
    ds_read_b64_tr_b16 a[200:201], v202 offset:32768
    v_mfma_f32_16x16x32_bf16 v[164:167], a[216:219], a[52:55], v[164:167]
    ds_read_b64_tr_b16 a[202:203], v202 offset:33792
    v_mfma_f32_16x16x32_bf16 v[168:171], a[216:219], a[56:59], v[168:171]
    buffer_load_dwordx4 v6, s[12:15], s28 offen offset:2048 lds
    v_mfma_f32_16x16x32_bf16 v[172:175], a[216:219], a[60:63], v[172:175]
    s_waitcnt lgkmcnt(6)
    v_mfma_f32_16x16x32_bf16 v[176:179], a[220:223], a[48:51], v[176:179]
    ds_read_b64_tr_b16 a[204:205], v203 offset:32768
    v_mfma_f32_16x16x32_bf16 v[180:183], a[220:223], a[52:55], v[180:183]
    ds_read_b64_tr_b16 a[206:207], v203 offset:33792
    v_mfma_f32_16x16x32_bf16 v[184:187], a[220:223], a[56:59], v[184:187]
    buffer_load_dwordx4 a[144:147], v16, s[16:19], s29 offen offset:2048
    v_mfma_f32_16x16x32_bf16 v[188:191], a[220:223], a[60:63], v[188:191]
    s_waitcnt lgkmcnt(6)
    v_mfma_f32_16x16x32_bf16 v[64:67], a[192:195], a[64:67], v[64:67]
    ds_read_b64_tr_b16 a[208:209], v204 offset:32768
    v_mfma_f32_16x16x32_bf16 v[68:71], a[192:195], a[68:71], v[68:71]
    ds_read_b64_tr_b16 a[210:211], v204 offset:33792
    v_mfma_f32_16x16x32_bf16 v[72:75], a[192:195], a[72:75], v[72:75]
    buffer_load_dwordx4 a[148:151], v16, s[16:19], s29 offen offset:2304
    v_mfma_f32_16x16x32_bf16 v[76:79], a[192:195], a[76:79], v[76:79]
    s_waitcnt lgkmcnt(6)
    v_mfma_f32_16x16x32_bf16 v[80:83], a[196:199], a[64:67], v[80:83]
    ds_read_b64_tr_b16 a[212:213], v205 offset:32768
    v_mfma_f32_16x16x32_bf16 v[84:87], a[196:199], a[68:71], v[84:87]
    ds_read_b64_tr_b16 a[214:215], v205 offset:33792
    v_mfma_f32_16x16x32_bf16 v[88:91], a[196:199], a[72:75], v[88:91]
    buffer_load_dwordx4 v7, s[12:15], s28 offen offset:3072 lds
    v_mfma_f32_16x16x32_bf16 v[92:95], a[196:199], a[76:79], v[92:95]
    s_waitcnt lgkmcnt(6)
    v_mfma_f32_16x16x32_bf16 v[96:99], a[200:203], a[64:67], v[96:99]
    ds_read_b64_tr_b16 a[216:217], v206 offset:32768
    v_mfma_f32_16x16x32_bf16 v[100:103], a[200:203], a[68:71], v[100:103]
    ds_read_b64_tr_b16 a[218:219], v206 offset:33792
    v_mfma_f32_16x16x32_bf16 v[104:107], a[200:203], a[72:75], v[104:107]
    buffer_load_dwordx4 a[152:155], v17, s[16:19], s29 offen offset:2048
    v_mfma_f32_16x16x32_bf16 v[108:111], a[200:203], a[76:79], v[108:111]
    s_waitcnt lgkmcnt(6)
    v_mfma_f32_16x16x32_bf16 v[112:115], a[204:207], a[64:67], v[112:115]
    ds_read_b64_tr_b16 a[220:221], v207 offset:32768
    v_mfma_f32_16x16x32_bf16 v[116:119], a[204:207], a[68:71], v[116:119]
    ds_read_b64_tr_b16 a[222:223], v207 offset:33792
    v_mfma_f32_16x16x32_bf16 v[120:123], a[204:207], a[72:75], v[120:123]
    buffer_load_dwordx4 a[156:159], v17, s[16:19], s29 offen offset:2304
    v_mfma_f32_16x16x32_bf16 v[124:127], a[204:207], a[76:79], v[124:127]
    s_waitcnt lgkmcnt(6)
    v_mfma_f32_16x16x32_bf16 v[128:131], a[208:211], a[64:67], v[128:131]
    ds_read_b64_tr_b16 a[192:193], v200 offset:40960
    v_mfma_f32_16x16x32_bf16 v[132:135], a[208:211], a[68:71], v[132:135]
    ds_read_b64_tr_b16 a[194:195], v200 offset:41984
    s_add_u32 s28, s28, 131072
    s_add_u32 m0, s30, 81920
    v_mfma_f32_16x16x32_bf16 v[136:139], a[208:211], a[72:75], v[136:139]
    buffer_load_dwordx4 v4, s[12:15], s28 offen offset:0 lds
    v_mfma_f32_16x16x32_bf16 v[140:143], a[208:211], a[76:79], v[140:143]
    s_waitcnt lgkmcnt(6)
    v_mfma_f32_16x16x32_bf16 v[144:147], a[212:215], a[64:67], v[144:147]
    ds_read_b64_tr_b16 a[196:197], v201 offset:40960
    v_mfma_f32_16x16x32_bf16 v[148:151], a[212:215], a[68:71], v[148:151]
    ds_read_b64_tr_b16 a[198:199], v201 offset:41984
    s_mov_b32 s29, 20480
    v_mfma_f32_16x16x32_bf16 v[152:155], a[212:215], a[72:75], v[152:155]
    buffer_load_dwordx4 a[160:163], v16, s[16:19], s29 offen offset:0
    v_mfma_f32_16x16x32_bf16 v[156:159], a[212:215], a[76:79], v[156:159]
    s_waitcnt lgkmcnt(6)
    v_mfma_f32_16x16x32_bf16 v[160:163], a[216:219], a[64:67], v[160:163]
    ds_read_b64_tr_b16 a[200:201], v202 offset:40960
    v_mfma_f32_16x16x32_bf16 v[164:167], a[216:219], a[68:71], v[164:167]
    ds_read_b64_tr_b16 a[202:203], v202 offset:41984
    v_mfma_f32_16x16x32_bf16 v[168:171], a[216:219], a[72:75], v[168:171]
    buffer_load_dwordx4 a[164:167], v16, s[16:19], s29 offen offset:256
    v_mfma_f32_16x16x32_bf16 v[172:175], a[216:219], a[76:79], v[172:175]
    s_waitcnt lgkmcnt(6)
    v_mfma_f32_16x16x32_bf16 v[176:179], a[220:223], a[64:67], v[176:179]
    ds_read_b64_tr_b16 a[204:205], v203 offset:40960
    v_mfma_f32_16x16x32_bf16 v[180:183], a[220:223], a[68:71], v[180:183]
    ds_read_b64_tr_b16 a[206:207], v203 offset:41984
    v_mfma_f32_16x16x32_bf16 v[184:187], a[220:223], a[72:75], v[184:187]
    buffer_load_dwordx4 v5, s[12:15], s28 offen offset:1024 lds
    v_mfma_f32_16x16x32_bf16 v[188:191], a[220:223], a[76:79], v[188:191]
    s_waitcnt lgkmcnt(6)
    v_mfma_f32_16x16x32_bf16 v[64:67], a[192:195], a[80:83], v[64:67]
    ds_read_b64_tr_b16 a[208:209], v204 offset:40960
    v_mfma_f32_16x16x32_bf16 v[68:71], a[192:195], a[84:87], v[68:71]
    ds_read_b64_tr_b16 a[210:211], v204 offset:41984
    v_mfma_f32_16x16x32_bf16 v[72:75], a[192:195], a[88:91], v[72:75]
    buffer_load_dwordx4 a[168:171], v17, s[16:19], s29 offen offset:0
    v_mfma_f32_16x16x32_bf16 v[76:79], a[192:195], a[92:95], v[76:79]
    s_waitcnt lgkmcnt(6)
    v_mfma_f32_16x16x32_bf16 v[80:83], a[196:199], a[80:83], v[80:83]
    ds_read_b64_tr_b16 a[212:213], v205 offset:40960
    v_mfma_f32_16x16x32_bf16 v[84:87], a[196:199], a[84:87], v[84:87]
    ds_read_b64_tr_b16 a[214:215], v205 offset:41984
    v_mfma_f32_16x16x32_bf16 v[88:91], a[196:199], a[88:91], v[88:91]
    buffer_load_dwordx4 a[172:175], v17, s[16:19], s29 offen offset:256
    v_mfma_f32_16x16x32_bf16 v[92:95], a[196:199], a[92:95], v[92:95]
    s_waitcnt lgkmcnt(6)
    v_mfma_f32_16x16x32_bf16 v[96:99], a[200:203], a[80:83], v[96:99]
    ds_read_b64_tr_b16 a[216:217], v206 offset:40960
    v_mfma_f32_16x16x32_bf16 v[100:103], a[200:203], a[84:87], v[100:103]
    ds_read_b64_tr_b16 a[218:219], v206 offset:41984
    v_mfma_f32_16x16x32_bf16 v[104:107], a[200:203], a[88:91], v[104:107]
    buffer_load_dwordx4 v6, s[12:15], s28 offen offset:2048 lds
    v_mfma_f32_16x16x32_bf16 v[108:111], a[200:203], a[92:95], v[108:111]
    s_waitcnt lgkmcnt(6)
    v_mfma_f32_16x16x32_bf16 v[112:115], a[204:207], a[80:83], v[112:115]
    ds_read_b64_tr_b16 a[220:221], v207 offset:40960
    v_mfma_f32_16x16x32_bf16 v[116:119], a[204:207], a[84:87], v[116:119]
    ds_read_b64_tr_b16 a[222:223], v207 offset:41984
    v_mfma_f32_16x16x32_bf16 v[120:123], a[204:207], a[88:91], v[120:123]
    buffer_load_dwordx4 a[176:179], v16, s[16:19], s29 offen offset:2048
    v_mfma_f32_16x16x32_bf16 v[124:127], a[204:207], a[92:95], v[124:127]
    s_waitcnt vmcnt(20) lgkmcnt(0)
    s_barrier
    v_mfma_f32_16x16x32_bf16 v[128:131], a[208:211], a[80:83], v[128:131]
    ds_read_b64_tr_b16 a[192:193], v200 offset:49152
    v_mfma_f32_16x16x32_bf16 v[132:135], a[208:211], a[84:87], v[132:135]
    ds_read_b64_tr_b16 a[194:195], v200 offset:50176
    v_mfma_f32_16x16x32_bf16 v[136:139], a[208:211], a[88:91], v[136:139]
    buffer_load_dwordx4 a[180:183], v16, s[16:19], s29 offen offset:2304
    v_mfma_f32_16x16x32_bf16 v[140:143], a[208:211], a[92:95], v[140:143]
    s_waitcnt lgkmcnt(6)
    v_mfma_f32_16x16x32_bf16 v[144:147], a[212:215], a[80:83], v[144:147]
    ds_read_b64_tr_b16 a[196:197], v201 offset:49152
    v_mfma_f32_16x16x32_bf16 v[148:151], a[212:215], a[84:87], v[148:151]
    ds_read_b64_tr_b16 a[198:199], v201 offset:50176
    v_mfma_f32_16x16x32_bf16 v[152:155], a[212:215], a[88:91], v[152:155]
    buffer_load_dwordx4 v7, s[12:15], s28 offen offset:3072 lds
    v_mfma_f32_16x16x32_bf16 v[156:159], a[212:215], a[92:95], v[156:159]
    s_waitcnt lgkmcnt(6)
    v_mfma_f32_16x16x32_bf16 v[160:163], a[216:219], a[80:83], v[160:163]
    ds_read_b64_tr_b16 a[200:201], v202 offset:49152
    v_mfma_f32_16x16x32_bf16 v[164:167], a[216:219], a[84:87], v[164:167]
    ds_read_b64_tr_b16 a[202:203], v202 offset:50176
    v_mfma_f32_16x16x32_bf16 v[168:171], a[216:219], a[88:91], v[168:171]
    buffer_load_dwordx4 a[184:187], v17, s[16:19], s29 offen offset:2048
    v_mfma_f32_16x16x32_bf16 v[172:175], a[216:219], a[92:95], v[172:175]
    s_waitcnt lgkmcnt(6)
    v_mfma_f32_16x16x32_bf16 v[176:179], a[220:223], a[80:83], v[176:179]
    ds_read_b64_tr_b16 a[204:205], v203 offset:49152
    v_mfma_f32_16x16x32_bf16 v[180:183], a[220:223], a[84:87], v[180:183]
    ds_read_b64_tr_b16 a[206:207], v203 offset:50176
    v_mfma_f32_16x16x32_bf16 v[184:187], a[220:223], a[88:91], v[184:187]
    buffer_load_dwordx4 a[188:191], v17, s[16:19], s29 offen offset:2304
    v_mfma_f32_16x16x32_bf16 v[188:191], a[220:223], a[92:95], v[188:191]
    s_waitcnt lgkmcnt(6)
    v_mfma_f32_16x16x32_bf16 v[64:67], a[192:195], a[96:99], v[64:67]
    ds_read_b64_tr_b16 a[208:209], v204 offset:49152
    v_mfma_f32_16x16x32_bf16 v[68:71], a[192:195], a[100:103], v[68:71]
    ds_read_b64_tr_b16 a[210:211], v204 offset:50176
    s_add_u32 s28, s28, 131072
    s_add_u32 m0, s30, 98304
    v_mfma_f32_16x16x32_bf16 v[72:75], a[192:195], a[104:107], v[72:75]
    buffer_load_dwordx4 v4, s[12:15], s28 offen offset:0 lds
    v_mfma_f32_16x16x32_bf16 v[76:79], a[192:195], a[108:111], v[76:79]
    s_waitcnt lgkmcnt(6)
    v_mfma_f32_16x16x32_bf16 v[80:83], a[196:199], a[96:99], v[80:83]
    ds_read_b64_tr_b16 a[212:213], v205 offset:49152
    v_mfma_f32_16x16x32_bf16 v[84:87], a[196:199], a[100:103], v[84:87]
    ds_read_b64_tr_b16 a[214:215], v205 offset:50176
    s_mov_b32 s29, 24576
    v_mfma_f32_16x16x32_bf16 v[88:91], a[196:199], a[104:107], v[88:91]
    buffer_load_dwordx4 a[0:3], v16, s[16:19], s29 offen offset:0
    v_mfma_f32_16x16x32_bf16 v[92:95], a[196:199], a[108:111], v[92:95]
    s_waitcnt lgkmcnt(6)
    v_mfma_f32_16x16x32_bf16 v[96:99], a[200:203], a[96:99], v[96:99]
    ds_read_b64_tr_b16 a[216:217], v206 offset:49152
    v_mfma_f32_16x16x32_bf16 v[100:103], a[200:203], a[100:103], v[100:103]
    ds_read_b64_tr_b16 a[218:219], v206 offset:50176
    v_mfma_f32_16x16x32_bf16 v[104:107], a[200:203], a[104:107], v[104:107]
    buffer_load_dwordx4 a[4:7], v16, s[16:19], s29 offen offset:256
    v_mfma_f32_16x16x32_bf16 v[108:111], a[200:203], a[108:111], v[108:111]
    s_waitcnt lgkmcnt(6)
    v_mfma_f32_16x16x32_bf16 v[112:115], a[204:207], a[96:99], v[112:115]
    ds_read_b64_tr_b16 a[220:221], v207 offset:49152
    v_mfma_f32_16x16x32_bf16 v[116:119], a[204:207], a[100:103], v[116:119]
    ds_read_b64_tr_b16 a[222:223], v207 offset:50176
    v_mfma_f32_16x16x32_bf16 v[120:123], a[204:207], a[104:107], v[120:123]
    buffer_load_dwordx4 v5, s[12:15], s28 offen offset:1024 lds
    v_mfma_f32_16x16x32_bf16 v[124:127], a[204:207], a[108:111], v[124:127]
    s_waitcnt lgkmcnt(6)
    v_mfma_f32_16x16x32_bf16 v[128:131], a[208:211], a[96:99], v[128:131]
    ds_read_b64_tr_b16 a[192:193], v200 offset:57344
    v_mfma_f32_16x16x32_bf16 v[132:135], a[208:211], a[100:103], v[132:135]
    ds_read_b64_tr_b16 a[194:195], v200 offset:58368
    v_mfma_f32_16x16x32_bf16 v[136:139], a[208:211], a[104:107], v[136:139]
    buffer_load_dwordx4 a[8:11], v17, s[16:19], s29 offen offset:0
    v_mfma_f32_16x16x32_bf16 v[140:143], a[208:211], a[108:111], v[140:143]
    s_waitcnt lgkmcnt(6)
    v_mfma_f32_16x16x32_bf16 v[144:147], a[212:215], a[96:99], v[144:147]
    ds_read_b64_tr_b16 a[196:197], v201 offset:57344
    v_mfma_f32_16x16x32_bf16 v[148:151], a[212:215], a[100:103], v[148:151]
    ds_read_b64_tr_b16 a[198:199], v201 offset:58368
    v_mfma_f32_16x16x32_bf16 v[152:155], a[212:215], a[104:107], v[152:155]
    buffer_load_dwordx4 a[12:15], v17, s[16:19], s29 offen offset:256
    v_mfma_f32_16x16x32_bf16 v[156:159], a[212:215], a[108:111], v[156:159]
    s_waitcnt lgkmcnt(6)
    v_mfma_f32_16x16x32_bf16 v[160:163], a[216:219], a[96:99], v[160:163]
    ds_read_b64_tr_b16 a[200:201], v202 offset:57344
    v_mfma_f32_16x16x32_bf16 v[164:167], a[216:219], a[100:103], v[164:167]
    ds_read_b64_tr_b16 a[202:203], v202 offset:58368
    v_mfma_f32_16x16x32_bf16 v[168:171], a[216:219], a[104:107], v[168:171]
    buffer_load_dwordx4 v6, s[12:15], s28 offen offset:2048 lds
    v_mfma_f32_16x16x32_bf16 v[172:175], a[216:219], a[108:111], v[172:175]
    s_waitcnt lgkmcnt(6)
    v_mfma_f32_16x16x32_bf16 v[176:179], a[220:223], a[96:99], v[176:179]
    ds_read_b64_tr_b16 a[204:205], v203 offset:57344
    v_mfma_f32_16x16x32_bf16 v[180:183], a[220:223], a[100:103], v[180:183]
    ds_read_b64_tr_b16 a[206:207], v203 offset:58368
    v_mfma_f32_16x16x32_bf16 v[184:187], a[220:223], a[104:107], v[184:187]
    buffer_load_dwordx4 a[16:19], v16, s[16:19], s29 offen offset:2048
    v_mfma_f32_16x16x32_bf16 v[188:191], a[220:223], a[108:111], v[188:191]
    s_waitcnt lgkmcnt(6)
    v_mfma_f32_16x16x32_bf16 v[64:67], a[192:195], a[112:115], v[64:67]
    ds_read_b64_tr_b16 a[208:209], v204 offset:57344
    v_mfma_f32_16x16x32_bf16 v[68:71], a[192:195], a[116:119], v[68:71]
    ds_read_b64_tr_b16 a[210:211], v204 offset:58368
    v_mfma_f32_16x16x32_bf16 v[72:75], a[192:195], a[120:123], v[72:75]
    buffer_load_dwordx4 a[20:23], v16, s[16:19], s29 offen offset:2304
    v_mfma_f32_16x16x32_bf16 v[76:79], a[192:195], a[124:127], v[76:79]
    s_waitcnt lgkmcnt(6)
    v_mfma_f32_16x16x32_bf16 v[80:83], a[196:199], a[112:115], v[80:83]
    ds_read_b64_tr_b16 a[212:213], v205 offset:57344
    v_mfma_f32_16x16x32_bf16 v[84:87], a[196:199], a[116:119], v[84:87]
    ds_read_b64_tr_b16 a[214:215], v205 offset:58368
    v_mfma_f32_16x16x32_bf16 v[88:91], a[196:199], a[120:123], v[88:91]
    buffer_load_dwordx4 v7, s[12:15], s28 offen offset:3072 lds
    v_mfma_f32_16x16x32_bf16 v[92:95], a[196:199], a[124:127], v[92:95]
    s_waitcnt lgkmcnt(6)
    v_mfma_f32_16x16x32_bf16 v[96:99], a[200:203], a[112:115], v[96:99]
    ds_read_b64_tr_b16 a[216:217], v206 offset:57344
    v_mfma_f32_16x16x32_bf16 v[100:103], a[200:203], a[116:119], v[100:103]
    ds_read_b64_tr_b16 a[218:219], v206 offset:58368
    v_mfma_f32_16x16x32_bf16 v[104:107], a[200:203], a[120:123], v[104:107]
    buffer_load_dwordx4 a[24:27], v17, s[16:19], s29 offen offset:2048
    v_mfma_f32_16x16x32_bf16 v[108:111], a[200:203], a[124:127], v[108:111]
    s_waitcnt lgkmcnt(6)
    v_mfma_f32_16x16x32_bf16 v[112:115], a[204:207], a[112:115], v[112:115]
    ds_read_b64_tr_b16 a[220:221], v207 offset:57344
    v_mfma_f32_16x16x32_bf16 v[116:119], a[204:207], a[116:119], v[116:119]
    ds_read_b64_tr_b16 a[222:223], v207 offset:58368
    v_mfma_f32_16x16x32_bf16 v[120:123], a[204:207], a[120:123], v[120:123]
    buffer_load_dwordx4 a[28:31], v17, s[16:19], s29 offen offset:2304
    v_mfma_f32_16x16x32_bf16 v[124:127], a[204:207], a[124:127], v[124:127]
    s_waitcnt vmcnt(24) lgkmcnt(0)
    s_barrier
    v_mfma_f32_16x16x32_bf16 v[128:131], a[208:211], a[112:115], v[128:131]
    ds_read_b64_tr_b16 a[192:193], v208 offset:0
    v_mfma_f32_16x16x32_bf16 v[132:135], a[208:211], a[116:119], v[132:135]
    ds_read_b64_tr_b16 a[194:195], v208 offset:1024
    s_add_u32 s28, s28, 131072
    s_add_u32 m0, s30, 0
    v_mfma_f32_16x16x32_bf16 v[136:139], a[208:211], a[120:123], v[136:139]
    buffer_load_dwordx4 v4, s[12:15], s28 offen offset:0 lds
    v_mfma_f32_16x16x32_bf16 v[140:143], a[208:211], a[124:127], v[140:143]
    s_waitcnt lgkmcnt(6)
    v_mfma_f32_16x16x32_bf16 v[144:147], a[212:215], a[112:115], v[144:147]
    ds_read_b64_tr_b16 a[196:197], v209 offset:0
    v_mfma_f32_16x16x32_bf16 v[148:151], a[212:215], a[116:119], v[148:151]
    ds_read_b64_tr_b16 a[198:199], v209 offset:1024
    s_mov_b32 s29, 28672
    v_mfma_f32_16x16x32_bf16 v[152:155], a[212:215], a[120:123], v[152:155]
    buffer_load_dwordx4 a[32:35], v16, s[16:19], s29 offen offset:0
    v_mfma_f32_16x16x32_bf16 v[156:159], a[212:215], a[124:127], v[156:159]
    s_waitcnt lgkmcnt(6)
    v_mfma_f32_16x16x32_bf16 v[160:163], a[216:219], a[112:115], v[160:163]
    ds_read_b64_tr_b16 a[200:201], v210 offset:0
    v_mfma_f32_16x16x32_bf16 v[164:167], a[216:219], a[116:119], v[164:167]
    ds_read_b64_tr_b16 a[202:203], v210 offset:1024
    v_mfma_f32_16x16x32_bf16 v[168:171], a[216:219], a[120:123], v[168:171]
    buffer_load_dwordx4 a[36:39], v16, s[16:19], s29 offen offset:256
    v_mfma_f32_16x16x32_bf16 v[172:175], a[216:219], a[124:127], v[172:175]
    s_waitcnt lgkmcnt(6)
    v_mfma_f32_16x16x32_bf16 v[176:179], a[220:223], a[112:115], v[176:179]
    ds_read_b64_tr_b16 a[204:205], v211 offset:0
    v_mfma_f32_16x16x32_bf16 v[180:183], a[220:223], a[116:119], v[180:183]
    ds_read_b64_tr_b16 a[206:207], v211 offset:1024
    v_mfma_f32_16x16x32_bf16 v[184:187], a[220:223], a[120:123], v[184:187]
    buffer_load_dwordx4 v5, s[12:15], s28 offen offset:1024 lds
    v_mfma_f32_16x16x32_bf16 v[188:191], a[220:223], a[124:127], v[188:191]
    s_waitcnt lgkmcnt(6)
    v_mfma_f32_16x16x32_bf16 v[64:67], a[192:195], a[128:131], v[64:67]
    ds_read_b64_tr_b16 a[208:209], v212 offset:0
    v_mfma_f32_16x16x32_bf16 v[68:71], a[192:195], a[132:135], v[68:71]
    ds_read_b64_tr_b16 a[210:211], v212 offset:1024
    v_mfma_f32_16x16x32_bf16 v[72:75], a[192:195], a[136:139], v[72:75]
    buffer_load_dwordx4 a[40:43], v17, s[16:19], s29 offen offset:0
    v_mfma_f32_16x16x32_bf16 v[76:79], a[192:195], a[140:143], v[76:79]
    s_waitcnt lgkmcnt(6)
    v_mfma_f32_16x16x32_bf16 v[80:83], a[196:199], a[128:131], v[80:83]
    ds_read_b64_tr_b16 a[212:213], v213 offset:0
    v_mfma_f32_16x16x32_bf16 v[84:87], a[196:199], a[132:135], v[84:87]
    ds_read_b64_tr_b16 a[214:215], v213 offset:1024
    v_mfma_f32_16x16x32_bf16 v[88:91], a[196:199], a[136:139], v[88:91]
    buffer_load_dwordx4 a[44:47], v17, s[16:19], s29 offen offset:256
    v_mfma_f32_16x16x32_bf16 v[92:95], a[196:199], a[140:143], v[92:95]
    s_waitcnt lgkmcnt(6)
    v_mfma_f32_16x16x32_bf16 v[96:99], a[200:203], a[128:131], v[96:99]
    ds_read_b64_tr_b16 a[216:217], v214 offset:0
    v_mfma_f32_16x16x32_bf16 v[100:103], a[200:203], a[132:135], v[100:103]
    ds_read_b64_tr_b16 a[218:219], v214 offset:1024
    v_mfma_f32_16x16x32_bf16 v[104:107], a[200:203], a[136:139], v[104:107]
    buffer_load_dwordx4 v6, s[12:15], s28 offen offset:2048 lds
    v_mfma_f32_16x16x32_bf16 v[108:111], a[200:203], a[140:143], v[108:111]
    s_waitcnt lgkmcnt(6)
    v_mfma_f32_16x16x32_bf16 v[112:115], a[204:207], a[128:131], v[112:115]
    ds_read_b64_tr_b16 a[220:221], v215 offset:0
    v_mfma_f32_16x16x32_bf16 v[116:119], a[204:207], a[132:135], v[116:119]
    ds_read_b64_tr_b16 a[222:223], v215 offset:1024
    v_mfma_f32_16x16x32_bf16 v[120:123], a[204:207], a[136:139], v[120:123]
    buffer_load_dwordx4 a[48:51], v16, s[16:19], s29 offen offset:2048
    v_mfma_f32_16x16x32_bf16 v[124:127], a[204:207], a[140:143], v[124:127]
    s_waitcnt lgkmcnt(6)
    v_mfma_f32_16x16x32_bf16 v[128:131], a[208:211], a[128:131], v[128:131]
    ds_read_b64_tr_b16 a[192:193], v208 offset:8192
    v_mfma_f32_16x16x32_bf16 v[132:135], a[208:211], a[132:135], v[132:135]
    ds_read_b64_tr_b16 a[194:195], v208 offset:9216
    v_mfma_f32_16x16x32_bf16 v[136:139], a[208:211], a[136:139], v[136:139]
    buffer_load_dwordx4 a[52:55], v16, s[16:19], s29 offen offset:2304
    v_mfma_f32_16x16x32_bf16 v[140:143], a[208:211], a[140:143], v[140:143]
    s_waitcnt lgkmcnt(6)
    v_mfma_f32_16x16x32_bf16 v[144:147], a[212:215], a[128:131], v[144:147]
    ds_read_b64_tr_b16 a[196:197], v209 offset:8192
    v_mfma_f32_16x16x32_bf16 v[148:151], a[212:215], a[132:135], v[148:151]
    ds_read_b64_tr_b16 a[198:199], v209 offset:9216
    v_mfma_f32_16x16x32_bf16 v[152:155], a[212:215], a[136:139], v[152:155]
    buffer_load_dwordx4 v7, s[12:15], s28 offen offset:3072 lds
    v_mfma_f32_16x16x32_bf16 v[156:159], a[212:215], a[140:143], v[156:159]
    s_waitcnt lgkmcnt(6)
    v_mfma_f32_16x16x32_bf16 v[160:163], a[216:219], a[128:131], v[160:163]
    ds_read_b64_tr_b16 a[200:201], v210 offset:8192
    v_mfma_f32_16x16x32_bf16 v[164:167], a[216:219], a[132:135], v[164:167]
    ds_read_b64_tr_b16 a[202:203], v210 offset:9216
    v_mfma_f32_16x16x32_bf16 v[168:171], a[216:219], a[136:139], v[168:171]
    buffer_load_dwordx4 a[56:59], v17, s[16:19], s29 offen offset:2048
    v_mfma_f32_16x16x32_bf16 v[172:175], a[216:219], a[140:143], v[172:175]
    s_waitcnt lgkmcnt(6)
    v_mfma_f32_16x16x32_bf16 v[176:179], a[220:223], a[128:131], v[176:179]
    ds_read_b64_tr_b16 a[204:205], v211 offset:8192
    v_mfma_f32_16x16x32_bf16 v[180:183], a[220:223], a[132:135], v[180:183]
    ds_read_b64_tr_b16 a[206:207], v211 offset:9216
    v_mfma_f32_16x16x32_bf16 v[184:187], a[220:223], a[136:139], v[184:187]
    buffer_load_dwordx4 a[60:63], v17, s[16:19], s29 offen offset:2304
    v_mfma_f32_16x16x32_bf16 v[188:191], a[220:223], a[140:143], v[188:191]
    s_waitcnt lgkmcnt(6)
    v_mfma_f32_16x16x32_bf16 v[64:67], a[192:195], a[144:147], v[64:67]
    ds_read_b64_tr_b16 a[208:209], v212 offset:8192
    v_mfma_f32_16x16x32_bf16 v[68:71], a[192:195], a[148:151], v[68:71]
    ds_read_b64_tr_b16 a[210:211], v212 offset:9216
    s_add_u32 s28, s28, 131072
    s_add_u32 m0, s30, 16384
    v_mfma_f32_16x16x32_bf16 v[72:75], a[192:195], a[152:155], v[72:75]
    buffer_load_dwordx4 v4, s[12:15], s28 offen offset:0 lds
    v_mfma_f32_16x16x32_bf16 v[76:79], a[192:195], a[156:159], v[76:79]
    s_waitcnt lgkmcnt(6)
    v_mfma_f32_16x16x32_bf16 v[80:83], a[196:199], a[144:147], v[80:83]
    ds_read_b64_tr_b16 a[212:213], v213 offset:8192
    v_mfma_f32_16x16x32_bf16 v[84:87], a[196:199], a[148:151], v[84:87]
    ds_read_b64_tr_b16 a[214:215], v213 offset:9216
    s_mov_b32 s29, 32768
    v_mfma_f32_16x16x32_bf16 v[88:91], a[196:199], a[152:155], v[88:91]
    buffer_load_dwordx4 a[64:67], v16, s[16:19], s29 offen offset:0
    v_mfma_f32_16x16x32_bf16 v[92:95], a[196:199], a[156:159], v[92:95]
    s_waitcnt lgkmcnt(6)
    v_mfma_f32_16x16x32_bf16 v[96:99], a[200:203], a[144:147], v[96:99]
    ds_read_b64_tr_b16 a[216:217], v214 offset:8192
    v_mfma_f32_16x16x32_bf16 v[100:103], a[200:203], a[148:151], v[100:103]
    ds_read_b64_tr_b16 a[218:219], v214 offset:9216
    v_mfma_f32_16x16x32_bf16 v[104:107], a[200:203], a[152:155], v[104:107]
    buffer_load_dwordx4 a[68:71], v16, s[16:19], s29 offen offset:256
    v_mfma_f32_16x16x32_bf16 v[108:111], a[200:203], a[156:159], v[108:111]
    s_waitcnt lgkmcnt(6)
    v_mfma_f32_16x16x32_bf16 v[112:115], a[204:207], a[144:147], v[112:115]
    ds_read_b64_tr_b16 a[220:221], v215 offset:8192
    v_mfma_f32_16x16x32_bf16 v[116:119], a[204:207], a[148:151], v[116:119]
    ds_read_b64_tr_b16 a[222:223], v215 offset:9216
    v_mfma_f32_16x16x32_bf16 v[120:123], a[204:207], a[152:155], v[120:123]
    buffer_load_dwordx4 v5, s[12:15], s28 offen offset:1024 lds
    v_mfma_f32_16x16x32_bf16 v[124:127], a[204:207], a[156:159], v[124:127]
    s_waitcnt vmcnt(28) lgkmcnt(0)
    s_barrier
    v_mfma_f32_16x16x32_bf16 v[128:131], a[208:211], a[144:147], v[128:131]
    ds_read_b64_tr_b16 a[192:193], v208 offset:16384
    v_mfma_f32_16x16x32_bf16 v[132:135], a[208:211], a[148:151], v[132:135]
    ds_read_b64_tr_b16 a[194:195], v208 offset:17408
    v_mfma_f32_16x16x32_bf16 v[136:139], a[208:211], a[152:155], v[136:139]
    buffer_load_dwordx4 a[72:75], v17, s[16:19], s29 offen offset:0
    v_mfma_f32_16x16x32_bf16 v[140:143], a[208:211], a[156:159], v[140:143]
    s_waitcnt lgkmcnt(6)
    v_mfma_f32_16x16x32_bf16 v[144:147], a[212:215], a[144:147], v[144:147]
    ds_read_b64_tr_b16 a[196:197], v209 offset:16384
    v_mfma_f32_16x16x32_bf16 v[148:151], a[212:215], a[148:151], v[148:151]
    ds_read_b64_tr_b16 a[198:199], v209 offset:17408
    v_mfma_f32_16x16x32_bf16 v[152:155], a[212:215], a[152:155], v[152:155]
    buffer_load_dwordx4 a[76:79], v17, s[16:19], s29 offen offset:256
    v_mfma_f32_16x16x32_bf16 v[156:159], a[212:215], a[156:159], v[156:159]
    s_waitcnt lgkmcnt(6)
    v_mfma_f32_16x16x32_bf16 v[160:163], a[216:219], a[144:147], v[160:163]
    ds_read_b64_tr_b16 a[200:201], v210 offset:16384
    v_mfma_f32_16x16x32_bf16 v[164:167], a[216:219], a[148:151], v[164:167]
    ds_read_b64_tr_b16 a[202:203], v210 offset:17408
    v_mfma_f32_16x16x32_bf16 v[168:171], a[216:219], a[152:155], v[168:171]
    buffer_load_dwordx4 v6, s[12:15], s28 offen offset:2048 lds
    v_mfma_f32_16x16x32_bf16 v[172:175], a[216:219], a[156:159], v[172:175]
    s_waitcnt lgkmcnt(6)
    v_mfma_f32_16x16x32_bf16 v[176:179], a[220:223], a[144:147], v[176:179]
    ds_read_b64_tr_b16 a[204:205], v211 offset:16384
    v_mfma_f32_16x16x32_bf16 v[180:183], a[220:223], a[148:151], v[180:183]
    ds_read_b64_tr_b16 a[206:207], v211 offset:17408
    v_mfma_f32_16x16x32_bf16 v[184:187], a[220:223], a[152:155], v[184:187]
    buffer_load_dwordx4 a[80:83], v16, s[16:19], s29 offen offset:2048
    v_mfma_f32_16x16x32_bf16 v[188:191], a[220:223], a[156:159], v[188:191]
    s_waitcnt lgkmcnt(6)
    v_mfma_f32_16x16x32_bf16 v[64:67], a[192:195], a[160:163], v[64:67]
    ds_read_b64_tr_b16 a[208:209], v212 offset:16384
    v_mfma_f32_16x16x32_bf16 v[68:71], a[192:195], a[164:167], v[68:71]
    ds_read_b64_tr_b16 a[210:211], v212 offset:17408
    v_mfma_f32_16x16x32_bf16 v[72:75], a[192:195], a[168:171], v[72:75]
    buffer_load_dwordx4 a[84:87], v16, s[16:19], s29 offen offset:2304
    v_mfma_f32_16x16x32_bf16 v[76:79], a[192:195], a[172:175], v[76:79]
    s_waitcnt lgkmcnt(6)
    v_mfma_f32_16x16x32_bf16 v[80:83], a[196:199], a[160:163], v[80:83]
    ds_read_b64_tr_b16 a[212:213], v213 offset:16384
    v_mfma_f32_16x16x32_bf16 v[84:87], a[196:199], a[164:167], v[84:87]
    ds_read_b64_tr_b16 a[214:215], v213 offset:17408
    v_mfma_f32_16x16x32_bf16 v[88:91], a[196:199], a[168:171], v[88:91]
    buffer_load_dwordx4 v7, s[12:15], s28 offen offset:3072 lds
    v_mfma_f32_16x16x32_bf16 v[92:95], a[196:199], a[172:175], v[92:95]
    s_waitcnt lgkmcnt(6)
    v_mfma_f32_16x16x32_bf16 v[96:99], a[200:203], a[160:163], v[96:99]
    ds_read_b64_tr_b16 a[216:217], v214 offset:16384
    v_mfma_f32_16x16x32_bf16 v[100:103], a[200:203], a[164:167], v[100:103]
    ds_read_b64_tr_b16 a[218:219], v214 offset:17408
    v_mfma_f32_16x16x32_bf16 v[104:107], a[200:203], a[168:171], v[104:107]
    buffer_load_dwordx4 a[88:91], v17, s[16:19], s29 offen offset:2048
    v_mfma_f32_16x16x32_bf16 v[108:111], a[200:203], a[172:175], v[108:111]
    s_waitcnt lgkmcnt(6)
    v_mfma_f32_16x16x32_bf16 v[112:115], a[204:207], a[160:163], v[112:115]
    ds_read_b64_tr_b16 a[220:221], v215 offset:16384
    v_mfma_f32_16x16x32_bf16 v[116:119], a[204:207], a[164:167], v[116:119]
    ds_read_b64_tr_b16 a[222:223], v215 offset:17408
    v_mfma_f32_16x16x32_bf16 v[120:123], a[204:207], a[168:171], v[120:123]
    buffer_load_dwordx4 a[92:95], v17, s[16:19], s29 offen offset:2304
    v_mfma_f32_16x16x32_bf16 v[124:127], a[204:207], a[172:175], v[124:127]
    s_waitcnt lgkmcnt(6)
    v_mfma_f32_16x16x32_bf16 v[128:131], a[208:211], a[160:163], v[128:131]
    ds_read_b64_tr_b16 a[192:193], v208 offset:24576
    v_mfma_f32_16x16x32_bf16 v[132:135], a[208:211], a[164:167], v[132:135]
    ds_read_b64_tr_b16 a[194:195], v208 offset:25600
    s_add_u32 s28, s28, 131072
    s_add_u32 m0, s30, 32768
    v_mfma_f32_16x16x32_bf16 v[136:139], a[208:211], a[168:171], v[136:139]
    buffer_load_dwordx4 v4, s[12:15], s28 offen offset:0 lds
    v_mfma_f32_16x16x32_bf16 v[140:143], a[208:211], a[172:175], v[140:143]
    s_waitcnt lgkmcnt(6)
    v_mfma_f32_16x16x32_bf16 v[144:147], a[212:215], a[160:163], v[144:147]
    ds_read_b64_tr_b16 a[196:197], v209 offset:24576
    v_mfma_f32_16x16x32_bf16 v[148:151], a[212:215], a[164:167], v[148:151]
    ds_read_b64_tr_b16 a[198:199], v209 offset:25600
    s_mov_b32 s29, 36864
    v_mfma_f32_16x16x32_bf16 v[152:155], a[212:215], a[168:171], v[152:155]
    buffer_load_dwordx4 a[96:99], v16, s[16:19], s29 offen offset:0
    v_mfma_f32_16x16x32_bf16 v[156:159], a[212:215], a[172:175], v[156:159]
    s_waitcnt lgkmcnt(6)
    v_mfma_f32_16x16x32_bf16 v[160:163], a[216:219], a[160:163], v[160:163]
    ds_read_b64_tr_b16 a[200:201], v210 offset:24576
    v_mfma_f32_16x16x32_bf16 v[164:167], a[216:219], a[164:167], v[164:167]
    ds_read_b64_tr_b16 a[202:203], v210 offset:25600
    v_mfma_f32_16x16x32_bf16 v[168:171], a[216:219], a[168:171], v[168:171]
    buffer_load_dwordx4 a[100:103], v16, s[16:19], s29 offen offset:256
    v_mfma_f32_16x16x32_bf16 v[172:175], a[216:219], a[172:175], v[172:175]
    s_waitcnt lgkmcnt(6)
    v_mfma_f32_16x16x32_bf16 v[176:179], a[220:223], a[160:163], v[176:179]
    ds_read_b64_tr_b16 a[204:205], v211 offset:24576
    v_mfma_f32_16x16x32_bf16 v[180:183], a[220:223], a[164:167], v[180:183]
    ds_read_b64_tr_b16 a[206:207], v211 offset:25600
    v_mfma_f32_16x16x32_bf16 v[184:187], a[220:223], a[168:171], v[184:187]
    buffer_load_dwordx4 v5, s[12:15], s28 offen offset:1024 lds
    v_mfma_f32_16x16x32_bf16 v[188:191], a[220:223], a[172:175], v[188:191]
    s_waitcnt lgkmcnt(6)
    v_mfma_f32_16x16x32_bf16 v[64:67], a[192:195], a[176:179], v[64:67]
    ds_read_b64_tr_b16 a[208:209], v212 offset:24576
    v_mfma_f32_16x16x32_bf16 v[68:71], a[192:195], a[180:183], v[68:71]
    ds_read_b64_tr_b16 a[210:211], v212 offset:25600
    v_mfma_f32_16x16x32_bf16 v[72:75], a[192:195], a[184:187], v[72:75]
    buffer_load_dwordx4 a[104:107], v17, s[16:19], s29 offen offset:0
    v_mfma_f32_16x16x32_bf16 v[76:79], a[192:195], a[188:191], v[76:79]
    s_waitcnt lgkmcnt(6)
    v_mfma_f32_16x16x32_bf16 v[80:83], a[196:199], a[176:179], v[80:83]
    ds_read_b64_tr_b16 a[212:213], v213 offset:24576
    v_mfma_f32_16x16x32_bf16 v[84:87], a[196:199], a[180:183], v[84:87]
    ds_read_b64_tr_b16 a[214:215], v213 offset:25600
    v_mfma_f32_16x16x32_bf16 v[88:91], a[196:199], a[184:187], v[88:91]
    buffer_load_dwordx4 a[108:111], v17, s[16:19], s29 offen offset:256
    v_mfma_f32_16x16x32_bf16 v[92:95], a[196:199], a[188:191], v[92:95]
    s_waitcnt lgkmcnt(6)
    v_mfma_f32_16x16x32_bf16 v[96:99], a[200:203], a[176:179], v[96:99]
    ds_read_b64_tr_b16 a[216:217], v214 offset:24576
    v_mfma_f32_16x16x32_bf16 v[100:103], a[200:203], a[180:183], v[100:103]
    ds_read_b64_tr_b16 a[218:219], v214 offset:25600
    v_mfma_f32_16x16x32_bf16 v[104:107], a[200:203], a[184:187], v[104:107]
    buffer_load_dwordx4 v6, s[12:15], s28 offen offset:2048 lds
    v_mfma_f32_16x16x32_bf16 v[108:111], a[200:203], a[188:191], v[108:111]
    s_waitcnt lgkmcnt(6)
    v_mfma_f32_16x16x32_bf16 v[112:115], a[204:207], a[176:179], v[112:115]
    ds_read_b64_tr_b16 a[220:221], v215 offset:24576
    v_mfma_f32_16x16x32_bf16 v[116:119], a[204:207], a[180:183], v[116:119]
    ds_read_b64_tr_b16 a[222:223], v215 offset:25600
    v_mfma_f32_16x16x32_bf16 v[120:123], a[204:207], a[184:187], v[120:123]
    buffer_load_dwordx4 a[112:115], v16, s[16:19], s29 offen offset:2048
    v_mfma_f32_16x16x32_bf16 v[124:127], a[204:207], a[188:191], v[124:127]
    s_waitcnt vmcnt(32) lgkmcnt(0)
    s_barrier
    v_mfma_f32_16x16x32_bf16 v[128:131], a[208:211], a[176:179], v[128:131]
    ds_read_b64_tr_b16 a[192:193], v208 offset:32768
    v_mfma_f32_16x16x32_bf16 v[132:135], a[208:211], a[180:183], v[132:135]
    ds_read_b64_tr_b16 a[194:195], v208 offset:33792
    v_mfma_f32_16x16x32_bf16 v[136:139], a[208:211], a[184:187], v[136:139]
    buffer_load_dwordx4 a[116:119], v16, s[16:19], s29 offen offset:2304
    v_mfma_f32_16x16x32_bf16 v[140:143], a[208:211], a[188:191], v[140:143]
    s_waitcnt lgkmcnt(6)
    v_mfma_f32_16x16x32_bf16 v[144:147], a[212:215], a[176:179], v[144:147]
    ds_read_b64_tr_b16 a[196:197], v209 offset:32768
    v_mfma_f32_16x16x32_bf16 v[148:151], a[212:215], a[180:183], v[148:151]
    ds_read_b64_tr_b16 a[198:199], v209 offset:33792
    v_mfma_f32_16x16x32_bf16 v[152:155], a[212:215], a[184:187], v[152:155]
    buffer_load_dwordx4 v7, s[12:15], s28 offen offset:3072 lds
    v_mfma_f32_16x16x32_bf16 v[156:159], a[212:215], a[188:191], v[156:159]
    s_waitcnt lgkmcnt(6)
    v_mfma_f32_16x16x32_bf16 v[160:163], a[216:219], a[176:179], v[160:163]
    ds_read_b64_tr_b16 a[200:201], v210 offset:32768
    v_mfma_f32_16x16x32_bf16 v[164:167], a[216:219], a[180:183], v[164:167]
    ds_read_b64_tr_b16 a[202:203], v210 offset:33792
    v_mfma_f32_16x16x32_bf16 v[168:171], a[216:219], a[184:187], v[168:171]
    buffer_load_dwordx4 a[120:123], v17, s[16:19], s29 offen offset:2048
    v_mfma_f32_16x16x32_bf16 v[172:175], a[216:219], a[188:191], v[172:175]
    s_waitcnt lgkmcnt(6)
    v_mfma_f32_16x16x32_bf16 v[176:179], a[220:223], a[176:179], v[176:179]
    ds_read_b64_tr_b16 a[204:205], v211 offset:32768
    v_mfma_f32_16x16x32_bf16 v[180:183], a[220:223], a[180:183], v[180:183]
    ds_read_b64_tr_b16 a[206:207], v211 offset:33792
    v_mfma_f32_16x16x32_bf16 v[184:187], a[220:223], a[184:187], v[184:187]
    buffer_load_dwordx4 a[124:127], v17, s[16:19], s29 offen offset:2304
    v_mfma_f32_16x16x32_bf16 v[188:191], a[220:223], a[188:191], v[188:191]
    s_waitcnt lgkmcnt(6)
    v_mfma_f32_16x16x32_bf16 v[64:67], a[192:195], a[0:3], v[64:67]
    ds_read_b64_tr_b16 a[208:209], v212 offset:32768
    v_mfma_f32_16x16x32_bf16 v[68:71], a[192:195], a[4:7], v[68:71]
    ds_read_b64_tr_b16 a[210:211], v212 offset:33792
    s_add_u32 s28, s28, 131072
    s_add_u32 m0, s30, 49152
    v_mfma_f32_16x16x32_bf16 v[72:75], a[192:195], a[8:11], v[72:75]
    buffer_load_dwordx4 v4, s[12:15], s28 offen offset:0 lds
    v_mfma_f32_16x16x32_bf16 v[76:79], a[192:195], a[12:15], v[76:79]
    s_waitcnt lgkmcnt(6)
    v_mfma_f32_16x16x32_bf16 v[80:83], a[196:199], a[0:3], v[80:83]
    ds_read_b64_tr_b16 a[212:213], v213 offset:32768
    v_mfma_f32_16x16x32_bf16 v[84:87], a[196:199], a[4:7], v[84:87]
    ds_read_b64_tr_b16 a[214:215], v213 offset:33792
    s_mov_b32 s29, 40960
    v_mfma_f32_16x16x32_bf16 v[88:91], a[196:199], a[8:11], v[88:91]
    buffer_load_dwordx4 a[128:131], v16, s[16:19], s29 offen offset:0
    v_mfma_f32_16x16x32_bf16 v[92:95], a[196:199], a[12:15], v[92:95]
    s_waitcnt lgkmcnt(6)
    v_mfma_f32_16x16x32_bf16 v[96:99], a[200:203], a[0:3], v[96:99]
    ds_read_b64_tr_b16 a[216:217], v214 offset:32768
    v_mfma_f32_16x16x32_bf16 v[100:103], a[200:203], a[4:7], v[100:103]
    ds_read_b64_tr_b16 a[218:219], v214 offset:33792
    v_mfma_f32_16x16x32_bf16 v[104:107], a[200:203], a[8:11], v[104:107]
    buffer_load_dwordx4 a[132:135], v16, s[16:19], s29 offen offset:256
    v_mfma_f32_16x16x32_bf16 v[108:111], a[200:203], a[12:15], v[108:111]
    s_waitcnt lgkmcnt(6)
    v_mfma_f32_16x16x32_bf16 v[112:115], a[204:207], a[0:3], v[112:115]
    ds_read_b64_tr_b16 a[220:221], v215 offset:32768
    v_mfma_f32_16x16x32_bf16 v[116:119], a[204:207], a[4:7], v[116:119]
    ds_read_b64_tr_b16 a[222:223], v215 offset:33792
    v_mfma_f32_16x16x32_bf16 v[120:123], a[204:207], a[8:11], v[120:123]
    buffer_load_dwordx4 v5, s[12:15], s28 offen offset:1024 lds
    v_mfma_f32_16x16x32_bf16 v[124:127], a[204:207], a[12:15], v[124:127]
    s_waitcnt lgkmcnt(6)
    v_mfma_f32_16x16x32_bf16 v[128:131], a[208:211], a[0:3], v[128:131]
    ds_read_b64_tr_b16 a[192:193], v208 offset:40960
    v_mfma_f32_16x16x32_bf16 v[132:135], a[208:211], a[4:7], v[132:135]
    ds_read_b64_tr_b16 a[194:195], v208 offset:41984
    v_mfma_f32_16x16x32_bf16 v[136:139], a[208:211], a[8:11], v[136:139]
    buffer_load_dwordx4 a[136:139], v17, s[16:19], s29 offen offset:0
    v_mfma_f32_16x16x32_bf16 v[140:143], a[208:211], a[12:15], v[140:143]
    s_waitcnt lgkmcnt(6)
    v_mfma_f32_16x16x32_bf16 v[144:147], a[212:215], a[0:3], v[144:147]
    ds_read_b64_tr_b16 a[196:197], v209 offset:40960
    v_mfma_f32_16x16x32_bf16 v[148:151], a[212:215], a[4:7], v[148:151]
    ds_read_b64_tr_b16 a[198:199], v209 offset:41984
    v_mfma_f32_16x16x32_bf16 v[152:155], a[212:215], a[8:11], v[152:155]
    buffer_load_dwordx4 a[140:143], v17, s[16:19], s29 offen offset:256
    v_mfma_f32_16x16x32_bf16 v[156:159], a[212:215], a[12:15], v[156:159]
    s_waitcnt lgkmcnt(6)
    v_mfma_f32_16x16x32_bf16 v[160:163], a[216:219], a[0:3], v[160:163]
    ds_read_b64_tr_b16 a[200:201], v210 offset:40960
    v_mfma_f32_16x16x32_bf16 v[164:167], a[216:219], a[4:7], v[164:167]
    ds_read_b64_tr_b16 a[202:203], v210 offset:41984
    v_mfma_f32_16x16x32_bf16 v[168:171], a[216:219], a[8:11], v[168:171]
    buffer_load_dwordx4 v6, s[12:15], s28 offen offset:2048 lds
    v_mfma_f32_16x16x32_bf16 v[172:175], a[216:219], a[12:15], v[172:175]
    s_waitcnt lgkmcnt(6)
    v_mfma_f32_16x16x32_bf16 v[176:179], a[220:223], a[0:3], v[176:179]
    ds_read_b64_tr_b16 a[204:205], v211 offset:40960
    v_mfma_f32_16x16x32_bf16 v[180:183], a[220:223], a[4:7], v[180:183]
    ds_read_b64_tr_b16 a[206:207], v211 offset:41984
    v_mfma_f32_16x16x32_bf16 v[184:187], a[220:223], a[8:11], v[184:187]
    buffer_load_dwordx4 a[144:147], v16, s[16:19], s29 offen offset:2048
    v_mfma_f32_16x16x32_bf16 v[188:191], a[220:223], a[12:15], v[188:191]
    s_waitcnt lgkmcnt(6)
    v_mfma_f32_16x16x32_bf16 v[64:67], a[192:195], a[16:19], v[64:67]
    ds_read_b64_tr_b16 a[208:209], v212 offset:40960
    v_mfma_f32_16x16x32_bf16 v[68:71], a[192:195], a[20:23], v[68:71]
    ds_read_b64_tr_b16 a[210:211], v212 offset:41984
    v_mfma_f32_16x16x32_bf16 v[72:75], a[192:195], a[24:27], v[72:75]
    buffer_load_dwordx4 a[148:151], v16, s[16:19], s29 offen offset:2304
    v_mfma_f32_16x16x32_bf16 v[76:79], a[192:195], a[28:31], v[76:79]
    s_waitcnt lgkmcnt(6)
    v_mfma_f32_16x16x32_bf16 v[80:83], a[196:199], a[16:19], v[80:83]
    ds_read_b64_tr_b16 a[212:213], v213 offset:40960
    v_mfma_f32_16x16x32_bf16 v[84:87], a[196:199], a[20:23], v[84:87]
    ds_read_b64_tr_b16 a[214:215], v213 offset:41984
    v_mfma_f32_16x16x32_bf16 v[88:91], a[196:199], a[24:27], v[88:91]
    buffer_load_dwordx4 v7, s[12:15], s28 offen offset:3072 lds
    v_mfma_f32_16x16x32_bf16 v[92:95], a[196:199], a[28:31], v[92:95]
    s_waitcnt lgkmcnt(6)
    v_mfma_f32_16x16x32_bf16 v[96:99], a[200:203], a[16:19], v[96:99]
    ds_read_b64_tr_b16 a[216:217], v214 offset:40960
    v_mfma_f32_16x16x32_bf16 v[100:103], a[200:203], a[20:23], v[100:103]
    ds_read_b64_tr_b16 a[218:219], v214 offset:41984
    v_mfma_f32_16x16x32_bf16 v[104:107], a[200:203], a[24:27], v[104:107]
    buffer_load_dwordx4 a[152:155], v17, s[16:19], s29 offen offset:2048
    v_mfma_f32_16x16x32_bf16 v[108:111], a[200:203], a[28:31], v[108:111]
    s_waitcnt lgkmcnt(6)
    v_mfma_f32_16x16x32_bf16 v[112:115], a[204:207], a[16:19], v[112:115]
    ds_read_b64_tr_b16 a[220:221], v215 offset:40960
    v_mfma_f32_16x16x32_bf16 v[116:119], a[204:207], a[20:23], v[116:119]
    ds_read_b64_tr_b16 a[222:223], v215 offset:41984
    v_mfma_f32_16x16x32_bf16 v[120:123], a[204:207], a[24:27], v[120:123]
    buffer_load_dwordx4 a[156:159], v17, s[16:19], s29 offen offset:2304
    v_mfma_f32_16x16x32_bf16 v[124:127], a[204:207], a[28:31], v[124:127]
    s_waitcnt vmcnt(36) lgkmcnt(0)
    s_barrier
    v_mfma_f32_16x16x32_bf16 v[128:131], a[208:211], a[16:19], v[128:131]
    ds_read_b64_tr_b16 a[192:193], v200 offset:0
    v_mfma_f32_16x16x32_bf16 v[132:135], a[208:211], a[20:23], v[132:135]
    ds_read_b64_tr_b16 a[194:195], v200 offset:1024
    s_add_u32 s28, s28, 131072
    s_add_u32 m0, s30, 65536
    v_mfma_f32_16x16x32_bf16 v[136:139], a[208:211], a[24:27], v[136:139]
    buffer_load_dwordx4 v4, s[12:15], s28 offen offset:0 lds
    v_mfma_f32_16x16x32_bf16 v[140:143], a[208:211], a[28:31], v[140:143]
    s_waitcnt lgkmcnt(6)
    v_mfma_f32_16x16x32_bf16 v[144:147], a[212:215], a[16:19], v[144:147]
    ds_read_b64_tr_b16 a[196:197], v201 offset:0
    v_mfma_f32_16x16x32_bf16 v[148:151], a[212:215], a[20:23], v[148:151]
    ds_read_b64_tr_b16 a[198:199], v201 offset:1024
    s_mov_b32 s29, 45056
    v_mfma_f32_16x16x32_bf16 v[152:155], a[212:215], a[24:27], v[152:155]
    buffer_load_dwordx4 a[160:163], v16, s[16:19], s29 offen offset:0
    v_mfma_f32_16x16x32_bf16 v[156:159], a[212:215], a[28:31], v[156:159]
    s_waitcnt lgkmcnt(6)
    v_mfma_f32_16x16x32_bf16 v[160:163], a[216:219], a[16:19], v[160:163]
    ds_read_b64_tr_b16 a[200:201], v202 offset:0
    v_mfma_f32_16x16x32_bf16 v[164:167], a[216:219], a[20:23], v[164:167]
    ds_read_b64_tr_b16 a[202:203], v202 offset:1024
    v_mfma_f32_16x16x32_bf16 v[168:171], a[216:219], a[24:27], v[168:171]
    buffer_load_dwordx4 a[164:167], v16, s[16:19], s29 offen offset:256
    v_mfma_f32_16x16x32_bf16 v[172:175], a[216:219], a[28:31], v[172:175]
    s_waitcnt lgkmcnt(6)
    v_mfma_f32_16x16x32_bf16 v[176:179], a[220:223], a[16:19], v[176:179]
    ds_read_b64_tr_b16 a[204:205], v203 offset:0
    v_mfma_f32_16x16x32_bf16 v[180:183], a[220:223], a[20:23], v[180:183]
    ds_read_b64_tr_b16 a[206:207], v203 offset:1024
    v_mfma_f32_16x16x32_bf16 v[184:187], a[220:223], a[24:27], v[184:187]
    buffer_load_dwordx4 v5, s[12:15], s28 offen offset:1024 lds
    v_mfma_f32_16x16x32_bf16 v[188:191], a[220:223], a[28:31], v[188:191]
    s_waitcnt lgkmcnt(6)
    v_mfma_f32_16x16x32_bf16 v[64:67], a[192:195], a[32:35], v[64:67]
    ds_read_b64_tr_b16 a[208:209], v204 offset:0
    v_mfma_f32_16x16x32_bf16 v[68:71], a[192:195], a[36:39], v[68:71]
    ds_read_b64_tr_b16 a[210:211], v204 offset:1024
    v_mfma_f32_16x16x32_bf16 v[72:75], a[192:195], a[40:43], v[72:75]
    buffer_load_dwordx4 a[168:171], v17, s[16:19], s29 offen offset:0
    v_mfma_f32_16x16x32_bf16 v[76:79], a[192:195], a[44:47], v[76:79]
    s_waitcnt lgkmcnt(6)
    v_mfma_f32_16x16x32_bf16 v[80:83], a[196:199], a[32:35], v[80:83]
    ds_read_b64_tr_b16 a[212:213], v205 offset:0
    v_mfma_f32_16x16x32_bf16 v[84:87], a[196:199], a[36:39], v[84:87]
    ds_read_b64_tr_b16 a[214:215], v205 offset:1024
    v_mfma_f32_16x16x32_bf16 v[88:91], a[196:199], a[40:43], v[88:91]
    buffer_load_dwordx4 a[172:175], v17, s[16:19], s29 offen offset:256
    v_mfma_f32_16x16x32_bf16 v[92:95], a[196:199], a[44:47], v[92:95]
    s_waitcnt lgkmcnt(6)
    v_mfma_f32_16x16x32_bf16 v[96:99], a[200:203], a[32:35], v[96:99]
    ds_read_b64_tr_b16 a[216:217], v206 offset:0
    v_mfma_f32_16x16x32_bf16 v[100:103], a[200:203], a[36:39], v[100:103]
    ds_read_b64_tr_b16 a[218:219], v206 offset:1024
    v_mfma_f32_16x16x32_bf16 v[104:107], a[200:203], a[40:43], v[104:107]
    buffer_load_dwordx4 v6, s[12:15], s28 offen offset:2048 lds
    v_mfma_f32_16x16x32_bf16 v[108:111], a[200:203], a[44:47], v[108:111]
    s_waitcnt lgkmcnt(6)
    v_mfma_f32_16x16x32_bf16 v[112:115], a[204:207], a[32:35], v[112:115]
    ds_read_b64_tr_b16 a[220:221], v207 offset:0
    v_mfma_f32_16x16x32_bf16 v[116:119], a[204:207], a[36:39], v[116:119]
    ds_read_b64_tr_b16 a[222:223], v207 offset:1024
    v_mfma_f32_16x16x32_bf16 v[120:123], a[204:207], a[40:43], v[120:123]
    buffer_load_dwordx4 a[176:179], v16, s[16:19], s29 offen offset:2048
    v_mfma_f32_16x16x32_bf16 v[124:127], a[204:207], a[44:47], v[124:127]
    s_waitcnt lgkmcnt(6)
    v_mfma_f32_16x16x32_bf16 v[128:131], a[208:211], a[32:35], v[128:131]
    ds_read_b64_tr_b16 a[192:193], v200 offset:8192
    v_mfma_f32_16x16x32_bf16 v[132:135], a[208:211], a[36:39], v[132:135]
    ds_read_b64_tr_b16 a[194:195], v200 offset:9216
    v_mfma_f32_16x16x32_bf16 v[136:139], a[208:211], a[40:43], v[136:139]
    buffer_load_dwordx4 a[180:183], v16, s[16:19], s29 offen offset:2304
    v_mfma_f32_16x16x32_bf16 v[140:143], a[208:211], a[44:47], v[140:143]
    s_waitcnt lgkmcnt(6)
    v_mfma_f32_16x16x32_bf16 v[144:147], a[212:215], a[32:35], v[144:147]
    ds_read_b64_tr_b16 a[196:197], v201 offset:8192
    v_mfma_f32_16x16x32_bf16 v[148:151], a[212:215], a[36:39], v[148:151]
    ds_read_b64_tr_b16 a[198:199], v201 offset:9216
    v_mfma_f32_16x16x32_bf16 v[152:155], a[212:215], a[40:43], v[152:155]
    buffer_load_dwordx4 v7, s[12:15], s28 offen offset:3072 lds
    v_mfma_f32_16x16x32_bf16 v[156:159], a[212:215], a[44:47], v[156:159]
    s_waitcnt lgkmcnt(6)
    v_mfma_f32_16x16x32_bf16 v[160:163], a[216:219], a[32:35], v[160:163]
    ds_read_b64_tr_b16 a[200:201], v202 offset:8192
    v_mfma_f32_16x16x32_bf16 v[164:167], a[216:219], a[36:39], v[164:167]
    ds_read_b64_tr_b16 a[202:203], v202 offset:9216
    v_mfma_f32_16x16x32_bf16 v[168:171], a[216:219], a[40:43], v[168:171]
    buffer_load_dwordx4 a[184:187], v17, s[16:19], s29 offen offset:2048
    v_mfma_f32_16x16x32_bf16 v[172:175], a[216:219], a[44:47], v[172:175]
    s_waitcnt lgkmcnt(6)
    v_mfma_f32_16x16x32_bf16 v[176:179], a[220:223], a[32:35], v[176:179]
    ds_read_b64_tr_b16 a[204:205], v203 offset:8192
    v_mfma_f32_16x16x32_bf16 v[180:183], a[220:223], a[36:39], v[180:183]
    ds_read_b64_tr_b16 a[206:207], v203 offset:9216
    v_mfma_f32_16x16x32_bf16 v[184:187], a[220:223], a[40:43], v[184:187]
    buffer_load_dwordx4 a[188:191], v17, s[16:19], s29 offen offset:2304
    v_mfma_f32_16x16x32_bf16 v[188:191], a[220:223], a[44:47], v[188:191]
    s_waitcnt lgkmcnt(6)
    v_mfma_f32_16x16x32_bf16 v[64:67], a[192:195], a[48:51], v[64:67]
    ds_read_b64_tr_b16 a[208:209], v204 offset:8192
    v_mfma_f32_16x16x32_bf16 v[68:71], a[192:195], a[52:55], v[68:71]
    ds_read_b64_tr_b16 a[210:211], v204 offset:9216
    s_add_u32 s28, s28, 131072
    s_add_u32 m0, s30, 81920
    v_mfma_f32_16x16x32_bf16 v[72:75], a[192:195], a[56:59], v[72:75]
    buffer_load_dwordx4 v4, s[12:15], s28 offen offset:0 lds
    v_mfma_f32_16x16x32_bf16 v[76:79], a[192:195], a[60:63], v[76:79]
    s_waitcnt lgkmcnt(6)
    v_mfma_f32_16x16x32_bf16 v[80:83], a[196:199], a[48:51], v[80:83]
    ds_read_b64_tr_b16 a[212:213], v205 offset:8192
    v_mfma_f32_16x16x32_bf16 v[84:87], a[196:199], a[52:55], v[84:87]
    ds_read_b64_tr_b16 a[214:215], v205 offset:9216
    s_mov_b32 s29, 49152
    v_mfma_f32_16x16x32_bf16 v[88:91], a[196:199], a[56:59], v[88:91]
    buffer_load_dwordx4 a[0:3], v16, s[16:19], s29 offen offset:0
    v_mfma_f32_16x16x32_bf16 v[92:95], a[196:199], a[60:63], v[92:95]
    s_waitcnt lgkmcnt(6)
    v_mfma_f32_16x16x32_bf16 v[96:99], a[200:203], a[48:51], v[96:99]
    ds_read_b64_tr_b16 a[216:217], v206 offset:8192
    v_mfma_f32_16x16x32_bf16 v[100:103], a[200:203], a[52:55], v[100:103]
    ds_read_b64_tr_b16 a[218:219], v206 offset:9216
    v_mfma_f32_16x16x32_bf16 v[104:107], a[200:203], a[56:59], v[104:107]
    buffer_load_dwordx4 a[4:7], v16, s[16:19], s29 offen offset:256
    v_mfma_f32_16x16x32_bf16 v[108:111], a[200:203], a[60:63], v[108:111]
    s_waitcnt lgkmcnt(6)
    v_mfma_f32_16x16x32_bf16 v[112:115], a[204:207], a[48:51], v[112:115]
    ds_read_b64_tr_b16 a[220:221], v207 offset:8192
    v_mfma_f32_16x16x32_bf16 v[116:119], a[204:207], a[52:55], v[116:119]
    ds_read_b64_tr_b16 a[222:223], v207 offset:9216
    v_mfma_f32_16x16x32_bf16 v[120:123], a[204:207], a[56:59], v[120:123]
    buffer_load_dwordx4 v5, s[12:15], s28 offen offset:1024 lds
    v_mfma_f32_16x16x32_bf16 v[124:127], a[204:207], a[60:63], v[124:127]
    s_waitcnt vmcnt(40) lgkmcnt(0)
    s_barrier
    v_mfma_f32_16x16x32_bf16 v[128:131], a[208:211], a[48:51], v[128:131]
    ds_read_b64_tr_b16 a[192:193], v200 offset:16384
    v_mfma_f32_16x16x32_bf16 v[132:135], a[208:211], a[52:55], v[132:135]
    ds_read_b64_tr_b16 a[194:195], v200 offset:17408
    v_mfma_f32_16x16x32_bf16 v[136:139], a[208:211], a[56:59], v[136:139]
    buffer_load_dwordx4 a[8:11], v17, s[16:19], s29 offen offset:0
    v_mfma_f32_16x16x32_bf16 v[140:143], a[208:211], a[60:63], v[140:143]
    s_waitcnt lgkmcnt(6)
    v_mfma_f32_16x16x32_bf16 v[144:147], a[212:215], a[48:51], v[144:147]
    ds_read_b64_tr_b16 a[196:197], v201 offset:16384
    v_mfma_f32_16x16x32_bf16 v[148:151], a[212:215], a[52:55], v[148:151]
    ds_read_b64_tr_b16 a[198:199], v201 offset:17408
    v_mfma_f32_16x16x32_bf16 v[152:155], a[212:215], a[56:59], v[152:155]
    buffer_load_dwordx4 a[12:15], v17, s[16:19], s29 offen offset:256
    v_mfma_f32_16x16x32_bf16 v[156:159], a[212:215], a[60:63], v[156:159]
    s_waitcnt lgkmcnt(6)
    v_mfma_f32_16x16x32_bf16 v[160:163], a[216:219], a[48:51], v[160:163]
    ds_read_b64_tr_b16 a[200:201], v202 offset:16384
    v_mfma_f32_16x16x32_bf16 v[164:167], a[216:219], a[52:55], v[164:167]
    ds_read_b64_tr_b16 a[202:203], v202 offset:17408
    v_mfma_f32_16x16x32_bf16 v[168:171], a[216:219], a[56:59], v[168:171]
    buffer_load_dwordx4 v6, s[12:15], s28 offen offset:2048 lds
    v_mfma_f32_16x16x32_bf16 v[172:175], a[216:219], a[60:63], v[172:175]
    s_waitcnt lgkmcnt(6)
    v_mfma_f32_16x16x32_bf16 v[176:179], a[220:223], a[48:51], v[176:179]
    ds_read_b64_tr_b16 a[204:205], v203 offset:16384
    v_mfma_f32_16x16x32_bf16 v[180:183], a[220:223], a[52:55], v[180:183]
    ds_read_b64_tr_b16 a[206:207], v203 offset:17408
    v_mfma_f32_16x16x32_bf16 v[184:187], a[220:223], a[56:59], v[184:187]
    buffer_load_dwordx4 a[16:19], v16, s[16:19], s29 offen offset:2048
    v_mfma_f32_16x16x32_bf16 v[188:191], a[220:223], a[60:63], v[188:191]
    s_waitcnt lgkmcnt(6)
    v_mfma_f32_16x16x32_bf16 v[64:67], a[192:195], a[64:67], v[64:67]
    ds_read_b64_tr_b16 a[208:209], v204 offset:16384
    v_mfma_f32_16x16x32_bf16 v[68:71], a[192:195], a[68:71], v[68:71]
    ds_read_b64_tr_b16 a[210:211], v204 offset:17408
    v_mfma_f32_16x16x32_bf16 v[72:75], a[192:195], a[72:75], v[72:75]
    buffer_load_dwordx4 a[20:23], v16, s[16:19], s29 offen offset:2304
    v_mfma_f32_16x16x32_bf16 v[76:79], a[192:195], a[76:79], v[76:79]
    s_waitcnt lgkmcnt(6)
    v_mfma_f32_16x16x32_bf16 v[80:83], a[196:199], a[64:67], v[80:83]
    ds_read_b64_tr_b16 a[212:213], v205 offset:16384
    v_mfma_f32_16x16x32_bf16 v[84:87], a[196:199], a[68:71], v[84:87]
    ds_read_b64_tr_b16 a[214:215], v205 offset:17408
    v_mfma_f32_16x16x32_bf16 v[88:91], a[196:199], a[72:75], v[88:91]
    buffer_load_dwordx4 v7, s[12:15], s28 offen offset:3072 lds
    v_mfma_f32_16x16x32_bf16 v[92:95], a[196:199], a[76:79], v[92:95]
    s_waitcnt lgkmcnt(6)
    v_mfma_f32_16x16x32_bf16 v[96:99], a[200:203], a[64:67], v[96:99]
    ds_read_b64_tr_b16 a[216:217], v206 offset:16384
    v_mfma_f32_16x16x32_bf16 v[100:103], a[200:203], a[68:71], v[100:103]
    ds_read_b64_tr_b16 a[218:219], v206 offset:17408
    v_mfma_f32_16x16x32_bf16 v[104:107], a[200:203], a[72:75], v[104:107]
    buffer_load_dwordx4 a[24:27], v17, s[16:19], s29 offen offset:2048
    v_mfma_f32_16x16x32_bf16 v[108:111], a[200:203], a[76:79], v[108:111]
    s_waitcnt lgkmcnt(6)
    v_mfma_f32_16x16x32_bf16 v[112:115], a[204:207], a[64:67], v[112:115]
    ds_read_b64_tr_b16 a[220:221], v207 offset:16384
    v_mfma_f32_16x16x32_bf16 v[116:119], a[204:207], a[68:71], v[116:119]
    ds_read_b64_tr_b16 a[222:223], v207 offset:17408
    v_mfma_f32_16x16x32_bf16 v[120:123], a[204:207], a[72:75], v[120:123]
    buffer_load_dwordx4 a[28:31], v17, s[16:19], s29 offen offset:2304
    v_mfma_f32_16x16x32_bf16 v[124:127], a[204:207], a[76:79], v[124:127]
    s_waitcnt lgkmcnt(6)
    v_mfma_f32_16x16x32_bf16 v[128:131], a[208:211], a[64:67], v[128:131]
    ds_read_b64_tr_b16 a[192:193], v200 offset:24576
    v_mfma_f32_16x16x32_bf16 v[132:135], a[208:211], a[68:71], v[132:135]
    ds_read_b64_tr_b16 a[194:195], v200 offset:25600
    s_add_u32 s28, s28, 131072
    s_add_u32 m0, s30, 98304
    v_mfma_f32_16x16x32_bf16 v[136:139], a[208:211], a[72:75], v[136:139]
    buffer_load_dwordx4 v4, s[12:15], s28 offen offset:0 lds
    v_mfma_f32_16x16x32_bf16 v[140:143], a[208:211], a[76:79], v[140:143]
    s_waitcnt lgkmcnt(6)
    v_mfma_f32_16x16x32_bf16 v[144:147], a[212:215], a[64:67], v[144:147]
    ds_read_b64_tr_b16 a[196:197], v201 offset:24576
    v_mfma_f32_16x16x32_bf16 v[148:151], a[212:215], a[68:71], v[148:151]
    ds_read_b64_tr_b16 a[198:199], v201 offset:25600
    s_mov_b32 s29, 53248
    v_mfma_f32_16x16x32_bf16 v[152:155], a[212:215], a[72:75], v[152:155]
    buffer_load_dwordx4 a[32:35], v16, s[16:19], s29 offen offset:0
    v_mfma_f32_16x16x32_bf16 v[156:159], a[212:215], a[76:79], v[156:159]
    s_waitcnt lgkmcnt(6)
    v_mfma_f32_16x16x32_bf16 v[160:163], a[216:219], a[64:67], v[160:163]
    ds_read_b64_tr_b16 a[200:201], v202 offset:24576
    v_mfma_f32_16x16x32_bf16 v[164:167], a[216:219], a[68:71], v[164:167]
    ds_read_b64_tr_b16 a[202:203], v202 offset:25600
    v_mfma_f32_16x16x32_bf16 v[168:171], a[216:219], a[72:75], v[168:171]
    buffer_load_dwordx4 a[36:39], v16, s[16:19], s29 offen offset:256
    v_mfma_f32_16x16x32_bf16 v[172:175], a[216:219], a[76:79], v[172:175]
    s_waitcnt lgkmcnt(6)
    v_mfma_f32_16x16x32_bf16 v[176:179], a[220:223], a[64:67], v[176:179]
    ds_read_b64_tr_b16 a[204:205], v203 offset:24576
    v_mfma_f32_16x16x32_bf16 v[180:183], a[220:223], a[68:71], v[180:183]
    ds_read_b64_tr_b16 a[206:207], v203 offset:25600
    v_mfma_f32_16x16x32_bf16 v[184:187], a[220:223], a[72:75], v[184:187]
    buffer_load_dwordx4 v5, s[12:15], s28 offen offset:1024 lds
    v_mfma_f32_16x16x32_bf16 v[188:191], a[220:223], a[76:79], v[188:191]
    s_waitcnt lgkmcnt(6)
    v_mfma_f32_16x16x32_bf16 v[64:67], a[192:195], a[80:83], v[64:67]
    ds_read_b64_tr_b16 a[208:209], v204 offset:24576
    v_mfma_f32_16x16x32_bf16 v[68:71], a[192:195], a[84:87], v[68:71]
    ds_read_b64_tr_b16 a[210:211], v204 offset:25600
    v_mfma_f32_16x16x32_bf16 v[72:75], a[192:195], a[88:91], v[72:75]
    buffer_load_dwordx4 a[40:43], v17, s[16:19], s29 offen offset:0
    v_mfma_f32_16x16x32_bf16 v[76:79], a[192:195], a[92:95], v[76:79]
    s_waitcnt lgkmcnt(6)
    v_mfma_f32_16x16x32_bf16 v[80:83], a[196:199], a[80:83], v[80:83]
    ds_read_b64_tr_b16 a[212:213], v205 offset:24576
    v_mfma_f32_16x16x32_bf16 v[84:87], a[196:199], a[84:87], v[84:87]
    ds_read_b64_tr_b16 a[214:215], v205 offset:25600
    v_mfma_f32_16x16x32_bf16 v[88:91], a[196:199], a[88:91], v[88:91]
    buffer_load_dwordx4 a[44:47], v17, s[16:19], s29 offen offset:256
    v_mfma_f32_16x16x32_bf16 v[92:95], a[196:199], a[92:95], v[92:95]
    s_waitcnt lgkmcnt(6)
    v_mfma_f32_16x16x32_bf16 v[96:99], a[200:203], a[80:83], v[96:99]
    ds_read_b64_tr_b16 a[216:217], v206 offset:24576
    v_mfma_f32_16x16x32_bf16 v[100:103], a[200:203], a[84:87], v[100:103]
    ds_read_b64_tr_b16 a[218:219], v206 offset:25600
    v_mfma_f32_16x16x32_bf16 v[104:107], a[200:203], a[88:91], v[104:107]
    buffer_load_dwordx4 v6, s[12:15], s28 offen offset:2048 lds
    v_mfma_f32_16x16x32_bf16 v[108:111], a[200:203], a[92:95], v[108:111]
    s_waitcnt lgkmcnt(6)
    v_mfma_f32_16x16x32_bf16 v[112:115], a[204:207], a[80:83], v[112:115]
    ds_read_b64_tr_b16 a[220:221], v207 offset:24576
    v_mfma_f32_16x16x32_bf16 v[116:119], a[204:207], a[84:87], v[116:119]
    ds_read_b64_tr_b16 a[222:223], v207 offset:25600
    v_mfma_f32_16x16x32_bf16 v[120:123], a[204:207], a[88:91], v[120:123]
    buffer_load_dwordx4 a[48:51], v16, s[16:19], s29 offen offset:2048
    v_mfma_f32_16x16x32_bf16 v[124:127], a[204:207], a[92:95], v[124:127]
    s_waitcnt vmcnt(44) lgkmcnt(0)
    s_barrier
    v_mfma_f32_16x16x32_bf16 v[128:131], a[208:211], a[80:83], v[128:131]
    ds_read_b64_tr_b16 a[192:193], v200 offset:32768
    v_mfma_f32_16x16x32_bf16 v[132:135], a[208:211], a[84:87], v[132:135]
    ds_read_b64_tr_b16 a[194:195], v200 offset:33792
    v_mfma_f32_16x16x32_bf16 v[136:139], a[208:211], a[88:91], v[136:139]
    buffer_load_dwordx4 a[52:55], v16, s[16:19], s29 offen offset:2304
    v_mfma_f32_16x16x32_bf16 v[140:143], a[208:211], a[92:95], v[140:143]
    s_waitcnt lgkmcnt(6)
    v_mfma_f32_16x16x32_bf16 v[144:147], a[212:215], a[80:83], v[144:147]
    ds_read_b64_tr_b16 a[196:197], v201 offset:32768
    v_mfma_f32_16x16x32_bf16 v[148:151], a[212:215], a[84:87], v[148:151]
    ds_read_b64_tr_b16 a[198:199], v201 offset:33792
    v_mfma_f32_16x16x32_bf16 v[152:155], a[212:215], a[88:91], v[152:155]
    buffer_load_dwordx4 v7, s[12:15], s28 offen offset:3072 lds
    v_mfma_f32_16x16x32_bf16 v[156:159], a[212:215], a[92:95], v[156:159]
    s_waitcnt lgkmcnt(6)
    v_mfma_f32_16x16x32_bf16 v[160:163], a[216:219], a[80:83], v[160:163]
    ds_read_b64_tr_b16 a[200:201], v200 offset:40960
    v_mfma_f32_16x16x32_bf16 v[164:167], a[216:219], a[84:87], v[164:167]
    ds_read_b64_tr_b16 a[202:203], v200 offset:41984
    v_mfma_f32_16x16x32_bf16 v[168:171], a[216:219], a[88:91], v[168:171]
    buffer_load_dwordx4 a[56:59], v17, s[16:19], s29 offen offset:2048
    v_mfma_f32_16x16x32_bf16 v[172:175], a[216:219], a[92:95], v[172:175]
    s_waitcnt lgkmcnt(6)
    v_mfma_f32_16x16x32_bf16 v[176:179], a[220:223], a[80:83], v[176:179]
    ds_read_b64_tr_b16 a[204:205], v201 offset:40960
    v_mfma_f32_16x16x32_bf16 v[180:183], a[220:223], a[84:87], v[180:183]
    ds_read_b64_tr_b16 a[206:207], v201 offset:41984
    v_mfma_f32_16x16x32_bf16 v[184:187], a[220:223], a[88:91], v[184:187]
    buffer_load_dwordx4 a[60:63], v17, s[16:19], s29 offen offset:2304
    v_mfma_f32_16x16x32_bf16 v[188:191], a[220:223], a[92:95], v[188:191]
    s_waitcnt vmcnt(36) lgkmcnt(0)
    s_barrier
    v_mfma_f32_16x16x32_bf16 v[64:67], a[192:195], a[96:99], v[64:67]
    ds_read_b64_tr_b16 a[208:209], v200 offset:49152
    v_mfma_f32_16x16x32_bf16 v[68:71], a[192:195], a[100:103], v[68:71]
    ds_read_b64_tr_b16 a[210:211], v200 offset:50176
    v_mfma_f32_16x16x32_bf16 v[72:75], a[192:195], a[104:107], v[72:75]
    v_mfma_f32_16x16x32_bf16 v[76:79], a[192:195], a[108:111], v[76:79]
    s_waitcnt lgkmcnt(6)
    v_mfma_f32_16x16x32_bf16 v[80:83], a[196:199], a[96:99], v[80:83]
    ds_read_b64_tr_b16 a[212:213], v201 offset:49152
    v_mfma_f32_16x16x32_bf16 v[84:87], a[196:199], a[100:103], v[84:87]
    ds_read_b64_tr_b16 a[214:215], v201 offset:50176
    v_mfma_f32_16x16x32_bf16 v[88:91], a[196:199], a[104:107], v[88:91]
    v_mfma_f32_16x16x32_bf16 v[92:95], a[196:199], a[108:111], v[92:95]
    s_waitcnt lgkmcnt(6)
    v_mfma_f32_16x16x32_bf16 v[64:67], a[200:203], a[112:115], v[64:67]
    ds_read_b64_tr_b16 a[216:217], v200 offset:57344
    v_mfma_f32_16x16x32_bf16 v[68:71], a[200:203], a[116:119], v[68:71]
    ds_read_b64_tr_b16 a[218:219], v200 offset:58368
    v_mfma_f32_16x16x32_bf16 v[72:75], a[200:203], a[120:123], v[72:75]
    v_mfma_f32_16x16x32_bf16 v[76:79], a[200:203], a[124:127], v[76:79]
    s_waitcnt lgkmcnt(6)
    v_mfma_f32_16x16x32_bf16 v[80:83], a[204:207], a[112:115], v[80:83]
    ds_read_b64_tr_b16 a[220:221], v201 offset:57344
    v_mfma_f32_16x16x32_bf16 v[84:87], a[204:207], a[116:119], v[84:87]
    ds_read_b64_tr_b16 a[222:223], v201 offset:58368
    v_mfma_f32_16x16x32_bf16 v[88:91], a[204:207], a[120:123], v[88:91]
    v_mfma_f32_16x16x32_bf16 v[92:95], a[204:207], a[124:127], v[92:95]
    s_waitcnt vmcnt(24) lgkmcnt(0)
    s_barrier
    v_mfma_f32_16x16x32_bf16 v[64:67], a[208:211], a[128:131], v[64:67]
    ds_read_b64_tr_b16 a[192:193], v208 offset:0
    v_mfma_f32_16x16x32_bf16 v[68:71], a[208:211], a[132:135], v[68:71]
    ds_read_b64_tr_b16 a[194:195], v208 offset:1024
    v_mfma_f32_16x16x32_bf16 v[72:75], a[208:211], a[136:139], v[72:75]
    v_mfma_f32_16x16x32_bf16 v[76:79], a[208:211], a[140:143], v[76:79]
    s_waitcnt lgkmcnt(6)
    v_mfma_f32_16x16x32_bf16 v[80:83], a[212:215], a[128:131], v[80:83]
    ds_read_b64_tr_b16 a[196:197], v209 offset:0
    v_mfma_f32_16x16x32_bf16 v[84:87], a[212:215], a[132:135], v[84:87]
    ds_read_b64_tr_b16 a[198:199], v209 offset:1024
    v_mfma_f32_16x16x32_bf16 v[88:91], a[212:215], a[136:139], v[88:91]
    v_mfma_f32_16x16x32_bf16 v[92:95], a[212:215], a[140:143], v[92:95]
    s_waitcnt lgkmcnt(6)
    v_mfma_f32_16x16x32_bf16 v[64:67], a[216:219], a[144:147], v[64:67]
    ds_read_b64_tr_b16 a[200:201], v208 offset:8192
    v_mfma_f32_16x16x32_bf16 v[68:71], a[216:219], a[148:151], v[68:71]
    ds_read_b64_tr_b16 a[202:203], v208 offset:9216
    v_mfma_f32_16x16x32_bf16 v[72:75], a[216:219], a[152:155], v[72:75]
    v_mfma_f32_16x16x32_bf16 v[76:79], a[216:219], a[156:159], v[76:79]
    s_waitcnt lgkmcnt(6)
    v_mfma_f32_16x16x32_bf16 v[80:83], a[220:223], a[144:147], v[80:83]
    ds_read_b64_tr_b16 a[204:205], v209 offset:8192
    v_mfma_f32_16x16x32_bf16 v[84:87], a[220:223], a[148:151], v[84:87]
    ds_read_b64_tr_b16 a[206:207], v209 offset:9216
    v_mfma_f32_16x16x32_bf16 v[88:91], a[220:223], a[152:155], v[88:91]
    v_mfma_f32_16x16x32_bf16 v[92:95], a[220:223], a[156:159], v[92:95]
    s_waitcnt vmcnt(12) lgkmcnt(0)
    s_barrier
    v_mfma_f32_16x16x32_bf16 v[64:67], a[192:195], a[160:163], v[64:67]
    ds_read_b64_tr_b16 a[208:209], v208 offset:16384
    v_mfma_f32_16x16x32_bf16 v[68:71], a[192:195], a[164:167], v[68:71]
    ds_read_b64_tr_b16 a[210:211], v208 offset:17408
    v_mfma_f32_16x16x32_bf16 v[72:75], a[192:195], a[168:171], v[72:75]
    v_mfma_f32_16x16x32_bf16 v[76:79], a[192:195], a[172:175], v[76:79]
    s_waitcnt lgkmcnt(6)
    v_mfma_f32_16x16x32_bf16 v[80:83], a[196:199], a[160:163], v[80:83]
    ds_read_b64_tr_b16 a[212:213], v209 offset:16384
    v_mfma_f32_16x16x32_bf16 v[84:87], a[196:199], a[164:167], v[84:87]
    ds_read_b64_tr_b16 a[214:215], v209 offset:17408
    v_mfma_f32_16x16x32_bf16 v[88:91], a[196:199], a[168:171], v[88:91]
    v_mfma_f32_16x16x32_bf16 v[92:95], a[196:199], a[172:175], v[92:95]
    s_waitcnt lgkmcnt(6)
    v_mfma_f32_16x16x32_bf16 v[64:67], a[200:203], a[176:179], v[64:67]
    ds_read_b64_tr_b16 a[216:217], v208 offset:24576
    v_mfma_f32_16x16x32_bf16 v[68:71], a[200:203], a[180:183], v[68:71]
    ds_read_b64_tr_b16 a[218:219], v208 offset:25600
    v_mfma_f32_16x16x32_bf16 v[72:75], a[200:203], a[184:187], v[72:75]
    v_mfma_f32_16x16x32_bf16 v[76:79], a[200:203], a[188:191], v[76:79]
    s_waitcnt lgkmcnt(6)
    v_mfma_f32_16x16x32_bf16 v[80:83], a[204:207], a[176:179], v[80:83]
    ds_read_b64_tr_b16 a[220:221], v209 offset:24576
    v_mfma_f32_16x16x32_bf16 v[84:87], a[204:207], a[180:183], v[84:87]
    ds_read_b64_tr_b16 a[222:223], v209 offset:25600
    v_mfma_f32_16x16x32_bf16 v[88:91], a[204:207], a[184:187], v[88:91]
    v_mfma_f32_16x16x32_bf16 v[92:95], a[204:207], a[188:191], v[92:95]
    s_waitcnt vmcnt(0) lgkmcnt(0)
    s_barrier
    v_mfma_f32_16x16x32_bf16 v[64:67], a[208:211], a[0:3], v[64:67]
    ds_read_b64_tr_b16 a[192:193], v208 offset:32768
    v_mfma_f32_16x16x32_bf16 v[68:71], a[208:211], a[4:7], v[68:71]
    ds_read_b64_tr_b16 a[194:195], v208 offset:33792
    v_mfma_f32_16x16x32_bf16 v[72:75], a[208:211], a[8:11], v[72:75]
    v_mfma_f32_16x16x32_bf16 v[76:79], a[208:211], a[12:15], v[76:79]
    s_waitcnt lgkmcnt(6)
    v_mfma_f32_16x16x32_bf16 v[80:83], a[212:215], a[0:3], v[80:83]
    ds_read_b64_tr_b16 a[196:197], v209 offset:32768
    v_mfma_f32_16x16x32_bf16 v[84:87], a[212:215], a[4:7], v[84:87]
    ds_read_b64_tr_b16 a[198:199], v209 offset:33792
    v_mfma_f32_16x16x32_bf16 v[88:91], a[212:215], a[8:11], v[88:91]
    v_mfma_f32_16x16x32_bf16 v[92:95], a[212:215], a[12:15], v[92:95]
    s_waitcnt lgkmcnt(6)
    v_mfma_f32_16x16x32_bf16 v[64:67], a[216:219], a[16:19], v[64:67]
    ds_read_b64_tr_b16 a[200:201], v208 offset:40960
    v_mfma_f32_16x16x32_bf16 v[68:71], a[216:219], a[20:23], v[68:71]
    ds_read_b64_tr_b16 a[202:203], v208 offset:41984
    v_mfma_f32_16x16x32_bf16 v[72:75], a[216:219], a[24:27], v[72:75]
    v_mfma_f32_16x16x32_bf16 v[76:79], a[216:219], a[28:31], v[76:79]
    s_waitcnt lgkmcnt(6)
    v_mfma_f32_16x16x32_bf16 v[80:83], a[220:223], a[16:19], v[80:83]
    ds_read_b64_tr_b16 a[204:205], v209 offset:40960
    v_mfma_f32_16x16x32_bf16 v[84:87], a[220:223], a[20:23], v[84:87]
    ds_read_b64_tr_b16 a[206:207], v209 offset:41984
    v_mfma_f32_16x16x32_bf16 v[88:91], a[220:223], a[24:27], v[88:91]
    v_mfma_f32_16x16x32_bf16 v[92:95], a[220:223], a[28:31], v[92:95]
    s_waitcnt lgkmcnt(6)
    v_mfma_f32_16x16x32_bf16 v[64:67], a[192:195], a[32:35], v[64:67]
    ds_read_b64_tr_b16 a[208:209], v202 offset:32768
    v_mfma_f32_16x16x32_bf16 v[68:71], a[192:195], a[36:39], v[68:71]
    ds_read_b64_tr_b16 a[210:211], v202 offset:33792
    v_mfma_f32_16x16x32_bf16 v[72:75], a[192:195], a[40:43], v[72:75]
    v_mfma_f32_16x16x32_bf16 v[76:79], a[192:195], a[44:47], v[76:79]
    s_waitcnt lgkmcnt(6)
    v_mfma_f32_16x16x32_bf16 v[80:83], a[196:199], a[32:35], v[80:83]
    ds_read_b64_tr_b16 a[212:213], v203 offset:32768
    v_mfma_f32_16x16x32_bf16 v[84:87], a[196:199], a[36:39], v[84:87]
    ds_read_b64_tr_b16 a[214:215], v203 offset:33792
    v_mfma_f32_16x16x32_bf16 v[88:91], a[196:199], a[40:43], v[88:91]
    v_mfma_f32_16x16x32_bf16 v[92:95], a[196:199], a[44:47], v[92:95]
    s_waitcnt lgkmcnt(6)
    v_mfma_f32_16x16x32_bf16 v[64:67], a[200:203], a[48:51], v[64:67]
    ds_read_b64_tr_b16 a[216:217], v202 offset:40960
    v_mfma_f32_16x16x32_bf16 v[68:71], a[200:203], a[52:55], v[68:71]
    ds_read_b64_tr_b16 a[218:219], v202 offset:41984
    v_mfma_f32_16x16x32_bf16 v[72:75], a[200:203], a[56:59], v[72:75]
    v_mfma_f32_16x16x32_bf16 v[76:79], a[200:203], a[60:63], v[76:79]
    s_waitcnt lgkmcnt(6)
    v_mfma_f32_16x16x32_bf16 v[80:83], a[204:207], a[48:51], v[80:83]
    ds_read_b64_tr_b16 a[220:221], v203 offset:40960
    v_mfma_f32_16x16x32_bf16 v[84:87], a[204:207], a[52:55], v[84:87]
    ds_read_b64_tr_b16 a[222:223], v203 offset:41984
    v_mfma_f32_16x16x32_bf16 v[88:91], a[204:207], a[56:59], v[88:91]
    v_mfma_f32_16x16x32_bf16 v[92:95], a[204:207], a[60:63], v[92:95]
    s_waitcnt lgkmcnt(6)
    v_mfma_f32_16x16x32_bf16 v[96:99], a[208:211], a[96:99], v[96:99]
    ds_read_b64_tr_b16 a[192:193], v202 offset:49152
    v_mfma_f32_16x16x32_bf16 v[100:103], a[208:211], a[100:103], v[100:103]
    ds_read_b64_tr_b16 a[194:195], v202 offset:50176
    v_mfma_f32_16x16x32_bf16 v[104:107], a[208:211], a[104:107], v[104:107]
    v_mfma_f32_16x16x32_bf16 v[108:111], a[208:211], a[108:111], v[108:111]
    s_waitcnt lgkmcnt(6)
    v_mfma_f32_16x16x32_bf16 v[112:115], a[212:215], a[96:99], v[112:115]
    ds_read_b64_tr_b16 a[196:197], v203 offset:49152
    v_mfma_f32_16x16x32_bf16 v[116:119], a[212:215], a[100:103], v[116:119]
    ds_read_b64_tr_b16 a[198:199], v203 offset:50176
    v_mfma_f32_16x16x32_bf16 v[120:123], a[212:215], a[104:107], v[120:123]
    v_mfma_f32_16x16x32_bf16 v[124:127], a[212:215], a[108:111], v[124:127]
    s_waitcnt lgkmcnt(6)
    v_mfma_f32_16x16x32_bf16 v[96:99], a[216:219], a[112:115], v[96:99]
    ds_read_b64_tr_b16 a[200:201], v202 offset:57344
    v_mfma_f32_16x16x32_bf16 v[100:103], a[216:219], a[116:119], v[100:103]
    ds_read_b64_tr_b16 a[202:203], v202 offset:58368
    v_mfma_f32_16x16x32_bf16 v[104:107], a[216:219], a[120:123], v[104:107]
    v_mfma_f32_16x16x32_bf16 v[108:111], a[216:219], a[124:127], v[108:111]
    s_waitcnt lgkmcnt(6)
    v_mfma_f32_16x16x32_bf16 v[112:115], a[220:223], a[112:115], v[112:115]
    ds_read_b64_tr_b16 a[204:205], v203 offset:57344
    v_cvt_pk_bf16_f32 v20, v64, v65
    v_cvt_pk_bf16_f32 v21, v66, v67
    v_mfma_f32_16x16x32_bf16 v[116:119], a[220:223], a[116:119], v[116:119]
    ds_read_b64_tr_b16 a[206:207], v203 offset:58368
    v_mfma_f32_16x16x32_bf16 v[120:123], a[220:223], a[120:123], v[120:123]
    v_mfma_f32_16x16x32_bf16 v[124:127], a[220:223], a[124:127], v[124:127]
    v_cvt_pk_bf16_f32 v22, v68, v69
    v_cvt_pk_bf16_f32 v23, v70, v71
    s_waitcnt lgkmcnt(6)
    v_mfma_f32_16x16x32_bf16 v[96:99], a[192:195], a[128:131], v[96:99]
    ds_read_b64_tr_b16 a[208:209], v210 offset:0
    s_nop 1
    v_permlane16_swap_b32 v20, v22
    v_mfma_f32_16x16x32_bf16 v[100:103], a[192:195], a[132:135], v[100:103]
    ds_read_b64_tr_b16 a[210:211], v210 offset:1024
    v_mfma_f32_16x16x32_bf16 v[104:107], a[192:195], a[136:139], v[104:107]
    v_mfma_f32_16x16x32_bf16 v[108:111], a[192:195], a[140:143], v[108:111]
    v_permlane16_swap_b32 v21, v23
    s_nop 0
    s_waitcnt lgkmcnt(6)
    v_mfma_f32_16x16x32_bf16 v[112:115], a[196:199], a[128:131], v[112:115]
    ds_read_b64_tr_b16 a[212:213], v211 offset:0
    buffer_store_dwordx4 v[20:23], v2, s[40:43], s37 offen offset:0 sc1
    v_cvt_pk_bf16_f32 v24, v80, v81
    v_mfma_f32_16x16x32_bf16 v[116:119], a[196:199], a[132:135], v[116:119]
    ds_read_b64_tr_b16 a[214:215], v211 offset:1024
    v_mfma_f32_16x16x32_bf16 v[120:123], a[196:199], a[136:139], v[120:123]
    v_mfma_f32_16x16x32_bf16 v[124:127], a[196:199], a[140:143], v[124:127]
    v_cvt_pk_bf16_f32 v25, v82, v83
    v_cvt_pk_bf16_f32 v26, v84, v85
    s_waitcnt lgkmcnt(6)
    v_mfma_f32_16x16x32_bf16 v[96:99], a[200:203], a[144:147], v[96:99]
    ds_read_b64_tr_b16 a[216:217], v210 offset:8192
    v_cvt_pk_bf16_f32 v27, v86, v87
    s_nop 1
    v_mfma_f32_16x16x32_bf16 v[100:103], a[200:203], a[148:151], v[100:103]
    ds_read_b64_tr_b16 a[218:219], v210 offset:9216
    v_mfma_f32_16x16x32_bf16 v[104:107], a[200:203], a[152:155], v[104:107]
    v_mfma_f32_16x16x32_bf16 v[108:111], a[200:203], a[156:159], v[108:111]
    v_permlane16_swap_b32 v24, v26
    v_permlane16_swap_b32 v25, v27
    s_waitcnt lgkmcnt(6)
    v_mfma_f32_16x16x32_bf16 v[112:115], a[204:207], a[144:147], v[112:115]
    ds_read_b64_tr_b16 a[220:221], v211 offset:8192
    s_nop 0
    buffer_store_dwordx4 v[24:27], v2, s[40:43], s37 offen offset:1024 sc1
    v_mfma_f32_16x16x32_bf16 v[116:119], a[204:207], a[148:151], v[116:119]
    ds_read_b64_tr_b16 a[222:223], v211 offset:9216
    v_mfma_f32_16x16x32_bf16 v[120:123], a[204:207], a[152:155], v[120:123]
    v_mfma_f32_16x16x32_bf16 v[124:127], a[204:207], a[156:159], v[124:127]
    v_cvt_pk_bf16_f32 v28, v72, v73
    v_cvt_pk_bf16_f32 v29, v74, v75
    s_waitcnt lgkmcnt(6)
    v_mfma_f32_16x16x32_bf16 v[96:99], a[208:211], a[160:163], v[96:99]
    ds_read_b64_tr_b16 a[192:193], v210 offset:16384
    v_cvt_pk_bf16_f32 v30, v76, v77
    v_cvt_pk_bf16_f32 v31, v78, v79
    v_mfma_f32_16x16x32_bf16 v[100:103], a[208:211], a[164:167], v[100:103]
    ds_read_b64_tr_b16 a[194:195], v210 offset:17408
    v_mfma_f32_16x16x32_bf16 v[104:107], a[208:211], a[168:171], v[104:107]
    v_mfma_f32_16x16x32_bf16 v[108:111], a[208:211], a[172:175], v[108:111]
    s_nop 1
    v_permlane16_swap_b32 v28, v30
    s_waitcnt lgkmcnt(6)
    v_mfma_f32_16x16x32_bf16 v[112:115], a[212:215], a[160:163], v[112:115]
    ds_read_b64_tr_b16 a[196:197], v211 offset:16384
    v_permlane16_swap_b32 v29, v31
    s_nop 0
    v_mfma_f32_16x16x32_bf16 v[116:119], a[212:215], a[164:167], v[116:119]
    ds_read_b64_tr_b16 a[198:199], v211 offset:17408
    v_mfma_f32_16x16x32_bf16 v[120:123], a[212:215], a[168:171], v[120:123]
    v_mfma_f32_16x16x32_bf16 v[124:127], a[212:215], a[172:175], v[124:127]
    buffer_store_dwordx4 v[28:31], v2, s[40:43], s37 offen offset:2048 sc1
    v_cvt_pk_bf16_f32 v32, v88, v89
    s_waitcnt lgkmcnt(6)
    v_mfma_f32_16x16x32_bf16 v[96:99], a[216:219], a[176:179], v[96:99]
    ds_read_b64_tr_b16 a[200:201], v210 offset:24576
    v_cvt_pk_bf16_f32 v33, v90, v91
    v_cvt_pk_bf16_f32 v34, v92, v93
    v_mfma_f32_16x16x32_bf16 v[100:103], a[216:219], a[180:183], v[100:103]
    ds_read_b64_tr_b16 a[202:203], v210 offset:25600
    v_mfma_f32_16x16x32_bf16 v[104:107], a[216:219], a[184:187], v[104:107]
    v_mfma_f32_16x16x32_bf16 v[108:111], a[216:219], a[188:191], v[108:111]
    v_cvt_pk_bf16_f32 v35, v94, v95
    s_nop 1
    s_waitcnt lgkmcnt(6)
    v_mfma_f32_16x16x32_bf16 v[112:115], a[220:223], a[176:179], v[112:115]
    ds_read_b64_tr_b16 a[204:205], v211 offset:24576
    v_permlane16_swap_b32 v32, v34
    v_permlane16_swap_b32 v33, v35
    v_mfma_f32_16x16x32_bf16 v[116:119], a[220:223], a[180:183], v[116:119]
    ds_read_b64_tr_b16 a[206:207], v211 offset:25600
    v_mfma_f32_16x16x32_bf16 v[120:123], a[220:223], a[184:187], v[120:123]
    v_mfma_f32_16x16x32_bf16 v[124:127], a[220:223], a[188:191], v[124:127]
    s_nop 0
    buffer_store_dwordx4 v[32:35], v2, s[40:43], s37 offen offset:3072 sc1
    s_waitcnt lgkmcnt(6)
    v_mfma_f32_16x16x32_bf16 v[96:99], a[192:195], a[0:3], v[96:99]
    ds_read_b64_tr_b16 a[208:209], v210 offset:32768
    v_mfma_f32_16x16x32_bf16 v[100:103], a[192:195], a[4:7], v[100:103]
    ds_read_b64_tr_b16 a[210:211], v210 offset:33792
    v_mfma_f32_16x16x32_bf16 v[104:107], a[192:195], a[8:11], v[104:107]
    v_mfma_f32_16x16x32_bf16 v[108:111], a[192:195], a[12:15], v[108:111]
    s_waitcnt lgkmcnt(6)
    v_mfma_f32_16x16x32_bf16 v[112:115], a[196:199], a[0:3], v[112:115]
    ds_read_b64_tr_b16 a[212:213], v211 offset:32768
    v_mfma_f32_16x16x32_bf16 v[116:119], a[196:199], a[4:7], v[116:119]
    ds_read_b64_tr_b16 a[214:215], v211 offset:33792
    v_mfma_f32_16x16x32_bf16 v[120:123], a[196:199], a[8:11], v[120:123]
    v_mfma_f32_16x16x32_bf16 v[124:127], a[196:199], a[12:15], v[124:127]
    s_waitcnt lgkmcnt(6)
    v_mfma_f32_16x16x32_bf16 v[96:99], a[200:203], a[16:19], v[96:99]
    ds_read_b64_tr_b16 a[216:217], v210 offset:40960
    v_mfma_f32_16x16x32_bf16 v[100:103], a[200:203], a[20:23], v[100:103]
    ds_read_b64_tr_b16 a[218:219], v210 offset:41984
    v_mfma_f32_16x16x32_bf16 v[104:107], a[200:203], a[24:27], v[104:107]
    v_mfma_f32_16x16x32_bf16 v[108:111], a[200:203], a[28:31], v[108:111]
    s_waitcnt lgkmcnt(6)
    v_mfma_f32_16x16x32_bf16 v[112:115], a[204:207], a[16:19], v[112:115]
    ds_read_b64_tr_b16 a[220:221], v211 offset:40960
    v_mfma_f32_16x16x32_bf16 v[116:119], a[204:207], a[20:23], v[116:119]
    ds_read_b64_tr_b16 a[222:223], v211 offset:41984
    v_mfma_f32_16x16x32_bf16 v[120:123], a[204:207], a[24:27], v[120:123]
    v_mfma_f32_16x16x32_bf16 v[124:127], a[204:207], a[28:31], v[124:127]
    s_waitcnt lgkmcnt(6)
    v_mfma_f32_16x16x32_bf16 v[96:99], a[208:211], a[32:35], v[96:99]
    ds_read_b64_tr_b16 a[192:193], v204 offset:32768
    v_mfma_f32_16x16x32_bf16 v[100:103], a[208:211], a[36:39], v[100:103]
    ds_read_b64_tr_b16 a[194:195], v204 offset:33792
    v_mfma_f32_16x16x32_bf16 v[104:107], a[208:211], a[40:43], v[104:107]
    v_mfma_f32_16x16x32_bf16 v[108:111], a[208:211], a[44:47], v[108:111]
    s_waitcnt lgkmcnt(6)
    v_mfma_f32_16x16x32_bf16 v[112:115], a[212:215], a[32:35], v[112:115]
    ds_read_b64_tr_b16 a[196:197], v205 offset:32768
    v_mfma_f32_16x16x32_bf16 v[116:119], a[212:215], a[36:39], v[116:119]
    ds_read_b64_tr_b16 a[198:199], v205 offset:33792
    v_mfma_f32_16x16x32_bf16 v[120:123], a[212:215], a[40:43], v[120:123]
    v_mfma_f32_16x16x32_bf16 v[124:127], a[212:215], a[44:47], v[124:127]
    s_waitcnt lgkmcnt(6)
    v_mfma_f32_16x16x32_bf16 v[96:99], a[216:219], a[48:51], v[96:99]
    ds_read_b64_tr_b16 a[200:201], v204 offset:40960
    v_mfma_f32_16x16x32_bf16 v[100:103], a[216:219], a[52:55], v[100:103]
    ds_read_b64_tr_b16 a[202:203], v204 offset:41984
    v_mfma_f32_16x16x32_bf16 v[104:107], a[216:219], a[56:59], v[104:107]
    v_mfma_f32_16x16x32_bf16 v[108:111], a[216:219], a[60:63], v[108:111]
    s_waitcnt lgkmcnt(6)
    v_mfma_f32_16x16x32_bf16 v[112:115], a[220:223], a[48:51], v[112:115]
    ds_read_b64_tr_b16 a[204:205], v205 offset:40960
    v_mfma_f32_16x16x32_bf16 v[116:119], a[220:223], a[52:55], v[116:119]
    ds_read_b64_tr_b16 a[206:207], v205 offset:41984
    v_mfma_f32_16x16x32_bf16 v[120:123], a[220:223], a[56:59], v[120:123]
    v_mfma_f32_16x16x32_bf16 v[124:127], a[220:223], a[60:63], v[124:127]
    s_waitcnt lgkmcnt(6)
    v_mfma_f32_16x16x32_bf16 v[128:131], a[192:195], a[96:99], v[128:131]
    ds_read_b64_tr_b16 a[208:209], v204 offset:49152
    v_mfma_f32_16x16x32_bf16 v[132:135], a[192:195], a[100:103], v[132:135]
    ds_read_b64_tr_b16 a[210:211], v204 offset:50176
    v_mfma_f32_16x16x32_bf16 v[136:139], a[192:195], a[104:107], v[136:139]
    v_mfma_f32_16x16x32_bf16 v[140:143], a[192:195], a[108:111], v[140:143]
    s_waitcnt lgkmcnt(6)
    v_mfma_f32_16x16x32_bf16 v[144:147], a[196:199], a[96:99], v[144:147]
    ds_read_b64_tr_b16 a[212:213], v205 offset:49152
    v_mfma_f32_16x16x32_bf16 v[148:151], a[196:199], a[100:103], v[148:151]
    ds_read_b64_tr_b16 a[214:215], v205 offset:50176
    v_mfma_f32_16x16x32_bf16 v[152:155], a[196:199], a[104:107], v[152:155]
    v_mfma_f32_16x16x32_bf16 v[156:159], a[196:199], a[108:111], v[156:159]
    s_waitcnt lgkmcnt(6)
    v_mfma_f32_16x16x32_bf16 v[128:131], a[200:203], a[112:115], v[128:131]
    ds_read_b64_tr_b16 a[216:217], v204 offset:57344
    v_mfma_f32_16x16x32_bf16 v[132:135], a[200:203], a[116:119], v[132:135]
    ds_read_b64_tr_b16 a[218:219], v204 offset:58368
    v_mfma_f32_16x16x32_bf16 v[136:139], a[200:203], a[120:123], v[136:139]
    v_mfma_f32_16x16x32_bf16 v[140:143], a[200:203], a[124:127], v[140:143]
    s_waitcnt lgkmcnt(6)
    v_mfma_f32_16x16x32_bf16 v[144:147], a[204:207], a[112:115], v[144:147]
    ds_read_b64_tr_b16 a[220:221], v205 offset:57344
    v_cvt_pk_bf16_f32 v20, v96, v97
    v_cvt_pk_bf16_f32 v21, v98, v99
    v_mfma_f32_16x16x32_bf16 v[148:151], a[204:207], a[116:119], v[148:151]
    ds_read_b64_tr_b16 a[222:223], v205 offset:58368
    v_mfma_f32_16x16x32_bf16 v[152:155], a[204:207], a[120:123], v[152:155]
    v_mfma_f32_16x16x32_bf16 v[156:159], a[204:207], a[124:127], v[156:159]
    v_cvt_pk_bf16_f32 v22, v100, v101
    v_cvt_pk_bf16_f32 v23, v102, v103
    s_waitcnt lgkmcnt(6)
    v_mfma_f32_16x16x32_bf16 v[128:131], a[208:211], a[128:131], v[128:131]
    ds_read_b64_tr_b16 a[192:193], v212 offset:0
    s_nop 1
    v_permlane16_swap_b32 v20, v22
    v_mfma_f32_16x16x32_bf16 v[132:135], a[208:211], a[132:135], v[132:135]
    ds_read_b64_tr_b16 a[194:195], v212 offset:1024
    v_mfma_f32_16x16x32_bf16 v[136:139], a[208:211], a[136:139], v[136:139]
    v_mfma_f32_16x16x32_bf16 v[140:143], a[208:211], a[140:143], v[140:143]
    v_permlane16_swap_b32 v21, v23
    s_nop 0
    s_waitcnt lgkmcnt(6)
    v_mfma_f32_16x16x32_bf16 v[144:147], a[212:215], a[128:131], v[144:147]
    ds_read_b64_tr_b16 a[196:197], v213 offset:0
    buffer_store_dwordx4 v[20:23], v2, s[40:43], s38 offen offset:0 sc1
    v_cvt_pk_bf16_f32 v24, v112, v113
    v_mfma_f32_16x16x32_bf16 v[148:151], a[212:215], a[132:135], v[148:151]
    ds_read_b64_tr_b16 a[198:199], v213 offset:1024
    v_mfma_f32_16x16x32_bf16 v[152:155], a[212:215], a[136:139], v[152:155]
    v_mfma_f32_16x16x32_bf16 v[156:159], a[212:215], a[140:143], v[156:159]
    v_cvt_pk_bf16_f32 v25, v114, v115
    v_cvt_pk_bf16_f32 v26, v116, v117
    s_waitcnt lgkmcnt(6)
    v_mfma_f32_16x16x32_bf16 v[128:131], a[216:219], a[144:147], v[128:131]
    ds_read_b64_tr_b16 a[200:201], v212 offset:8192
    v_cvt_pk_bf16_f32 v27, v118, v119
    s_nop 1
    v_mfma_f32_16x16x32_bf16 v[132:135], a[216:219], a[148:151], v[132:135]
    ds_read_b64_tr_b16 a[202:203], v212 offset:9216
    v_mfma_f32_16x16x32_bf16 v[136:139], a[216:219], a[152:155], v[136:139]
    v_mfma_f32_16x16x32_bf16 v[140:143], a[216:219], a[156:159], v[140:143]
    v_permlane16_swap_b32 v24, v26
    v_permlane16_swap_b32 v25, v27
    s_waitcnt lgkmcnt(6)
    v_mfma_f32_16x16x32_bf16 v[144:147], a[220:223], a[144:147], v[144:147]
    ds_read_b64_tr_b16 a[204:205], v213 offset:8192
    s_nop 0
    buffer_store_dwordx4 v[24:27], v2, s[40:43], s38 offen offset:1024 sc1
    v_mfma_f32_16x16x32_bf16 v[148:151], a[220:223], a[148:151], v[148:151]
    ds_read_b64_tr_b16 a[206:207], v213 offset:9216
    v_mfma_f32_16x16x32_bf16 v[152:155], a[220:223], a[152:155], v[152:155]
    v_mfma_f32_16x16x32_bf16 v[156:159], a[220:223], a[156:159], v[156:159]
    v_cvt_pk_bf16_f32 v28, v104, v105
    v_cvt_pk_bf16_f32 v29, v106, v107
    s_waitcnt lgkmcnt(6)
    v_mfma_f32_16x16x32_bf16 v[128:131], a[192:195], a[160:163], v[128:131]
    ds_read_b64_tr_b16 a[208:209], v212 offset:16384
    v_cvt_pk_bf16_f32 v30, v108, v109
    v_cvt_pk_bf16_f32 v31, v110, v111
    v_mfma_f32_16x16x32_bf16 v[132:135], a[192:195], a[164:167], v[132:135]
    ds_read_b64_tr_b16 a[210:211], v212 offset:17408
    v_mfma_f32_16x16x32_bf16 v[136:139], a[192:195], a[168:171], v[136:139]
    v_mfma_f32_16x16x32_bf16 v[140:143], a[192:195], a[172:175], v[140:143]
    s_nop 1
    v_permlane16_swap_b32 v28, v30
    s_waitcnt lgkmcnt(6)
    v_mfma_f32_16x16x32_bf16 v[144:147], a[196:199], a[160:163], v[144:147]
    ds_read_b64_tr_b16 a[212:213], v213 offset:16384
    v_permlane16_swap_b32 v29, v31
    s_nop 0
    v_mfma_f32_16x16x32_bf16 v[148:151], a[196:199], a[164:167], v[148:151]
    ds_read_b64_tr_b16 a[214:215], v213 offset:17408
    v_mfma_f32_16x16x32_bf16 v[152:155], a[196:199], a[168:171], v[152:155]
    v_mfma_f32_16x16x32_bf16 v[156:159], a[196:199], a[172:175], v[156:159]
    buffer_store_dwordx4 v[28:31], v2, s[40:43], s38 offen offset:2048 sc1
    v_cvt_pk_bf16_f32 v32, v120, v121
    s_waitcnt lgkmcnt(6)
    v_mfma_f32_16x16x32_bf16 v[128:131], a[200:203], a[176:179], v[128:131]
    ds_read_b64_tr_b16 a[216:217], v212 offset:24576
    v_cvt_pk_bf16_f32 v33, v122, v123
    v_cvt_pk_bf16_f32 v34, v124, v125
    v_mfma_f32_16x16x32_bf16 v[132:135], a[200:203], a[180:183], v[132:135]
    ds_read_b64_tr_b16 a[218:219], v212 offset:25600
    v_mfma_f32_16x16x32_bf16 v[136:139], a[200:203], a[184:187], v[136:139]
    v_mfma_f32_16x16x32_bf16 v[140:143], a[200:203], a[188:191], v[140:143]
    v_cvt_pk_bf16_f32 v35, v126, v127
    s_nop 1
    s_waitcnt lgkmcnt(6)
    v_mfma_f32_16x16x32_bf16 v[144:147], a[204:207], a[176:179], v[144:147]
    ds_read_b64_tr_b16 a[220:221], v213 offset:24576
    v_permlane16_swap_b32 v32, v34
    v_permlane16_swap_b32 v33, v35
    v_mfma_f32_16x16x32_bf16 v[148:151], a[204:207], a[180:183], v[148:151]
    ds_read_b64_tr_b16 a[222:223], v213 offset:25600
    v_mfma_f32_16x16x32_bf16 v[152:155], a[204:207], a[184:187], v[152:155]
    v_mfma_f32_16x16x32_bf16 v[156:159], a[204:207], a[188:191], v[156:159]
    s_nop 0
    buffer_store_dwordx4 v[32:35], v2, s[40:43], s38 offen offset:3072 sc1
    s_waitcnt lgkmcnt(6)
    v_mfma_f32_16x16x32_bf16 v[128:131], a[208:211], a[0:3], v[128:131]
    ds_read_b64_tr_b16 a[192:193], v212 offset:32768
    v_mfma_f32_16x16x32_bf16 v[132:135], a[208:211], a[4:7], v[132:135]
    ds_read_b64_tr_b16 a[194:195], v212 offset:33792
    v_mfma_f32_16x16x32_bf16 v[136:139], a[208:211], a[8:11], v[136:139]
    v_mfma_f32_16x16x32_bf16 v[140:143], a[208:211], a[12:15], v[140:143]
    s_waitcnt lgkmcnt(6)
    v_mfma_f32_16x16x32_bf16 v[144:147], a[212:215], a[0:3], v[144:147]
    ds_read_b64_tr_b16 a[196:197], v213 offset:32768
    v_mfma_f32_16x16x32_bf16 v[148:151], a[212:215], a[4:7], v[148:151]
    ds_read_b64_tr_b16 a[198:199], v213 offset:33792
    v_mfma_f32_16x16x32_bf16 v[152:155], a[212:215], a[8:11], v[152:155]
    v_mfma_f32_16x16x32_bf16 v[156:159], a[212:215], a[12:15], v[156:159]
    s_waitcnt lgkmcnt(6)
    v_mfma_f32_16x16x32_bf16 v[128:131], a[216:219], a[16:19], v[128:131]
    ds_read_b64_tr_b16 a[200:201], v212 offset:40960
    v_mfma_f32_16x16x32_bf16 v[132:135], a[216:219], a[20:23], v[132:135]
    ds_read_b64_tr_b16 a[202:203], v212 offset:41984
    v_mfma_f32_16x16x32_bf16 v[136:139], a[216:219], a[24:27], v[136:139]
    v_mfma_f32_16x16x32_bf16 v[140:143], a[216:219], a[28:31], v[140:143]
    s_waitcnt lgkmcnt(6)
    v_mfma_f32_16x16x32_bf16 v[144:147], a[220:223], a[16:19], v[144:147]
    ds_read_b64_tr_b16 a[204:205], v213 offset:40960
    v_mfma_f32_16x16x32_bf16 v[148:151], a[220:223], a[20:23], v[148:151]
    ds_read_b64_tr_b16 a[206:207], v213 offset:41984
    v_mfma_f32_16x16x32_bf16 v[152:155], a[220:223], a[24:27], v[152:155]
    v_mfma_f32_16x16x32_bf16 v[156:159], a[220:223], a[28:31], v[156:159]
    s_waitcnt lgkmcnt(6)
    v_mfma_f32_16x16x32_bf16 v[128:131], a[192:195], a[32:35], v[128:131]
    ds_read_b64_tr_b16 a[208:209], v206 offset:32768
    v_mfma_f32_16x16x32_bf16 v[132:135], a[192:195], a[36:39], v[132:135]
    ds_read_b64_tr_b16 a[210:211], v206 offset:33792
    v_mfma_f32_16x16x32_bf16 v[136:139], a[192:195], a[40:43], v[136:139]
    v_mfma_f32_16x16x32_bf16 v[140:143], a[192:195], a[44:47], v[140:143]
    s_waitcnt lgkmcnt(6)
    v_mfma_f32_16x16x32_bf16 v[144:147], a[196:199], a[32:35], v[144:147]
    ds_read_b64_tr_b16 a[212:213], v207 offset:32768
    v_mfma_f32_16x16x32_bf16 v[148:151], a[196:199], a[36:39], v[148:151]
    ds_read_b64_tr_b16 a[214:215], v207 offset:33792
    v_mfma_f32_16x16x32_bf16 v[152:155], a[196:199], a[40:43], v[152:155]
    v_mfma_f32_16x16x32_bf16 v[156:159], a[196:199], a[44:47], v[156:159]
    s_waitcnt lgkmcnt(6)
    v_mfma_f32_16x16x32_bf16 v[128:131], a[200:203], a[48:51], v[128:131]
    ds_read_b64_tr_b16 a[216:217], v206 offset:40960
    v_mfma_f32_16x16x32_bf16 v[132:135], a[200:203], a[52:55], v[132:135]
    ds_read_b64_tr_b16 a[218:219], v206 offset:41984
    v_mfma_f32_16x16x32_bf16 v[136:139], a[200:203], a[56:59], v[136:139]
    v_mfma_f32_16x16x32_bf16 v[140:143], a[200:203], a[60:63], v[140:143]
    s_waitcnt lgkmcnt(6)
    v_mfma_f32_16x16x32_bf16 v[144:147], a[204:207], a[48:51], v[144:147]
    ds_read_b64_tr_b16 a[220:221], v207 offset:40960
    v_mfma_f32_16x16x32_bf16 v[148:151], a[204:207], a[52:55], v[148:151]
    ds_read_b64_tr_b16 a[222:223], v207 offset:41984
    v_mfma_f32_16x16x32_bf16 v[152:155], a[204:207], a[56:59], v[152:155]
    v_mfma_f32_16x16x32_bf16 v[156:159], a[204:207], a[60:63], v[156:159]
    s_waitcnt lgkmcnt(6)
    v_mfma_f32_16x16x32_bf16 v[160:163], a[208:211], a[96:99], v[160:163]
    ds_read_b64_tr_b16 a[192:193], v206 offset:49152
    v_mfma_f32_16x16x32_bf16 v[164:167], a[208:211], a[100:103], v[164:167]
    ds_read_b64_tr_b16 a[194:195], v206 offset:50176
    v_mfma_f32_16x16x32_bf16 v[168:171], a[208:211], a[104:107], v[168:171]
    v_mfma_f32_16x16x32_bf16 v[172:175], a[208:211], a[108:111], v[172:175]
    s_waitcnt vmcnt(4)
    global_store_dword v250, v249, s[56:57] sc1
    s_waitcnt lgkmcnt(6)
    v_mfma_f32_16x16x32_bf16 v[176:179], a[212:215], a[96:99], v[176:179]
    ds_read_b64_tr_b16 a[196:197], v207 offset:49152
    v_mfma_f32_16x16x32_bf16 v[180:183], a[212:215], a[100:103], v[180:183]
    ds_read_b64_tr_b16 a[198:199], v207 offset:50176
    v_mfma_f32_16x16x32_bf16 v[184:187], a[212:215], a[104:107], v[184:187]
    v_mfma_f32_16x16x32_bf16 v[188:191], a[212:215], a[108:111], v[188:191]
    s_waitcnt lgkmcnt(6)
    v_mfma_f32_16x16x32_bf16 v[160:163], a[216:219], a[112:115], v[160:163]
    ds_read_b64_tr_b16 a[200:201], v206 offset:57344
    v_mfma_f32_16x16x32_bf16 v[164:167], a[216:219], a[116:119], v[164:167]
    ds_read_b64_tr_b16 a[202:203], v206 offset:58368
    v_mfma_f32_16x16x32_bf16 v[168:171], a[216:219], a[120:123], v[168:171]
    v_mfma_f32_16x16x32_bf16 v[172:175], a[216:219], a[124:127], v[172:175]
    s_waitcnt lgkmcnt(6)
    v_mfma_f32_16x16x32_bf16 v[176:179], a[220:223], a[112:115], v[176:179]
    ds_read_b64_tr_b16 a[204:205], v207 offset:57344
    v_cvt_pk_bf16_f32 v20, v128, v129
    v_cvt_pk_bf16_f32 v21, v130, v131
    v_mfma_f32_16x16x32_bf16 v[180:183], a[220:223], a[116:119], v[180:183]
    ds_read_b64_tr_b16 a[206:207], v207 offset:58368
    v_mfma_f32_16x16x32_bf16 v[184:187], a[220:223], a[120:123], v[184:187]
    v_mfma_f32_16x16x32_bf16 v[188:191], a[220:223], a[124:127], v[188:191]
    v_cvt_pk_bf16_f32 v22, v132, v133
    v_cvt_pk_bf16_f32 v23, v134, v135
    s_waitcnt lgkmcnt(6)
    v_mfma_f32_16x16x32_bf16 v[160:163], a[192:195], a[128:131], v[160:163]
    ds_read_b64_tr_b16 a[208:209], v214 offset:0
    s_nop 1
    v_permlane16_swap_b32 v20, v22
    v_mfma_f32_16x16x32_bf16 v[164:167], a[192:195], a[132:135], v[164:167]
    ds_read_b64_tr_b16 a[210:211], v214 offset:1024
    v_mfma_f32_16x16x32_bf16 v[168:171], a[192:195], a[136:139], v[168:171]
    v_mfma_f32_16x16x32_bf16 v[172:175], a[192:195], a[140:143], v[172:175]
    v_permlane16_swap_b32 v21, v23
    s_nop 0
    s_waitcnt lgkmcnt(6)
    v_mfma_f32_16x16x32_bf16 v[176:179], a[196:199], a[128:131], v[176:179]
    ds_read_b64_tr_b16 a[212:213], v215 offset:0
    buffer_store_dwordx4 v[20:23], v2, s[40:43], s39 offen offset:0 sc1
    v_cvt_pk_bf16_f32 v24, v144, v145
    v_mfma_f32_16x16x32_bf16 v[180:183], a[196:199], a[132:135], v[180:183]
    ds_read_b64_tr_b16 a[214:215], v215 offset:1024
    v_mfma_f32_16x16x32_bf16 v[184:187], a[196:199], a[136:139], v[184:187]
    v_mfma_f32_16x16x32_bf16 v[188:191], a[196:199], a[140:143], v[188:191]
    v_cvt_pk_bf16_f32 v25, v146, v147
    v_cvt_pk_bf16_f32 v26, v148, v149
    s_waitcnt lgkmcnt(6)
    v_mfma_f32_16x16x32_bf16 v[160:163], a[200:203], a[144:147], v[160:163]
    ds_read_b64_tr_b16 a[216:217], v214 offset:8192
    v_cvt_pk_bf16_f32 v27, v150, v151
    s_nop 1
    v_mfma_f32_16x16x32_bf16 v[164:167], a[200:203], a[148:151], v[164:167]
    ds_read_b64_tr_b16 a[218:219], v214 offset:9216
    v_mfma_f32_16x16x32_bf16 v[168:171], a[200:203], a[152:155], v[168:171]
    v_mfma_f32_16x16x32_bf16 v[172:175], a[200:203], a[156:159], v[172:175]
    v_permlane16_swap_b32 v24, v26
    v_permlane16_swap_b32 v25, v27
    s_waitcnt lgkmcnt(6)
    v_mfma_f32_16x16x32_bf16 v[176:179], a[204:207], a[144:147], v[176:179]
    ds_read_b64_tr_b16 a[220:221], v215 offset:8192
    s_nop 0
    buffer_store_dwordx4 v[24:27], v2, s[40:43], s39 offen offset:1024 sc1
    v_mfma_f32_16x16x32_bf16 v[180:183], a[204:207], a[148:151], v[180:183]
    ds_read_b64_tr_b16 a[222:223], v215 offset:9216
    v_mfma_f32_16x16x32_bf16 v[184:187], a[204:207], a[152:155], v[184:187]
    v_mfma_f32_16x16x32_bf16 v[188:191], a[204:207], a[156:159], v[188:191]
    v_cvt_pk_bf16_f32 v28, v136, v137
    v_cvt_pk_bf16_f32 v29, v138, v139
    s_waitcnt lgkmcnt(6)
    v_mfma_f32_16x16x32_bf16 v[160:163], a[208:211], a[160:163], v[160:163]
    ds_read_b64_tr_b16 a[192:193], v214 offset:16384
    v_cvt_pk_bf16_f32 v30, v140, v141
    v_cvt_pk_bf16_f32 v31, v142, v143
    v_mfma_f32_16x16x32_bf16 v[164:167], a[208:211], a[164:167], v[164:167]
    ds_read_b64_tr_b16 a[194:195], v214 offset:17408
    v_mfma_f32_16x16x32_bf16 v[168:171], a[208:211], a[168:171], v[168:171]
    v_mfma_f32_16x16x32_bf16 v[172:175], a[208:211], a[172:175], v[172:175]
    s_nop 1
    v_permlane16_swap_b32 v28, v30
    s_waitcnt lgkmcnt(6)
    v_mfma_f32_16x16x32_bf16 v[176:179], a[212:215], a[160:163], v[176:179]
    ds_read_b64_tr_b16 a[196:197], v215 offset:16384
    v_permlane16_swap_b32 v29, v31
    s_nop 0
    v_mfma_f32_16x16x32_bf16 v[180:183], a[212:215], a[164:167], v[180:183]
    ds_read_b64_tr_b16 a[198:199], v215 offset:17408
    v_mfma_f32_16x16x32_bf16 v[184:187], a[212:215], a[168:171], v[184:187]
    v_mfma_f32_16x16x32_bf16 v[188:191], a[212:215], a[172:175], v[188:191]
    buffer_store_dwordx4 v[28:31], v2, s[40:43], s39 offen offset:2048 sc1
    v_cvt_pk_bf16_f32 v32, v152, v153
    s_waitcnt lgkmcnt(6)
    v_mfma_f32_16x16x32_bf16 v[160:163], a[216:219], a[176:179], v[160:163]
    ds_read_b64_tr_b16 a[200:201], v214 offset:24576
    v_cvt_pk_bf16_f32 v33, v154, v155
    v_cvt_pk_bf16_f32 v34, v156, v157
    v_mfma_f32_16x16x32_bf16 v[164:167], a[216:219], a[180:183], v[164:167]
    ds_read_b64_tr_b16 a[202:203], v214 offset:25600
    v_mfma_f32_16x16x32_bf16 v[168:171], a[216:219], a[184:187], v[168:171]
    v_mfma_f32_16x16x32_bf16 v[172:175], a[216:219], a[188:191], v[172:175]
    v_cvt_pk_bf16_f32 v35, v158, v159
    s_nop 1
    s_waitcnt vmcnt(4)
    global_store_dword v39, v249, s[56:57] sc1
    s_waitcnt lgkmcnt(6)
    v_mfma_f32_16x16x32_bf16 v[176:179], a[220:223], a[176:179], v[176:179]
    ds_read_b64_tr_b16 a[204:205], v215 offset:24576
    v_permlane16_swap_b32 v32, v34
    v_permlane16_swap_b32 v33, v35
    v_mfma_f32_16x16x32_bf16 v[180:183], a[220:223], a[180:183], v[180:183]
    ds_read_b64_tr_b16 a[206:207], v215 offset:25600
    v_mfma_f32_16x16x32_bf16 v[184:187], a[220:223], a[184:187], v[184:187]
    v_mfma_f32_16x16x32_bf16 v[188:191], a[220:223], a[188:191], v[188:191]
    s_nop 0
    buffer_store_dwordx4 v[32:35], v2, s[40:43], s39 offen offset:3072 sc1
    s_waitcnt lgkmcnt(6)
    v_mfma_f32_16x16x32_bf16 v[160:163], a[192:195], a[0:3], v[160:163]
    ds_read_b64_tr_b16 a[208:209], v214 offset:32768
    v_mfma_f32_16x16x32_bf16 v[164:167], a[192:195], a[4:7], v[164:167]
    ds_read_b64_tr_b16 a[210:211], v214 offset:33792
    v_mfma_f32_16x16x32_bf16 v[168:171], a[192:195], a[8:11], v[168:171]
    v_mfma_f32_16x16x32_bf16 v[172:175], a[192:195], a[12:15], v[172:175]
    s_waitcnt lgkmcnt(6)
    v_mfma_f32_16x16x32_bf16 v[176:179], a[196:199], a[0:3], v[176:179]
    ds_read_b64_tr_b16 a[212:213], v215 offset:32768
    v_mfma_f32_16x16x32_bf16 v[180:183], a[196:199], a[4:7], v[180:183]
    ds_read_b64_tr_b16 a[214:215], v215 offset:33792
    v_mfma_f32_16x16x32_bf16 v[184:187], a[196:199], a[8:11], v[184:187]
    v_mfma_f32_16x16x32_bf16 v[188:191], a[196:199], a[12:15], v[188:191]
    s_waitcnt lgkmcnt(6)
    v_mfma_f32_16x16x32_bf16 v[160:163], a[200:203], a[16:19], v[160:163]
    ds_read_b64_tr_b16 a[216:217], v214 offset:40960
    v_mfma_f32_16x16x32_bf16 v[164:167], a[200:203], a[20:23], v[164:167]
    ds_read_b64_tr_b16 a[218:219], v214 offset:41984
    v_mfma_f32_16x16x32_bf16 v[168:171], a[200:203], a[24:27], v[168:171]
    v_mfma_f32_16x16x32_bf16 v[172:175], a[200:203], a[28:31], v[172:175]
    s_waitcnt lgkmcnt(6)
    v_mfma_f32_16x16x32_bf16 v[176:179], a[204:207], a[16:19], v[176:179]
    ds_read_b64_tr_b16 a[220:221], v215 offset:40960
    v_mfma_f32_16x16x32_bf16 v[180:183], a[204:207], a[20:23], v[180:183]
    ds_read_b64_tr_b16 a[222:223], v215 offset:41984
    v_mfma_f32_16x16x32_bf16 v[184:187], a[204:207], a[24:27], v[184:187]
    v_mfma_f32_16x16x32_bf16 v[188:191], a[204:207], a[28:31], v[188:191]
    s_waitcnt lgkmcnt(6)
    v_mfma_f32_16x16x32_bf16 v[160:163], a[208:211], a[32:35], v[160:163]
    v_mfma_f32_16x16x32_bf16 v[164:167], a[208:211], a[36:39], v[164:167]
    v_mfma_f32_16x16x32_bf16 v[168:171], a[208:211], a[40:43], v[168:171]
    v_mfma_f32_16x16x32_bf16 v[172:175], a[208:211], a[44:47], v[172:175]
    s_waitcnt lgkmcnt(4)
    v_mfma_f32_16x16x32_bf16 v[176:179], a[212:215], a[32:35], v[176:179]
    v_mfma_f32_16x16x32_bf16 v[180:183], a[212:215], a[36:39], v[180:183]
    v_mfma_f32_16x16x32_bf16 v[184:187], a[212:215], a[40:43], v[184:187]
    v_mfma_f32_16x16x32_bf16 v[188:191], a[212:215], a[44:47], v[188:191]
    s_waitcnt lgkmcnt(2)
    v_mfma_f32_16x16x32_bf16 v[160:163], a[216:219], a[48:51], v[160:163]
    v_mfma_f32_16x16x32_bf16 v[164:167], a[216:219], a[52:55], v[164:167]
    v_mfma_f32_16x16x32_bf16 v[168:171], a[216:219], a[56:59], v[168:171]
    v_mfma_f32_16x16x32_bf16 v[172:175], a[216:219], a[60:63], v[172:175]
    s_waitcnt lgkmcnt(0)
    v_mfma_f32_16x16x32_bf16 v[176:179], a[220:223], a[48:51], v[176:179]
    v_mfma_f32_16x16x32_bf16 v[180:183], a[220:223], a[52:55], v[180:183]
    v_mfma_f32_16x16x32_bf16 v[184:187], a[220:223], a[56:59], v[184:187]
    v_mfma_f32_16x16x32_bf16 v[188:191], a[220:223], a[60:63], v[188:191]
    s_nop 15
    s_waitcnt vmcnt(0)
    global_store_dword v251, v249, s[56:57] sc1
    v_cvt_pk_bf16_f32 v20, v160, v161
    v_cvt_pk_bf16_f32 v21, v162, v163
    v_cvt_pk_bf16_f32 v22, v164, v165
    v_cvt_pk_bf16_f32 v23, v166, v167
    s_nop 1
    v_permlane16_swap_b32 v20, v22
    v_permlane16_swap_b32 v21, v23
    v_cvt_pk_bf16_f32 v24, v176, v177
    v_cvt_pk_bf16_f32 v25, v178, v179
    v_cvt_pk_bf16_f32 v26, v180, v181
    v_cvt_pk_bf16_f32 v27, v182, v183
    s_nop 1
    v_permlane16_swap_b32 v24, v26
    v_permlane16_swap_b32 v25, v27
    v_cvt_pk_bf16_f32 v28, v168, v169
    v_cvt_pk_bf16_f32 v29, v170, v171
    v_cvt_pk_bf16_f32 v30, v172, v173
    v_cvt_pk_bf16_f32 v31, v174, v175
    s_nop 1
    v_permlane16_swap_b32 v28, v30
    v_permlane16_swap_b32 v29, v31
    v_cvt_pk_bf16_f32 v32, v184, v185
    v_cvt_pk_bf16_f32 v33, v186, v187
    v_cvt_pk_bf16_f32 v34, v188, v189
    v_cvt_pk_bf16_f32 v35, v190, v191
    s_nop 1
    v_permlane16_swap_b32 v32, v34
    v_permlane16_swap_b32 v33, v35
    s_mov_b32 s59, 0
L_ffn2_kernel_polla:
    global_load_dwordx4 v[40:43], v252, s[56:57] sc1
    s_waitcnt vmcnt(0)
    v_or_b32 v52, v40, v44
    v_or_b32 v53, v41, v45
    v_or_b32 v54, v42, v46
    v_or_b32 v55, v43, v47
    v_and_b32 v52, v52, v53
    v_and_b32 v54, v54, v55
    v_and_b32 v52, v52, v54
    s_nop 0
    v_readfirstlane_b32 s58, v52
    s_cmp_eq_u32 s58, 1
    s_cbranch_scc1 L_ffn2_kernel_polleda
    s_add_u32 s59, s59, 1
    s_cmp_lt_u32 s59, 200000
    s_cbranch_scc0 L_ffn2_kernel_polleda
    s_sleep 1
    s_branch L_ffn2_kernel_polla
L_ffn2_kernel_polleda:
    v_or_b32 v52, v40, v48
    v_or_b32 v53, v41, v49
    v_or_b32 v54, v42, v50
    v_or_b32 v55, v43, v51
    v_and_b32 v52, v52, v53
    v_and_b32 v54, v54, v55
    v_and_b32 v52, v52, v54
    s_nop 0
    v_readfirstlane_b32 s58, v52
    buffer_load_dwordx4 v[80:83], v2, s[40:43], s65 offen offset:0 sc1
    buffer_load_dwordx4 v[84:87], v2, s[40:43], s65 offen offset:1024 sc1
    buffer_load_dwordx4 v[88:91], v2, s[40:43], s65 offen offset:2048 sc1
    buffer_load_dwordx4 v[92:95], v2, s[40:43], s65 offen offset:3072 sc1
    buffer_load_dwordx4 v[96:99], v2, s[40:43], s66 offen offset:0 sc1
    buffer_load_dwordx4 v[100:103], v2, s[40:43], s66 offen offset:1024 sc1
    buffer_load_dwordx4 v[104:107], v2, s[40:43], s66 offen offset:2048 sc1
    buffer_load_dwordx4 v[108:111], v2, s[40:43], s66 offen offset:3072 sc1
    s_cmp_eq_u32 s58, 1
    s_cbranch_scc1 L_ffn2_kernel_polledb
    s_mov_b32 s59, 0
L_ffn2_kernel_pollb:
    global_load_dwordx4 v[40:43], v252, s[56:57] sc1
    s_waitcnt vmcnt(0)
    v_or_b32 v52, v40, v48
    v_or_b32 v53, v41, v49
    v_or_b32 v54, v42, v50
    v_or_b32 v55, v43, v51
    v_and_b32 v52, v52, v53
    v_and_b32 v54, v54, v55
    v_and_b32 v52, v52, v54
    s_nop 0
    v_readfirstlane_b32 s58, v52
    s_cmp_eq_u32 s58, 1
    s_cbranch_scc1 L_ffn2_kernel_polledb
    s_add_u32 s59, s59, 1
    s_cmp_lt_u32 s59, 200000
    s_cbranch_scc0 L_ffn2_kernel_polledb
    s_sleep 1
    s_branch L_ffn2_kernel_pollb
L_ffn2_kernel_polledb:
    buffer_load_dwordx4 v[64:67], v2, s[40:43], s64 offen offset:0 sc1
    buffer_load_dwordx4 v[68:71], v2, s[40:43], s64 offen offset:1024 sc1
    buffer_load_dwordx4 v[72:75], v2, s[40:43], s64 offen offset:2048 sc1
    buffer_load_dwordx4 v[76:79], v2, s[40:43], s64 offen offset:3072 sc1
    v_and_b32 v36, 31, v1
    v_lshlrev_b32 v36, 11, v36
    v_lshrrev_b32 v37, 5, v1
    v_lshl_add_u32 v36, v37, 4, v36
    s_lshl_b32 s31, s24, 16
    s_lshl_b32 s59, s25, 8
    s_add_u32 s31, s31, s59
    s_lshl_b32 s59, s23, 6
    s_add_u32 s31, s31, s59
    s_add_u32 s59, s31, 65536
    s_mov_b32 s58, 0xffff0000
    s_waitcnt vmcnt(4)
    v_lshlrev_b32 v112, 16, v20
    v_and_b32 v113, s58, v20
    v_lshlrev_b32 v42, 16, v80
    v_and_b32 v43, s58, v80
    v_pk_add_f32 v[112:113], v[112:113], v[42:43]
    v_lshlrev_b32 v42, 16, v96
    v_and_b32 v43, s58, v96
    v_pk_add_f32 v[112:113], v[112:113], v[42:43]
    v_lshlrev_b32 v114, 16, v21
    v_and_b32 v115, s58, v21
    v_lshlrev_b32 v42, 16, v81
    v_and_b32 v43, s58, v81
    v_pk_add_f32 v[114:115], v[114:115], v[42:43]
    v_lshlrev_b32 v42, 16, v97
    v_and_b32 v43, s58, v97
    v_pk_add_f32 v[114:115], v[114:115], v[42:43]
    v_lshlrev_b32 v116, 16, v22
    v_and_b32 v117, s58, v22
    v_lshlrev_b32 v42, 16, v82
    v_and_b32 v43, s58, v82
    v_pk_add_f32 v[116:117], v[116:117], v[42:43]
    v_lshlrev_b32 v42, 16, v98
    v_and_b32 v43, s58, v98
    v_pk_add_f32 v[116:117], v[116:117], v[42:43]
    v_lshlrev_b32 v118, 16, v23
    v_and_b32 v119, s58, v23
    v_lshlrev_b32 v42, 16, v83
    v_and_b32 v43, s58, v83
    v_pk_add_f32 v[118:119], v[118:119], v[42:43]
    v_lshlrev_b32 v42, 16, v99
    v_and_b32 v43, s58, v99
    v_pk_add_f32 v[118:119], v[118:119], v[42:43]
    v_lshlrev_b32 v120, 16, v24
    v_and_b32 v121, s58, v24
    v_lshlrev_b32 v42, 16, v84
    v_and_b32 v43, s58, v84
    v_pk_add_f32 v[120:121], v[120:121], v[42:43]
    v_lshlrev_b32 v42, 16, v100
    v_and_b32 v43, s58, v100
    v_pk_add_f32 v[120:121], v[120:121], v[42:43]
    v_lshlrev_b32 v122, 16, v25
    v_and_b32 v123, s58, v25
    v_lshlrev_b32 v42, 16, v85
    v_and_b32 v43, s58, v85
    v_pk_add_f32 v[122:123], v[122:123], v[42:43]
    v_lshlrev_b32 v42, 16, v101
    v_and_b32 v43, s58, v101
    v_pk_add_f32 v[122:123], v[122:123], v[42:43]
    v_lshlrev_b32 v124, 16, v26
    v_and_b32 v125, s58, v26
    v_lshlrev_b32 v42, 16, v86
    v_and_b32 v43, s58, v86
    v_pk_add_f32 v[124:125], v[124:125], v[42:43]
    v_lshlrev_b32 v42, 16, v102
    v_and_b32 v43, s58, v102
    v_pk_add_f32 v[124:125], v[124:125], v[42:43]
    v_lshlrev_b32 v126, 16, v27
    v_and_b32 v127, s58, v27
    v_lshlrev_b32 v42, 16, v87
    v_and_b32 v43, s58, v87
    v_pk_add_f32 v[126:127], v[126:127], v[42:43]
    v_lshlrev_b32 v42, 16, v103
    v_and_b32 v43, s58, v103
    v_pk_add_f32 v[126:127], v[126:127], v[42:43]
    v_lshlrev_b32 v128, 16, v28
    v_and_b32 v129, s58, v28
    v_lshlrev_b32 v42, 16, v88
    v_and_b32 v43, s58, v88
    v_pk_add_f32 v[128:129], v[128:129], v[42:43]
    v_lshlrev_b32 v42, 16, v104
    v_and_b32 v43, s58, v104
    v_pk_add_f32 v[128:129], v[128:129], v[42:43]
    v_lshlrev_b32 v130, 16, v29
    v_and_b32 v131, s58, v29
    v_lshlrev_b32 v42, 16, v89
    v_and_b32 v43, s58, v89
    v_pk_add_f32 v[130:131], v[130:131], v[42:43]
    v_lshlrev_b32 v42, 16, v105
    v_and_b32 v43, s58, v105
    v_pk_add_f32 v[130:131], v[130:131], v[42:43]
    v_lshlrev_b32 v132, 16, v30
    v_and_b32 v133, s58, v30
    v_lshlrev_b32 v42, 16, v90
    v_and_b32 v43, s58, v90
    v_pk_add_f32 v[132:133], v[132:133], v[42:43]
    v_lshlrev_b32 v42, 16, v106
    v_and_b32 v43, s58, v106
    v_pk_add_f32 v[132:133], v[132:133], v[42:43]
    v_lshlrev_b32 v134, 16, v31
    v_and_b32 v135, s58, v31
    v_lshlrev_b32 v42, 16, v91
    v_and_b32 v43, s58, v91
    v_pk_add_f32 v[134:135], v[134:135], v[42:43]
    v_lshlrev_b32 v42, 16, v107
    v_and_b32 v43, s58, v107
    v_pk_add_f32 v[134:135], v[134:135], v[42:43]
    v_lshlrev_b32 v136, 16, v32
    v_and_b32 v137, s58, v32
    v_lshlrev_b32 v42, 16, v92
    v_and_b32 v43, s58, v92
    v_pk_add_f32 v[136:137], v[136:137], v[42:43]
    v_lshlrev_b32 v42, 16, v108
    v_and_b32 v43, s58, v108
    v_pk_add_f32 v[136:137], v[136:137], v[42:43]
    v_lshlrev_b32 v138, 16, v33
    v_and_b32 v139, s58, v33
    v_lshlrev_b32 v42, 16, v93
    v_and_b32 v43, s58, v93
    v_pk_add_f32 v[138:139], v[138:139], v[42:43]
    v_lshlrev_b32 v42, 16, v109
    v_and_b32 v43, s58, v109
    v_pk_add_f32 v[138:139], v[138:139], v[42:43]
    v_lshlrev_b32 v140, 16, v34
    v_and_b32 v141, s58, v34
    v_lshlrev_b32 v42, 16, v94
    v_and_b32 v43, s58, v94
    v_pk_add_f32 v[140:141], v[140:141], v[42:43]
    v_lshlrev_b32 v42, 16, v110
    v_and_b32 v43, s58, v110
    v_pk_add_f32 v[140:141], v[140:141], v[42:43]
    v_lshlrev_b32 v142, 16, v35
    v_and_b32 v143, s58, v35
    v_lshlrev_b32 v42, 16, v95
    v_and_b32 v43, s58, v95
    v_pk_add_f32 v[142:143], v[142:143], v[42:43]
    v_lshlrev_b32 v42, 16, v111
    v_and_b32 v43, s58, v111
    v_pk_add_f32 v[142:143], v[142:143], v[42:43]
    s_waitcnt vmcnt(0)
    v_lshlrev_b32 v42, 16, v64
    v_and_b32 v43, s58, v64
    v_lshlrev_b32 v40, 16, v216
    v_and_b32 v41, s58, v216
    v_pk_add_f32 v[112:113], v[112:113], v[42:43]
    v_pk_fma_f32 v[40:41], v[232:233], v[112:113], v[40:41]
    v_cvt_pk_bf16_f32 v144, v40, v41
    v_lshlrev_b32 v42, 16, v65
    v_and_b32 v43, s58, v65
    v_lshlrev_b32 v40, 16, v217
    v_and_b32 v41, s58, v217
    v_pk_add_f32 v[114:115], v[114:115], v[42:43]
    v_pk_fma_f32 v[40:41], v[234:235], v[114:115], v[40:41]
    v_cvt_pk_bf16_f32 v145, v40, v41
    v_lshlrev_b32 v42, 16, v66
    v_and_b32 v43, s58, v66
    v_lshlrev_b32 v40, 16, v218
    v_and_b32 v41, s58, v218
    v_pk_add_f32 v[116:117], v[116:117], v[42:43]
    v_pk_fma_f32 v[40:41], v[236:237], v[116:117], v[40:41]
    v_cvt_pk_bf16_f32 v146, v40, v41
    v_lshlrev_b32 v42, 16, v67
    v_and_b32 v43, s58, v67
    v_lshlrev_b32 v40, 16, v219
    v_and_b32 v41, s58, v219
    v_pk_add_f32 v[118:119], v[118:119], v[42:43]
    v_pk_fma_f32 v[40:41], v[238:239], v[118:119], v[40:41]
    v_cvt_pk_bf16_f32 v147, v40, v41
    buffer_store_dwordx4 v[144:147], v36, s[52:55], s31 offen offset:0
    v_lshlrev_b32 v42, 16, v68
    v_and_b32 v43, s58, v68
    v_lshlrev_b32 v40, 16, v220
    v_and_b32 v41, s58, v220
    v_pk_add_f32 v[120:121], v[120:121], v[42:43]
    v_pk_fma_f32 v[40:41], v[240:241], v[120:121], v[40:41]
    v_cvt_pk_bf16_f32 v148, v40, v41
    v_lshlrev_b32 v42, 16, v69
    v_and_b32 v43, s58, v69
    v_lshlrev_b32 v40, 16, v221
    v_and_b32 v41, s58, v221
    v_pk_add_f32 v[122:123], v[122:123], v[42:43]
    v_pk_fma_f32 v[40:41], v[242:243], v[122:123], v[40:41]
    v_cvt_pk_bf16_f32 v149, v40, v41
    v_lshlrev_b32 v42, 16, v70
    v_and_b32 v43, s58, v70
    v_lshlrev_b32 v40, 16, v222
    v_and_b32 v41, s58, v222
    v_pk_add_f32 v[124:125], v[124:125], v[42:43]
    v_pk_fma_f32 v[40:41], v[244:245], v[124:125], v[40:41]
    v_cvt_pk_bf16_f32 v150, v40, v41
    v_lshlrev_b32 v42, 16, v71
    v_and_b32 v43, s58, v71
    v_lshlrev_b32 v40, 16, v223
    v_and_b32 v41, s58, v223
    v_pk_add_f32 v[126:127], v[126:127], v[42:43]
    v_pk_fma_f32 v[40:41], v[246:247], v[126:127], v[40:41]
    v_cvt_pk_bf16_f32 v151, v40, v41
    buffer_store_dwordx4 v[148:151], v36, s[52:55], s31 offen offset:32
    v_lshlrev_b32 v42, 16, v72
    v_and_b32 v43, s58, v72
    v_lshlrev_b32 v40, 16, v224
    v_and_b32 v41, s58, v224
    v_pk_add_f32 v[128:129], v[128:129], v[42:43]
    v_pk_fma_f32 v[40:41], v[232:233], v[128:129], v[40:41]
    v_cvt_pk_bf16_f32 v152, v40, v41
    v_lshlrev_b32 v42, 16, v73
    v_and_b32 v43, s58, v73
    v_lshlrev_b32 v40, 16, v225
    v_and_b32 v41, s58, v225
    v_pk_add_f32 v[130:131], v[130:131], v[42:43]
    v_pk_fma_f32 v[40:41], v[234:235], v[130:131], v[40:41]
    v_cvt_pk_bf16_f32 v153, v40, v41
    v_lshlrev_b32 v42, 16, v74
    v_and_b32 v43, s58, v74
    v_lshlrev_b32 v40, 16, v226
    v_and_b32 v41, s58, v226
    v_pk_add_f32 v[132:133], v[132:133], v[42:43]
    v_pk_fma_f32 v[40:41], v[236:237], v[132:133], v[40:41]
    v_cvt_pk_bf16_f32 v154, v40, v41
    v_lshlrev_b32 v42, 16, v75
    v_and_b32 v43, s58, v75
    v_lshlrev_b32 v40, 16, v227
    v_and_b32 v41, s58, v227
    v_pk_add_f32 v[134:135], v[134:135], v[42:43]
    v_pk_fma_f32 v[40:41], v[238:239], v[134:135], v[40:41]
    v_cvt_pk_bf16_f32 v155, v40, v41
    buffer_store_dwordx4 v[152:155], v36, s[52:55], s59 offen offset:0
    v_lshlrev_b32 v42, 16, v76
    v_and_b32 v43, s58, v76
    v_lshlrev_b32 v40, 16, v228
    v_and_b32 v41, s58, v228
    v_pk_add_f32 v[136:137], v[136:137], v[42:43]
    v_pk_fma_f32 v[40:41], v[240:241], v[136:137], v[40:41]
    v_cvt_pk_bf16_f32 v156, v40, v41
    v_lshlrev_b32 v42, 16, v77
    v_and_b32 v43, s58, v77
    v_lshlrev_b32 v40, 16, v229
    v_and_b32 v41, s58, v229
    v_pk_add_f32 v[138:139], v[138:139], v[42:43]
    v_pk_fma_f32 v[40:41], v[242:243], v[138:139], v[40:41]
    v_cvt_pk_bf16_f32 v157, v40, v41
    v_lshlrev_b32 v42, 16, v78
    v_and_b32 v43, s58, v78
    v_lshlrev_b32 v40, 16, v230
    v_and_b32 v41, s58, v230
    v_pk_add_f32 v[140:141], v[140:141], v[42:43]
    v_pk_fma_f32 v[40:41], v[244:245], v[140:141], v[40:41]
    v_cvt_pk_bf16_f32 v158, v40, v41
    v_lshlrev_b32 v42, 16, v79
    v_and_b32 v43, s58, v79
    v_lshlrev_b32 v40, 16, v231
    v_and_b32 v41, s58, v231
    v_pk_add_f32 v[142:143], v[142:143], v[42:43]
    v_pk_fma_f32 v[40:41], v[246:247], v[142:143], v[40:41]
    v_cvt_pk_bf16_f32 v159, v40, v41
    buffer_store_dwordx4 v[156:159], v36, s[52:55], s59 offen offset:32
L_ffn2_kernel_done:
    s_endpgm
L_code_end:
    s_endpgm
.section .rodata,"a"
.p2align 6
.amdhsa_kernel k0_kernel
  .amdhsa_next_free_vgpr 80
  .amdhsa_next_free_sgpr 102
  .amdhsa_accum_offset 80
  .amdhsa_group_segment_fixed_size 0
  .amdhsa_kernarg_size 104
  .amdhsa_user_sgpr_count 2
  .amdhsa_user_sgpr_kernarg_segment_ptr 1
  .amdhsa_system_sgpr_workgroup_id_x 1
  .amdhsa_float_denorm_mode_32 3
.end_amdhsa_kernel
.p2align 6
.amdhsa_kernel ln1_kernel
  .amdhsa_next_free_vgpr 120
  .amdhsa_next_free_sgpr 102
  .amdhsa_accum_offset 120
  .amdhsa_group_segment_fixed_size 0
  .amdhsa_kernarg_size 104
  .amdhsa_user_sgpr_count 2
  .amdhsa_user_sgpr_kernarg_segment_ptr 1
  .amdhsa_system_sgpr_workgroup_id_x 1
  .amdhsa_float_denorm_mode_32 3
.end_amdhsa_kernel
.p2align 6
.amdhsa_kernel attn_kernel
  .amdhsa_next_free_vgpr 448
  .amdhsa_next_free_sgpr 102
  .amdhsa_accum_offset 256
  .amdhsa_group_segment_fixed_size 0
  .amdhsa_kernarg_size 104
  .amdhsa_user_sgpr_count 2
  .amdhsa_user_sgpr_kernarg_segment_ptr 1
  .amdhsa_system_sgpr_workgroup_id_x 1
  .amdhsa_float_denorm_mode_32 3
.end_amdhsa_kernel
.p2align 6
.amdhsa_kernel oproj_kernel
  .amdhsa_next_free_vgpr 480
  .amdhsa_next_free_sgpr 102
  .amdhsa_accum_offset 256
  .amdhsa_group_segment_fixed_size 0
  .amdhsa_kernarg_size 104
  .amdhsa_user_sgpr_count 2
  .amdhsa_user_sgpr_kernarg_segment_ptr 1
  .amdhsa_system_sgpr_workgroup_id_x 1
  .amdhsa_float_denorm_mode_32 3
.end_amdhsa_kernel
.p2align 6
.amdhsa_kernel ln2_kernel
  .amdhsa_next_free_vgpr 192
  .amdhsa_next_free_sgpr 102
  .amdhsa_accum_offset 192
  .amdhsa_group_segment_fixed_size 0
  .amdhsa_kernarg_size 104
  .amdhsa_user_sgpr_count 2
  .amdhsa_user_sgpr_kernarg_segment_ptr 1
  .amdhsa_system_sgpr_workgroup_id_x 1
  .amdhsa_float_denorm_mode_32 3
.end_amdhsa_kernel
.p2align 6
.amdhsa_kernel ffn1_kernel
  .amdhsa_next_free_vgpr 480
  .amdhsa_next_free_sgpr 102
  .amdhsa_accum_offset 256
  .amdhsa_group_segment_fixed_size 0
  .amdhsa_kernarg_size 104
  .amdhsa_user_sgpr_count 2
  .amdhsa_user_sgpr_kernarg_segment_ptr 1
  .amdhsa_system_sgpr_workgroup_id_x 1
  .amdhsa_float_denorm_mode_32 3
.end_amdhsa_kernel
.p2align 6
.amdhsa_kernel ffn2_kernel
  .amdhsa_next_free_vgpr 480
  .amdhsa_next_free_sgpr 102
  .amdhsa_accum_offset 256
  .amdhsa_group_segment_fixed_size 0
  .amdhsa_kernarg_size 104
  .amdhsa_user_sgpr_count 2
  .amdhsa_user_sgpr_kernarg_segment_ptr 1
  .amdhsa_system_sgpr_workgroup_id_x 1
  .amdhsa_float_denorm_mode_32 3
.end_amdhsa_kernel
```
